```python
import torch

def _softmax(x, axis=-1):
    return torch.softmax(x, dim=axis)
def _gelu(x):
    return torch.nn.functional.gelu(x, approximate="tanh")
def _silu(x):
    return torch.nn.functional.silu(x)
def _sigmoid(x):
    return torch.sigmoid(x)
def _layernorm(x, axis=-1, eps=1e-5):
    m = x.mean(dim=axis, keepdim=True)
    v = x.var(dim=axis, keepdim=True, unbiased=False)
    return (x - m) / torch.sqrt(v + eps)
def _scatter_add(tgt, idx, src, axis=0):
    return tgt.clone().index_add_(axis, idx, src)
def _segment_sum(src, seg, n):
    out = torch.zeros((n,) + src.shape[1:], dtype=src.dtype)
    return out.index_add_(0, seg, src)
def _pad(x, pw):
    flat = tuple(v for pair in reversed(pw) for v in pair)
    return torch.nn.functional.pad(x, flat)

kernel_name = 'recurrent_scan__gqa_block_cached__glu_gated_geglu__prompt'

def setup_inputs():

    _w = (lambda a: (lambda t: t.to(torch.bfloat16) if t.is_floating_point() else t)(torch.as_tensor(a)))
    def _A_setup():
        B, Sq, D = 1, 2048, 448
        Hq, Hkv, Sk, Dh = 16, 8, 2048, 256
        assert Hq % Hkv == 0, (Hq, Hkv)
        return {
            "x": _w((lambda *s: torch.randn(*s, dtype=torch.bfloat16) * 0.05)(B, Sq, D)),
            "k_cache": _w((lambda *s: torch.randn(*s, dtype=torch.bfloat16) * 3.2)(B, Hkv, Sk, Dh)),
            "v_cache": _w((lambda *s: torch.randn(*s, dtype=torch.bfloat16) * 3.2)(B, Hkv, Sk, Dh)),
            "wq": _w((lambda *s: torch.randn(*s, dtype=torch.bfloat16) * 3.2)(D, Hq * Dh) * (D ** -0.5)),
            "wo": _w((lambda *s: torch.randn(*s, dtype=torch.bfloat16) * 3.2)(Hq * Dh, D) * ((Hq * Dh) ** -0.5)),
        }
    _A_in = _A_setup()

    def _B_setup():
        B, S, Dm, Df = 1, 2048, 448, 1792
        return {
            "x": _w((lambda *s: torch.randn(*s, dtype=torch.bfloat16) * 0.05)(B, S, Dm)),
            "w_gate": _w((lambda *s: torch.randn(*s, dtype=torch.bfloat16) * 0.4)(Dm, Df) * (Dm ** -0.5)),
            "w_up": _w((lambda *s: torch.randn(*s, dtype=torch.bfloat16) * 0.4)(Dm, Df) * (Dm ** -0.5)),
            "w_down": _w((lambda *s: torch.randn(*s, dtype=torch.bfloat16) * 0.4)(Df, Dm) * (Df ** -0.5)),
        }
    _B_in = _B_setup()

    return {
        "A_x": _A_in["x"],
        "A_k_cache": _A_in["k_cache"],
        "A_v_cache": _A_in["v_cache"],
        "A_wq": _A_in["wq"],
        "A_wo": _A_in["wo"],
        "B_x": _B_in["x"],
        "B_w_gate": _B_in["w_gate"],
        "B_w_up": _B_in["w_up"],
        "B_w_down": _B_in["w_down"],
    }

def reference(A_x, A_k_cache, A_v_cache, A_wq, A_wo, B_x, B_w_gate, B_w_up, B_w_down):
    def _A_ref(x, k_cache, v_cache, wq, wo):
        B, Sq, D = x.shape
        Hq, Dh = 16, 256
        Hkv = k_cache.shape[1]
        rep = Hq // Hkv
        q = (lambda x, *d: x.permute(*d))((x @ wq).reshape(B, Sq, Hq, Dh), 0, 2, 1, 3)
        k = (lambda x, n, axis: torch.repeat_interleave(x, n, dim=axis))(k_cache, rep, axis=1)
        v = (lambda x, n, axis: torch.repeat_interleave(x, n, dim=axis))(v_cache, rep, axis=1)
        scores = torch.einsum("bhqd,bhkd->bhqk", q, k) * (Dh ** -0.5)
        p = _softmax(scores, axis=-1)
        o = torch.einsum("bhqk,bhkd->bhqd", p, v)
        return (lambda x, *d: x.permute(*d))(o, 0, 2, 1, 3).reshape(B, Sq, Hq * Dh) @ wo

    def _B_ref(x, w_gate, w_up, w_down):
        g = torch.einsum("bsd,df->bsf", x, w_gate)
        u = torch.einsum("bsd,df->bsf", x, w_up)
        h = _gelu(g) * u
        return torch.einsum("bsf,fd->bsd", h, w_down)

    x = A_x
    xn = _layernorm(x, axis=-1)
    s = _A_ref(xn, A_k_cache, A_v_cache, A_wq, A_wo)
    g = _silu(_B_ref(xn, B_w_gate, B_w_up, B_w_down))
    return x + s * g
```

```asm
; @launch grid=(256,1,1) block=(256,1,1) lds=163840
.amdgcn_target "amdgcn-amd-amdhsa--gfx950"
.text
.globl recurrent_scan__gqa_block_cached__glu_gated_geglu__prompt_kernel
.p2align 8
.type recurrent_scan__gqa_block_cached__glu_gated_geglu__prompt_kernel,@function
recurrent_scan__gqa_block_cached__glu_gated_geglu__prompt_kernel:
    s_load_dwordx16 s[64:79], s[0:1], 0
    s_load_dwordx8 s[80:87], s[0:1], 64
    s_cmp_ge_u32 s2, 256
    s_cbranch_scc1 L_k1_exit
    s_lshr_b32 s48, s2, 3
    s_and_b32 s45, s2, 7
    s_lshl_b32 s45, s45, 0
    s_and_b32 s49, s48, 0
    s_or_b32 s45, s45, s49
    s_lshr_b32 s3, s48, 0
    s_bfe_u32 s46, s2, 3
    s_lshl_b32 s46, s46, 5
    s_or_b32 s46, s46, s3
    s_lshl_b32 s52, s48, 12
    s_lshl_b32 s2, s46, 3
    s_or_b32 s2, s2, s45
    v_lshlrev_b32 v255, 4, v0
    s_getpc_b64 s[4:5]
L_pc:
    s_sub_u32 s4, s4, (L_pc - recurrent_scan__gqa_block_cached__glu_gated_geglu__prompt_kernel)
    s_subb_u32 s5, s5, 0
    s_mov_b32 s6, (L_hot_end - recurrent_scan__gqa_block_cached__glu_gated_geglu__prompt_kernel)
    s_mov_b32 s7, 0x00020000
    s_mov_b32 exec_lo, 0x01010101
    s_mov_b32 exec_hi, 0x01010101
    buffer_load_dword v247, v255, s[4:7], s52 offen
    s_mov_b64 exec, -1
    v_lshrrev_b32 v251, 6, v0
    v_and_b32 v250, 63, v0
    v_readfirstlane_b32 s44, v251
    v_and_b32 v251, 15, v250
    v_lshrrev_b32 v252, 4, v250
    s_mul_i32 s47, s44, 8448
    s_and_b32 s60, s44, 1
    s_lshr_b32 s61, s44, 1
    s_lshl_b32 s59, s60, 11
    s_lshl_b32 s89, s46, 2
    s_add_u32 s89, s89, s44
    s_mul_i32 s89, s89, 14336
    v_mul_u32_u24 v253, 896, v251
    v_lshl_add_u32 v253, v252, 4, v253
    s_bitcmp1_b32 s45, 0
    s_cselect_b32 s57, 512, 0
    s_cselect_b32 s58, 0, 33792
    s_cselect_b32 s53, 0, 101376
    s_cselect_b32 s54, 33792, 0
    s_add_u32 s53, s53, s47
    s_add_u32 s54, s54, s47
    s_add_u32 s55, s54, 33792
    s_lshr_b32 s49, s45, 1
    s_mul_i32 s49, s49, 896
    s_add_u32 s57, s57, s49
    s_mul_i32 s48, s60, 57344
    s_add_u32 s48, s48, s57
    v_lshrrev_b32 v60, 5, v250
    v_and_b32 v61, 1, v252
    v_lshl_add_u32 v60, v60, 3, v61
    v_mul_u32_u24 v60, 14336, v60
    v_lshl_add_u32 v60, v251, 4, v60
    v_add_u32 v244, s48, v60
    v_bfe_u32 v61, v250, 3, 1
    v_lshl_add_u32 v60, v252, 3, v61
    v_mul_u32_u24 v60, 14336, v60
    v_and_b32 v61, 7, v250
    v_lshl_add_u32 v60, v61, 4, v60
    v_add_u32 v239, s48, v60
    s_waitcnt lgkmcnt(0)
    s_cmp_lt_u32 s44, 2
    s_cselect_b32 s50, s76, s78
    s_cselect_b32 s51, s77, s79
    s_load_dword s100, s[64:65], s89
    s_load_dword s101, s[50:51], 0
    s_mov_b32 s28, s50
    s_mov_b32 s29, s51
    s_mov_b32 s30, 0x00188000
    s_mov_b32 s31, 0x00020000
    s_mov_b32 s8, s64
    s_mov_b32 s9, s65
    s_mov_b32 s10, 0x001c0000
    s_mov_b32 s11, 0x00020000
    s_lshl_b32 s48, s45, 20
    s_mul_i32 s49, s45, 458752
    s_mul_i32 s50, s46, 458752
    s_add_u32 s51, s50, 16777216
    s_mov_b32 s88, 3145728
    s_cmp_lg_u32 s44, 0
    s_cbranch_scc1 L_t0
    s_load_dword s100, s[70:71], 0
    s_load_dword s101, s[66:67], s48
    s_branch L_tdone
L_t0:
    s_cmp_lg_u32 s44, 1
    s_cbranch_scc1 L_t1
    s_load_dword s100, s[70:71], s88
    s_load_dword s101, s[68:69], s48
    s_branch L_tdone
L_t1:
    s_cmp_lg_u32 s44, 2
    s_cbranch_scc1 L_t2
    s_load_dword s100, s[80:81], 0
    s_load_dword s101, s[86:87], s51
    s_branch L_tdone
L_t2:
    s_load_dword s100, s[72:73], s49
    s_load_dword s101, s[86:87], s50
L_tdone:
    s_add_u32 m0, s53, 0
    s_mov_b32 s62, 0x00000000
    buffer_load_dwordx4 v244, s[28:31], s62 offen lds
    s_mov_b32 s63, 0x000009e0
    buffer_load_dwordx4 v244, s[28:31], s63 offen offset:1056 lds
    s_mov_b32 s62, 0x000013c0
    buffer_load_dwordx4 v244, s[28:31], s62 offen offset:2112 lds
    s_mov_b32 s63, 0x00001da0
    buffer_load_dwordx4 v244, s[28:31], s63 offen offset:3168 lds
    s_add_u32 m0, s53, 4224
    s_mov_b32 s62, 0x00007000
    buffer_load_dwordx4 v244, s[28:31], s62 offen lds
    s_mov_b32 s63, 0x000079e0
    buffer_load_dwordx4 v244, s[28:31], s63 offen offset:1056 lds
    s_mov_b32 s62, 0x000083c0
    buffer_load_dwordx4 v244, s[28:31], s62 offen offset:2112 lds
    s_mov_b32 s63, 0x00008da0
    buffer_load_dwordx4 v244, s[28:31], s63 offen offset:3168 lds
    s_mov_b64 exec, 0x0fffffff
    v_lshrrev_b32 v56, 2, v250
    v_mul_u32_u24 v56, 3584, v56
    v_and_b32 v57, 3, v250
    v_lshl_add_u32 v56, v57, 7, v56
    s_lshl_b32 s48, s3, 1
    s_add_u32 s48, s48, s60
    s_mul_i32 s48, s48, 25088
    s_add_u32 s48, s48, s57
    buffer_load_dword v247, v56, s[28:31], s48 offen
    s_mov_b64 exec, -1
    buffer_load_dwordx4 v[0:3], v253, s[8:11], s89 offen
    buffer_load_dwordx4 v[4:7], v253, s[8:11], s89 offen offset:64
    buffer_load_dwordx4 v[8:11], v253, s[8:11], s89 offen offset:128
    buffer_load_dwordx4 v[12:15], v253, s[8:11], s89 offen offset:192
    buffer_load_dwordx4 v[16:19], v253, s[8:11], s89 offen offset:256
    buffer_load_dwordx4 v[20:23], v253, s[8:11], s89 offen offset:320
    buffer_load_dwordx4 v[24:27], v253, s[8:11], s89 offen offset:384
    buffer_load_dwordx4 v[28:31], v253, s[8:11], s89 offen offset:448
    buffer_load_dwordx4 v[32:35], v253, s[8:11], s89 offen offset:512
    buffer_load_dwordx4 v[36:39], v253, s[8:11], s89 offen offset:576
    buffer_load_dwordx4 v[40:43], v253, s[8:11], s89 offen offset:640
    buffer_load_dwordx4 v[44:47], v253, s[8:11], s89 offen offset:704
    buffer_load_dwordx4 v[48:51], v253, s[8:11], s89 offen offset:768
    buffer_load_dwordx4 v[52:55], v253, s[8:11], s89 offen offset:832
    s_mov_b32 s20, s70
    s_mov_b32 s21, s71
    s_mov_b32 s22, 0x00380000
    s_mov_b32 s23, 0x00020000
    s_mov_b32 s32, s80
    s_mov_b32 s33, s81
    s_sub_u32 s32, s32, 512
    s_subb_u32 s33, s33, 0
    s_mov_b32 s34, 0x00188200
    s_mov_b32 s35, 0x00020000
    s_lshl_b32 s88, s3, 2
    s_add_u32 s88, s88, s44
    s_mul_i32 s88, s88, 28
    s_mov_b64 exec, 0x0fffffff
    v_add_u32 v58, s88, v250
    v_lshrrev_b32 v56, 3, v58
    v_lshlrev_b32 v56, 13, v56
    v_and_b32 v57, 7, v58
    v_lshl_add_u32 v56, v57, 7, v56
    s_lshl_b32 s48, s45, 10
    v_add_u32 v57, s48, v56
    s_bitcmp1_b32 s45, 0
    s_cselect_b32 s48, 48, 64
    v_mul_u32_u24 v56, s48, v58
    s_mul_i32 s48, s57, 448
    v_add_u32 v56, s48, v56
    s_mov_b64 exec, -1
    s_lshl_b32 s49, s45, 20
    s_add_u32 s12, s66, s49
    s_addc_u32 s13, s67, 0
    s_sub_u32 s12, s12, 128
    s_subb_u32 s13, s13, 0
    s_mov_b32 s14, 0x00100080
    s_mov_b32 s15, 0x00020000
    s_add_u32 s16, s68, s49
    s_addc_u32 s17, s69, 0
    s_sub_u32 s16, s16, 128
    s_subb_u32 s17, s17, 0
    s_mov_b32 s18, 0x00100080
    s_mov_b32 s19, 0x00020000
    s_mov_b32 s24, s72
    s_mov_b32 s25, s73
    s_mov_b32 s26, 0x00380000
    s_mov_b32 s27, 0x00020000
    s_mov_b32 s40, s82
    s_mov_b32 s41, s83
    s_mov_b32 s42, 0x001c0000
    s_mov_b32 s43, 0x00020000
    s_mov_b32 s36, s86
    s_mov_b32 s37, s87
    s_mov_b32 s38, 0x10000000
    s_mov_b32 s39, 0x00020000
    v_lshlrev_b32 v59, 4, v250
    s_lshl_b32 s48, s60, 17
    s_lshl_b32 s49, s61, 15
    s_add_u32 s48, s48, s49
    s_lshl_b32 s49, s45, 10
    s_add_u32 s48, s48, s49
    v_add_u32 v245, s48, v59
    s_mul_i32 s48, s57, 448
    s_mul_i32 s49, s44, 7168
    s_add_u32 s48, s48, s49
    v_add_u32 v246, s48, v59
    v_mov_b32 v63, 0x40000000
    v_cmp_lt_u32 vcc, 55, v250
    s_nop 1
    v_cndmask_b32 v246, v246, v63, vcc
    v_lshrrev_b32 v60, 2, v250
    v_mul_u32_u24 v60, 1056, v60
    v_and_b32 v61, 3, v250
    v_lshl_add_u32 v60, v61, 3, v60
    s_lshl_b32 s48, s44, 6
    v_add_u32 v240, s48, v60
    v_add_u32 v241, 67584, v240
    v_add_u32 v248, s59, v59
    s_sub_u32 s48, 2048, s59
    v_add_u32 v249, s48, v59
    s_mov_b32 s52, s58
    s_mov_b32 s56, 0x3db8aa3b
    s_mul_i32 s48, s46, 458752
    s_mul_i32 s49, s45, 7168
    s_add_u32 s48, s48, s49
    s_mul_i32 s49, s60, 229376
    s_add_u32 s58, s48, s49
    s_sub_u32 s57, s48, s49
    s_add_u32 s57, s57, 229376
    s_mov_b32 s4, s84
    s_mov_b32 s5, s85
    s_mov_b32 s6, 0x00000200
    s_mov_b32 s7, 0x00020000
    v_and_b32 v232, 1, v250
    v_lshlrev_b32 v232, 4, v232
    v_mov_b32 v233, 0x3f80
    v_lshlrev_b32 v233, v232, v233
    v_lshrrev_b32 v236, 4, v250
    v_bfe_u32 v237, v250, 1, 3
    v_lshlrev_b32 v236, 1, v236
    v_cmp_eq_u32 vcc, v236, v237
    v_or_b32 v236, 1, v236
    s_nop 0
    v_cndmask_b32 v234, 0, v233, vcc
    v_cmp_eq_u32 vcc, v236, v237
    v_mov_b32 v232, 0
    s_nop 0
    v_cndmask_b32 v235, 0, v233, vcc
    v_mov_b32 v233, 0
    v_mov_b32 v236, 0
    v_mov_b32 v237, 0
    v_mov_b32 v172, 0x3f803f80
    v_mov_b32 v173, 0x3f803f80
    v_mov_b32 v174, 0x3f803f80
    v_mov_b32 v175, 0x3f803f80
    s_lshl_b32 s48, s44, 10
    s_sub_u32 s49, 102400, s52
    s_add_u32 s48, s48, s49
    v_add_u32 v255, s48, v59
    v_add_u32 v253, s49, v248
    v_add_u32 v254, s49, v249
    s_waitcnt vmcnt(14)
    s_waitcnt vmcnt(7)
    v_mfma_f32_16x16x32_bf16 v[164:167], v[172:175], v[0:3], 0
    v_mfma_f32_16x16x32_bf16 v[168:171], v[172:175], v[4:7], 0
    v_mfma_f32_16x16x32_bf16 v[164:167], v[172:175], v[8:11], v[164:167]
    v_mfma_f32_16x16x32_bf16 v[168:171], v[172:175], v[12:15], v[168:171]
    v_mfma_f32_16x16x32_bf16 v[164:167], v[172:175], v[16:19], v[164:167]
    v_mfma_f32_16x16x32_bf16 v[168:171], v[172:175], v[20:23], v[168:171]
    v_mfma_f32_16x16x32_bf16 v[164:167], v[172:175], v[24:27], v[164:167]
    s_waitcnt vmcnt(2)
    v_mfma_f32_16x16x32_bf16 v[168:171], v[172:175], v[28:31], v[168:171]
    v_mfma_f32_16x16x32_bf16 v[164:167], v[172:175], v[32:35], v[164:167]
    v_mfma_f32_16x16x32_bf16 v[168:171], v[172:175], v[36:39], v[168:171]
    v_mfma_f32_16x16x32_bf16 v[164:167], v[172:175], v[40:43], v[164:167]
    v_mfma_f32_16x16x32_bf16 v[168:171], v[172:175], v[44:47], v[168:171]
    s_waitcnt vmcnt(1)
    v_mfma_f32_16x16x32_bf16 v[164:167], v[172:175], v[48:51], v[164:167]
    s_waitcnt vmcnt(0)
    v_mfma_f32_16x16x32_bf16 v[168:171], v[172:175], v[52:55], v[168:171]
    s_add_u32 m0, s54, 0
    s_mov_b32 s62, 0x00038000
    s_nop 0
    buffer_load_dwordx4 v244, s[28:31], s62 offen lds
    s_mov_b32 s63, 0x000389e0
    s_nop 0
    buffer_load_dwordx4 v244, s[28:31], s63 offen offset:1056 lds
    s_mov_b32 s62, 0x000393c0
    s_nop 0
    buffer_load_dwordx4 v244, s[28:31], s62 offen offset:2112 lds
    s_mov_b32 s63, 0x00039da0
    s_nop 0
    buffer_load_dwordx4 v244, s[28:31], s63 offen offset:3168 lds
    v_add_f32 v164, v164, v168
    v_mul_f32 v238, 0x3b124925, v164
    v_cvt_pk_bf16_f32 v60, v238, v238
    v_and_b32 v60, 0xffff0000, v60
    v_sub_f32 v238, v238, v60
    v_sub_f32 v63, 0, v60
    v_sub_f32 v62, 0, v60
    v_sub_f32 v61, 0, v60
    v_sub_f32 v60, 0, v60
    s_nop 1
    v_mfma_f32_16x16x32_bf16 v[64:67], v[234:237], v[0:3], v[60:63]
    s_add_u32 m0, s54, 4224
    s_mov_b32 s62, 0x0003f000
    s_nop 0
    buffer_load_dwordx4 v244, s[28:31], s62 offen lds
    v_mfma_f32_16x16x32_bf16 v[68:71], v[232:235], v[0:3], v[60:63]
    s_mov_b32 s63, 0x0003f9e0
    s_nop 0
    buffer_load_dwordx4 v244, s[28:31], s63 offen offset:1056 lds
    v_mfma_f32_16x16x32_bf16 v[72:75], v[234:237], v[4:7], v[60:63]
    s_mov_b32 s62, 0x000403c0
    s_nop 0
    buffer_load_dwordx4 v244, s[28:31], s62 offen offset:2112 lds
    v_mfma_f32_16x16x32_bf16 v[76:79], v[232:235], v[4:7], v[60:63]
    s_mov_b32 s63, 0x00040da0
    s_nop 0
    buffer_load_dwordx4 v244, s[28:31], s63 offen offset:3168 lds
    v_mfma_f32_16x16x32_bf16 v[80:83], v[234:237], v[8:11], v[60:63]
    v_cvt_pk_bf16_f32 v176, v64, v65
    v_cvt_pk_bf16_f32 v177, v66, v67
    s_add_u32 m0, s55, 0
    s_mov_b32 s62, 0x00070000
    s_nop 0
    buffer_load_dwordx4 v244, s[28:31], s62 offen lds
    v_mfma_f32_16x16x32_bf16 v[84:87], v[232:235], v[8:11], v[60:63]
    v_cvt_pk_bf16_f32 v178, v68, v69
    v_cvt_pk_bf16_f32 v179, v70, v71
    s_mov_b32 s63, 0x000709e0
    s_nop 0
    buffer_load_dwordx4 v244, s[28:31], s63 offen offset:1056 lds
    v_mfma_f32_16x16x32_bf16 v[88:91], v[234:237], v[12:15], v[60:63]
    v_cvt_pk_bf16_f32 v180, v72, v73
    v_cvt_pk_bf16_f32 v181, v74, v75
    s_mov_b32 s62, 0x000713c0
    s_nop 0
    buffer_load_dwordx4 v244, s[28:31], s62 offen offset:2112 lds
    v_mfma_f32_16x16x32_bf16 v[92:95], v[232:235], v[12:15], v[60:63]
    v_cvt_pk_bf16_f32 v182, v76, v77
    v_cvt_pk_bf16_f32 v183, v78, v79
    s_mov_b32 s63, 0x00071da0
    s_nop 0
    buffer_load_dwordx4 v244, s[28:31], s63 offen offset:3168 lds
    ds_write_b128 v255, v[176:179]
    v_mfma_f32_16x16x32_bf16 v[96:99], v[234:237], v[16:19], v[60:63]
    v_cvt_pk_bf16_f32 v184, v80, v81
    v_cvt_pk_bf16_f32 v185, v82, v83
    s_add_u32 m0, s55, 4224
    s_mov_b32 s62, 0x00077000
    s_nop 0
    buffer_load_dwordx4 v244, s[28:31], s62 offen lds
    v_mfma_f32_16x16x32_bf16 v[100:103], v[232:235], v[16:19], v[60:63]
    v_cvt_pk_bf16_f32 v186, v84, v85
    v_cvt_pk_bf16_f32 v187, v86, v87
    s_mov_b32 s63, 0x000779e0
    s_nop 0
    buffer_load_dwordx4 v244, s[28:31], s63 offen offset:1056 lds
    ds_write_b128 v255, v[180:183] offset:4096
    v_mfma_f32_16x16x32_bf16 v[104:107], v[234:237], v[20:23], v[60:63]
    v_cvt_pk_bf16_f32 v188, v88, v89
    v_cvt_pk_bf16_f32 v189, v90, v91
    s_mov_b32 s62, 0x000783c0
    s_nop 0
    buffer_load_dwordx4 v244, s[28:31], s62 offen offset:2112 lds
    v_mfma_f32_16x16x32_bf16 v[108:111], v[232:235], v[20:23], v[60:63]
    v_cvt_pk_bf16_f32 v190, v92, v93
    v_cvt_pk_bf16_f32 v191, v94, v95
    s_mov_b32 s63, 0x00078da0
    s_nop 0
    buffer_load_dwordx4 v244, s[28:31], s63 offen offset:3168 lds
    ds_write_b128 v255, v[184:187] offset:8192
    v_mfma_f32_16x16x32_bf16 v[112:115], v[234:237], v[24:27], v[60:63]
    v_cvt_pk_bf16_f32 v192, v96, v97
    v_cvt_pk_bf16_f32 v193, v98, v99
    v_mfma_f32_16x16x32_bf16 v[116:119], v[232:235], v[24:27], v[60:63]
    v_cvt_pk_bf16_f32 v194, v100, v101
    v_cvt_pk_bf16_f32 v195, v102, v103
    ds_write_b128 v255, v[188:191] offset:12288
    v_mfma_f32_16x16x32_bf16 v[120:123], v[234:237], v[28:31], v[60:63]
    v_cvt_pk_bf16_f32 v196, v104, v105
    v_cvt_pk_bf16_f32 v197, v106, v107
    v_mfma_f32_16x16x32_bf16 v[124:127], v[232:235], v[28:31], v[60:63]
    v_cvt_pk_bf16_f32 v198, v108, v109
    v_cvt_pk_bf16_f32 v199, v110, v111
    ds_write_b128 v255, v[192:195] offset:16384
    v_mfma_f32_16x16x32_bf16 v[128:131], v[234:237], v[32:35], v[60:63]
    v_cvt_pk_bf16_f32 v200, v112, v113
    v_cvt_pk_bf16_f32 v201, v114, v115
    v_mfma_f32_16x16x32_bf16 v[132:135], v[232:235], v[32:35], v[60:63]
    v_cvt_pk_bf16_f32 v202, v116, v117
    v_cvt_pk_bf16_f32 v203, v118, v119
    ds_write_b128 v255, v[196:199] offset:20480
    v_mfma_f32_16x16x32_bf16 v[136:139], v[234:237], v[36:39], v[60:63]
    v_cvt_pk_bf16_f32 v204, v120, v121
    v_cvt_pk_bf16_f32 v205, v122, v123
    v_mfma_f32_16x16x32_bf16 v[140:143], v[232:235], v[36:39], v[60:63]
    v_cvt_pk_bf16_f32 v206, v124, v125
    v_cvt_pk_bf16_f32 v207, v126, v127
    ds_write_b128 v255, v[200:203] offset:24576
    v_mfma_f32_16x16x32_bf16 v[144:147], v[234:237], v[40:43], v[60:63]
    v_cvt_pk_bf16_f32 v208, v128, v129
    v_cvt_pk_bf16_f32 v209, v130, v131
    v_mfma_f32_16x16x32_bf16 v[148:151], v[232:235], v[40:43], v[60:63]
    v_cvt_pk_bf16_f32 v210, v132, v133
    v_cvt_pk_bf16_f32 v211, v134, v135
    ds_write_b128 v255, v[204:207] offset:28672
    v_add_u32 v255, s52, v255
    v_mfma_f32_16x16x32_bf16 v[152:155], v[234:237], v[44:47], v[60:63]
    v_cvt_pk_bf16_f32 v212, v136, v137
    v_cvt_pk_bf16_f32 v213, v138, v139
    v_mfma_f32_16x16x32_bf16 v[156:159], v[232:235], v[44:47], v[60:63]
    v_cvt_pk_bf16_f32 v214, v140, v141
    v_cvt_pk_bf16_f32 v215, v142, v143
    ds_write_b128 v255, v[208:211] offset:32768
    v_mfma_f32_16x16x32_bf16 v[160:163], v[234:237], v[48:51], v[60:63]
    v_cvt_pk_bf16_f32 v216, v144, v145
    v_cvt_pk_bf16_f32 v217, v146, v147
    v_mfma_f32_16x16x32_bf16 v[164:167], v[232:235], v[48:51], v[60:63]
    v_cvt_pk_bf16_f32 v218, v148, v149
    v_cvt_pk_bf16_f32 v219, v150, v151
    ds_write_b128 v255, v[212:215] offset:36864
    v_mfma_f32_16x16x32_bf16 v[168:171], v[234:237], v[52:55], v[60:63]
    v_cvt_pk_bf16_f32 v220, v152, v153
    v_cvt_pk_bf16_f32 v221, v154, v155
    v_mfma_f32_16x16x32_bf16 v[172:175], v[232:235], v[52:55], v[60:63]
    v_cvt_pk_bf16_f32 v222, v156, v157
    v_cvt_pk_bf16_f32 v223, v158, v159
    ds_write_b128 v255, v[216:219] offset:40960
    v_cvt_pk_bf16_f32 v224, v160, v161
    v_cvt_pk_bf16_f32 v225, v162, v163
    v_cvt_pk_bf16_f32 v226, v164, v165
    v_cvt_pk_bf16_f32 v227, v166, v167
    ds_write_b128 v255, v[220:223] offset:45056
    v_cvt_pk_bf16_f32 v228, v168, v169
    v_cvt_pk_bf16_f32 v229, v170, v171
    v_cvt_pk_bf16_f32 v230, v172, v173
    v_cvt_pk_bf16_f32 v231, v174, v175
    ds_write_b128 v255, v[224:227] offset:49152
    ds_write_b128 v255, v[228:231] offset:53248
    s_mov_b64 exec, 0x0fffffff
    buffer_load_dword v247, v57, s[20:23], 0 offen
    buffer_load_dword v247, v56, s[32:35], 0 offen offset:512
    s_mov_b64 exec, -1
    s_waitcnt lgkmcnt(0)
    s_barrier
    ds_read_b128 a[0:3], v253
    ds_read_b128 a[4:7], v253 offset:1024
    ds_read_b128 a[8:11], v254
    ds_read_b128 a[12:15], v254 offset:1024
    ds_read_b128 a[16:19], v253 offset:4096
    ds_read_b128 a[20:23], v253 offset:5120
    ds_read_b128 a[24:27], v254 offset:4096
    ds_read_b128 a[28:31], v254 offset:5120
    s_bitcmp1_b32 s45, 0
    s_cbranch_scc1 L_odd
    s_lshl_b32 s50, s44, 5
    s_mul_i32 s88, s44, 192
    s_lshl_b32 s48, s44, 12
    s_add_u32 s48, s48, 135168
    s_add_u32 s49, s48, 16384
    s_cmp_eq_u32 s44, 3
    s_cselect_b32 s49, 135168, s49
    ds_read_b64_tr_b16 a[224:225], v241 offset:33792
    ds_read_b64_tr_b16 a[226:227], v241 offset:34048
    ds_read_b64_tr_b16 a[228:229], v241 offset:50688
    ds_read_b64_tr_b16 a[230:231], v241 offset:50944
    ds_read_b64_tr_b16 a[232:233], v241 offset:33824
    ds_read_b64_tr_b16 a[234:235], v241 offset:34080
    ds_read_b64_tr_b16 a[236:237], v241 offset:50720
    ds_read_b64_tr_b16 a[238:239], v241 offset:50976
    v_mfma_f32_16x16x32_bf16 v[136:139], v[176:179], v[176:179], 0
    v_mfma_f32_16x16x32_bf16 v[140:143], v[180:183], v[180:183], 0
    v_mfma_f32_16x16x32_bf16 v[136:139], v[184:187], v[184:187], v[136:139]
    v_mfma_f32_16x16x32_bf16 v[140:143], v[188:191], v[188:191], v[140:143]
    v_mfma_f32_16x16x32_bf16 v[136:139], v[192:195], v[192:195], v[136:139]
    v_mfma_f32_16x16x32_bf16 v[140:143], v[196:199], v[196:199], v[140:143]
    v_mfma_f32_16x16x32_bf16 v[136:139], v[200:203], v[200:203], v[136:139]
    v_mfma_f32_16x16x32_bf16 v[140:143], v[204:207], v[204:207], v[140:143]
    v_mfma_f32_16x16x32_bf16 v[136:139], v[208:211], v[208:211], v[136:139]
    v_mfma_f32_16x16x32_bf16 v[140:143], v[212:215], v[212:215], v[140:143]
    v_mfma_f32_16x16x32_bf16 v[136:139], v[216:219], v[216:219], v[136:139]
    v_mfma_f32_16x16x32_bf16 v[140:143], v[220:223], v[220:223], v[140:143]
    v_mfma_f32_16x16x32_bf16 v[136:139], v[224:227], v[224:227], v[136:139]
    v_mfma_f32_16x16x32_bf16 v[140:143], v[228:231], v[228:231], v[140:143]
    s_waitcnt lgkmcnt(4)
    v_mfma_f32_16x16x32_bf16 v[112:115], a[224:227], a[0:3], 0
    ds_read_b128 a[32:35], v253 offset:8192
    ds_read_b128 a[36:39], v253 offset:9216
    v_mfma_f32_16x16x32_bf16 v[0:3], a[228:231], a[0:3], 0
    ds_read_b64_tr_b16 a[240:241], v241 offset:34304
    ds_read_b64_tr_b16 a[242:243], v241 offset:34560
    v_mfma_f32_16x16x32_bf16 v[24:27], a[228:231], a[4:7], 0
    ds_read_b128 a[40:43], v254 offset:8192
    ds_read_b128 a[44:47], v254 offset:9216
    v_mfma_f32_16x16x32_bf16 v[20:23], a[224:227], a[4:7], 0
    ds_read_b128 a[48:51], v253 offset:12288
    ds_read_b128 a[52:55], v253 offset:13312
    v_mfma_f32_16x16x32_bf16 v[48:51], a[224:227], a[8:11], 0
    ds_read_b128 a[56:59], v254 offset:12288
    ds_read_b128 a[60:63], v254 offset:13312
    v_mfma_f32_16x16x32_bf16 v[52:55], a[228:231], a[8:11], 0
    ds_read_b64_tr_b16 a[244:245], v241 offset:51200
    ds_read_b64_tr_b16 a[246:247], v241 offset:51456
    v_mfma_f32_16x16x32_bf16 v[84:87], a[228:231], a[12:15], 0
    ds_read_b128 a[64:67], v253 offset:16384
    ds_read_b128 a[68:71], v253 offset:17408
    v_add_f32 v136, v136, v140
    v_mfma_f32_16x16x32_bf16 v[80:83], a[224:227], a[12:15], 0
    ds_read_b128 a[72:75], v254 offset:16384
    s_waitcnt lgkmcnt(15)
    v_mfma_f32_16x16x32_bf16 v[88:91], a[232:235], a[12:15], 0
    ds_read_b128 a[76:79], v254 offset:17408
    ds_read_b128 a[80:83], v253 offset:20480
    v_mfma_f32_16x16x32_bf16 v[92:95], a[236:239], a[12:15], 0
    ds_read_b64_tr_b16 a[248:249], v241 offset:34336
    ds_read_b64_tr_b16 a[250:251], v241 offset:34592
    v_mfma_f32_16x16x32_bf16 v[60:63], a[236:239], a[8:11], 0
    ds_read_b128 a[84:87], v253 offset:21504
    ds_read_b128 a[88:91], v254 offset:20480
    v_mfma_f32_16x16x32_bf16 v[56:59], a[232:235], a[8:11], 0
    ds_read_b128 a[92:95], v254 offset:21504
    ds_read_b128 a[96:99], v253 offset:24576
    v_add_f32 v137, v137, v141
    v_mfma_f32_16x16x32_bf16 v[124:127], a[232:235], a[4:7], 0
    ds_read_b128 a[100:103], v253 offset:25600
    ds_read_b128 a[104:107], v254 offset:24576
    v_mfma_f32_16x16x32_bf16 v[28:31], a[236:239], a[4:7], 0
    ds_read_b64_tr_b16 a[224:225], v241 offset:51232
    ds_read_b64_tr_b16 a[226:227], v241 offset:51488
    v_mfma_f32_16x16x32_bf16 v[120:123], a[236:239], a[0:3], 0
    ds_read_b128 a[108:111], v254 offset:25600
    ds_read_b128 a[112:115], v253 offset:28672
    v_mfma_f32_16x16x32_bf16 v[116:119], a[232:235], a[0:3], 0
    ds_read_b128 a[116:119], v253 offset:29696
    s_waitcnt lgkmcnt(15)
    v_mfma_f32_16x16x32_bf16 v[112:115], a[240:243], a[16:19], v[112:115]
    ds_read_b128 a[120:123], v254 offset:28672
    ds_read_b128 a[124:127], v254 offset:29696
    v_add_f32 v138, v138, v142
    v_mfma_f32_16x16x32_bf16 v[0:3], a[244:247], a[16:19], v[0:3]
    v_add_f32 v139, v139, v143
    v_mfma_f32_16x16x32_bf16 v[24:27], a[244:247], a[20:23], v[24:27]
    v_and_b32 v144, 3, v250
    v_mfma_f32_16x16x32_bf16 v[20:23], a[240:243], a[20:23], v[20:23]
    v_cmp_eq_u32 vcc, 1, v144
    v_mfma_f32_16x16x32_bf16 v[48:51], a[240:243], a[24:27], v[48:51]
    s_waitcnt vmcnt(10) lgkmcnt(0)
    s_barrier
    v_mfma_f32_16x16x32_bf16 v[52:55], a[244:247], a[24:27], v[52:55]
    ds_read_b64_tr_b16 a[228:229], v240
    ds_read_b64_tr_b16 a[230:231], v240 offset:256
    v_bfe_u32 v145, v250, 2, 2
    v_mfma_f32_16x16x32_bf16 v[84:87], a[244:247], a[28:31], v[84:87]
    ds_read_b64_tr_b16 a[232:233], v240 offset:16896
    ds_read_b64_tr_b16 a[234:235], v240 offset:17152
    v_mfma_f32_16x16x32_bf16 v[80:83], a[240:243], a[28:31], v[80:83]
    v_add_u32 v253, s52, v253
    v_add_u32 v254, s52, v254
    v_mfma_f32_16x16x32_bf16 v[88:91], a[248:251], a[28:31], v[88:91]
    v_cndmask_b32 v136, v136, v137, vcc
    v_mfma_f32_16x16x32_bf16 v[92:95], a[224:227], a[28:31], v[92:95]
    ds_read_b64_tr_b16 a[236:237], v240 offset:32
    ds_read_b64_tr_b16 a[238:239], v240 offset:288
    v_mfma_f32_16x16x32_bf16 v[60:63], a[224:227], a[24:27], v[60:63]
    ds_read_b128 a[128:131], v253 offset:32768
    ds_read_b128 a[132:135], v253 offset:33792
    v_cmp_eq_u32 vcc, 2, v144
    v_mfma_f32_16x16x32_bf16 v[56:59], a[248:251], a[24:27], v[56:59]
    ds_read_b128 a[136:139], v254 offset:32768
    ds_read_b128 a[140:143], v254 offset:33792
    v_mfma_f32_16x16x32_bf16 v[124:127], a[248:251], a[20:23], v[124:127]
    ds_read_b128 a[144:147], v253 offset:36864
    ds_read_b128 a[148:151], v253 offset:37888
    v_mfma_f32_16x16x32_bf16 v[28:31], a[224:227], a[20:23], v[28:31]
    ds_read_b64_tr_b16 a[240:241], v240 offset:16928
    ds_read_b64_tr_b16 a[242:243], v240 offset:17184
    v_mfma_f32_16x16x32_bf16 v[120:123], a[224:227], a[16:19], v[120:123]
    ds_read_b128 a[152:155], v254 offset:36864
    ds_read_b128 a[156:159], v254 offset:37888
    v_mfma_f32_16x16x32_bf16 v[116:119], a[248:251], a[16:19], v[116:119]
    ds_read_b128 a[160:163], v253 offset:40960
    v_lshrrev_b32 v146, 4, v250
    s_waitcnt lgkmcnt(13)
    v_mfma_f32_16x16x32_bf16 v[112:115], a[228:231], a[32:35], v[112:115]
    s_add_u32 m0, s47, 67584
    s_mov_b32 s62, 0x000a8000
    buffer_load_dwordx4 v244, s[28:31], s62 offen lds
    v_mfma_f32_16x16x32_bf16 v[0:3], a[232:235], a[32:35], v[0:3]
    ds_read_b64_tr_b16 a[244:245], v240 offset:512
    ds_read_b64_tr_b16 a[246:247], v240 offset:768
    s_mov_b32 s63, 0x000a89e0
    v_mfma_f32_16x16x32_bf16 v[24:27], a[232:235], a[36:39], v[24:27]
    buffer_load_dwordx4 v244, s[28:31], s63 offen offset:1056 lds
    v_mfma_f32_16x16x32_bf16 v[20:23], a[228:231], a[36:39], v[20:23]
    ds_read_b128 a[164:167], v253 offset:41984
    s_mov_b32 s62, 0x000a93c0
    v_mfma_f32_16x16x32_bf16 v[48:51], a[228:231], a[40:43], v[48:51]
    buffer_load_dwordx4 v244, s[28:31], s62 offen offset:2112 lds
    v_cndmask_b32 v136, v136, v138, vcc
    v_mfma_f32_16x16x32_bf16 v[52:55], a[232:235], a[40:43], v[52:55]
    ds_read_b64_tr_b16 a[248:249], v240 offset:17408
    ds_read_b64_tr_b16 a[250:251], v240 offset:17664
    s_mov_b32 s63, 0x000a9da0
    v_mfma_f32_16x16x32_bf16 v[84:87], a[232:235], a[44:47], v[84:87]
    buffer_load_dwordx4 v244, s[28:31], s63 offen offset:3168 lds
    v_mfma_f32_16x16x32_bf16 v[80:83], a[228:231], a[44:47], v[80:83]
    s_waitcnt lgkmcnt(8)
    s_add_u32 m0, s47, 71808
    s_mov_b32 s62, 0x000af000
    v_mfma_f32_16x16x32_bf16 v[88:91], a[236:239], a[44:47], v[88:91]
    buffer_load_dwordx4 v244, s[28:31], s62 offen lds
    v_mfma_f32_16x16x32_bf16 v[92:95], a[240:243], a[44:47], v[92:95]
    ds_read_b64_tr_b16 a[224:225], v240 offset:544
    ds_read_b64_tr_b16 a[226:227], v240 offset:800
    s_mov_b32 s63, 0x000af9e0
    v_mfma_f32_16x16x32_bf16 v[60:63], a[240:243], a[40:43], v[60:63]
    buffer_load_dwordx4 v244, s[28:31], s63 offen offset:1056 lds
    v_mfma_f32_16x16x32_bf16 v[56:59], a[236:239], a[40:43], v[56:59]
    ds_read_b128 a[168:171], v254 offset:40960
    s_mov_b32 s62, 0x000b03c0
    v_mfma_f32_16x16x32_bf16 v[124:127], a[236:239], a[36:39], v[124:127]
    buffer_load_dwordx4 v244, s[28:31], s62 offen offset:2112 lds
    v_mfma_f32_16x16x32_bf16 v[28:31], a[240:243], a[36:39], v[28:31]
    ds_read_b64_tr_b16 a[228:229], v240 offset:17440
    ds_read_b64_tr_b16 a[230:231], v240 offset:17696
    s_mov_b32 s63, 0x000b0da0
    v_mfma_f32_16x16x32_bf16 v[120:123], a[240:243], a[32:35], v[120:123]
    buffer_load_dwordx4 v244, s[28:31], s63 offen offset:3168 lds
    v_cmp_eq_u32 vcc, 3, v144
    v_mfma_f32_16x16x32_bf16 v[116:119], a[236:239], a[32:35], v[116:119]
    s_waitcnt lgkmcnt(5)
    s_add_u32 m0, s47, 101376
    s_mov_b32 s62, 0x000e0000
    v_mfma_f32_16x16x32_bf16 v[112:115], a[244:247], a[48:51], v[112:115]
    buffer_load_dwordx4 v244, s[28:31], s62 offen lds
    v_mfma_f32_16x16x32_bf16 v[0:3], a[248:251], a[48:51], v[0:3]
    ds_read_b128 a[172:175], v254 offset:41984
    s_mov_b32 s63, 0x000e09e0
    v_mfma_f32_16x16x32_bf16 v[24:27], a[248:251], a[52:55], v[24:27]
    buffer_load_dwordx4 v244, s[28:31], s63 offen offset:1056 lds
    s_mov_b32 s62, 0x000e13c0
    v_mfma_f32_16x16x32_bf16 v[20:23], a[244:247], a[52:55], v[20:23]
    buffer_load_dwordx4 v244, s[28:31], s62 offen offset:2112 lds
    v_mul_f32 v238, v238, v238
    v_mfma_f32_16x16x32_bf16 v[48:51], a[244:247], a[56:59], v[48:51]
    s_waitcnt vmcnt(13) lgkmcnt(0)
    s_barrier
    v_mfma_f32_16x16x32_bf16 v[52:55], a[248:251], a[56:59], v[52:55]
    ds_read_b64_tr_b16 a[232:233], v240 offset:33792
    ds_read_b64_tr_b16 a[234:235], v240 offset:34048
    v_mfma_f32_16x16x32_bf16 v[84:87], a[248:251], a[60:63], v[84:87]
    ds_read_b64_tr_b16 a[236:237], v240 offset:50688
    ds_read_b64_tr_b16 a[238:239], v240 offset:50944
    v_mfma_f32_16x16x32_bf16 v[80:83], a[244:247], a[60:63], v[80:83]
    s_mov_b32 s63, 0x000e1da0
    v_mfma_f32_16x16x32_bf16 v[88:91], a[224:227], a[60:63], v[88:91]
    buffer_load_dwordx4 v244, s[28:31], s63 offen offset:3168 lds
    v_cndmask_b32 v136, v136, v139, vcc
    v_mfma_f32_16x16x32_bf16 v[92:95], a[228:231], a[60:63], v[92:95]
    ds_read_b64_tr_b16 a[240:241], v240 offset:33824
    ds_read_b64_tr_b16 a[242:243], v240 offset:34080
    s_add_u32 m0, s47, 105600
    s_mov_b32 s62, 0x000e7000
    v_mfma_f32_16x16x32_bf16 v[60:63], a[228:231], a[56:59], v[60:63]
    buffer_load_dwordx4 v244, s[28:31], s62 offen lds
    s_mov_b32 s63, 0x000e79e0
    v_mfma_f32_16x16x32_bf16 v[56:59], a[224:227], a[56:59], v[56:59]
    buffer_load_dwordx4 v244, s[28:31], s63 offen offset:1056 lds
    s_mov_b32 s62, 0x000e83c0
    v_mfma_f32_16x16x32_bf16 v[124:127], a[224:227], a[52:55], v[124:127]
    buffer_load_dwordx4 v244, s[28:31], s62 offen offset:2112 lds
    v_mfma_f32_16x16x32_bf16 v[28:31], a[228:231], a[52:55], v[28:31]
    ds_read_b64_tr_b16 a[244:245], v240 offset:50720
    ds_read_b64_tr_b16 a[246:247], v240 offset:50976
    s_mov_b32 s63, 0x000e8da0
    v_mfma_f32_16x16x32_bf16 v[120:123], a[228:231], a[48:51], v[120:123]
    buffer_load_dwordx4 v244, s[28:31], s63 offen offset:3168 lds
    v_mfma_f32_16x16x32_bf16 v[116:119], a[224:227], a[48:51], v[116:119]
    ds_read_b128 a[176:179], v253 offset:45056
    s_waitcnt lgkmcnt(5)
    v_mfma_f32_16x16x32_bf16 v[112:115], a[232:235], a[64:67], v[112:115]
    ds_read_b128 a[180:183], v253 offset:46080
    ds_read_b128 a[184:187], v254 offset:45056
    v_mfma_f32_16x16x32_bf16 v[0:3], a[236:239], a[64:67], v[0:3]
    ds_read_b64_tr_b16 a[248:249], v240 offset:34304
    ds_read_b64_tr_b16 a[250:251], v240 offset:34560
    s_add_u32 m0, s47, 0
    s_mov_b32 s62, 0x00118000
    v_mfma_f32_16x16x32_bf16 v[24:27], a[236:239], a[68:71], v[24:27]
    buffer_load_dwordx4 v244, s[28:31], s62 offen lds
    v_cmp_eq_u32 vcc, v145, v146
    v_mfma_f32_16x16x32_bf16 v[20:23], a[232:235], a[68:71], v[20:23]
    ds_read_b128 a[188:191], v254 offset:46080
    ds_read_b128 a[192:195], v253 offset:49152
    v_mfma_f32_16x16x32_bf16 v[48:51], a[232:235], a[72:75], v[48:51]
    ds_read_b128 a[196:199], v253 offset:50176
    ds_read_b128 a[200:203], v254 offset:49152
    v_mfma_f32_16x16x32_bf16 v[52:55], a[236:239], a[72:75], v[52:55]
    ds_read_b64_tr_b16 a[224:225], v240 offset:51200
    ds_read_b64_tr_b16 a[226:227], v240 offset:51456
    s_mov_b32 s63, 0x001189e0
    v_mfma_f32_16x16x32_bf16 v[84:87], a[236:239], a[76:79], v[84:87]
    buffer_load_dwordx4 v244, s[28:31], s63 offen offset:1056 lds
    v_mfma_f32_16x16x32_bf16 v[80:83], a[232:235], a[76:79], v[80:83]
    ds_read_b128 a[204:207], v254 offset:50176
    v_mov_b32 v144, 0x3b124925
    s_waitcnt lgkmcnt(12)
    v_mfma_f32_16x16x32_bf16 v[88:91], a[240:243], a[76:79], v[88:91]
    ds_read_b128 a[208:211], v253 offset:53248
    ds_read_b128 a[212:215], v253 offset:54272
    v_mfma_f32_16x16x32_bf16 v[92:95], a[244:247], a[76:79], v[92:95]
    ds_read_b64_tr_b16 a[228:229], v240 offset:34336
    ds_read_b64_tr_b16 a[230:231], v240 offset:34592
    s_mov_b32 s62, 0x001193c0
    v_mfma_f32_16x16x32_bf16 v[60:63], a[244:247], a[72:75], v[60:63]
    buffer_load_dwordx4 v244, s[28:31], s62 offen offset:2112 lds
    v_mfma_f32_16x16x32_bf16 v[56:59], a[240:243], a[72:75], v[56:59]
    ds_read_b128 a[216:219], v254 offset:53248
    ds_read_b128 a[220:223], v254 offset:54272
    v_mfma_f32_16x16x32_bf16 v[124:127], a[240:243], a[68:71], v[124:127]
    v_cndmask_b32 v136, 0, v136, vcc
    v_mfma_f32_16x16x32_bf16 v[28:31], a[244:247], a[68:71], v[28:31]
    ds_read_b64_tr_b16 a[232:233], v240 offset:51232
    ds_read_b64_tr_b16 a[234:235], v240 offset:51488
    s_mov_b32 s63, 0x00119da0
    v_mfma_f32_16x16x32_bf16 v[120:123], a[244:247], a[64:67], v[120:123]
    buffer_load_dwordx4 v244, s[28:31], s63 offen offset:3168 lds
    v_mfma_f32_16x16x32_bf16 v[116:119], a[240:243], a[64:67], v[116:119]
    v_mov_b32 v137, v136
    s_waitcnt lgkmcnt(9)
    v_mfma_f32_16x16x32_bf16 v[112:115], a[248:251], a[80:83], v[112:115]
    s_add_u32 m0, s47, 4224
    s_mov_b32 s62, 0x0011f000
    v_mfma_f32_16x16x32_bf16 v[0:3], a[224:227], a[80:83], v[0:3]
    buffer_load_dwordx4 v244, s[28:31], s62 offen lds
    v_permlane32_swap_b32 v136, v137
    v_mfma_f32_16x16x32_bf16 v[24:27], a[224:227], a[84:87], v[24:27]
    v_add_f32 v136, v136, v137
    s_mov_b32 s63, 0x0011f9e0
    v_mfma_f32_16x16x32_bf16 v[20:23], a[248:251], a[84:87], v[20:23]
    buffer_load_dwordx4 v244, s[28:31], s63 offen offset:1056 lds
    v_mfma_f32_16x16x32_bf16 v[48:51], a[248:251], a[88:91], v[48:51]
    s_waitcnt vmcnt(14) lgkmcnt(0)
    s_barrier
    v_mfma_f32_16x16x32_bf16 v[52:55], a[224:227], a[88:91], v[52:55]
    ds_read_b64_tr_b16 a[236:237], v241
    ds_read_b64_tr_b16 a[238:239], v241 offset:256
    v_mfma_f32_16x16x32_bf16 v[84:87], a[224:227], a[92:95], v[84:87]
    ds_read_b64_tr_b16 a[240:241], v241 offset:16896
    ds_read_b64_tr_b16 a[242:243], v241 offset:17152
    v_mov_b32 v137, v136
    v_mfma_f32_16x16x32_bf16 v[80:83], a[248:251], a[92:95], v[80:83]
    s_nop 0
    v_permlane16_swap_b32 v136, v137
    v_mfma_f32_16x16x32_bf16 v[88:91], a[228:231], a[92:95], v[88:91]
    v_add_f32 v136, v136, v137
    s_mov_b32 s55, 0x5f800000
    v_mfma_f32_16x16x32_bf16 v[92:95], a[232:235], a[92:95], v[92:95]
    ds_read_b64_tr_b16 a[244:245], v241 offset:32
    ds_read_b64_tr_b16 a[246:247], v241 offset:288
    s_mov_b32 s62, 0x001203c0
    v_mfma_f32_16x16x32_bf16 v[60:63], a[232:235], a[88:91], v[60:63]
    buffer_load_dwordx4 v244, s[28:31], s62 offen offset:2112 lds
    v_mfma_f32_16x16x32_bf16 v[56:59], a[228:231], a[88:91], v[56:59]
    v_fma_f32 v136, v136, v144, -v238
    s_mov_b32 s53, 0
    v_mfma_f32_16x16x32_bf16 v[124:127], a[228:231], a[84:87], v[124:127]
    v_max_f32 v136, 0, v136
    s_mov_b32 s54, 0
    v_mfma_f32_16x16x32_bf16 v[28:31], a[232:235], a[84:87], v[28:31]
    ds_read_b64_tr_b16 a[248:249], v241 offset:16928
    ds_read_b64_tr_b16 a[250:251], v241 offset:17184
    s_mov_b32 s63, 0x00120da0
    v_mfma_f32_16x16x32_bf16 v[120:123], a[232:235], a[80:83], v[120:123]
    buffer_load_dwordx4 v244, s[28:31], s63 offen offset:3168 lds
    v_mfma_f32_16x16x32_bf16 v[116:119], a[228:231], a[80:83], v[116:119]
    v_cvt_pk_bf16_f32 v136, v136, v136
    s_waitcnt lgkmcnt(4)
    v_mfma_f32_16x16x32_bf16 v[112:115], a[236:239], a[96:99], v[112:115]
    v_and_b32 v136, 0xffff0000, v136
    v_mfma_f32_16x16x32_bf16 v[0:3], a[240:243], a[96:99], v[0:3]
    ds_read_b64_tr_b16 a[224:225], v241 offset:512
    ds_read_b64_tr_b16 a[226:227], v241 offset:768
    s_add_u32 m0, s47, 33792
    s_mov_b32 s62, 0x00150000
    v_mfma_f32_16x16x32_bf16 v[24:27], a[240:243], a[100:103], v[24:27]
    buffer_load_dwordx4 v244, s[28:31], s62 offen lds
    v_mfma_f32_16x16x32_bf16 v[20:23], a[236:239], a[100:103], v[20:23]
    v_add_f32 v136, 0x3727c5ac, v136
    v_mfma_f32_16x16x32_bf16 v[48:51], a[236:239], a[104:107], v[48:51]
    v_cvt_pk_bf16_f32 v136, v136, v136
    v_mfma_f32_16x16x32_bf16 v[52:55], a[240:243], a[104:107], v[52:55]
    ds_read_b64_tr_b16 a[228:229], v241 offset:17408
    ds_read_b64_tr_b16 a[230:231], v241 offset:17664
    s_mov_b32 s63, 0x001509e0
    v_mfma_f32_16x16x32_bf16 v[84:87], a[240:243], a[108:111], v[84:87]
    buffer_load_dwordx4 v244, s[28:31], s63 offen offset:1056 lds
    v_mfma_f32_16x16x32_bf16 v[80:83], a[236:239], a[108:111], v[80:83]
    v_and_b32 v136, 0xffff0000, v136
    s_waitcnt lgkmcnt(4)
    v_mfma_f32_16x16x32_bf16 v[88:91], a[244:247], a[108:111], v[88:91]
    v_sqrt_f32 v136, v136
    v_mfma_f32_16x16x32_bf16 v[92:95], a[248:251], a[108:111], v[92:95]
    ds_read_b64_tr_b16 a[232:233], v241 offset:544
    ds_read_b64_tr_b16 a[234:235], v241 offset:800
    s_mov_b32 s62, 0x001513c0
    v_mfma_f32_16x16x32_bf16 v[60:63], a[248:251], a[104:107], v[60:63]
    buffer_load_dwordx4 v244, s[28:31], s62 offen offset:2112 lds
    v_cvt_pk_bf16_f32 v136, v136, v136
    v_mfma_f32_16x16x32_bf16 v[56:59], a[244:247], a[104:107], v[56:59]
    v_and_b32 v136, 0xffff0000, v136
    v_mfma_f32_16x16x32_bf16 v[124:127], a[244:247], a[100:103], v[124:127]
    ds_write_b32 v255, v136 offset:57344
    v_mfma_f32_16x16x32_bf16 v[28:31], a[248:251], a[100:103], v[28:31]
    ds_read_b64_tr_b16 a[236:237], v241 offset:17440
    ds_read_b64_tr_b16 a[238:239], v241 offset:17696
    s_mov_b32 s63, 0x00151da0
    v_mfma_f32_16x16x32_bf16 v[120:123], a[248:251], a[96:99], v[120:123]
    buffer_load_dwordx4 v244, s[28:31], s63 offen offset:3168 lds
    v_mfma_f32_16x16x32_bf16 v[116:119], a[244:247], a[96:99], v[116:119]
    s_waitcnt lgkmcnt(5)
    v_mfma_f32_16x16x32_bf16 v[112:115], a[224:227], a[112:115], v[112:115]
    s_add_u32 m0, s47, 38016
    s_mov_b32 s62, 0x00157000
    v_mfma_f32_16x16x32_bf16 v[0:3], a[228:231], a[112:115], v[0:3]
    buffer_load_dwordx4 v244, s[28:31], s62 offen lds
    v_mfma_f32_16x16x32_bf16 v[24:27], a[228:231], a[116:119], v[24:27]
    s_mov_b32 s63, 0x001579e0
    v_mfma_f32_16x16x32_bf16 v[20:23], a[224:227], a[116:119], v[20:23]
    buffer_load_dwordx4 v244, s[28:31], s63 offen offset:1056 lds
    v_mfma_f32_16x16x32_bf16 v[48:51], a[224:227], a[120:123], v[48:51]
    s_waitcnt vmcnt(14) lgkmcnt(0)
    s_barrier
    v_mfma_f32_16x16x32_bf16 v[52:55], a[228:231], a[120:123], v[52:55]
    ds_read_b64_tr_b16 a[240:241], v241 offset:33792
    ds_read_b64_tr_b16 a[242:243], v241 offset:34048
    v_mfma_f32_16x16x32_bf16 v[84:87], a[228:231], a[124:127], v[84:87]
    ds_read_b64_tr_b16 a[244:245], v241 offset:50688
    ds_read_b64_tr_b16 a[246:247], v241 offset:50944
    v_mfma_f32_16x16x32_bf16 v[80:83], a[224:227], a[124:127], v[80:83]
    ds_read_b32 a252, v253 offset:57344
    v_mfma_f32_16x16x32_bf16 v[88:91], a[232:235], a[124:127], v[88:91]
    ds_read_b32 a253, v253 offset:58368
    ds_read_b32 a254, v254 offset:57344
    v_mfma_f32_16x16x32_bf16 v[92:95], a[236:239], a[124:127], v[92:95]
    ds_read_b64_tr_b16 a[248:249], v241 offset:33824
    ds_read_b64_tr_b16 a[250:251], v241 offset:34080
    s_mov_b32 s62, 0x001583c0
    v_mfma_f32_16x16x32_bf16 v[60:63], a[236:239], a[120:123], v[60:63]
    buffer_load_dwordx4 v244, s[28:31], s62 offen offset:2112 lds
    v_mfma_f32_16x16x32_bf16 v[56:59], a[232:235], a[120:123], v[56:59]
    ds_read_b32 a255, v254 offset:58368
    v_mfma_f32_16x16x32_bf16 v[124:127], a[232:235], a[116:119], v[124:127]
    v_mfma_f32_16x16x32_bf16 v[28:31], a[236:239], a[116:119], v[28:31]
    ds_read_b64_tr_b16 a[224:225], v241 offset:50720
    ds_read_b64_tr_b16 a[226:227], v241 offset:50976
    s_mov_b32 s63, 0x00158da0
    v_mfma_f32_16x16x32_bf16 v[120:123], a[236:239], a[112:115], v[120:123]
    buffer_load_dwordx4 v244, s[28:31], s63 offen offset:3168 lds
    v_mfma_f32_16x16x32_bf16 v[116:119], a[232:235], a[112:115], v[116:119]
    s_waitcnt lgkmcnt(8)
    v_mfma_f32_16x16x32_bf16 v[112:115], a[240:243], a[128:131], v[112:115]
    v_mfma_f32_16x16x32_bf16 v[0:3], a[244:247], a[128:131], v[0:3]
    ds_read_b64_tr_b16 a[228:229], v241 offset:34304
    ds_read_b64_tr_b16 a[230:231], v241 offset:34560
    s_add_u32 m0, s47, 67584
    s_mov_b32 s62, 0x00000100
    v_mfma_f32_16x16x32_bf16 v[24:27], a[244:247], a[132:135], v[24:27]
    buffer_load_dwordx4 v244, s[28:31], s62 offen lds
    v_mfma_f32_16x16x32_bf16 v[20:23], a[240:243], a[132:135], v[20:23]
    v_mfma_f32_16x16x32_bf16 v[48:51], a[240:243], a[136:139], v[48:51]
    v_mfma_f32_16x16x32_bf16 v[52:55], a[244:247], a[136:139], v[52:55]
    ds_read_b64_tr_b16 a[232:233], v241 offset:51200
    ds_read_b64_tr_b16 a[234:235], v241 offset:51456
    s_mov_b32 s63, 0x00000ae0
    v_mfma_f32_16x16x32_bf16 v[84:87], a[244:247], a[140:143], v[84:87]
    buffer_load_dwordx4 v244, s[28:31], s63 offen offset:1056 lds
    v_mfma_f32_16x16x32_bf16 v[80:83], a[240:243], a[140:143], v[80:83]
    s_waitcnt lgkmcnt(4)
    v_mfma_f32_16x16x32_bf16 v[88:91], a[248:251], a[140:143], v[88:91]
    v_mfma_f32_16x16x32_bf16 v[92:95], a[224:227], a[140:143], v[92:95]
    ds_read_b64_tr_b16 a[236:237], v241 offset:34336
    ds_read_b64_tr_b16 a[238:239], v241 offset:34592
    s_mov_b32 s62, 0x000014c0
    v_mfma_f32_16x16x32_bf16 v[60:63], a[224:227], a[136:139], v[60:63]
    buffer_load_dwordx4 v244, s[28:31], s62 offen offset:2112 lds
    v_mfma_f32_16x16x32_bf16 v[56:59], a[248:251], a[136:139], v[56:59]
    v_mfma_f32_16x16x32_bf16 v[124:127], a[248:251], a[132:135], v[124:127]
    v_mfma_f32_16x16x32_bf16 v[28:31], a[224:227], a[132:135], v[28:31]
    ds_read_b64_tr_b16 a[240:241], v241 offset:51232
    ds_read_b64_tr_b16 a[242:243], v241 offset:51488
    s_mov_b32 s63, 0x00001ea0
    v_mfma_f32_16x16x32_bf16 v[120:123], a[224:227], a[128:131], v[120:123]
    buffer_load_dwordx4 v244, s[28:31], s63 offen offset:3168 lds
    v_mfma_f32_16x16x32_bf16 v[116:119], a[248:251], a[128:131], v[116:119]
    s_waitcnt lgkmcnt(4)
    v_mfma_f32_16x16x32_bf16 v[112:115], a[228:231], a[144:147], v[112:115]
    s_add_u32 m0, s47, 71808
    s_mov_b32 s62, 0x00007100
    v_mfma_f32_16x16x32_bf16 v[0:3], a[232:235], a[144:147], v[0:3]
    buffer_load_dwordx4 v244, s[28:31], s62 offen lds
    v_mfma_f32_16x16x32_bf16 v[24:27], a[232:235], a[148:151], v[24:27]
    s_mov_b32 s63, 0x00007ae0
    v_mfma_f32_16x16x32_bf16 v[20:23], a[228:231], a[148:151], v[20:23]
    buffer_load_dwordx4 v244, s[28:31], s63 offen offset:1056 lds
    v_mfma_f32_16x16x32_bf16 v[48:51], a[228:231], a[152:155], v[48:51]
    s_waitcnt vmcnt(14) lgkmcnt(0)
    s_barrier
    v_mfma_f32_16x16x32_bf16 v[52:55], a[232:235], a[152:155], v[52:55]
    ds_read_b64_tr_b16 a[244:245], v240
    ds_read_b64_tr_b16 a[246:247], v240 offset:256
    v_mfma_f32_16x16x32_bf16 v[84:87], a[232:235], a[156:159], v[84:87]
    ds_read_b64_tr_b16 a[248:249], v240 offset:16896
    ds_read_b64_tr_b16 a[250:251], v240 offset:17152
    v_mfma_f32_16x16x32_bf16 v[80:83], a[228:231], a[156:159], v[80:83]
    v_accvgpr_read_b32 v255, a252
    v_mfma_f32_16x16x32_bf16 v[88:91], a[236:239], a[156:159], v[88:91]
    v_rcp_f32 v242, v255
    v_mfma_f32_16x16x32_bf16 v[92:95], a[240:243], a[156:159], v[92:95]
    ds_read_b64_tr_b16 a[224:225], v240 offset:32
    ds_read_b64_tr_b16 a[226:227], v240 offset:288
    s_mov_b32 s62, 0x000084c0
    v_mfma_f32_16x16x32_bf16 v[60:63], a[240:243], a[152:155], v[60:63]
    buffer_load_dwordx4 v244, s[28:31], s62 offen offset:2112 lds
    v_mfma_f32_16x16x32_bf16 v[56:59], a[236:239], a[152:155], v[56:59]
    v_mul_f32 v255, v255, v255
    v_mfma_f32_16x16x32_bf16 v[124:127], a[236:239], a[148:151], v[124:127]
    v_mul_f32 v243, 0xbdd2d3e8, v242
    v_mfma_f32_16x16x32_bf16 v[28:31], a[240:243], a[148:151], v[28:31]
    ds_read_b64_tr_b16 a[228:229], v240 offset:16928
    ds_read_b64_tr_b16 a[230:231], v240 offset:17184
    s_mov_b32 s63, 0x00008ea0
    v_mfma_f32_16x16x32_bf16 v[120:123], a[240:243], a[144:147], v[120:123]
    buffer_load_dwordx4 v244, s[28:31], s63 offen offset:3168 lds
    v_mfma_f32_16x16x32_bf16 v[116:119], a[236:239], a[144:147], v[116:119]
    v_mul_f32 v243, v243, v242
    s_waitcnt lgkmcnt(4)
    v_mfma_f32_16x16x32_bf16 v[112:115], a[244:247], a[160:163], v[112:115]
    v_mul_f32 v243, v243, v242
    v_mfma_f32_16x16x32_bf16 v[0:3], a[248:251], a[160:163], v[0:3]
    ds_read_b64_tr_b16 a[232:233], v240 offset:512
    ds_read_b64_tr_b16 a[234:235], v240 offset:768
    s_add_u32 m0, s47, 101376
    s_mov_b32 s62, 0x00038100
    v_mfma_f32_16x16x32_bf16 v[24:27], a[248:251], a[164:167], v[24:27]
    buffer_load_dwordx4 v244, s[28:31], s62 offen lds
    v_mfma_f32_16x16x32_bf16 v[20:23], a[244:247], a[164:167], v[20:23]
    v_mul_f32 v242, 0xc0135761, v242
    v_mfma_f32_16x16x32_bf16 v[48:51], a[244:247], a[168:171], v[48:51]
    v_mfma_f32_16x16x32_bf16 v[52:55], a[248:251], a[168:171], v[52:55]
    ds_read_b64_tr_b16 a[236:237], v240 offset:17408
    ds_read_b64_tr_b16 a[238:239], v240 offset:17664
    s_mov_b32 s63, 0x00038ae0
    v_mfma_f32_16x16x32_bf16 v[84:87], a[248:251], a[172:175], v[84:87]
    buffer_load_dwordx4 v244, s[28:31], s63 offen offset:1056 lds
    v_mfma_f32_16x16x32_bf16 v[80:83], a[244:247], a[172:175], v[80:83]
    s_waitcnt lgkmcnt(4)
    v_mfma_f32_16x16x32_bf16 v[88:91], a[224:227], a[172:175], v[88:91]
    v_mfma_f32_16x16x32_bf16 v[92:95], a[228:231], a[172:175], v[92:95]
    ds_read_b64_tr_b16 a[240:241], v240 offset:544
    ds_read_b64_tr_b16 a[242:243], v240 offset:800
    s_mov_b32 s62, 0x000394c0
    v_mfma_f32_16x16x32_bf16 v[60:63], a[228:231], a[168:171], v[60:63]
    buffer_load_dwordx4 v244, s[28:31], s62 offen offset:2112 lds
    v_mfma_f32_16x16x32_bf16 v[56:59], a[224:227], a[168:171], v[56:59]
    v_mfma_f32_16x16x32_bf16 v[124:127], a[224:227], a[164:167], v[124:127]
    v_mfma_f32_16x16x32_bf16 v[28:31], a[228:231], a[164:167], v[28:31]
    ds_read_b64_tr_b16 a[244:245], v240 offset:17440
    ds_read_b64_tr_b16 a[246:247], v240 offset:17696
    s_mov_b32 s63, 0x00039ea0
    v_mfma_f32_16x16x32_bf16 v[120:123], a[228:231], a[160:163], v[120:123]
    buffer_load_dwordx4 v244, s[28:31], s63 offen offset:3168 lds
    v_mfma_f32_16x16x32_bf16 v[116:119], a[224:227], a[160:163], v[116:119]
    s_waitcnt lgkmcnt(4)
    v_mfma_f32_16x16x32_bf16 v[112:115], a[232:235], a[176:179], v[112:115]
    s_add_u32 m0, s47, 105600
    s_mov_b32 s62, 0x0003f100
    v_mfma_f32_16x16x32_bf16 v[0:3], a[236:239], a[176:179], v[0:3]
    buffer_load_dwordx4 v244, s[28:31], s62 offen lds
    v_mfma_f32_16x16x32_bf16 v[24:27], a[236:239], a[180:183], v[24:27]
    s_mov_b32 s63, 0x0003fae0
    v_mfma_f32_16x16x32_bf16 v[20:23], a[232:235], a[180:183], v[20:23]
    buffer_load_dwordx4 v244, s[28:31], s63 offen offset:1056 lds
    v_mfma_f32_16x16x32_bf16 v[48:51], a[232:235], a[184:187], v[48:51]
    s_waitcnt vmcnt(14) lgkmcnt(0)
    s_barrier
    v_mfma_f32_16x16x32_bf16 v[52:55], a[236:239], a[184:187], v[52:55]
    ds_read_b64_tr_b16 a[248:249], v240 offset:33792
    ds_read_b64_tr_b16 a[250:251], v240 offset:34048
    v_mfma_f32_16x16x32_bf16 v[84:87], a[236:239], a[188:191], v[84:87]
    ds_read_b64_tr_b16 a[224:225], v240 offset:50688
    ds_read_b64_tr_b16 a[226:227], v240 offset:50944
    v_mfma_f32_16x16x32_bf16 v[80:83], a[232:235], a[188:191], v[80:83]
    v_mfma_f32_16x16x32_bf16 v[88:91], a[240:243], a[188:191], v[88:91]
    v_mfma_f32_16x16x32_bf16 v[92:95], a[244:247], a[188:191], v[92:95]
    ds_read_b64_tr_b16 a[228:229], v240 offset:33824
    ds_read_b64_tr_b16 a[230:231], v240 offset:34080
    s_mov_b32 s62, 0x000404c0
    v_mfma_f32_16x16x32_bf16 v[60:63], a[244:247], a[184:187], v[60:63]
    buffer_load_dwordx4 v244, s[28:31], s62 offen offset:2112 lds
    v_mfma_f32_16x16x32_bf16 v[56:59], a[240:243], a[184:187], v[56:59]
    v_mfma_f32_16x16x32_bf16 v[124:127], a[240:243], a[180:183], v[124:127]
    v_mfma_f32_16x16x32_bf16 v[28:31], a[244:247], a[180:183], v[28:31]
    ds_read_b64_tr_b16 a[232:233], v240 offset:50720
    ds_read_b64_tr_b16 a[234:235], v240 offset:50976
    s_mov_b32 s63, 0x00040ea0
    v_mfma_f32_16x16x32_bf16 v[120:123], a[244:247], a[176:179], v[120:123]
    buffer_load_dwordx4 v244, s[28:31], s63 offen offset:3168 lds
    v_mfma_f32_16x16x32_bf16 v[116:119], a[240:243], a[176:179], v[116:119]
    s_waitcnt lgkmcnt(4)
    v_mfma_f32_16x16x32_bf16 v[112:115], a[248:251], a[192:195], v[112:115]
    v_mfma_f32_16x16x32_bf16 v[0:3], a[224:227], a[192:195], v[0:3]
    ds_read_b64_tr_b16 a[236:237], v240 offset:34304
    ds_read_b64_tr_b16 a[238:239], v240 offset:34560
    s_add_u32 m0, s47, 0
    s_mov_b32 s62, 0x00070100
    v_mfma_f32_16x16x32_bf16 v[24:27], a[224:227], a[196:199], v[24:27]
    buffer_load_dwordx4 v244, s[28:31], s62 offen lds
    v_mfma_f32_16x16x32_bf16 v[20:23], a[248:251], a[196:199], v[20:23]
    v_mfma_f32_16x16x32_bf16 v[48:51], a[248:251], a[200:203], v[48:51]
    v_mfma_f32_16x16x32_bf16 v[52:55], a[224:227], a[200:203], v[52:55]
    ds_read_b64_tr_b16 a[240:241], v240 offset:51200
    ds_read_b64_tr_b16 a[242:243], v240 offset:51456
    s_mov_b32 s63, 0x00070ae0
    v_mfma_f32_16x16x32_bf16 v[84:87], a[224:227], a[204:207], v[84:87]
    buffer_load_dwordx4 v244, s[28:31], s63 offen offset:1056 lds
    v_mfma_f32_16x16x32_bf16 v[80:83], a[248:251], a[204:207], v[80:83]
    s_waitcnt lgkmcnt(4)
    v_mfma_f32_16x16x32_bf16 v[88:91], a[228:231], a[204:207], v[88:91]
    v_mfma_f32_16x16x32_bf16 v[92:95], a[232:235], a[204:207], v[92:95]
    ds_read_b64_tr_b16 a[244:245], v240 offset:34336
    ds_read_b64_tr_b16 a[246:247], v240 offset:34592
    s_mov_b32 s62, 0x000714c0
    v_mfma_f32_16x16x32_bf16 v[60:63], a[232:235], a[200:203], v[60:63]
    buffer_load_dwordx4 v244, s[28:31], s62 offen offset:2112 lds
    v_mfma_f32_16x16x32_bf16 v[56:59], a[228:231], a[200:203], v[56:59]
    v_mfma_f32_16x16x32_bf16 v[124:127], a[228:231], a[196:199], v[124:127]
    v_mfma_f32_16x16x32_bf16 v[28:31], a[232:235], a[196:199], v[28:31]
    ds_read_b64_tr_b16 a[248:249], v240 offset:51232
    ds_read_b64_tr_b16 a[250:251], v240 offset:51488
    s_mov_b32 s63, 0x00071ea0
    v_mfma_f32_16x16x32_bf16 v[120:123], a[232:235], a[192:195], v[120:123]
    buffer_load_dwordx4 v244, s[28:31], s63 offen offset:3168 lds
    v_mfma_f32_16x16x32_bf16 v[116:119], a[228:231], a[192:195], v[116:119]
    s_waitcnt lgkmcnt(4)
    v_mfma_f32_16x16x32_bf16 v[112:115], a[236:239], a[208:211], v[112:115]
    s_add_u32 m0, s47, 4224
    s_mov_b32 s62, 0x00077100
    v_mfma_f32_16x16x32_bf16 v[0:3], a[240:243], a[208:211], v[0:3]
    buffer_load_dwordx4 v244, s[28:31], s62 offen lds
    v_mfma_f32_16x16x32_bf16 v[24:27], a[240:243], a[212:215], v[24:27]
    s_mov_b32 s63, 0x00077ae0
    v_mfma_f32_16x16x32_bf16 v[20:23], a[236:239], a[212:215], v[20:23]
    buffer_load_dwordx4 v244, s[28:31], s63 offen offset:1056 lds
    v_mfma_f32_16x16x32_bf16 v[48:51], a[236:239], a[216:219], v[48:51]
    s_waitcnt vmcnt(14) lgkmcnt(0)
    s_barrier
    v_mfma_f32_16x16x32_bf16 v[52:55], a[240:243], a[216:219], v[52:55]
    ds_read_b64_tr_b16 a[224:225], v241
    ds_read_b64_tr_b16 a[226:227], v241 offset:256
    v_mfma_f32_16x16x32_bf16 v[84:87], a[240:243], a[220:223], v[84:87]
    ds_read_b64_tr_b16 a[228:229], v241 offset:16896
    ds_read_b64_tr_b16 a[230:231], v241 offset:17152
    v_mfma_f32_16x16x32_bf16 v[80:83], a[236:239], a[220:223], v[80:83]
    v_mfma_f32_16x16x32_bf16 v[88:91], a[244:247], a[220:223], v[88:91]
    v_mfma_f32_16x16x32_bf16 v[92:95], a[248:251], a[220:223], v[92:95]
    ds_read_b64_tr_b16 a[232:233], v241 offset:32
    ds_read_b64_tr_b16 a[234:235], v241 offset:288
    s_mov_b32 s62, 0x000784c0
    v_mfma_f32_16x16x32_bf16 v[60:63], a[248:251], a[216:219], v[60:63]
    buffer_load_dwordx4 v244, s[28:31], s62 offen offset:2112 lds
    v_mfma_f32_16x16x32_bf16 v[56:59], a[244:247], a[216:219], v[56:59]
    v_mfma_f32_16x16x32_bf16 v[124:127], a[244:247], a[212:215], v[124:127]
    v_mfma_f32_16x16x32_bf16 v[28:31], a[248:251], a[212:215], v[28:31]
    ds_read_b64_tr_b16 a[236:237], v241 offset:16928
    ds_read_b64_tr_b16 a[238:239], v241 offset:17184
    s_mov_b32 s63, 0x00078ea0
    v_mfma_f32_16x16x32_bf16 v[120:123], a[248:251], a[208:211], v[120:123]
    buffer_load_dwordx4 v244, s[28:31], s63 offen offset:3168 lds
    v_mfma_f32_16x16x32_bf16 v[116:119], a[244:247], a[208:211], v[116:119]
    s_waitcnt lgkmcnt(4)
    v_mfma_f32_16x16x32_bf16 v[4:7], a[224:227], a[0:3], 0
    v_mfma_f32_16x16x32_bf16 v[8:11], a[228:231], a[0:3], 0
    ds_read_b64_tr_b16 a[240:241], v241 offset:512
    ds_read_b64_tr_b16 a[242:243], v241 offset:768
    s_add_u32 m0, s47, 33792
    s_mov_b32 s62, 0x000a8100
    v_mfma_f32_16x16x32_bf16 v[36:39], a[228:231], a[4:7], 0
    buffer_load_dwordx4 v244, s[28:31], s62 offen lds
    v_mfma_f32_16x16x32_bf16 v[32:35], a[224:227], a[4:7], 0
    v_mul_f32 v251, v112, v112
    v_mul_f32 v252, v113, v113
    v_mfma_f32_16x16x32_bf16 v[64:67], a[224:227], a[8:11], 0
    v_mul_f32 v253, v114, v114
    v_mul_f32 v254, v115, v115
    v_fma_f32 v251, v251, v243, v242
    v_mfma_f32_16x16x32_bf16 v[68:71], a[228:231], a[8:11], 0
    ds_read_b64_tr_b16 a[244:245], v241 offset:17408
    ds_read_b64_tr_b16 a[246:247], v241 offset:17664
    s_mov_b32 s63, 0x000a8ae0
    v_mfma_f32_16x16x32_bf16 v[100:103], a[228:231], a[12:15], 0
    buffer_load_dwordx4 v244, s[28:31], s63 offen offset:1056 lds
    v_fma_f32 v252, v252, v243, v242
    v_mfma_f32_16x16x32_bf16 v[96:99], a[224:227], a[12:15], 0
    v_fma_f32 v253, v253, v243, v242
    v_fma_f32 v254, v254, v243, v242
    s_waitcnt lgkmcnt(4)
    v_mfma_f32_16x16x32_bf16 v[104:107], a[232:235], a[12:15], 0
    v_mul_f32 v251, v251, v112
    v_mul_f32 v252, v252, v113
    v_mfma_f32_16x16x32_bf16 v[108:111], a[236:239], a[12:15], 0
    ds_read_b64_tr_b16 a[248:249], v241 offset:544
    ds_read_b64_tr_b16 a[250:251], v241 offset:800
    s_mov_b32 s62, 0x000a94c0
    v_mfma_f32_16x16x32_bf16 v[76:79], a[236:239], a[8:11], 0
    buffer_load_dwordx4 v244, s[28:31], s62 offen offset:2112 lds
    v_mul_f32 v253, v253, v114
    v_mfma_f32_16x16x32_bf16 v[72:75], a[232:235], a[8:11], 0
    v_exp_f32 v251, v251
    v_mul_f32 v254, v254, v115
    v_mfma_f32_16x16x32_bf16 v[40:43], a[232:235], a[4:7], 0
    v_exp_f32 v252, v252
    v_fma_f32 v251, v251, v255, v255
    v_mfma_f32_16x16x32_bf16 v[44:47], a[236:239], a[4:7], 0
    ds_read_b64_tr_b16 a[224:225], v241 offset:17440
    ds_read_b64_tr_b16 a[226:227], v241 offset:17696
    s_mov_b32 s63, 0x000a9ea0
    v_mfma_f32_16x16x32_bf16 v[16:19], a[236:239], a[0:3], 0
    buffer_load_dwordx4 v244, s[28:31], s63 offen offset:3168 lds
    v_fma_f32 v252, v252, v255, v255
    v_mfma_f32_16x16x32_bf16 v[12:15], a[232:235], a[0:3], 0
    v_exp_f32 v253, v253
    s_waitcnt lgkmcnt(4)
    v_mfma_f32_16x16x32_bf16 v[4:7], a[240:243], a[16:19], v[4:7]
    v_fma_f32 v253, v253, v255, v255
    s_add_u32 m0, s47, 38016
    s_mov_b32 s62, 0x000af100
    v_mfma_f32_16x16x32_bf16 v[8:11], a[244:247], a[16:19], v[8:11]
    buffer_load_dwordx4 v244, s[28:31], s62 offen lds
    v_mul_f32 v0, v0, v112
    v_mfma_f32_16x16x32_bf16 v[36:39], a[244:247], a[20:23], v[36:39]
    v_mul_f32 v1, v1, v113
    s_mov_b32 s63, 0x000afae0
    v_mfma_f32_16x16x32_bf16 v[32:35], a[240:243], a[20:23], v[32:35]
    buffer_load_dwordx4 v244, s[28:31], s63 offen offset:1056 lds
    v_mul_f32 v2, v2, v114
    v_mfma_f32_16x16x32_bf16 v[64:67], a[240:243], a[24:27], v[64:67]
    s_waitcnt vmcnt(14) lgkmcnt(0)
    s_barrier
    v_mul_f32 v3, v3, v115
    v_mfma_f32_16x16x32_bf16 v[68:71], a[244:247], a[24:27], v[68:71]
    ds_read_b64_tr_b16 a[228:229], v241 offset:33792
    ds_read_b64_tr_b16 a[230:231], v241 offset:34048
    v_mfma_f32_16x16x32_bf16 v[100:103], a[244:247], a[28:31], v[100:103]
    ds_read_b64_tr_b16 a[232:233], v241 offset:50688
    ds_read_b64_tr_b16 a[234:235], v241 offset:50944
    v_mfma_f32_16x16x32_bf16 v[96:99], a[240:243], a[28:31], v[96:99]
    v_mfma_f32_16x16x32_bf16 v[104:107], a[248:251], a[28:31], v[104:107]
    v_exp_f32 v254, v254
    v_mfma_f32_16x16x32_bf16 v[108:111], a[224:227], a[28:31], v[108:111]
    ds_read_b64_tr_b16 a[236:237], v241 offset:33824
    ds_read_b64_tr_b16 a[238:239], v241 offset:34080
    s_mov_b32 s62, 0x000b04c0
    v_mfma_f32_16x16x32_bf16 v[76:79], a[224:227], a[24:27], v[76:79]
    buffer_load_dwordx4 v244, s[28:31], s62 offen offset:2112 lds
    v_fma_f32 v254, v254, v255, v255
    v_mfma_f32_16x16x32_bf16 v[72:75], a[248:251], a[24:27], v[72:75]
    v_rcp_f32 v251, v251
    v_mfma_f32_16x16x32_bf16 v[40:43], a[248:251], a[20:23], v[40:43]
    v_rcp_f32 v252, v252
    v_mfma_f32_16x16x32_bf16 v[44:47], a[224:227], a[20:23], v[44:47]
    ds_read_b64_tr_b16 a[240:241], v241 offset:50720
    ds_read_b64_tr_b16 a[242:243], v241 offset:50976
    s_mov_b32 s63, 0x000b0ea0
    v_mfma_f32_16x16x32_bf16 v[16:19], a[224:227], a[16:19], v[16:19]
    buffer_load_dwordx4 v244, s[28:31], s63 offen offset:3168 lds
    v_mul_f32 v0, v0, v251
    v_mfma_f32_16x16x32_bf16 v[12:15], a[248:251], a[16:19], v[12:15]
    v_rcp_f32 v253, v253
    s_waitcnt lgkmcnt(4)
    v_mfma_f32_16x16x32_bf16 v[4:7], a[228:231], a[32:35], v[4:7]
    v_rcp_f32 v254, v254
    v_mul_f32 v1, v1, v252
    v_mfma_f32_16x16x32_bf16 v[8:11], a[232:235], a[32:35], v[8:11]
    ds_read_b64_tr_b16 a[244:245], v241 offset:34304
    ds_read_b64_tr_b16 a[246:247], v241 offset:34560
    s_add_u32 m0, s47, 67584
    s_mov_b32 s62, 0x000e0100
    v_mfma_f32_16x16x32_bf16 v[36:39], a[232:235], a[36:39], v[36:39]
    buffer_load_dwordx4 v244, s[28:31], s62 offen lds
    v_mul_f32 v2, v2, v253
    v_mfma_f32_16x16x32_bf16 v[32:35], a[228:231], a[36:39], v[32:35]
    v_mul_f32 v3, v3, v254
    v_cvt_pk_bf16_f32 v112, v0, v1
    v_mul_f32 v251, v116, v116
    v_mfma_f32_16x16x32_bf16 v[64:67], a[228:231], a[40:43], v[64:67]
    v_cvt_pk_bf16_f32 v113, v2, v3
    v_accvgpr_read_b32 v2, a253
    v_mul_f32 v252, v117, v117
    v_mfma_f32_16x16x32_bf16 v[68:71], a[232:235], a[40:43], v[68:71]
    ds_read_b64_tr_b16 a[248:249], v241 offset:51200
    ds_read_b64_tr_b16 a[250:251], v241 offset:51456
    s_mov_b32 s63, 0x000e0ae0
    v_mfma_f32_16x16x32_bf16 v[100:103], a[232:235], a[44:47], v[100:103]
    buffer_load_dwordx4 v244, s[28:31], s63 offen offset:1056 lds
    v_mfma_f32_16x16x32_bf16 v[96:99], a[228:231], a[44:47], v[96:99]
    v_rcp_f32 v0, v2
    v_mul_f32 v253, v118, v118
    s_waitcnt lgkmcnt(4)
    v_mfma_f32_16x16x32_bf16 v[104:107], a[236:239], a[44:47], v[104:107]
    v_mul_f32 v2, v2, v2
    v_mul_f32 v254, v119, v119
    v_fma_f32 v251, v251, v243, v242
    v_mfma_f32_16x16x32_bf16 v[108:111], a[240:243], a[44:47], v[108:111]
    ds_read_b64_tr_b16 a[224:225], v241 offset:34336
    ds_read_b64_tr_b16 a[226:227], v241 offset:34592
    s_mov_b32 s62, 0x000e14c0
    v_mfma_f32_16x16x32_bf16 v[76:79], a[240:243], a[40:43], v[76:79]
    buffer_load_dwordx4 v244, s[28:31], s62 offen offset:2112 lds
    v_mul_f32 v1, 0xbdd2d3e8, v0
    v_mfma_f32_16x16x32_bf16 v[72:75], a[236:239], a[40:43], v[72:75]
    v_mul_f32 v1, v1, v0
    v_fma_f32 v252, v252, v243, v242
    v_mfma_f32_16x16x32_bf16 v[40:43], a[236:239], a[36:39], v[40:43]
    v_mul_f32 v1, v1, v0
    v_fma_f32 v253, v253, v243, v242
    v_fma_f32 v254, v254, v243, v242
    v_mfma_f32_16x16x32_bf16 v[44:47], a[240:243], a[36:39], v[44:47]
    ds_read_b64_tr_b16 a[228:229], v241 offset:51232
    ds_read_b64_tr_b16 a[230:231], v241 offset:51488
    s_mov_b32 s63, 0x000e1ea0
    v_mfma_f32_16x16x32_bf16 v[16:19], a[240:243], a[32:35], v[16:19]
    buffer_load_dwordx4 v244, s[28:31], s63 offen offset:3168 lds
    v_mul_f32 v0, 0xc0135761, v0
    v_mfma_f32_16x16x32_bf16 v[12:15], a[236:239], a[32:35], v[12:15]
    v_mul_f32 v251, v251, v116
    v_mul_f32 v252, v252, v117
    s_waitcnt lgkmcnt(4)
    v_mfma_f32_16x16x32_bf16 v[4:7], a[244:247], a[48:51], v[4:7]
    s_add_u32 m0, s47, 71808
    s_mov_b32 s62, 0x000e7100
    v_mfma_f32_16x16x32_bf16 v[8:11], a[248:251], a[48:51], v[8:11]
    buffer_load_dwordx4 v244, s[28:31], s62 offen lds
    v_mul_f32 v253, v253, v118
    v_mfma_f32_16x16x32_bf16 v[36:39], a[248:251], a[52:55], v[36:39]
    v_exp_f32 v251, v251
    s_mov_b32 s63, 0x000e7ae0
    v_mfma_f32_16x16x32_bf16 v[32:35], a[244:247], a[52:55], v[32:35]
    buffer_load_dwordx4 v244, s[28:31], s63 offen offset:1056 lds
    v_mul_f32 v254, v254, v119
    v_mfma_f32_16x16x32_bf16 v[64:67], a[244:247], a[56:59], v[64:67]
    s_waitcnt vmcnt(14) lgkmcnt(0)
    s_barrier
    v_fma_f32 v251, v251, v255, v255
    v_mfma_f32_16x16x32_bf16 v[68:71], a[248:251], a[56:59], v[68:71]
    ds_read_b64_tr_b16 a[232:233], v240
    ds_read_b64_tr_b16 a[234:235], v240 offset:256
    v_mfma_f32_16x16x32_bf16 v[100:103], a[248:251], a[60:63], v[100:103]
    ds_read_b64_tr_b16 a[236:237], v240 offset:16896
    ds_read_b64_tr_b16 a[238:239], v240 offset:17152
    v_mul_f32 v120, v120, v116
    v_mfma_f32_16x16x32_bf16 v[96:99], a[244:247], a[60:63], v[96:99]
    v_exp_f32 v252, v252
    v_mfma_f32_16x16x32_bf16 v[104:107], a[224:227], a[60:63], v[104:107]
    v_exp_f32 v253, v253
    v_fma_f32 v252, v252, v255, v255
    v_mfma_f32_16x16x32_bf16 v[108:111], a[228:231], a[60:63], v[108:111]
    ds_read_b64_tr_b16 a[240:241], v240 offset:32
    ds_read_b64_tr_b16 a[242:243], v240 offset:288
    s_mov_b32 s62, 0x000e84c0
    v_mfma_f32_16x16x32_bf16 v[76:79], a[228:231], a[56:59], v[76:79]
    buffer_load_dwordx4 v244, s[28:31], s62 offen offset:2112 lds
    v_mfma_f32_16x16x32_bf16 v[72:75], a[224:227], a[56:59], v[72:75]
    v_exp_f32 v254, v254
    v_fma_f32 v253, v253, v255, v255
    v_mfma_f32_16x16x32_bf16 v[40:43], a[224:227], a[52:55], v[40:43]
    v_rcp_f32 v251, v251
    v_fma_f32 v254, v254, v255, v255
    v_mfma_f32_16x16x32_bf16 v[44:47], a[228:231], a[52:55], v[44:47]
    ds_read_b64_tr_b16 a[244:245], v240 offset:16928
    ds_read_b64_tr_b16 a[246:247], v240 offset:17184
    s_mov_b32 s63, 0x000e8ea0
    v_mfma_f32_16x16x32_bf16 v[16:19], a[228:231], a[48:51], v[16:19]
    buffer_load_dwordx4 v244, s[28:31], s63 offen offset:3168 lds
    v_mul_f32 v121, v121, v117
    v_mfma_f32_16x16x32_bf16 v[12:15], a[224:227], a[48:51], v[12:15]
    v_mul_f32 v122, v122, v118
    s_waitcnt lgkmcnt(4)
    v_mfma_f32_16x16x32_bf16 v[4:7], a[232:235], a[64:67], v[4:7]
    v_rcp_f32 v252, v252
    v_mul_f32 v123, v123, v119
    v_mfma_f32_16x16x32_bf16 v[8:11], a[236:239], a[64:67], v[8:11]
    ds_read_b64_tr_b16 a[248:249], v240 offset:512
    ds_read_b64_tr_b16 a[250:251], v240 offset:768
    s_add_u32 m0, s47, 101376
    s_mov_b32 s62, 0x00118100
    v_mfma_f32_16x16x32_bf16 v[36:39], a[236:239], a[68:71], v[36:39]
    buffer_load_dwordx4 v244, s[28:31], s62 offen lds
    v_mul_f32 v120, v120, v251
    v_mfma_f32_16x16x32_bf16 v[32:35], a[232:235], a[68:71], v[32:35]
    v_rcp_f32 v253, v253
    v_mul_f32 v121, v121, v252
    v_mfma_f32_16x16x32_bf16 v[64:67], a[232:235], a[72:75], v[64:67]
    v_rcp_f32 v254, v254
    v_mfma_f32_16x16x32_bf16 v[68:71], a[236:239], a[72:75], v[68:71]
    ds_read_b64_tr_b16 a[224:225], v240 offset:17408
    ds_read_b64_tr_b16 a[226:227], v240 offset:17664
    s_mov_b32 s63, 0x00118ae0
    v_mfma_f32_16x16x32_bf16 v[100:103], a[236:239], a[76:79], v[100:103]
    buffer_load_dwordx4 v244, s[28:31], s63 offen offset:1056 lds
    v_mul_f32 v122, v122, v253
    v_mfma_f32_16x16x32_bf16 v[96:99], a[232:235], a[76:79], v[96:99]
    v_mul_f32 v123, v123, v254
    v_cvt_pk_bf16_f32 v114, v120, v121
    s_waitcnt lgkmcnt(4)
    v_mfma_f32_16x16x32_bf16 v[104:107], a[240:243], a[76:79], v[104:107]
    v_cvt_pk_bf16_f32 v115, v122, v123
    v_add_u32 v120, s48, v248
    v_mul_f32 v251, v20, v20
    v_mfma_f32_16x16x32_bf16 v[108:111], a[244:247], a[76:79], v[108:111]
    ds_read_b64_tr_b16 a[228:229], v240 offset:544
    ds_read_b64_tr_b16 a[230:231], v240 offset:800
    s_mov_b32 s62, 0x001194c0
    v_mfma_f32_16x16x32_bf16 v[76:79], a[244:247], a[72:75], v[76:79]
    buffer_load_dwordx4 v244, s[28:31], s62 offen offset:2112 lds
    ds_write_b128 v120, v[112:115]
    v_mfma_f32_16x16x32_bf16 v[72:75], a[240:243], a[72:75], v[72:75]
    v_mul_f32 v252, v21, v21
    v_mul_f32 v253, v22, v22
    v_mul_f32 v254, v23, v23
    v_mfma_f32_16x16x32_bf16 v[40:43], a[240:243], a[68:71], v[40:43]
    v_fma_f32 v251, v251, v1, v0
    v_fma_f32 v252, v252, v1, v0
    v_fma_f32 v253, v253, v1, v0
    v_mfma_f32_16x16x32_bf16 v[44:47], a[244:247], a[68:71], v[44:47]
    ds_read_b64_tr_b16 a[232:233], v240 offset:17440
    ds_read_b64_tr_b16 a[234:235], v240 offset:17696
    s_mov_b32 s63, 0x00119ea0
    v_mfma_f32_16x16x32_bf16 v[16:19], a[244:247], a[64:67], v[16:19]
    buffer_load_dwordx4 v244, s[28:31], s63 offen offset:3168 lds
    v_mfma_f32_16x16x32_bf16 v[12:15], a[240:243], a[64:67], v[12:15]
    v_fma_f32 v254, v254, v1, v0
    v_mul_f32 v251, v251, v20
    s_waitcnt lgkmcnt(5)
    v_mfma_f32_16x16x32_bf16 v[4:7], a[248:251], a[80:83], v[4:7]
    v_mul_f32 v252, v252, v21
    s_add_u32 m0, s47, 105600
    s_mov_b32 s62, 0x0011f100
    v_mfma_f32_16x16x32_bf16 v[8:11], a[224:227], a[80:83], v[8:11]
    buffer_load_dwordx4 v244, s[28:31], s62 offen lds
    v_mul_f32 v253, v253, v22
    v_mfma_f32_16x16x32_bf16 v[36:39], a[224:227], a[84:87], v[36:39]
    v_exp_f32 v251, v251
    s_mov_b32 s63, 0x0011fae0
    v_mfma_f32_16x16x32_bf16 v[32:35], a[248:251], a[84:87], v[32:35]
    buffer_load_dwordx4 v244, s[28:31], s63 offen offset:1056 lds
    v_mfma_f32_16x16x32_bf16 v[64:67], a[248:251], a[88:91], v[64:67]
    s_waitcnt vmcnt(14) lgkmcnt(0)
    s_barrier
    v_mul_f32 v254, v254, v23
    v_mfma_f32_16x16x32_bf16 v[68:71], a[224:227], a[88:91], v[68:71]
    ds_read_b64_tr_b16 a[236:237], v240 offset:33792
    ds_read_b64_tr_b16 a[238:239], v240 offset:34048
    v_fma_f32 v251, v251, v2, v2
    v_mfma_f32_16x16x32_bf16 v[100:103], a[224:227], a[92:95], v[100:103]
    ds_read_b64_tr_b16 a[240:241], v240 offset:50688
    ds_read_b64_tr_b16 a[242:243], v240 offset:50944
    v_mul_f32 v24, v24, v20
    v_mfma_f32_16x16x32_bf16 v[96:99], a[248:251], a[92:95], v[96:99]
    v_exp_f32 v252, v252
    v_mfma_f32_16x16x32_bf16 v[104:107], a[228:231], a[92:95], v[104:107]
    v_exp_f32 v253, v253
    v_mfma_f32_16x16x32_bf16 v[108:111], a[232:235], a[92:95], v[108:111]
    ds_read_b64_tr_b16 a[244:245], v240 offset:33824
    ds_read_b64_tr_b16 a[246:247], v240 offset:34080
    s_mov_b32 s62, 0x001204c0
    v_mfma_f32_16x16x32_bf16 v[76:79], a[232:235], a[88:91], v[76:79]
    buffer_load_dwordx4 v244, s[28:31], s62 offen offset:2112 lds
    v_fma_f32 v252, v252, v2, v2
    v_mfma_f32_16x16x32_bf16 v[72:75], a[228:231], a[88:91], v[72:75]
    v_exp_f32 v254, v254
    v_fma_f32 v253, v253, v2, v2
    v_mfma_f32_16x16x32_bf16 v[40:43], a[228:231], a[84:87], v[40:43]
    v_rcp_f32 v251, v251
    v_fma_f32 v254, v254, v2, v2
    v_mfma_f32_16x16x32_bf16 v[44:47], a[232:235], a[84:87], v[44:47]
    ds_read_b64_tr_b16 a[248:249], v240 offset:50720
    ds_read_b64_tr_b16 a[250:251], v240 offset:50976
    s_mov_b32 s63, 0x00120ea0
    v_mfma_f32_16x16x32_bf16 v[16:19], a[232:235], a[80:83], v[16:19]
    buffer_load_dwordx4 v244, s[28:31], s63 offen offset:3168 lds
    v_mul_f32 v25, v25, v21
    v_mfma_f32_16x16x32_bf16 v[12:15], a[228:231], a[80:83], v[12:15]
    v_rcp_f32 v252, v252
    s_waitcnt lgkmcnt(4)
    v_mfma_f32_16x16x32_bf16 v[4:7], a[236:239], a[96:99], v[4:7]
    v_rcp_f32 v253, v253
    v_mul_f32 v26, v26, v22
    v_mfma_f32_16x16x32_bf16 v[8:11], a[240:243], a[96:99], v[8:11]
    ds_read_b64_tr_b16 a[224:225], v240 offset:34304
    ds_read_b64_tr_b16 a[226:227], v240 offset:34560
    s_add_u32 m0, s47, 0
    s_mov_b32 s62, 0x00150100
    v_mfma_f32_16x16x32_bf16 v[36:39], a[240:243], a[100:103], v[36:39]
    buffer_load_dwordx4 v244, s[28:31], s62 offen lds
    v_mfma_f32_16x16x32_bf16 v[32:35], a[236:239], a[100:103], v[32:35]
    v_rcp_f32 v254, v254
    v_mul_f32 v27, v27, v23
    v_mfma_f32_16x16x32_bf16 v[64:67], a[236:239], a[104:107], v[64:67]
    v_mul_f32 v24, v24, v251
    v_mul_f32 v25, v25, v252
    v_mul_f32 v26, v26, v253
    v_mfma_f32_16x16x32_bf16 v[68:71], a[240:243], a[104:107], v[68:71]
    ds_read_b64_tr_b16 a[228:229], v240 offset:51200
    ds_read_b64_tr_b16 a[230:231], v240 offset:51456
    s_mov_b32 s63, 0x00150ae0
    v_mfma_f32_16x16x32_bf16 v[100:103], a[240:243], a[108:111], v[100:103]
    buffer_load_dwordx4 v244, s[28:31], s63 offen offset:1056 lds
    v_mul_f32 v27, v27, v254
    v_mfma_f32_16x16x32_bf16 v[96:99], a[236:239], a[108:111], v[96:99]
    v_cvt_pk_bf16_f32 v20, v24, v25
    s_waitcnt lgkmcnt(4)
    v_mfma_f32_16x16x32_bf16 v[104:107], a[244:247], a[108:111], v[104:107]
    v_cvt_pk_bf16_f32 v21, v26, v27
    v_accvgpr_read_b32 v26, a254
    v_mul_f32 v251, v124, v124
    v_mfma_f32_16x16x32_bf16 v[108:111], a[248:251], a[108:111], v[108:111]
    ds_read_b64_tr_b16 a[232:233], v240 offset:34336
    ds_read_b64_tr_b16 a[234:235], v240 offset:34592
    s_mov_b32 s62, 0x001514c0
    v_mfma_f32_16x16x32_bf16 v[76:79], a[248:251], a[104:107], v[76:79]
    buffer_load_dwordx4 v244, s[28:31], s62 offen offset:2112 lds
    v_rcp_f32 v24, v26
    v_mfma_f32_16x16x32_bf16 v[72:75], a[244:247], a[104:107], v[72:75]
    v_mul_f32 v26, v26, v26
    v_mul_f32 v252, v125, v125
    v_mul_f32 v253, v126, v126
    v_mfma_f32_16x16x32_bf16 v[40:43], a[244:247], a[100:103], v[40:43]
    v_mul_f32 v25, 0xbdd2d3e8, v24
    v_mul_f32 v254, v127, v127
    v_mfma_f32_16x16x32_bf16 v[44:47], a[248:251], a[100:103], v[44:47]
    ds_read_b64_tr_b16 a[236:237], v240 offset:51232
    ds_read_b64_tr_b16 a[238:239], v240 offset:51488
    s_mov_b32 s63, 0x00151ea0
    v_mfma_f32_16x16x32_bf16 v[16:19], a[248:251], a[96:99], v[16:19]
    buffer_load_dwordx4 v244, s[28:31], s63 offen offset:3168 lds
    v_mul_f32 v25, v25, v24
    v_mfma_f32_16x16x32_bf16 v[12:15], a[244:247], a[96:99], v[12:15]
    v_mul_f32 v25, v25, v24
    v_fma_f32 v251, v251, v1, v0
    s_waitcnt lgkmcnt(4)
    v_mfma_f32_16x16x32_bf16 v[4:7], a[224:227], a[112:115], v[4:7]
    v_mul_f32 v24, 0xc0135761, v24
    s_add_u32 m0, s47, 4224
    s_mov_b32 s62, 0x00157100
    v_mfma_f32_16x16x32_bf16 v[8:11], a[228:231], a[112:115], v[8:11]
    buffer_load_dwordx4 v244, s[28:31], s62 offen lds
    v_mfma_f32_16x16x32_bf16 v[36:39], a[228:231], a[116:119], v[36:39]
    v_fma_f32 v252, v252, v1, v0
    v_fma_f32 v253, v253, v1, v0
    s_mov_b32 s63, 0x00157ae0
    v_mfma_f32_16x16x32_bf16 v[32:35], a[224:227], a[116:119], v[32:35]
    buffer_load_dwordx4 v244, s[28:31], s63 offen offset:1056 lds
    v_fma_f32 v254, v254, v1, v0
    v_mfma_f32_16x16x32_bf16 v[64:67], a[224:227], a[120:123], v[64:67]
    s_waitcnt vmcnt(14) lgkmcnt(0)
    s_barrier
    v_mul_f32 v251, v251, v124
    v_mfma_f32_16x16x32_bf16 v[68:71], a[228:231], a[120:123], v[68:71]
    ds_read_b64_tr_b16 a[240:241], v241
    ds_read_b64_tr_b16 a[242:243], v241 offset:256
    v_mul_f32 v252, v252, v125
    v_mfma_f32_16x16x32_bf16 v[100:103], a[228:231], a[124:127], v[100:103]
    ds_read_b64_tr_b16 a[244:245], v241 offset:16896
    ds_read_b64_tr_b16 a[246:247], v241 offset:17152
    v_mfma_f32_16x16x32_bf16 v[96:99], a[224:227], a[124:127], v[96:99]
    v_exp_f32 v251, v251
    v_mfma_f32_16x16x32_bf16 v[104:107], a[232:235], a[124:127], v[104:107]
    v_exp_f32 v252, v252
    v_mul_f32 v253, v253, v126
    v_mfma_f32_16x16x32_bf16 v[108:111], a[236:239], a[124:127], v[108:111]
    ds_read_b64_tr_b16 a[248:249], v241 offset:32
    ds_read_b64_tr_b16 a[250:251], v241 offset:288
    s_mov_b32 s62, 0x001584c0
    v_mfma_f32_16x16x32_bf16 v[76:79], a[236:239], a[120:123], v[76:79]
    buffer_load_dwordx4 v244, s[28:31], s62 offen offset:2112 lds
    v_mul_f32 v254, v254, v127
    v_mfma_f32_16x16x32_bf16 v[72:75], a[232:235], a[120:123], v[72:75]
    v_exp_f32 v253, v253
    v_mfma_f32_16x16x32_bf16 v[40:43], a[232:235], a[116:119], v[40:43]
    v_exp_f32 v254, v254
    v_fma_f32 v251, v251, v2, v2
    v_mfma_f32_16x16x32_bf16 v[44:47], a[236:239], a[116:119], v[44:47]
    ds_read_b64_tr_b16 a[224:225], v241 offset:16928
    ds_read_b64_tr_b16 a[226:227], v241 offset:17184
    s_mov_b32 s63, 0x00158ea0
    v_mfma_f32_16x16x32_bf16 v[16:19], a[236:239], a[112:115], v[16:19]
    buffer_load_dwordx4 v244, s[28:31], s63 offen offset:3168 lds
    v_fma_f32 v252, v252, v2, v2
    v_mfma_f32_16x16x32_bf16 v[12:15], a[232:235], a[112:115], v[12:15]
    v_rcp_f32 v251, v251
    s_waitcnt lgkmcnt(4)
    v_mfma_f32_16x16x32_bf16 v[4:7], a[240:243], a[128:131], v[4:7]
    v_rcp_f32 v252, v252
    v_mfma_f32_16x16x32_bf16 v[8:11], a[244:247], a[128:131], v[8:11]
    ds_read_b64_tr_b16 a[228:229], v241 offset:512
    ds_read_b64_tr_b16 a[230:231], v241 offset:768
    s_add_u32 m0, s47, 33792
    s_mov_b32 s62, 0x00000000
    v_mfma_f32_16x16x32_bf16 v[36:39], a[244:247], a[132:135], v[36:39]
    buffer_load_dwordx4 v245, s[20:23], s62 offen lds
    v_fma_f32 v253, v253, v2, v2
    v_mfma_f32_16x16x32_bf16 v[32:35], a[240:243], a[132:135], v[32:35]
    v_rcp_f32 v253, v253
    v_fma_f32 v254, v254, v2, v2
    v_mfma_f32_16x16x32_bf16 v[64:67], a[240:243], a[136:139], v[64:67]
    v_rcp_f32 v254, v254
    v_mul_f32 v28, v28, v124
    v_mfma_f32_16x16x32_bf16 v[68:71], a[244:247], a[136:139], v[68:71]
    ds_read_b64_tr_b16 a[232:233], v241 offset:17408
    ds_read_b64_tr_b16 a[234:235], v241 offset:17664
    s_mov_b32 s63, 0x00001be0
    v_mfma_f32_16x16x32_bf16 v[100:103], a[244:247], a[140:143], v[100:103]
    buffer_load_dwordx4 v245, s[20:23], s63 offen offset:1056 lds
    v_mul_f32 v29, v29, v125
    v_mfma_f32_16x16x32_bf16 v[96:99], a[240:243], a[140:143], v[96:99]
    v_mul_f32 v30, v30, v126
    v_mul_f32 v31, v31, v127
    s_waitcnt lgkmcnt(4)
    v_mfma_f32_16x16x32_bf16 v[104:107], a[248:251], a[140:143], v[104:107]
    v_mul_f32 v28, v28, v251
    v_mul_f32 v29, v29, v252
    v_mul_f32 v30, v30, v253
    v_mfma_f32_16x16x32_bf16 v[108:111], a[224:227], a[140:143], v[108:111]
    ds_read_b64_tr_b16 a[236:237], v241 offset:544
    ds_read_b64_tr_b16 a[238:239], v241 offset:800
    s_mov_b32 s62, 0x000037c0
    v_mfma_f32_16x16x32_bf16 v[76:79], a[224:227], a[136:139], v[76:79]
    buffer_load_dwordx4 v245, s[20:23], s62 offen offset:2112 lds
    v_mfma_f32_16x16x32_bf16 v[72:75], a[248:251], a[136:139], v[72:75]
    v_mul_f32 v31, v31, v254
    v_cvt_pk_bf16_f32 v22, v28, v29
    v_add_u32 v28, s48, v248
    v_mfma_f32_16x16x32_bf16 v[40:43], a[248:251], a[132:135], v[40:43]
    v_cvt_pk_bf16_f32 v23, v30, v31
    v_mul_f32 v251, v48, v48
    v_mul_f32 v252, v49, v49
    v_mfma_f32_16x16x32_bf16 v[44:47], a[224:227], a[132:135], v[44:47]
    ds_read_b64_tr_b16 a[240:241], v241 offset:17440
    ds_read_b64_tr_b16 a[242:243], v241 offset:17696
    s_mov_b32 s63, 0x000053a0
    v_mfma_f32_16x16x32_bf16 v[16:19], a[224:227], a[128:131], v[16:19]
    buffer_load_dwordx4 v245, s[20:23], s63 offen offset:3168 lds
    ds_write_b128 v28, v[20:23] offset:1024
    v_mfma_f32_16x16x32_bf16 v[12:15], a[248:251], a[128:131], v[12:15]
    v_mul_f32 v253, v50, v50
    s_waitcnt lgkmcnt(5)
    v_mfma_f32_16x16x32_bf16 v[4:7], a[228:231], a[144:147], v[4:7]
    v_mul_f32 v254, v51, v51
    s_add_u32 m0, s47, 38016
    s_mov_b32 s62, 0x00010000
    v_mfma_f32_16x16x32_bf16 v[8:11], a[232:235], a[144:147], v[8:11]
    buffer_load_dwordx4 v245, s[20:23], s62 offen lds
    v_fma_f32 v251, v251, v25, v24
    v_mfma_f32_16x16x32_bf16 v[36:39], a[232:235], a[148:151], v[36:39]
    v_fma_f32 v252, v252, v25, v24
    v_fma_f32 v253, v253, v25, v24
    s_mov_b32 s63, 0x00011be0
    v_mfma_f32_16x16x32_bf16 v[32:35], a[228:231], a[148:151], v[32:35]
    buffer_load_dwordx4 v245, s[20:23], s63 offen offset:1056 lds
    v_fma_f32 v254, v254, v25, v24
    v_mfma_f32_16x16x32_bf16 v[64:67], a[228:231], a[152:155], v[64:67]
    s_waitcnt vmcnt(14) lgkmcnt(0)
    s_barrier
    v_mfma_f32_16x16x32_bf16 v[68:71], a[232:235], a[152:155], v[68:71]
    ds_read_b64_tr_b16 a[244:245], v241 offset:33792
    ds_read_b64_tr_b16 a[246:247], v241 offset:34048
    v_mul_f32 v251, v251, v48
    v_mfma_f32_16x16x32_bf16 v[100:103], a[232:235], a[156:159], v[100:103]
    ds_read_b64_tr_b16 a[248:249], v241 offset:50688
    ds_read_b64_tr_b16 a[250:251], v241 offset:50944
    v_mul_f32 v252, v252, v49
    v_mfma_f32_16x16x32_bf16 v[96:99], a[228:231], a[156:159], v[96:99]
    v_exp_f32 v251, v251
    v_mfma_f32_16x16x32_bf16 v[104:107], a[236:239], a[156:159], v[104:107]
    v_exp_f32 v252, v252
    v_mul_f32 v253, v253, v50
    v_mfma_f32_16x16x32_bf16 v[108:111], a[240:243], a[156:159], v[108:111]
    ds_read_b64_tr_b16 a[224:225], v241 offset:33824
    ds_read_b64_tr_b16 a[226:227], v241 offset:34080
    s_mov_b32 s62, 0x000137c0
    v_mfma_f32_16x16x32_bf16 v[76:79], a[240:243], a[152:155], v[76:79]
    buffer_load_dwordx4 v245, s[20:23], s62 offen offset:2112 lds
    v_mul_f32 v254, v254, v51
    v_mfma_f32_16x16x32_bf16 v[72:75], a[236:239], a[152:155], v[72:75]
    v_exp_f32 v253, v253
    v_fma_f32 v251, v251, v26, v26
    v_mfma_f32_16x16x32_bf16 v[40:43], a[236:239], a[148:151], v[40:43]
    v_exp_f32 v254, v254
    v_fma_f32 v252, v252, v26, v26
    v_mfma_f32_16x16x32_bf16 v[44:47], a[240:243], a[148:151], v[44:47]
    ds_read_b64_tr_b16 a[228:229], v241 offset:50720
    ds_read_b64_tr_b16 a[230:231], v241 offset:50976
    s_mov_b32 s63, 0x000153a0
    v_mfma_f32_16x16x32_bf16 v[16:19], a[240:243], a[144:147], v[16:19]
    buffer_load_dwordx4 v245, s[20:23], s63 offen offset:3168 lds
    v_mfma_f32_16x16x32_bf16 v[12:15], a[236:239], a[144:147], v[12:15]
    v_rcp_f32 v251, v251
    s_waitcnt lgkmcnt(4)
    v_mfma_f32_16x16x32_bf16 v[4:7], a[244:247], a[160:163], v[4:7]
    v_rcp_f32 v252, v252
    v_fma_f32 v253, v253, v26, v26
    v_mfma_f32_16x16x32_bf16 v[8:11], a[248:251], a[160:163], v[8:11]
    ds_read_b64_tr_b16 a[232:233], v241 offset:34304
    ds_read_b64_tr_b16 a[234:235], v241 offset:34560
    s_add_u32 m0, s47, 67584
    s_mov_b32 s62, 0x00040000
    v_mfma_f32_16x16x32_bf16 v[36:39], a[248:251], a[164:167], v[36:39]
    buffer_load_dwordx4 v245, s[20:23], s62 offen lds
    v_fma_f32 v254, v254, v26, v26
    v_mfma_f32_16x16x32_bf16 v[32:35], a[244:247], a[164:167], v[32:35]
    v_rcp_f32 v253, v253
    v_mfma_f32_16x16x32_bf16 v[64:67], a[244:247], a[168:171], v[64:67]
    v_rcp_f32 v254, v254
    v_mul_f32 v52, v52, v48
    v_mfma_f32_16x16x32_bf16 v[68:71], a[248:251], a[168:171], v[68:71]
    ds_read_b64_tr_b16 a[236:237], v241 offset:51200
    ds_read_b64_tr_b16 a[238:239], v241 offset:51456
    s_mov_b32 s63, 0x00041be0
    v_mfma_f32_16x16x32_bf16 v[100:103], a[248:251], a[172:175], v[100:103]
    buffer_load_dwordx4 v245, s[20:23], s63 offen offset:1056 lds
    v_mul_f32 v53, v53, v49
    v_mfma_f32_16x16x32_bf16 v[96:99], a[244:247], a[172:175], v[96:99]
    v_mul_f32 v54, v54, v50
    v_mul_f32 v55, v55, v51
    s_waitcnt lgkmcnt(4)
    v_mfma_f32_16x16x32_bf16 v[104:107], a[224:227], a[172:175], v[104:107]
    v_mul_f32 v52, v52, v251
    v_mul_f32 v53, v53, v252
    v_mfma_f32_16x16x32_bf16 v[108:111], a[228:231], a[172:175], v[108:111]
    ds_read_b64_tr_b16 a[240:241], v241 offset:34336
    ds_read_b64_tr_b16 a[242:243], v241 offset:34592
    s_mov_b32 s62, 0x000437c0
    v_mfma_f32_16x16x32_bf16 v[76:79], a[228:231], a[168:171], v[76:79]
    buffer_load_dwordx4 v245, s[20:23], s62 offen offset:2112 lds
    v_mul_f32 v54, v54, v253
    v_mfma_f32_16x16x32_bf16 v[72:75], a[224:227], a[168:171], v[72:75]
    v_mul_f32 v55, v55, v254
    v_cvt_pk_bf16_f32 v48, v52, v53
    v_mul_f32 v251, v56, v56
    v_mfma_f32_16x16x32_bf16 v[40:43], a[224:227], a[164:167], v[40:43]
    v_cvt_pk_bf16_f32 v49, v54, v55
    v_accvgpr_read_b32 v54, a255
    v_mul_f32 v252, v57, v57
    v_mfma_f32_16x16x32_bf16 v[44:47], a[228:231], a[164:167], v[44:47]
    ds_read_b64_tr_b16 a[244:245], v241 offset:51232
    ds_read_b64_tr_b16 a[246:247], v241 offset:51488
    s_mov_b32 s63, 0x000453a0
    v_mfma_f32_16x16x32_bf16 v[16:19], a[228:231], a[160:163], v[16:19]
    buffer_load_dwordx4 v245, s[20:23], s63 offen offset:3168 lds
    v_rcp_f32 v52, v54
    v_mfma_f32_16x16x32_bf16 v[12:15], a[224:227], a[160:163], v[12:15]
    v_mul_f32 v54, v54, v54
    v_mul_f32 v253, v58, v58
    s_waitcnt lgkmcnt(4)
    v_mfma_f32_16x16x32_bf16 v[4:7], a[232:235], a[176:179], v[4:7]
    v_mul_f32 v53, 0xbdd2d3e8, v52
    s_add_u32 m0, s47, 71808
    s_mov_b32 s62, 0x00050000
    v_mfma_f32_16x16x32_bf16 v[8:11], a[236:239], a[176:179], v[8:11]
    buffer_load_dwordx4 v245, s[20:23], s62 offen lds
    v_mul_f32 v53, v53, v52
    v_mfma_f32_16x16x32_bf16 v[36:39], a[236:239], a[180:183], v[36:39]
    v_mul_f32 v53, v53, v52
    s_mov_b32 s63, 0x00051be0
    v_mfma_f32_16x16x32_bf16 v[32:35], a[232:235], a[180:183], v[32:35]
    buffer_load_dwordx4 v245, s[20:23], s63 offen offset:1056 lds
    v_mul_f32 v52, 0xc0135761, v52
    v_mfma_f32_16x16x32_bf16 v[64:67], a[232:235], a[184:187], v[64:67]
    s_waitcnt vmcnt(14) lgkmcnt(0)
    s_barrier
    v_mul_f32 v254, v59, v59
    v_mfma_f32_16x16x32_bf16 v[68:71], a[236:239], a[184:187], v[68:71]
    ds_read_b64_tr_b16 a[248:249], v240
    ds_read_b64_tr_b16 a[250:251], v240 offset:256
    v_fma_f32 v251, v251, v25, v24
    v_mfma_f32_16x16x32_bf16 v[100:103], a[236:239], a[188:191], v[100:103]
    ds_read_b64_tr_b16 a[224:225], v240 offset:16896
    ds_read_b64_tr_b16 a[226:227], v240 offset:17152
    v_fma_f32 v252, v252, v25, v24
    v_mfma_f32_16x16x32_bf16 v[96:99], a[232:235], a[188:191], v[96:99]
    v_fma_f32 v253, v253, v25, v24
    v_mfma_f32_16x16x32_bf16 v[104:107], a[240:243], a[188:191], v[104:107]
    v_fma_f32 v254, v254, v25, v24
    v_mul_f32 v251, v251, v56
    v_mul_f32 v252, v252, v57
    v_mfma_f32_16x16x32_bf16 v[108:111], a[244:247], a[188:191], v[108:111]
    ds_read_b64_tr_b16 a[228:229], v240 offset:32
    ds_read_b64_tr_b16 a[230:231], v240 offset:288
    s_mov_b32 s62, 0x000537c0
    v_mfma_f32_16x16x32_bf16 v[76:79], a[244:247], a[184:187], v[76:79]
    buffer_load_dwordx4 v245, s[20:23], s62 offen offset:2112 lds
    v_mul_f32 v253, v253, v58
    v_mfma_f32_16x16x32_bf16 v[72:75], a[240:243], a[184:187], v[72:75]
    v_exp_f32 v251, v251
    v_mul_f32 v254, v254, v59
    v_mfma_f32_16x16x32_bf16 v[40:43], a[240:243], a[180:183], v[40:43]
    v_exp_f32 v252, v252
    v_mfma_f32_16x16x32_bf16 v[44:47], a[244:247], a[180:183], v[44:47]
    ds_read_b64_tr_b16 a[232:233], v240 offset:16928
    ds_read_b64_tr_b16 a[234:235], v240 offset:17184
    s_mov_b32 s63, 0x000553a0
    v_mfma_f32_16x16x32_bf16 v[16:19], a[244:247], a[176:179], v[16:19]
    buffer_load_dwordx4 v245, s[20:23], s63 offen offset:3168 lds
    v_fma_f32 v251, v251, v26, v26
    v_mfma_f32_16x16x32_bf16 v[12:15], a[240:243], a[176:179], v[12:15]
    v_exp_f32 v253, v253
    s_waitcnt lgkmcnt(4)
    v_mfma_f32_16x16x32_bf16 v[4:7], a[248:251], a[192:195], v[4:7]
    v_exp_f32 v254, v254
    v_fma_f32 v252, v252, v26, v26
    v_mfma_f32_16x16x32_bf16 v[8:11], a[224:227], a[192:195], v[8:11]
    ds_read_b64_tr_b16 a[236:237], v240 offset:512
    ds_read_b64_tr_b16 a[238:239], v240 offset:768
    s_add_u32 m0, s47, 101376
    s_mov_b32 s62, 0x00080000
    v_mfma_f32_16x16x32_bf16 v[36:39], a[224:227], a[196:199], v[36:39]
    buffer_load_dwordx4 v245, s[20:23], s62 offen lds
    v_fma_f32 v253, v253, v26, v26
    v_mfma_f32_16x16x32_bf16 v[32:35], a[248:251], a[196:199], v[32:35]
    v_rcp_f32 v251, v251
    v_fma_f32 v254, v254, v26, v26
    v_mfma_f32_16x16x32_bf16 v[64:67], a[248:251], a[200:203], v[64:67]
    v_rcp_f32 v252, v252
    v_mul_f32 v60, v60, v56
    v_mfma_f32_16x16x32_bf16 v[68:71], a[224:227], a[200:203], v[68:71]
    ds_read_b64_tr_b16 a[240:241], v240 offset:17408
    ds_read_b64_tr_b16 a[242:243], v240 offset:17664
    s_mov_b32 s63, 0x00081be0
    v_mfma_f32_16x16x32_bf16 v[100:103], a[224:227], a[204:207], v[100:103]
    buffer_load_dwordx4 v245, s[20:23], s63 offen offset:1056 lds
    v_mfma_f32_16x16x32_bf16 v[96:99], a[248:251], a[204:207], v[96:99]
    v_rcp_f32 v253, v253
    s_waitcnt lgkmcnt(4)
    v_mfma_f32_16x16x32_bf16 v[104:107], a[228:231], a[204:207], v[104:107]
    v_rcp_f32 v254, v254
    v_mul_f32 v61, v61, v57
    v_mfma_f32_16x16x32_bf16 v[108:111], a[232:235], a[204:207], v[108:111]
    ds_read_b64_tr_b16 a[244:245], v240 offset:544
    ds_read_b64_tr_b16 a[246:247], v240 offset:800
    s_mov_b32 s62, 0x000837c0
    v_mfma_f32_16x16x32_bf16 v[76:79], a[232:235], a[200:203], v[76:79]
    buffer_load_dwordx4 v245, s[20:23], s62 offen offset:2112 lds
    v_mul_f32 v62, v62, v58
    v_mfma_f32_16x16x32_bf16 v[72:75], a[228:231], a[200:203], v[72:75]
    v_mul_f32 v63, v63, v59
    v_mul_f32 v60, v60, v251
    v_mfma_f32_16x16x32_bf16 v[40:43], a[228:231], a[196:199], v[40:43]
    v_mul_f32 v61, v61, v252
    v_mul_f32 v62, v62, v253
    v_mul_f32 v63, v63, v254
    v_mfma_f32_16x16x32_bf16 v[44:47], a[232:235], a[196:199], v[44:47]
    ds_read_b64_tr_b16 a[248:249], v240 offset:17440
    ds_read_b64_tr_b16 a[250:251], v240 offset:17696
    s_mov_b32 s63, 0x000853a0
    v_mfma_f32_16x16x32_bf16 v[16:19], a[232:235], a[192:195], v[16:19]
    buffer_load_dwordx4 v245, s[20:23], s63 offen offset:3168 lds
    v_cvt_pk_bf16_f32 v50, v60, v61
    v_mfma_f32_16x16x32_bf16 v[12:15], a[228:231], a[192:195], v[12:15]
    v_cvt_pk_bf16_f32 v51, v62, v63
    v_add_u32 v60, s48, v249
    s_waitcnt lgkmcnt(4)
    v_mfma_f32_16x16x32_bf16 v[4:7], a[236:239], a[208:211], v[4:7]
    s_add_u32 m0, s47, 105600
    s_mov_b32 s62, 0x00090000
    v_mfma_f32_16x16x32_bf16 v[8:11], a[240:243], a[208:211], v[8:11]
    buffer_load_dwordx4 v245, s[20:23], s62 offen lds
    ds_write_b128 v60, v[48:51]
    v_mfma_f32_16x16x32_bf16 v[36:39], a[240:243], a[212:215], v[36:39]
    v_mul_f32 v251, v80, v80
    v_mul_f32 v252, v81, v81
    s_mov_b32 s63, 0x00091be0
    v_mfma_f32_16x16x32_bf16 v[32:35], a[236:239], a[212:215], v[32:35]
    buffer_load_dwordx4 v245, s[20:23], s63 offen offset:1056 lds
    v_mul_f32 v253, v82, v82
    v_mfma_f32_16x16x32_bf16 v[64:67], a[236:239], a[216:219], v[64:67]
    s_waitcnt vmcnt(14) lgkmcnt(0)
    s_barrier
    v_mul_f32 v254, v83, v83
    v_mfma_f32_16x16x32_bf16 v[68:71], a[240:243], a[216:219], v[68:71]
    v_add_u32 v240, s88, v240
    ds_read_b64_tr_b16 a[224:225], v240 offset:33792
    v_mfma_f32_16x16x32_bf16 v[100:103], a[240:243], a[220:223], v[100:103]
    ds_read_b64_tr_b16 a[226:227], v240 offset:50688
    ds_read_b64_tr_b16 a[228:229], v240 offset:33824
    v_fma_f32 v251, v251, v53, v52
    v_mfma_f32_16x16x32_bf16 v[96:99], a[236:239], a[220:223], v[96:99]
    ds_read_b64_tr_b16 a[230:231], v240 offset:50720
    v_fma_f32 v252, v252, v53, v52
    v_mfma_f32_16x16x32_bf16 v[104:107], a[244:247], a[220:223], v[104:107]
    v_fma_f32 v253, v253, v53, v52
    v_fma_f32 v254, v254, v53, v52
    v_mul_f32 v251, v251, v80
    v_mfma_f32_16x16x32_bf16 v[108:111], a[248:251], a[220:223], v[108:111]
    ds_read_b64_tr_b16 a[232:233], v240 offset:33856
    ds_read_b64_tr_b16 a[234:235], v240 offset:50752
    s_mov_b32 s62, 0x000937c0
    v_mfma_f32_16x16x32_bf16 v[76:79], a[248:251], a[216:219], v[76:79]
    buffer_load_dwordx4 v245, s[20:23], s62 offen offset:2112 lds
    v_mfma_f32_16x16x32_bf16 v[72:75], a[244:247], a[216:219], v[72:75]
    v_exp_f32 v251, v251
    v_mul_f32 v252, v252, v81
    v_mfma_f32_16x16x32_bf16 v[40:43], a[244:247], a[212:215], v[40:43]
    v_exp_f32 v252, v252
    v_mul_f32 v253, v253, v82
    v_mfma_f32_16x16x32_bf16 v[44:47], a[248:251], a[212:215], v[44:47]
    ds_read_b64_tr_b16 a[236:237], v240 offset:33888
    ds_read_b64_tr_b16 a[238:239], v240 offset:50784
    s_mov_b32 s63, 0x000953a0
    v_mfma_f32_16x16x32_bf16 v[16:19], a[248:251], a[208:211], v[16:19]
    buffer_load_dwordx4 v245, s[20:23], s63 offen offset:3168 lds
    v_mul_f32 v254, v254, v83
    v_mfma_f32_16x16x32_bf16 v[12:15], a[244:247], a[208:211], v[12:15]
    v_fma_f32 v251, v251, v54, v54
    s_waitcnt lgkmcnt(4)
    v_mfma_f32_16x16x32_bf16 v[112:115], a[224:227], a[0:3], 0
    v_exp_f32 v253, v253
    v_fma_f32 v252, v252, v54, v54
    v_mfma_f32_16x16x32_bf16 v[128:131], a[228:231], a[0:3], 0
    ds_read_b64_tr_b16 a[240:241], v240 offset:33920
    ds_read_b64_tr_b16 a[242:243], v240 offset:50816
    s_add_u32 m0, s47, 0
    s_mov_b32 s62, 0x000c0000
    v_mfma_f32_16x16x32_bf16 v[132:135], a[228:231], a[4:7], 0
    buffer_load_dwordx4 v245, s[20:23], s62 offen lds
    v_fma_f32 v253, v253, v54, v54
    v_mfma_f32_16x16x32_bf16 v[116:119], a[224:227], a[4:7], 0
    v_exp_f32 v254, v254
    v_mul_f32 v84, v84, v80
    v_mfma_f32_16x16x32_bf16 v[120:123], a[224:227], a[8:11], 0
    v_rcp_f32 v251, v251
    v_mfma_f32_16x16x32_bf16 v[136:139], a[228:231], a[8:11], 0
    ds_read_b64_tr_b16 a[244:245], v240 offset:33952
    ds_read_b64_tr_b16 a[246:247], v240 offset:50848
    s_mov_b32 s63, 0x000c1be0
    v_mfma_f32_16x16x32_bf16 v[140:143], a[228:231], a[12:15], 0
    buffer_load_dwordx4 v245, s[20:23], s63 offen offset:1056 lds
    v_fma_f32 v254, v254, v54, v54
    v_mfma_f32_16x16x32_bf16 v[124:127], a[224:227], a[12:15], 0
    v_rcp_f32 v252, v252
    s_waitcnt lgkmcnt(4)
    v_mfma_f32_16x16x32_bf16 v[156:159], a[232:235], a[12:15], 0
    v_rcp_f32 v253, v253
    v_mul_f32 v85, v85, v81
    v_mfma_f32_16x16x32_bf16 v[172:175], a[236:239], a[12:15], 0
    ds_read_b64_tr_b16 a[248:249], v240 offset:33984
    ds_read_b64_tr_b16 a[250:251], v240 offset:50880
    s_mov_b32 s62, 0x000c37c0
    v_mfma_f32_16x16x32_bf16 v[168:171], a[236:239], a[8:11], 0
    buffer_load_dwordx4 v245, s[20:23], s62 offen offset:2112 lds
    v_mul_f32 v86, v86, v82
    v_mfma_f32_16x16x32_bf16 v[152:155], a[232:235], a[8:11], 0
    v_rcp_f32 v254, v254
    v_mul_f32 v87, v87, v83
    v_mfma_f32_16x16x32_bf16 v[148:151], a[232:235], a[4:7], 0
    v_mul_f32 v84, v84, v251
    v_mul_f32 v85, v85, v252
    v_mul_f32 v86, v86, v253
    v_mfma_f32_16x16x32_bf16 v[164:167], a[236:239], a[4:7], 0
    ds_read_b64_tr_b16 a[224:225], v240 offset:34016
    ds_read_b64_tr_b16 a[226:227], v240 offset:50912
    s_mov_b32 s63, 0x000c53a0
    v_mfma_f32_16x16x32_bf16 v[160:163], a[236:239], a[0:3], 0
    buffer_load_dwordx4 v245, s[20:23], s63 offen offset:3168 lds
    v_mfma_f32_16x16x32_bf16 v[144:147], a[232:235], a[0:3], 0
    v_mul_f32 v87, v87, v254
    v_cvt_pk_bf16_f32 v80, v84, v85
    s_waitcnt lgkmcnt(4)
    v_mfma_f32_16x16x32_bf16 v[176:179], a[240:243], a[0:3], 0
    v_cvt_pk_bf16_f32 v81, v86, v87
    s_add_u32 m0, s47, 4224
    s_mov_b32 s62, 0x000d0000
    v_mfma_f32_16x16x32_bf16 v[192:195], a[244:247], a[0:3], 0
    buffer_load_dwordx4 v245, s[20:23], s62 offen lds
    v_mul_f32 v251, v88, v88
    v_mfma_f32_16x16x32_bf16 v[196:199], a[244:247], a[4:7], 0
    v_mul_f32 v252, v89, v89
    v_mul_f32 v253, v90, v90
    s_mov_b32 s63, 0x000d1be0
    v_mfma_f32_16x16x32_bf16 v[180:183], a[240:243], a[4:7], 0
    buffer_load_dwordx4 v245, s[20:23], s63 offen offset:1056 lds
    v_mfma_f32_16x16x32_bf16 v[184:187], a[240:243], a[8:11], 0
    s_waitcnt vmcnt(14) lgkmcnt(0)
    s_barrier
    v_mul_f32 v254, v91, v91
    v_mfma_f32_16x16x32_bf16 v[200:203], a[244:247], a[8:11], 0
    v_add_u32 v241, s88, v241
    ds_read_b64_tr_b16 a[228:229], v241
    v_fma_f32 v251, v251, v53, v52
    v_mfma_f32_16x16x32_bf16 v[204:207], a[244:247], a[12:15], 0
    ds_read_b64_tr_b16 a[230:231], v241 offset:16896
    ds_read_b64_tr_b16 a[232:233], v241 offset:32
    v_fma_f32 v252, v252, v53, v52
    v_mfma_f32_16x16x32_bf16 v[188:191], a[240:243], a[12:15], 0
    ds_read_b64_tr_b16 a[234:235], v241 offset:16928
    v_fma_f32 v253, v253, v53, v52
    v_mfma_f32_16x16x32_bf16 v[220:223], a[248:251], a[12:15], 0
    v_fma_f32 v254, v254, v53, v52
    v_mul_f32 v251, v251, v88
    v_mfma_f32_16x16x32_bf16 v[236:239], a[224:227], a[12:15], 0
    ds_read_b64_tr_b16 a[236:237], v241 offset:64
    ds_read_b64_tr_b16 a[238:239], v241 offset:16960
    s_mov_b32 s62, 0x000d37c0
    v_mfma_f32_16x16x32_bf16 v[232:235], a[224:227], a[8:11], 0
    buffer_load_dwordx4 v245, s[20:23], s62 offen offset:2112 lds
    v_mul_f32 v252, v252, v89
    v_mfma_f32_16x16x32_bf16 v[216:219], a[248:251], a[8:11], 0
    v_exp_f32 v251, v251
    v_mul_f32 v253, v253, v90
    v_mfma_f32_16x16x32_bf16 v[212:215], a[248:251], a[4:7], 0
    v_exp_f32 v252, v252
    v_mul_f32 v254, v254, v91
    v_mfma_f32_16x16x32_bf16 v[228:231], a[224:227], a[4:7], 0
    ds_read_b64_tr_b16 a[240:241], v241 offset:96
    ds_read_b64_tr_b16 a[242:243], v241 offset:16992
    s_mov_b32 s63, 0x000d53a0
    v_mfma_f32_16x16x32_bf16 v[224:227], a[224:227], a[0:3], 0
    buffer_load_dwordx4 v245, s[20:23], s63 offen offset:3168 lds
    v_fma_f32 v251, v251, v54, v54
    v_mfma_f32_16x16x32_bf16 v[208:211], a[248:251], a[0:3], 0
    v_exp_f32 v253, v253
    s_waitcnt lgkmcnt(4)
    v_mfma_f32_16x16x32_bf16 v[112:115], a[228:231], a[16:19], v[112:115]
    v_exp_f32 v254, v254
    v_fma_f32 v252, v252, v54, v54
    v_mfma_f32_16x16x32_bf16 v[128:131], a[232:235], a[16:19], v[128:131]
    ds_read_b64_tr_b16 a[244:245], v241 offset:128
    ds_read_b64_tr_b16 a[246:247], v241 offset:17024
    s_add_u32 m0, s47, 33792
    s_mov_b32 s62, 0x00100000
    v_mfma_f32_16x16x32_bf16 v[132:135], a[232:235], a[20:23], v[132:135]
    buffer_load_dwordx4 v245, s[20:23], s62 offen lds
    v_mfma_f32_16x16x32_bf16 v[116:119], a[228:231], a[20:23], v[116:119]
    v_rcp_f32 v251, v251
    v_fma_f32 v253, v253, v54, v54
    v_mfma_f32_16x16x32_bf16 v[120:123], a[228:231], a[24:27], v[120:123]
    v_rcp_f32 v252, v252
    v_fma_f32 v254, v254, v54, v54
    v_mfma_f32_16x16x32_bf16 v[136:139], a[232:235], a[24:27], v[136:139]
    ds_read_b64_tr_b16 a[248:249], v241 offset:160
    ds_read_b64_tr_b16 a[250:251], v241 offset:17056
    s_mov_b32 s63, 0x00101be0
    v_mfma_f32_16x16x32_bf16 v[140:143], a[232:235], a[28:31], v[140:143]
    buffer_load_dwordx4 v245, s[20:23], s63 offen offset:1056 lds
    v_mul_f32 v92, v92, v88
    v_mfma_f32_16x16x32_bf16 v[124:127], a[228:231], a[28:31], v[124:127]
    v_mul_f32 v93, v93, v89
    s_waitcnt lgkmcnt(4)
    v_mfma_f32_16x16x32_bf16 v[156:159], a[236:239], a[28:31], v[156:159]
    v_rcp_f32 v253, v253
    v_mul_f32 v94, v94, v90
    v_mfma_f32_16x16x32_bf16 v[172:175], a[240:243], a[28:31], v[172:175]
    ds_read_b64_tr_b16 a[224:225], v241 offset:192
    ds_read_b64_tr_b16 a[226:227], v241 offset:17088
    s_mov_b32 s62, 0x001037c0
    v_mfma_f32_16x16x32_bf16 v[168:171], a[240:243], a[24:27], v[168:171]
    buffer_load_dwordx4 v245, s[20:23], s62 offen offset:2112 lds
    v_mul_f32 v95, v95, v91
    v_mfma_f32_16x16x32_bf16 v[152:155], a[236:239], a[24:27], v[152:155]
    v_rcp_f32 v254, v254
    v_mul_f32 v92, v92, v251
    v_mfma_f32_16x16x32_bf16 v[148:151], a[236:239], a[20:23], v[148:151]
    v_mul_f32 v93, v93, v252
    v_mul_f32 v94, v94, v253
    v_mfma_f32_16x16x32_bf16 v[164:167], a[240:243], a[20:23], v[164:167]
    ds_read_b64_tr_b16 a[228:229], v241 offset:224
    ds_read_b64_tr_b16 a[230:231], v241 offset:17120
    s_mov_b32 s63, 0x001053a0
    v_mfma_f32_16x16x32_bf16 v[160:163], a[240:243], a[16:19], v[160:163]
    buffer_load_dwordx4 v245, s[20:23], s63 offen offset:3168 lds
    v_mul_f32 v95, v95, v254
    v_mfma_f32_16x16x32_bf16 v[144:147], a[236:239], a[16:19], v[144:147]
    v_cvt_pk_bf16_f32 v82, v92, v93
    v_cvt_pk_bf16_f32 v83, v94, v95
    s_waitcnt lgkmcnt(4)
    v_mfma_f32_16x16x32_bf16 v[176:179], a[244:247], a[16:19], v[176:179]
    v_add_u32 v92, s48, v249
    s_add_u32 m0, s47, 38016
    s_mov_b32 s62, 0x00110000
    v_mfma_f32_16x16x32_bf16 v[192:195], a[248:251], a[16:19], v[192:195]
    buffer_load_dwordx4 v245, s[20:23], s62 offen lds
    v_mfma_f32_16x16x32_bf16 v[196:199], a[248:251], a[20:23], v[196:199]
    ds_write_b128 v92, v[80:83] offset:1024
    v_mul_f32 v251, v4, v4
    s_mov_b32 s63, 0x00111be0
    v_mfma_f32_16x16x32_bf16 v[180:183], a[244:247], a[20:23], v[180:183]
    buffer_load_dwordx4 v245, s[20:23], s63 offen offset:1056 lds
    v_mfma_f32_16x16x32_bf16 v[184:187], a[244:247], a[24:27], v[184:187]
    s_waitcnt vmcnt(14) lgkmcnt(0)
    s_barrier
    v_mul_f32 v252, v5, v5
    v_mfma_f32_16x16x32_bf16 v[200:203], a[248:251], a[24:27], v[200:203]
    ds_read_b64_tr_b16 a[232:233], v241 offset:33792
    ds_read_b64_tr_b16 a[234:235], v241 offset:50688
    v_mul_f32 v253, v6, v6
    v_mfma_f32_16x16x32_bf16 v[204:207], a[248:251], a[28:31], v[204:207]
    ds_read_b64_tr_b16 a[236:237], v241 offset:33824
    ds_read_b64_tr_b16 a[238:239], v241 offset:50720
    v_add_u32 v56, 135168, v248
    v_mfma_f32_16x16x32_bf16 v[188:191], a[244:247], a[28:31], v[188:191]
    v_mul_f32 v254, v7, v7
    v_fma_f32 v251, v251, v243, v242
    v_mfma_f32_16x16x32_bf16 v[220:223], a[224:227], a[28:31], v[220:223]
    v_fma_f32 v252, v252, v243, v242
    v_fma_f32 v253, v253, v243, v242
    v_add_u32 v57, 135168, v249
    v_mfma_f32_16x16x32_bf16 v[236:239], a[228:231], a[28:31], v[236:239]
    ds_read_b64_tr_b16 a[240:241], v241 offset:33856
    ds_read_b64_tr_b16 a[242:243], v241 offset:50752
    s_mov_b32 s62, 0x001137c0
    v_mfma_f32_16x16x32_bf16 v[232:235], a[228:231], a[24:27], v[232:235]
    buffer_load_dwordx4 v245, s[20:23], s62 offen offset:2112 lds
    v_fma_f32 v254, v254, v243, v242
    v_mfma_f32_16x16x32_bf16 v[216:219], a[224:227], a[24:27], v[216:219]
    v_mul_f32 v251, v251, v4
    v_mul_f32 v252, v252, v5
    v_mfma_f32_16x16x32_bf16 v[212:215], a[224:227], a[20:23], v[212:215]
    v_exp_f32 v251, v251
    v_mul_f32 v253, v253, v6
    v_mfma_f32_16x16x32_bf16 v[228:231], a[228:231], a[20:23], v[228:231]
    ds_read_b64_tr_b16 a[244:245], v241 offset:33888
    ds_read_b64_tr_b16 a[246:247], v241 offset:50784
    s_mov_b32 s63, 0x001153a0
    v_mfma_f32_16x16x32_bf16 v[224:227], a[228:231], a[16:19], v[224:227]
    buffer_load_dwordx4 v245, s[20:23], s63 offen offset:3168 lds
    v_mul_f32 v254, v254, v7
    v_mfma_f32_16x16x32_bf16 v[208:211], a[224:227], a[16:19], v[208:211]
    v_exp_f32 v252, v252
    s_waitcnt lgkmcnt(4)
    v_mfma_f32_16x16x32_bf16 v[112:115], a[232:235], a[32:35], v[112:115]
    v_exp_f32 v253, v253
    ds_read_b128 a[0:3], v56
    v_mfma_f32_16x16x32_bf16 v[128:131], a[236:239], a[32:35], v[128:131]
    ds_read_b64_tr_b16 a[248:249], v241 offset:33920
    ds_read_b64_tr_b16 a[250:251], v241 offset:50816
    s_add_u32 m0, s47, 67584
    s_mov_b32 s62, 0x00140000
    v_mfma_f32_16x16x32_bf16 v[132:135], a[236:239], a[36:39], v[132:135]
    buffer_load_dwordx4 v245, s[20:23], s62 offen lds
    ds_read_b128 a[4:7], v56 offset:1024
    v_mfma_f32_16x16x32_bf16 v[116:119], a[232:235], a[36:39], v[116:119]
    v_exp_f32 v254, v254
    v_fma_f32 v251, v251, v255, v255
    v_mfma_f32_16x16x32_bf16 v[120:123], a[232:235], a[40:43], v[120:123]
    v_rcp_f32 v251, v251
    v_fma_f32 v252, v252, v255, v255
    v_mfma_f32_16x16x32_bf16 v[136:139], a[236:239], a[40:43], v[136:139]
    ds_read_b64_tr_b16 a[224:225], v241 offset:33952
    ds_read_b64_tr_b16 a[226:227], v241 offset:50848
    s_mov_b32 s63, 0x00141be0
    v_mfma_f32_16x16x32_bf16 v[140:143], a[236:239], a[44:47], v[140:143]
    buffer_load_dwordx4 v245, s[20:23], s63 offen offset:1056 lds
    v_fma_f32 v253, v253, v255, v255
    v_mfma_f32_16x16x32_bf16 v[124:127], a[232:235], a[44:47], v[124:127]
    v_fma_f32 v254, v254, v255, v255
    s_waitcnt lgkmcnt(6)
    v_mfma_f32_16x16x32_bf16 v[156:159], a[240:243], a[44:47], v[156:159]
    v_rcp_f32 v252, v252
    v_mul_f32 v8, v8, v4
    v_mfma_f32_16x16x32_bf16 v[172:175], a[244:247], a[44:47], v[172:175]
    ds_read_b64_tr_b16 a[228:229], v241 offset:33984
    ds_read_b64_tr_b16 a[230:231], v241 offset:50880
    s_mov_b32 s62, 0x001437c0
    v_mfma_f32_16x16x32_bf16 v[168:171], a[244:247], a[40:43], v[168:171]
    buffer_load_dwordx4 v245, s[20:23], s62 offen offset:2112 lds
    ds_read_b128 a[8:11], v57
    v_mfma_f32_16x16x32_bf16 v[152:155], a[240:243], a[40:43], v[152:155]
    v_rcp_f32 v253, v253
    v_mul_f32 v9, v9, v5
    v_mfma_f32_16x16x32_bf16 v[148:151], a[240:243], a[36:39], v[148:151]
    v_rcp_f32 v254, v254
    ds_read_b128 a[12:15], v57 offset:1024
    v_mfma_f32_16x16x32_bf16 v[164:167], a[244:247], a[36:39], v[164:167]
    ds_read_b64_tr_b16 a[232:233], v241 offset:34016
    ds_read_b64_tr_b16 a[234:235], v241 offset:50912
    s_mov_b32 s63, 0x001453a0
    v_mfma_f32_16x16x32_bf16 v[160:163], a[244:247], a[32:35], v[160:163]
    buffer_load_dwordx4 v245, s[20:23], s63 offen offset:3168 lds
    v_mul_f32 v10, v10, v6
    v_mfma_f32_16x16x32_bf16 v[144:147], a[240:243], a[32:35], v[144:147]
    v_mul_f32 v11, v11, v7
    s_waitcnt lgkmcnt(6)
    v_mfma_f32_16x16x32_bf16 v[176:179], a[248:251], a[32:35], v[176:179]
    v_mul_f32 v8, v8, v251
    s_add_u32 m0, s47, 71808
    s_mov_b32 s62, 0x00150000
    v_mfma_f32_16x16x32_bf16 v[192:195], a[224:227], a[32:35], v[192:195]
    buffer_load_dwordx4 v245, s[20:23], s62 offen lds
    v_mfma_f32_16x16x32_bf16 v[196:199], a[224:227], a[36:39], v[196:199]
    v_mul_f32 v9, v9, v252
    v_mul_f32 v10, v10, v253
    s_mov_b32 s63, 0x00151be0
    v_mfma_f32_16x16x32_bf16 v[180:183], a[248:251], a[36:39], v[180:183]
    buffer_load_dwordx4 v245, s[20:23], s63 offen offset:1056 lds
    v_mul_f32 v11, v11, v254
    v_mfma_f32_16x16x32_bf16 v[184:187], a[248:251], a[40:43], v[184:187]
    s_waitcnt vmcnt(14) lgkmcnt(0)
    s_barrier
    v_mfma_f32_16x16x32_bf16 v[200:203], a[224:227], a[40:43], v[200:203]
    ds_read_b64_tr_b16 a[236:237], v240
    ds_read_b64_tr_b16 a[238:239], v240 offset:16896
    v_cvt_pk_bf16_f32 v4, v8, v9
    v_mfma_f32_16x16x32_bf16 v[204:207], a[224:227], a[44:47], v[204:207]
    ds_read_b64_tr_b16 a[240:241], v240 offset:32
    ds_read_b64_tr_b16 a[242:243], v240 offset:16928
    v_mfma_f32_16x16x32_bf16 v[188:191], a[248:251], a[44:47], v[188:191]
    v_cvt_pk_bf16_f32 v5, v10, v11
    v_mul_f32 v251, v12, v12
    v_mfma_f32_16x16x32_bf16 v[220:223], a[228:231], a[44:47], v[220:223]
    v_mul_f32 v252, v13, v13
    v_mul_f32 v253, v14, v14
    v_mul_f32 v254, v15, v15
    v_mfma_f32_16x16x32_bf16 v[236:239], a[232:235], a[44:47], v[236:239]
    ds_read_b64_tr_b16 a[244:245], v240 offset:64
    ds_read_b64_tr_b16 a[246:247], v240 offset:16960
    s_mov_b32 s62, 0x001537c0
    v_mfma_f32_16x16x32_bf16 v[232:235], a[232:235], a[40:43], v[232:235]
    buffer_load_dwordx4 v245, s[20:23], s62 offen offset:2112 lds
    v_fma_f32 v251, v251, v243, v242
    v_mfma_f32_16x16x32_bf16 v[216:219], a[228:231], a[40:43], v[216:219]
    v_fma_f32 v252, v252, v243, v242
    v_fma_f32 v253, v253, v243, v242
    v_mfma_f32_16x16x32_bf16 v[212:215], a[228:231], a[36:39], v[212:215]
    v_fma_f32 v254, v254, v243, v242
    v_mul_f32 v251, v251, v12
    v_mul_f32 v252, v252, v13
    v_mfma_f32_16x16x32_bf16 v[228:231], a[232:235], a[36:39], v[228:231]
    ds_read_b64_tr_b16 a[248:249], v240 offset:96
    ds_read_b64_tr_b16 a[250:251], v240 offset:16992
    s_mov_b32 s63, 0x001553a0
    v_mfma_f32_16x16x32_bf16 v[224:227], a[232:235], a[32:35], v[224:227]
    buffer_load_dwordx4 v245, s[20:23], s63 offen offset:3168 lds
    v_mfma_f32_16x16x32_bf16 v[208:211], a[228:231], a[32:35], v[208:211]
    v_exp_f32 v251, v251
    s_waitcnt lgkmcnt(4)
    v_mfma_f32_16x16x32_bf16 v[112:115], a[236:239], a[48:51], v[112:115]
    v_exp_f32 v252, v252
    v_mfma_f32_16x16x32_bf16 v[128:131], a[240:243], a[48:51], v[128:131]
    ds_read_b64_tr_b16 a[224:225], v240 offset:128
    ds_read_b64_tr_b16 a[226:227], v240 offset:17024
    s_add_u32 m0, s47, 101376
    s_mov_b32 s62, 0x00180000
    v_mfma_f32_16x16x32_bf16 v[132:135], a[240:243], a[52:55], v[132:135]
    buffer_load_dwordx4 v245, s[20:23], s62 offen lds
    v_mul_f32 v253, v253, v14
    v_mfma_f32_16x16x32_bf16 v[116:119], a[236:239], a[52:55], v[116:119]
    v_exp_f32 v253, v253
    v_mfma_f32_16x16x32_bf16 v[120:123], a[236:239], a[56:59], v[120:123]
    v_mul_f32 v254, v254, v15
    v_fma_f32 v251, v251, v255, v255
    v_fma_f32 v252, v252, v255, v255
    v_mfma_f32_16x16x32_bf16 v[136:139], a[240:243], a[56:59], v[136:139]
    ds_read_b64_tr_b16 a[228:229], v240 offset:160
    ds_read_b64_tr_b16 a[230:231], v240 offset:17056
    s_mov_b32 s63, 0x00181be0
    v_mfma_f32_16x16x32_bf16 v[140:143], a[240:243], a[60:63], v[140:143]
    buffer_load_dwordx4 v245, s[20:23], s63 offen offset:1056 lds
    v_fma_f32 v253, v253, v255, v255
    v_mfma_f32_16x16x32_bf16 v[124:127], a[236:239], a[60:63], v[124:127]
    v_exp_f32 v254, v254
    s_waitcnt lgkmcnt(4)
    v_mfma_f32_16x16x32_bf16 v[156:159], a[244:247], a[60:63], v[156:159]
    v_rcp_f32 v251, v251
    v_mfma_f32_16x16x32_bf16 v[172:175], a[248:251], a[60:63], v[172:175]
    ds_read_b64_tr_b16 a[232:233], v240 offset:192
    ds_read_b64_tr_b16 a[234:235], v240 offset:17088
    s_mov_b32 s62, 0x001837c0
    v_mfma_f32_16x16x32_bf16 v[168:171], a[248:251], a[56:59], v[168:171]
    buffer_load_dwordx4 v245, s[20:23], s62 offen offset:2112 lds
    v_mfma_f32_16x16x32_bf16 v[152:155], a[244:247], a[56:59], v[152:155]
    v_rcp_f32 v252, v252
    v_fma_f32 v254, v254, v255, v255
    v_mfma_f32_16x16x32_bf16 v[148:151], a[244:247], a[52:55], v[148:151]
    v_rcp_f32 v253, v253
    v_mul_f32 v16, v16, v12
    v_mfma_f32_16x16x32_bf16 v[164:167], a[248:251], a[52:55], v[164:167]
    ds_read_b64_tr_b16 a[236:237], v240 offset:224
    ds_read_b64_tr_b16 a[238:239], v240 offset:17120
    s_mov_b32 s63, 0x001853a0
    v_mfma_f32_16x16x32_bf16 v[160:163], a[248:251], a[48:51], v[160:163]
    buffer_load_dwordx4 v245, s[20:23], s63 offen offset:3168 lds
    v_mul_f32 v17, v17, v13
    v_mfma_f32_16x16x32_bf16 v[144:147], a[244:247], a[48:51], v[144:147]
    v_mul_f32 v18, v18, v14
    s_waitcnt lgkmcnt(4)
    v_mfma_f32_16x16x32_bf16 v[176:179], a[224:227], a[48:51], v[176:179]
    v_mul_f32 v19, v19, v15
    s_add_u32 m0, s47, 105600
    s_mov_b32 s62, 0x00190000
    v_mfma_f32_16x16x32_bf16 v[192:195], a[228:231], a[48:51], v[192:195]
    buffer_load_dwordx4 v245, s[20:23], s62 offen lds
    v_mul_f32 v16, v16, v251
    v_mfma_f32_16x16x32_bf16 v[196:199], a[228:231], a[52:55], v[196:199]
    v_mul_f32 v17, v17, v252
    s_mov_b32 s63, 0x00191be0
    v_mfma_f32_16x16x32_bf16 v[180:183], a[224:227], a[52:55], v[180:183]
    buffer_load_dwordx4 v245, s[20:23], s63 offen offset:1056 lds
    v_mul_f32 v18, v18, v253
    v_mfma_f32_16x16x32_bf16 v[184:187], a[224:227], a[56:59], v[184:187]
    s_waitcnt vmcnt(14) lgkmcnt(0)
    s_barrier
    v_mfma_f32_16x16x32_bf16 v[200:203], a[228:231], a[56:59], v[200:203]
    ds_read_b64_tr_b16 a[240:241], v240 offset:33792
    ds_read_b64_tr_b16 a[242:243], v240 offset:50688
    v_cvt_pk_bf16_f32 v6, v16, v17
    v_mfma_f32_16x16x32_bf16 v[204:207], a[228:231], a[60:63], v[204:207]
    ds_read_b64_tr_b16 a[244:245], v240 offset:33824
    ds_read_b64_tr_b16 a[246:247], v240 offset:50720
    v_add_u32 v16, s49, v248
    v_mfma_f32_16x16x32_bf16 v[188:191], a[224:227], a[60:63], v[188:191]
    v_mul_f32 v251, v32, v32
    v_mfma_f32_16x16x32_bf16 v[220:223], a[232:235], a[60:63], v[220:223]
    v_rcp_f32 v254, v254
    v_mul_f32 v252, v33, v33
    v_mfma_f32_16x16x32_bf16 v[236:239], a[236:239], a[60:63], v[236:239]
    ds_read_b64_tr_b16 a[248:249], v240 offset:33856
    ds_read_b64_tr_b16 a[250:251], v240 offset:50752
    s_mov_b32 s62, 0x001937c0
    v_mfma_f32_16x16x32_bf16 v[232:235], a[236:239], a[56:59], v[232:235]
    buffer_load_dwordx4 v245, s[20:23], s62 offen offset:2112 lds
    v_mul_f32 v19, v19, v254
    v_mfma_f32_16x16x32_bf16 v[216:219], a[232:235], a[56:59], v[216:219]
    v_cvt_pk_bf16_f32 v7, v18, v19
    v_mul_f32 v253, v34, v34
    v_mul_f32 v254, v35, v35
    v_mfma_f32_16x16x32_bf16 v[212:215], a[232:235], a[52:55], v[212:215]
    ds_write_b128 v16, v[4:7]
    v_fma_f32 v251, v251, v1, v0
    v_mfma_f32_16x16x32_bf16 v[228:231], a[236:239], a[52:55], v[228:231]
    ds_read_b64_tr_b16 a[224:225], v240 offset:33888
    ds_read_b64_tr_b16 a[226:227], v240 offset:50784
    s_mov_b32 s63, 0x001953a0
    v_mfma_f32_16x16x32_bf16 v[224:227], a[236:239], a[48:51], v[224:227]
    buffer_load_dwordx4 v245, s[20:23], s63 offen offset:3168 lds
    v_mfma_f32_16x16x32_bf16 v[208:211], a[232:235], a[48:51], v[208:211]
    v_fma_f32 v252, v252, v1, v0
    v_fma_f32 v253, v253, v1, v0
    s_waitcnt lgkmcnt(5)
    v_mfma_f32_16x16x32_bf16 v[112:115], a[240:243], a[64:67], v[112:115]
    v_fma_f32 v254, v254, v1, v0
    v_mul_f32 v251, v251, v32
    v_mul_f32 v252, v252, v33
    v_mfma_f32_16x16x32_bf16 v[128:131], a[244:247], a[64:67], v[128:131]
    ds_read_b64_tr_b16 a[228:229], v240 offset:33920
    ds_read_b64_tr_b16 a[230:231], v240 offset:50816
    s_add_u32 m0, s47, 0
    s_mov_b32 s62, 0x001c0000
    v_mfma_f32_16x16x32_bf16 v[132:135], a[244:247], a[68:71], v[132:135]
    buffer_load_dwordx4 v245, s[20:23], s62 offen lds
    v_mul_f32 v253, v253, v34
    v_mfma_f32_16x16x32_bf16 v[116:119], a[240:243], a[68:71], v[116:119]
    v_exp_f32 v251, v251
    v_mfma_f32_16x16x32_bf16 v[120:123], a[240:243], a[72:75], v[120:123]
    v_exp_f32 v252, v252
    v_mul_f32 v254, v254, v35
    v_mfma_f32_16x16x32_bf16 v[136:139], a[244:247], a[72:75], v[136:139]
    ds_read_b64_tr_b16 a[232:233], v240 offset:33952
    ds_read_b64_tr_b16 a[234:235], v240 offset:50848
    s_mov_b32 s63, 0x001c1be0
    v_mfma_f32_16x16x32_bf16 v[140:143], a[244:247], a[76:79], v[140:143]
    buffer_load_dwordx4 v245, s[20:23], s63 offen offset:1056 lds
    v_mfma_f32_16x16x32_bf16 v[124:127], a[240:243], a[76:79], v[124:127]
    v_exp_f32 v253, v253
    s_waitcnt lgkmcnt(4)
    v_mfma_f32_16x16x32_bf16 v[156:159], a[248:251], a[76:79], v[156:159]
    v_exp_f32 v254, v254
    v_mfma_f32_16x16x32_bf16 v[172:175], a[224:227], a[76:79], v[172:175]
    ds_read_b64_tr_b16 a[236:237], v240 offset:33984
    ds_read_b64_tr_b16 a[238:239], v240 offset:50880
    s_mov_b32 s62, 0x001c37c0
    v_mfma_f32_16x16x32_bf16 v[168:171], a[224:227], a[72:75], v[168:171]
    buffer_load_dwordx4 v245, s[20:23], s62 offen offset:2112 lds
    v_fma_f32 v251, v251, v2, v2
    v_mfma_f32_16x16x32_bf16 v[152:155], a[248:251], a[72:75], v[152:155]
    v_rcp_f32 v251, v251
    v_mfma_f32_16x16x32_bf16 v[148:151], a[248:251], a[68:71], v[148:151]
    v_fma_f32 v252, v252, v2, v2
    v_fma_f32 v253, v253, v2, v2
    v_fma_f32 v254, v254, v2, v2
    v_mfma_f32_16x16x32_bf16 v[164:167], a[224:227], a[68:71], v[164:167]
    ds_read_b64_tr_b16 a[240:241], v240 offset:34016
    ds_read_b64_tr_b16 a[242:243], v240 offset:50912
    s_mov_b32 s63, 0x001c53a0
    v_mfma_f32_16x16x32_bf16 v[160:163], a[224:227], a[64:67], v[160:163]
    buffer_load_dwordx4 v245, s[20:23], s63 offen offset:3168 lds
    v_mul_f32 v36, v36, v32
    v_mfma_f32_16x16x32_bf16 v[144:147], a[248:251], a[64:67], v[144:147]
    v_rcp_f32 v252, v252
    s_waitcnt lgkmcnt(4)
    v_mfma_f32_16x16x32_bf16 v[176:179], a[228:231], a[64:67], v[176:179]
    s_add_u32 m0, s47, 4224
    s_mov_b32 s62, 0x001d0000
    v_mfma_f32_16x16x32_bf16 v[192:195], a[232:235], a[64:67], v[192:195]
    buffer_load_dwordx4 v245, s[20:23], s62 offen lds
    v_mul_f32 v37, v37, v33
    v_mfma_f32_16x16x32_bf16 v[196:199], a[232:235], a[68:71], v[196:199]
    v_mul_f32 v38, v38, v34
    s_mov_b32 s63, 0x001d1be0
    v_mfma_f32_16x16x32_bf16 v[180:183], a[228:231], a[68:71], v[180:183]
    buffer_load_dwordx4 v245, s[20:23], s63 offen offset:1056 lds
    v_mul_f32 v39, v39, v35
    v_mfma_f32_16x16x32_bf16 v[184:187], a[228:231], a[72:75], v[184:187]
    s_waitcnt vmcnt(14) lgkmcnt(0)
    s_barrier
    v_mul_f32 v36, v36, v251
    v_mfma_f32_16x16x32_bf16 v[200:203], a[232:235], a[72:75], v[200:203]
    ds_read_b64_tr_b16 a[244:245], v241
    ds_read_b64_tr_b16 a[246:247], v241 offset:16896
    v_mfma_f32_16x16x32_bf16 v[204:207], a[232:235], a[76:79], v[204:207]
    ds_read_b64_tr_b16 a[248:249], v241 offset:32
    ds_read_b64_tr_b16 a[250:251], v241 offset:16928
    v_mul_f32 v37, v37, v252
    v_mfma_f32_16x16x32_bf16 v[188:191], a[228:231], a[76:79], v[188:191]
    v_cvt_pk_bf16_f32 v32, v36, v37
    v_mfma_f32_16x16x32_bf16 v[220:223], a[236:239], a[76:79], v[220:223]
    v_rcp_f32 v253, v253
    v_mul_f32 v251, v40, v40
    v_mfma_f32_16x16x32_bf16 v[236:239], a[240:243], a[76:79], v[236:239]
    ds_read_b64_tr_b16 a[224:225], v241 offset:64
    ds_read_b64_tr_b16 a[226:227], v241 offset:16960
    s_mov_b32 s62, 0x001d37c0
    v_mfma_f32_16x16x32_bf16 v[232:235], a[240:243], a[72:75], v[232:235]
    buffer_load_dwordx4 v245, s[20:23], s62 offen offset:2112 lds
    v_mfma_f32_16x16x32_bf16 v[216:219], a[236:239], a[72:75], v[216:219]
    v_rcp_f32 v254, v254
    v_mul_f32 v38, v38, v253
    v_mfma_f32_16x16x32_bf16 v[212:215], a[236:239], a[68:71], v[212:215]
    v_mul_f32 v39, v39, v254
    v_mul_f32 v252, v41, v41
    ds_read_b128 a[16:19], v56 offset:4096
    v_mfma_f32_16x16x32_bf16 v[228:231], a[240:243], a[68:71], v[228:231]
    ds_read_b64_tr_b16 a[228:229], v241 offset:96
    ds_read_b64_tr_b16 a[230:231], v241 offset:16992
    s_mov_b32 s63, 0x001d53a0
    v_mfma_f32_16x16x32_bf16 v[224:227], a[240:243], a[64:67], v[224:227]
    buffer_load_dwordx4 v245, s[20:23], s63 offen offset:3168 lds
    v_cvt_pk_bf16_f32 v33, v38, v39
    v_mfma_f32_16x16x32_bf16 v[208:211], a[236:239], a[64:67], v[208:211]
    v_mul_f32 v253, v42, v42
    s_waitcnt lgkmcnt(5)
    v_mfma_f32_16x16x32_bf16 v[112:115], a[244:247], a[80:83], v[112:115]
    v_mul_f32 v254, v43, v43
    v_fma_f32 v251, v251, v1, v0
    v_fma_f32 v252, v252, v1, v0
    v_mfma_f32_16x16x32_bf16 v[128:131], a[248:251], a[80:83], v[128:131]
    ds_read_b64_tr_b16 a[232:233], v241 offset:128
    ds_read_b64_tr_b16 a[234:235], v241 offset:17024
    s_add_u32 m0, s47, 33792
    s_mov_b32 s62, 0x00200000
    v_mfma_f32_16x16x32_bf16 v[132:135], a[248:251], a[84:87], v[132:135]
    buffer_load_dwordx4 v245, s[20:23], s62 offen lds
    v_fma_f32 v253, v253, v1, v0
    v_mfma_f32_16x16x32_bf16 v[116:119], a[244:247], a[84:87], v[116:119]
    v_fma_f32 v254, v254, v1, v0
    v_mul_f32 v251, v251, v40
    v_mul_f32 v252, v252, v41
    v_mfma_f32_16x16x32_bf16 v[120:123], a[244:247], a[88:91], v[120:123]
    v_exp_f32 v251, v251
    ds_read_b128 a[20:23], v56 offset:5120
    v_mfma_f32_16x16x32_bf16 v[136:139], a[248:251], a[88:91], v[136:139]
    ds_read_b64_tr_b16 a[236:237], v241 offset:160
    ds_read_b64_tr_b16 a[238:239], v241 offset:17056
    s_mov_b32 s63, 0x00201be0
    v_mfma_f32_16x16x32_bf16 v[140:143], a[248:251], a[92:95], v[140:143]
    buffer_load_dwordx4 v245, s[20:23], s63 offen offset:1056 lds
    v_mfma_f32_16x16x32_bf16 v[124:127], a[244:247], a[92:95], v[124:127]
    v_exp_f32 v252, v252
    s_waitcnt lgkmcnt(5)
    v_mfma_f32_16x16x32_bf16 v[156:159], a[224:227], a[92:95], v[156:159]
    v_mul_f32 v253, v253, v42
    v_mul_f32 v254, v254, v43
    v_fma_f32 v251, v251, v2, v2
    v_mfma_f32_16x16x32_bf16 v[172:175], a[228:231], a[92:95], v[172:175]
    ds_read_b64_tr_b16 a[240:241], v241 offset:192
    ds_read_b64_tr_b16 a[242:243], v241 offset:17088
    s_mov_b32 s62, 0x002037c0
    v_mfma_f32_16x16x32_bf16 v[168:171], a[228:231], a[88:91], v[168:171]
    buffer_load_dwordx4 v245, s[20:23], s62 offen offset:2112 lds
    v_fma_f32 v252, v252, v2, v2
    v_mfma_f32_16x16x32_bf16 v[152:155], a[224:227], a[88:91], v[152:155]
    v_exp_f32 v253, v253
    v_mfma_f32_16x16x32_bf16 v[148:151], a[224:227], a[84:87], v[148:151]
    v_exp_f32 v254, v254
    v_fma_f32 v253, v253, v2, v2
    v_mfma_f32_16x16x32_bf16 v[164:167], a[228:231], a[84:87], v[164:167]
    ds_read_b64_tr_b16 a[244:245], v241 offset:224
    ds_read_b64_tr_b16 a[246:247], v241 offset:17120
    s_mov_b32 s63, 0x002053a0
    v_mfma_f32_16x16x32_bf16 v[160:163], a[228:231], a[80:83], v[160:163]
    buffer_load_dwordx4 v245, s[20:23], s63 offen offset:3168 lds
    v_mfma_f32_16x16x32_bf16 v[144:147], a[224:227], a[80:83], v[144:147]
    v_rcp_f32 v251, v251
    s_waitcnt lgkmcnt(4)
    v_mfma_f32_16x16x32_bf16 v[176:179], a[232:235], a[80:83], v[176:179]
    ds_read_b128 a[24:27], v57 offset:4096
    s_add_u32 m0, s47, 38016
    s_mov_b32 s62, 0x00210000
    v_mfma_f32_16x16x32_bf16 v[192:195], a[236:239], a[80:83], v[192:195]
    buffer_load_dwordx4 v245, s[20:23], s62 offen lds
    v_fma_f32 v254, v254, v2, v2
    v_mfma_f32_16x16x32_bf16 v[196:199], a[236:239], a[84:87], v[196:199]
    v_rcp_f32 v252, v252
    s_mov_b32 s63, 0x00211be0
    v_mfma_f32_16x16x32_bf16 v[180:183], a[232:235], a[84:87], v[180:183]
    buffer_load_dwordx4 v245, s[20:23], s63 offen offset:1056 lds
    v_mfma_f32_16x16x32_bf16 v[184:187], a[232:235], a[88:91], v[184:187]
    s_waitcnt vmcnt(14) lgkmcnt(0)
    s_barrier
    v_mul_f32 v44, v44, v40
    v_mfma_f32_16x16x32_bf16 v[200:203], a[236:239], a[88:91], v[200:203]
    ds_read_b64_tr_b16 a[248:249], v241 offset:33792
    ds_read_b64_tr_b16 a[250:251], v241 offset:50688
    v_mfma_f32_16x16x32_bf16 v[204:207], a[236:239], a[92:95], v[204:207]
    ds_read_b64_tr_b16 a[224:225], v241 offset:33824
    ds_read_b64_tr_b16 a[226:227], v241 offset:50720
    v_mul_f32 v45, v45, v41
    v_mfma_f32_16x16x32_bf16 v[188:191], a[232:235], a[92:95], v[188:191]
    v_rcp_f32 v253, v253
    v_mfma_f32_16x16x32_bf16 v[220:223], a[240:243], a[92:95], v[220:223]
    v_rcp_f32 v254, v254
    ds_read_b128 a[28:31], v57 offset:5120
    v_mfma_f32_16x16x32_bf16 v[236:239], a[244:247], a[92:95], v[236:239]
    ds_read_b64_tr_b16 a[228:229], v241 offset:33856
    ds_read_b64_tr_b16 a[230:231], v241 offset:50752
    s_mov_b32 s62, 0x002137c0
    v_mfma_f32_16x16x32_bf16 v[232:235], a[244:247], a[88:91], v[232:235]
    buffer_load_dwordx4 v245, s[20:23], s62 offen offset:2112 lds
    v_mfma_f32_16x16x32_bf16 v[216:219], a[240:243], a[88:91], v[216:219]
    v_mul_f32 v46, v46, v42
    v_mul_f32 v47, v47, v43
    v_mul_f32 v44, v44, v251
    v_mfma_f32_16x16x32_bf16 v[212:215], a[240:243], a[84:87], v[212:215]
    v_mul_f32 v45, v45, v252
    v_mul_f32 v46, v46, v253
    v_mul_f32 v47, v47, v254
    v_mfma_f32_16x16x32_bf16 v[228:231], a[244:247], a[84:87], v[228:231]
    ds_read_b64_tr_b16 a[232:233], v241 offset:33888
    ds_read_b64_tr_b16 a[234:235], v241 offset:50784
    s_mov_b32 s63, 0x002153a0
    v_mfma_f32_16x16x32_bf16 v[224:227], a[244:247], a[80:83], v[224:227]
    buffer_load_dwordx4 v245, s[20:23], s63 offen offset:3168 lds
    v_cvt_pk_bf16_f32 v34, v44, v45
    v_mfma_f32_16x16x32_bf16 v[208:211], a[240:243], a[80:83], v[208:211]
    v_cvt_pk_bf16_f32 v35, v46, v47
    s_waitcnt lgkmcnt(5)
    v_mfma_f32_16x16x32_bf16 v[112:115], a[248:251], a[96:99], v[112:115]
    v_add_u32 v44, s49, v248
    v_mul_f32 v251, v64, v64
    v_mul_f32 v252, v65, v65
    v_mfma_f32_16x16x32_bf16 v[128:131], a[224:227], a[96:99], v[128:131]
    ds_read_b64_tr_b16 a[236:237], v241 offset:33920
    ds_read_b64_tr_b16 a[238:239], v241 offset:50816
    s_add_u32 m0, s47, 67584
    s_mov_b32 s62, 0x00240000
    v_mfma_f32_16x16x32_bf16 v[132:135], a[224:227], a[100:103], v[132:135]
    buffer_load_dwordx4 v245, s[20:23], s62 offen lds
    v_mfma_f32_16x16x32_bf16 v[116:119], a[248:251], a[100:103], v[116:119]
    ds_write_b128 v44, v[32:35] offset:1024
    v_mul_f32 v253, v66, v66
    v_mul_f32 v254, v67, v67
    v_mfma_f32_16x16x32_bf16 v[120:123], a[248:251], a[104:107], v[120:123]
    v_fma_f32 v251, v251, v25, v24
    v_fma_f32 v252, v252, v25, v24
    ds_read_b128 a[32:35], v56 offset:8192
    v_mfma_f32_16x16x32_bf16 v[136:139], a[224:227], a[104:107], v[136:139]
    ds_read_b64_tr_b16 a[240:241], v241 offset:33952
    ds_read_b64_tr_b16 a[242:243], v241 offset:50848
    s_mov_b32 s63, 0x00241be0
    v_mfma_f32_16x16x32_bf16 v[140:143], a[224:227], a[108:111], v[140:143]
    buffer_load_dwordx4 v245, s[20:23], s63 offen offset:1056 lds
    v_fma_f32 v253, v253, v25, v24
    v_mfma_f32_16x16x32_bf16 v[124:127], a[248:251], a[108:111], v[124:127]
    v_fma_f32 v254, v254, v25, v24
    s_waitcnt lgkmcnt(6)
    v_mfma_f32_16x16x32_bf16 v[156:159], a[228:231], a[108:111], v[156:159]
    v_mul_f32 v251, v251, v64
    v_mul_f32 v252, v252, v65
    v_mul_f32 v253, v253, v66
    v_mfma_f32_16x16x32_bf16 v[172:175], a[232:235], a[108:111], v[172:175]
    ds_read_b64_tr_b16 a[244:245], v241 offset:33984
    ds_read_b64_tr_b16 a[246:247], v241 offset:50880
    s_mov_b32 s62, 0x002437c0
    v_mfma_f32_16x16x32_bf16 v[168:171], a[232:235], a[104:107], v[168:171]
    buffer_load_dwordx4 v245, s[20:23], s62 offen offset:2112 lds
    v_mul_f32 v254, v254, v67
    v_mfma_f32_16x16x32_bf16 v[152:155], a[228:231], a[104:107], v[152:155]
    v_exp_f32 v251, v251
    v_mul_f32 v68, v68, v64
    v_mfma_f32_16x16x32_bf16 v[148:151], a[228:231], a[100:103], v[148:151]
    v_exp_f32 v252, v252
    ds_read_b128 a[36:39], v56 offset:9216
    v_mfma_f32_16x16x32_bf16 v[164:167], a[232:235], a[100:103], v[164:167]
    ds_read_b64_tr_b16 a[248:249], v241 offset:34016
    ds_read_b64_tr_b16 a[250:251], v241 offset:50912
    s_mov_b32 s63, 0x002453a0
    v_mfma_f32_16x16x32_bf16 v[160:163], a[232:235], a[96:99], v[160:163]
    buffer_load_dwordx4 v245, s[20:23], s63 offen offset:3168 lds
    v_mfma_f32_16x16x32_bf16 v[144:147], a[228:231], a[96:99], v[144:147]
    v_exp_f32 v253, v253
    s_waitcnt lgkmcnt(5)
    v_mfma_f32_16x16x32_bf16 v[176:179], a[236:239], a[96:99], v[176:179]
    v_fma_f32 v251, v251, v26, v26
    s_add_u32 m0, s47, 71808
    s_mov_b32 s62, 0x00250000
    v_mfma_f32_16x16x32_bf16 v[192:195], a[240:243], a[96:99], v[192:195]
    buffer_load_dwordx4 v245, s[20:23], s62 offen lds
    v_mfma_f32_16x16x32_bf16 v[196:199], a[240:243], a[100:103], v[196:199]
    v_exp_f32 v254, v254
    s_mov_b32 s63, 0x00251be0
    v_mfma_f32_16x16x32_bf16 v[180:183], a[236:239], a[100:103], v[180:183]
    buffer_load_dwordx4 v245, s[20:23], s63 offen offset:1056 lds
    v_mfma_f32_16x16x32_bf16 v[184:187], a[236:239], a[104:107], v[184:187]
    s_waitcnt vmcnt(14) lgkmcnt(0)
    s_barrier
    v_fma_f32 v252, v252, v26, v26
    v_mfma_f32_16x16x32_bf16 v[200:203], a[240:243], a[104:107], v[200:203]
    ds_read_b64_tr_b16 a[224:225], v240
    ds_read_b64_tr_b16 a[226:227], v240 offset:16896
    v_fma_f32 v253, v253, v26, v26
    v_mfma_f32_16x16x32_bf16 v[204:207], a[240:243], a[108:111], v[204:207]
    ds_read_b64_tr_b16 a[228:229], v240 offset:32
    ds_read_b64_tr_b16 a[230:231], v240 offset:16928
    v_mfma_f32_16x16x32_bf16 v[188:191], a[236:239], a[108:111], v[188:191]
    v_rcp_f32 v251, v251
    v_mfma_f32_16x16x32_bf16 v[220:223], a[244:247], a[108:111], v[220:223]
    v_rcp_f32 v252, v252
    ds_read_b128 a[40:43], v57 offset:8192
    v_mfma_f32_16x16x32_bf16 v[236:239], a[248:251], a[108:111], v[236:239]
    ds_read_b64_tr_b16 a[232:233], v240 offset:64
    ds_read_b64_tr_b16 a[234:235], v240 offset:16960
    s_mov_b32 s62, 0x002537c0
    v_mfma_f32_16x16x32_bf16 v[232:235], a[248:251], a[104:107], v[232:235]
    buffer_load_dwordx4 v245, s[20:23], s62 offen offset:2112 lds
    v_fma_f32 v254, v254, v26, v26
    v_mfma_f32_16x16x32_bf16 v[216:219], a[244:247], a[104:107], v[216:219]
    v_rcp_f32 v253, v253
    v_mfma_f32_16x16x32_bf16 v[212:215], a[244:247], a[100:103], v[212:215]
    v_rcp_f32 v254, v254
    v_mul_f32 v69, v69, v65
    v_mfma_f32_16x16x32_bf16 v[228:231], a[248:251], a[100:103], v[228:231]
    ds_read_b64_tr_b16 a[236:237], v240 offset:96
    ds_read_b64_tr_b16 a[238:239], v240 offset:16992
    s_mov_b32 s63, 0x002553a0
    v_mfma_f32_16x16x32_bf16 v[224:227], a[248:251], a[96:99], v[224:227]
    buffer_load_dwordx4 v245, s[20:23], s63 offen offset:3168 lds
    v_mul_f32 v70, v70, v66
    v_mfma_f32_16x16x32_bf16 v[208:211], a[244:247], a[96:99], v[208:211]
    v_mul_f32 v71, v71, v67
    v_mul_f32 v68, v68, v251
    s_waitcnt lgkmcnt(5)
    v_mfma_f32_16x16x32_bf16 v[112:115], a[224:227], a[112:115], v[112:115]
    v_mul_f32 v69, v69, v252
    v_mul_f32 v70, v70, v253
    ds_read_b128 a[44:47], v57 offset:9216
    v_mfma_f32_16x16x32_bf16 v[128:131], a[228:231], a[112:115], v[128:131]
    ds_read_b64_tr_b16 a[240:241], v240 offset:128
    ds_read_b64_tr_b16 a[242:243], v240 offset:17024
    s_add_u32 m0, s47, 101376
    s_mov_b32 s62, 0x00280000
    v_mfma_f32_16x16x32_bf16 v[132:135], a[228:231], a[116:119], v[132:135]
    buffer_load_dwordx4 v245, s[20:23], s62 offen lds
    v_mfma_f32_16x16x32_bf16 v[116:119], a[224:227], a[116:119], v[116:119]
    v_mul_f32 v71, v71, v254
    v_cvt_pk_bf16_f32 v64, v68, v69
    v_mul_f32 v251, v72, v72
    v_mfma_f32_16x16x32_bf16 v[120:123], a[224:227], a[120:123], v[120:123]
    v_cvt_pk_bf16_f32 v65, v70, v71
    v_mul_f32 v252, v73, v73
    v_mul_f32 v253, v74, v74
    v_mfma_f32_16x16x32_bf16 v[136:139], a[228:231], a[120:123], v[136:139]
    ds_read_b64_tr_b16 a[244:245], v240 offset:160
    ds_read_b64_tr_b16 a[246:247], v240 offset:17056
    s_mov_b32 s63, 0x00281be0
    v_mfma_f32_16x16x32_bf16 v[140:143], a[228:231], a[124:127], v[140:143]
    buffer_load_dwordx4 v245, s[20:23], s63 offen offset:1056 lds
    v_mul_f32 v254, v75, v75
    v_mfma_f32_16x16x32_bf16 v[124:127], a[224:227], a[124:127], v[124:127]
    v_fma_f32 v251, v251, v25, v24
    s_waitcnt lgkmcnt(5)
    v_mfma_f32_16x16x32_bf16 v[156:159], a[232:235], a[124:127], v[156:159]
    v_fma_f32 v252, v252, v25, v24
    v_fma_f32 v253, v253, v25, v24
    v_fma_f32 v254, v254, v25, v24
    v_mfma_f32_16x16x32_bf16 v[172:175], a[236:239], a[124:127], v[172:175]
    ds_read_b64_tr_b16 a[248:249], v240 offset:192
    ds_read_b64_tr_b16 a[250:251], v240 offset:17088
    s_mov_b32 s62, 0x002837c0
    v_mfma_f32_16x16x32_bf16 v[168:171], a[236:239], a[120:123], v[168:171]
    buffer_load_dwordx4 v245, s[20:23], s62 offen offset:2112 lds
    v_mfma_f32_16x16x32_bf16 v[152:155], a[232:235], a[120:123], v[152:155]
    v_mul_f32 v251, v251, v72
    v_mul_f32 v252, v252, v73
    v_mul_f32 v253, v253, v74
    v_mfma_f32_16x16x32_bf16 v[148:151], a[232:235], a[116:119], v[148:151]
    v_exp_f32 v251, v251
    ds_read_b128 a[48:51], v56 offset:12288
    v_mfma_f32_16x16x32_bf16 v[164:167], a[236:239], a[116:119], v[164:167]
    ds_read_b64_tr_b16 a[224:225], v240 offset:224
    ds_read_b64_tr_b16 a[226:227], v240 offset:17120
    s_mov_b32 s63, 0x002853a0
    v_mfma_f32_16x16x32_bf16 v[160:163], a[236:239], a[112:115], v[160:163]
    buffer_load_dwordx4 v245, s[20:23], s63 offen offset:3168 lds
    v_mul_f32 v254, v254, v75
    v_mfma_f32_16x16x32_bf16 v[144:147], a[232:235], a[112:115], v[144:147]
    v_fma_f32 v251, v251, v26, v26
    s_waitcnt lgkmcnt(5)
    v_mfma_f32_16x16x32_bf16 v[176:179], a[240:243], a[112:115], v[176:179]
    v_mul_f32 v76, v76, v72
    s_add_u32 m0, s47, 105600
    s_mov_b32 s62, 0x00290000
    v_mfma_f32_16x16x32_bf16 v[192:195], a[244:247], a[112:115], v[192:195]
    buffer_load_dwordx4 v245, s[20:23], s62 offen lds
    v_mfma_f32_16x16x32_bf16 v[196:199], a[244:247], a[116:119], v[196:199]
    v_exp_f32 v252, v252
    s_mov_b32 s63, 0x00291be0
    v_mfma_f32_16x16x32_bf16 v[180:183], a[240:243], a[116:119], v[180:183]
    buffer_load_dwordx4 v245, s[20:23], s63 offen offset:1056 lds
    v_fma_f32 v252, v252, v26, v26
    v_mfma_f32_16x16x32_bf16 v[184:187], a[240:243], a[120:123], v[184:187]
    s_waitcnt vmcnt(14) lgkmcnt(0)
    s_barrier
    ds_read_b128 a[52:55], v56 offset:13312
    v_mfma_f32_16x16x32_bf16 v[200:203], a[244:247], a[120:123], v[200:203]
    ds_read_b64_tr_b16 a[228:229], v240 offset:33792
    ds_read_b64_tr_b16 a[230:231], v240 offset:50688
    v_mul_f32 v77, v77, v73
    v_mfma_f32_16x16x32_bf16 v[204:207], a[244:247], a[124:127], v[204:207]
    ds_read_b64_tr_b16 a[232:233], v240 offset:33824
    ds_read_b64_tr_b16 a[234:235], v240 offset:50720
    v_mfma_f32_16x16x32_bf16 v[188:191], a[240:243], a[124:127], v[188:191]
    v_exp_f32 v253, v253
    v_mfma_f32_16x16x32_bf16 v[220:223], a[248:251], a[124:127], v[220:223]
    v_exp_f32 v254, v254
    v_fma_f32 v253, v253, v26, v26
    v_mfma_f32_16x16x32_bf16 v[236:239], a[224:227], a[124:127], v[236:239]
    ds_read_b64_tr_b16 a[236:237], v240 offset:33856
    ds_read_b64_tr_b16 a[238:239], v240 offset:50752
    s_mov_b32 s62, 0x002937c0
    v_mfma_f32_16x16x32_bf16 v[232:235], a[224:227], a[120:123], v[232:235]
    buffer_load_dwordx4 v245, s[20:23], s62 offen offset:2112 lds
    v_fma_f32 v254, v254, v26, v26
    v_mfma_f32_16x16x32_bf16 v[216:219], a[248:251], a[120:123], v[216:219]
    v_rcp_f32 v251, v251
    v_mfma_f32_16x16x32_bf16 v[212:215], a[248:251], a[116:119], v[212:215]
    v_rcp_f32 v252, v252
    v_mul_f32 v78, v78, v74
    v_mfma_f32_16x16x32_bf16 v[228:231], a[224:227], a[116:119], v[228:231]
    ds_read_b64_tr_b16 a[240:241], v240 offset:33888
    ds_read_b64_tr_b16 a[242:243], v240 offset:50784
    s_mov_b32 s63, 0x002953a0
    v_mfma_f32_16x16x32_bf16 v[224:227], a[224:227], a[112:115], v[224:227]
    buffer_load_dwordx4 v245, s[20:23], s63 offen offset:3168 lds
    v_mfma_f32_16x16x32_bf16 v[208:211], a[248:251], a[112:115], v[208:211]
    v_rcp_f32 v253, v253
    s_waitcnt lgkmcnt(4)
    v_mfma_f32_16x16x32_bf16 v[112:115], a[228:231], a[128:131], v[112:115]
    v_rcp_f32 v254, v254
    ds_read_b128 a[56:59], v57 offset:12288
    v_mfma_f32_16x16x32_bf16 v[128:131], a[232:235], a[128:131], v[128:131]
    ds_read_b64_tr_b16 a[244:245], v240 offset:33920
    ds_read_b64_tr_b16 a[246:247], v240 offset:50816
    s_add_u32 m0, s47, 0
    s_mov_b32 s62, 0x002c0000
    v_mfma_f32_16x16x32_bf16 v[132:135], a[232:235], a[132:135], v[132:135]
    buffer_load_dwordx4 v245, s[20:23], s62 offen lds
    v_mul_f32 v79, v79, v75
    v_mfma_f32_16x16x32_bf16 v[116:119], a[228:231], a[132:135], v[116:119]
    v_mul_f32 v76, v76, v251
    v_mul_f32 v77, v77, v252
    v_mfma_f32_16x16x32_bf16 v[120:123], a[228:231], a[136:139], v[120:123]
    v_mul_f32 v78, v78, v253
    v_mul_f32 v79, v79, v254
    v_cvt_pk_bf16_f32 v66, v76, v77
    v_mfma_f32_16x16x32_bf16 v[136:139], a[232:235], a[136:139], v[136:139]
    ds_read_b64_tr_b16 a[248:249], v240 offset:33952
    ds_read_b64_tr_b16 a[250:251], v240 offset:50848
    s_mov_b32 s63, 0x002c1be0
    v_mfma_f32_16x16x32_bf16 v[140:143], a[232:235], a[140:143], v[140:143]
    buffer_load_dwordx4 v245, s[20:23], s63 offen offset:1056 lds
    v_cvt_pk_bf16_f32 v67, v78, v79
    v_mfma_f32_16x16x32_bf16 v[124:127], a[228:231], a[140:143], v[124:127]
    v_add_u32 v76, s49, v249
    v_mul_f32 v251, v96, v96
    s_waitcnt lgkmcnt(5)
    v_mfma_f32_16x16x32_bf16 v[156:159], a[236:239], a[140:143], v[156:159]
    ds_write_b128 v76, v[64:67]
    v_mul_f32 v252, v97, v97
    ds_read_b128 a[60:63], v57 offset:13312
    v_mfma_f32_16x16x32_bf16 v[172:175], a[240:243], a[140:143], v[172:175]
    ds_read_b64_tr_b16 a[224:225], v240 offset:33984
    ds_read_b64_tr_b16 a[226:227], v240 offset:50880
    s_mov_b32 s62, 0x002c37c0
    v_mfma_f32_16x16x32_bf16 v[168:171], a[240:243], a[136:139], v[168:171]
    buffer_load_dwordx4 v245, s[20:23], s62 offen offset:2112 lds
    v_mfma_f32_16x16x32_bf16 v[152:155], a[236:239], a[136:139], v[152:155]
    v_mul_f32 v253, v98, v98
    v_mul_f32 v254, v99, v99
    v_fma_f32 v251, v251, v53, v52
    v_mfma_f32_16x16x32_bf16 v[148:151], a[236:239], a[132:135], v[148:151]
    v_fma_f32 v252, v252, v53, v52
    v_fma_f32 v253, v253, v53, v52
    v_fma_f32 v254, v254, v53, v52
    v_mfma_f32_16x16x32_bf16 v[164:167], a[240:243], a[132:135], v[164:167]
    ds_read_b64_tr_b16 a[228:229], v240 offset:34016
    ds_read_b64_tr_b16 a[230:231], v240 offset:50912
    s_mov_b32 s63, 0x002c53a0
    v_mfma_f32_16x16x32_bf16 v[160:163], a[240:243], a[128:131], v[160:163]
    buffer_load_dwordx4 v245, s[20:23], s63 offen offset:3168 lds
    v_mul_f32 v251, v251, v96
    v_mfma_f32_16x16x32_bf16 v[144:147], a[236:239], a[128:131], v[144:147]
    v_mul_f32 v252, v252, v97
    s_waitcnt lgkmcnt(6)
    v_mfma_f32_16x16x32_bf16 v[176:179], a[244:247], a[128:131], v[176:179]
    v_mul_f32 v253, v253, v98
    s_add_u32 m0, s47, 4224
    s_mov_b32 s62, 0x002d0000
    v_mfma_f32_16x16x32_bf16 v[192:195], a[248:251], a[128:131], v[192:195]
    buffer_load_dwordx4 v245, s[20:23], s62 offen lds
    v_mul_f32 v254, v254, v99
    v_mfma_f32_16x16x32_bf16 v[196:199], a[248:251], a[132:135], v[196:199]
    v_mul_f32 v100, v100, v96
    s_mov_b32 s63, 0x002d1be0
    v_mfma_f32_16x16x32_bf16 v[180:183], a[244:247], a[132:135], v[180:183]
    buffer_load_dwordx4 v245, s[20:23], s63 offen offset:1056 lds
    v_mul_f32 v101, v101, v97
    v_mfma_f32_16x16x32_bf16 v[184:187], a[244:247], a[136:139], v[184:187]
    s_waitcnt vmcnt(14) lgkmcnt(0)
    s_barrier
    v_mfma_f32_16x16x32_bf16 v[200:203], a[248:251], a[136:139], v[200:203]
    ds_read_b64_tr_b16 a[232:233], v241
    ds_read_b64_tr_b16 a[234:235], v241 offset:16896
    v_mul_f32 v102, v102, v98
    v_mfma_f32_16x16x32_bf16 v[204:207], a[248:251], a[140:143], v[204:207]
    ds_read_b64_tr_b16 a[236:237], v241 offset:32
    ds_read_b64_tr_b16 a[238:239], v241 offset:16928
    v_mul_f32 v103, v103, v99
    v_mfma_f32_16x16x32_bf16 v[188:191], a[244:247], a[140:143], v[188:191]
    v_mfma_f32_16x16x32_bf16 v[220:223], a[224:227], a[140:143], v[220:223]
    v_exp_f32 v251, v251
    v_mfma_f32_16x16x32_bf16 v[236:239], a[228:231], a[140:143], v[236:239]
    ds_read_b64_tr_b16 a[240:241], v241 offset:64
    ds_read_b64_tr_b16 a[242:243], v241 offset:16960
    s_mov_b32 s62, 0x002d37c0
    v_mfma_f32_16x16x32_bf16 v[232:235], a[228:231], a[136:139], v[232:235]
    buffer_load_dwordx4 v245, s[20:23], s62 offen offset:2112 lds
    v_fma_f32 v251, v251, v54, v54
    v_mfma_f32_16x16x32_bf16 v[216:219], a[224:227], a[136:139], v[216:219]
    v_exp_f32 v252, v252
    v_mfma_f32_16x16x32_bf16 v[212:215], a[224:227], a[132:135], v[212:215]
    v_exp_f32 v253, v253
    v_mfma_f32_16x16x32_bf16 v[228:231], a[228:231], a[132:135], v[228:231]
    ds_read_b64_tr_b16 a[244:245], v241 offset:96
    ds_read_b64_tr_b16 a[246:247], v241 offset:16992
    s_mov_b32 s63, 0x002d53a0
    v_mfma_f32_16x16x32_bf16 v[224:227], a[228:231], a[128:131], v[224:227]
    buffer_load_dwordx4 v245, s[20:23], s63 offen offset:3168 lds
    v_mfma_f32_16x16x32_bf16 v[208:211], a[224:227], a[128:131], v[208:211]
    v_exp_f32 v254, v254
    s_waitcnt lgkmcnt(4)
    v_mfma_f32_16x16x32_bf16 v[112:115], a[232:235], a[144:147], v[112:115]
    v_rcp_f32 v251, v251
    v_fma_f32 v252, v252, v54, v54
    v_mfma_f32_16x16x32_bf16 v[128:131], a[236:239], a[144:147], v[128:131]
    ds_read_b64_tr_b16 a[248:249], v241 offset:128
    ds_read_b64_tr_b16 a[250:251], v241 offset:17024
    s_add_u32 m0, s47, 33792
    s_mov_b32 s62, 0x00300000
    v_mfma_f32_16x16x32_bf16 v[132:135], a[236:239], a[148:151], v[132:135]
    buffer_load_dwordx4 v245, s[20:23], s62 offen lds
    v_fma_f32 v253, v253, v54, v54
    v_mfma_f32_16x16x32_bf16 v[116:119], a[232:235], a[148:151], v[116:119]
    v_rcp_f32 v252, v252
    v_mfma_f32_16x16x32_bf16 v[120:123], a[232:235], a[152:155], v[120:123]
    v_rcp_f32 v253, v253
    v_fma_f32 v254, v254, v54, v54
    v_mfma_f32_16x16x32_bf16 v[136:139], a[236:239], a[152:155], v[136:139]
    ds_read_b64_tr_b16 a[224:225], v241 offset:160
    ds_read_b64_tr_b16 a[226:227], v241 offset:17056
    s_mov_b32 s63, 0x00301be0
    v_mfma_f32_16x16x32_bf16 v[140:143], a[236:239], a[156:159], v[140:143]
    buffer_load_dwordx4 v245, s[20:23], s63 offen offset:1056 lds
    v_mfma_f32_16x16x32_bf16 v[124:127], a[232:235], a[156:159], v[124:127]
    v_rcp_f32 v254, v254
    s_waitcnt lgkmcnt(4)
    v_mfma_f32_16x16x32_bf16 v[156:159], a[240:243], a[156:159], v[156:159]
    v_mul_f32 v100, v100, v251
    v_mul_f32 v101, v101, v252
    v_mfma_f32_16x16x32_bf16 v[172:175], a[244:247], a[156:159], v[172:175]
    ds_read_b64_tr_b16 a[228:229], v241 offset:192
    ds_read_b64_tr_b16 a[230:231], v241 offset:17088
    s_mov_b32 s62, 0x003037c0
    v_mfma_f32_16x16x32_bf16 v[168:171], a[244:247], a[152:155], v[168:171]
    buffer_load_dwordx4 v245, s[20:23], s62 offen offset:2112 lds
    v_mul_f32 v102, v102, v253
    v_mfma_f32_16x16x32_bf16 v[152:155], a[240:243], a[152:155], v[152:155]
    v_mul_f32 v103, v103, v254
    v_cvt_pk_bf16_f32 v96, v100, v101
    v_mfma_f32_16x16x32_bf16 v[148:151], a[240:243], a[148:151], v[148:151]
    v_cvt_pk_bf16_f32 v97, v102, v103
    v_mul_f32 v251, v104, v104
    v_mul_f32 v252, v105, v105
    v_mfma_f32_16x16x32_bf16 v[164:167], a[244:247], a[148:151], v[164:167]
    ds_read_b64_tr_b16 a[232:233], v241 offset:224
    ds_read_b64_tr_b16 a[234:235], v241 offset:17120
    s_mov_b32 s63, 0x003053a0
    v_mfma_f32_16x16x32_bf16 v[160:163], a[244:247], a[144:147], v[160:163]
    buffer_load_dwordx4 v245, s[20:23], s63 offen offset:3168 lds
    v_mul_f32 v253, v106, v106
    v_mfma_f32_16x16x32_bf16 v[144:147], a[240:243], a[144:147], v[144:147]
    v_mul_f32 v254, v107, v107
    v_fma_f32 v251, v251, v53, v52
    s_waitcnt lgkmcnt(4)
    v_mfma_f32_16x16x32_bf16 v[176:179], a[248:251], a[144:147], v[176:179]
    s_add_u32 m0, s47, 38016
    s_mov_b32 s62, 0x00310000
    v_mfma_f32_16x16x32_bf16 v[192:195], a[224:227], a[144:147], v[192:195]
    buffer_load_dwordx4 v245, s[20:23], s62 offen lds
    v_fma_f32 v252, v252, v53, v52
    v_mfma_f32_16x16x32_bf16 v[196:199], a[224:227], a[148:151], v[196:199]
    v_fma_f32 v253, v253, v53, v52
    s_mov_b32 s63, 0x00311be0
    v_mfma_f32_16x16x32_bf16 v[180:183], a[248:251], a[148:151], v[180:183]
    buffer_load_dwordx4 v245, s[20:23], s63 offen offset:1056 lds
    v_fma_f32 v254, v254, v53, v52
    v_mfma_f32_16x16x32_bf16 v[184:187], a[248:251], a[152:155], v[184:187]
    s_waitcnt vmcnt(14) lgkmcnt(0)
    s_barrier
    v_mul_f32 v251, v251, v104
    v_mfma_f32_16x16x32_bf16 v[200:203], a[224:227], a[152:155], v[200:203]
    ds_read_b64_tr_b16 a[236:237], v241 offset:33792
    ds_read_b64_tr_b16 a[238:239], v241 offset:50688
    v_mfma_f32_16x16x32_bf16 v[204:207], a[224:227], a[156:159], v[204:207]
    ds_read_b64_tr_b16 a[240:241], v241 offset:33824
    ds_read_b64_tr_b16 a[242:243], v241 offset:50720
    v_mul_f32 v252, v252, v105
    v_mfma_f32_16x16x32_bf16 v[188:191], a[248:251], a[156:159], v[188:191]
    v_mul_f32 v253, v253, v106
    v_mfma_f32_16x16x32_bf16 v[220:223], a[228:231], a[156:159], v[220:223]
    v_exp_f32 v251, v251
    v_mul_f32 v254, v254, v107
    v_mfma_f32_16x16x32_bf16 v[236:239], a[232:235], a[156:159], v[236:239]
    ds_read_b64_tr_b16 a[244:245], v241 offset:33856
    ds_read_b64_tr_b16 a[246:247], v241 offset:50752
    s_mov_b32 s62, 0x003137c0
    v_mfma_f32_16x16x32_bf16 v[232:235], a[232:235], a[152:155], v[232:235]
    buffer_load_dwordx4 v245, s[20:23], s62 offen offset:2112 lds
    v_mfma_f32_16x16x32_bf16 v[216:219], a[228:231], a[152:155], v[216:219]
    v_exp_f32 v252, v252
    v_fma_f32 v251, v251, v54, v54
    v_mfma_f32_16x16x32_bf16 v[212:215], a[228:231], a[148:151], v[212:215]
    v_exp_f32 v253, v253
    v_mfma_f32_16x16x32_bf16 v[228:231], a[232:235], a[148:151], v[228:231]
    ds_read_b64_tr_b16 a[248:249], v241 offset:33888
    ds_read_b64_tr_b16 a[250:251], v241 offset:50784
    s_mov_b32 s63, 0x003153a0
    v_mfma_f32_16x16x32_bf16 v[224:227], a[232:235], a[144:147], v[224:227]
    buffer_load_dwordx4 v245, s[20:23], s63 offen offset:3168 lds
    v_fma_f32 v252, v252, v54, v54
    v_mfma_f32_16x16x32_bf16 v[208:211], a[228:231], a[144:147], v[208:211]
    v_fma_f32 v253, v253, v54, v54
    s_waitcnt lgkmcnt(4)
    v_mfma_f32_16x16x32_bf16 v[112:115], a[236:239], a[160:163], v[112:115]
    v_exp_f32 v254, v254
    v_mul_f32 v108, v108, v104
    v_mfma_f32_16x16x32_bf16 v[128:131], a[240:243], a[160:163], v[128:131]
    ds_read_b64_tr_b16 a[224:225], v241 offset:33920
    ds_read_b64_tr_b16 a[226:227], v241 offset:50816
    s_add_u32 m0, s47, 67584
    s_mov_b32 s62, 0x00340000
    v_mfma_f32_16x16x32_bf16 v[132:135], a[240:243], a[164:167], v[132:135]
    buffer_load_dwordx4 v245, s[20:23], s62 offen lds
    v_fma_f32 v254, v254, v54, v54
    v_mfma_f32_16x16x32_bf16 v[116:119], a[236:239], a[164:167], v[116:119]
    v_rcp_f32 v251, v251
    v_mul_f32 v109, v109, v105
    v_mfma_f32_16x16x32_bf16 v[120:123], a[236:239], a[168:171], v[120:123]
    v_rcp_f32 v252, v252
    v_mfma_f32_16x16x32_bf16 v[136:139], a[240:243], a[168:171], v[136:139]
    ds_read_b64_tr_b16 a[228:229], v241 offset:33952
    ds_read_b64_tr_b16 a[230:231], v241 offset:50848
    s_mov_b32 s63, 0x00341be0
    v_mfma_f32_16x16x32_bf16 v[140:143], a[240:243], a[172:175], v[140:143]
    buffer_load_dwordx4 v245, s[20:23], s63 offen offset:1056 lds
    v_mfma_f32_16x16x32_bf16 v[124:127], a[236:239], a[172:175], v[124:127]
    v_rcp_f32 v253, v253
    s_waitcnt lgkmcnt(4)
    v_mfma_f32_16x16x32_bf16 v[156:159], a[244:247], a[172:175], v[156:159]
    v_rcp_f32 v254, v254
    v_mul_f32 v110, v110, v106
    v_mfma_f32_16x16x32_bf16 v[172:175], a[248:251], a[172:175], v[172:175]
    ds_read_b64_tr_b16 a[232:233], v241 offset:33984
    ds_read_b64_tr_b16 a[234:235], v241 offset:50880
    s_mov_b32 s62, 0x003437c0
    v_mfma_f32_16x16x32_bf16 v[168:171], a[248:251], a[168:171], v[168:171]
    buffer_load_dwordx4 v245, s[20:23], s62 offen offset:2112 lds
    v_mul_f32 v111, v111, v107
    v_mfma_f32_16x16x32_bf16 v[152:155], a[244:247], a[168:171], v[152:155]
    v_mul_f32 v108, v108, v251
    v_mul_f32 v109, v109, v252
    v_mfma_f32_16x16x32_bf16 v[148:151], a[244:247], a[164:167], v[148:151]
    v_mul_f32 v110, v110, v253
    v_mul_f32 v111, v111, v254
    v_cvt_pk_bf16_f32 v98, v108, v109
    v_mfma_f32_16x16x32_bf16 v[164:167], a[248:251], a[164:167], v[164:167]
    ds_read_b64_tr_b16 a[236:237], v241 offset:34016
    ds_read_b64_tr_b16 a[238:239], v241 offset:50912
    s_mov_b32 s63, 0x003453a0
    v_mfma_f32_16x16x32_bf16 v[160:163], a[248:251], a[160:163], v[160:163]
    buffer_load_dwordx4 v245, s[20:23], s63 offen offset:3168 lds
    v_mfma_f32_16x16x32_bf16 v[144:147], a[244:247], a[160:163], v[144:147]
    v_cvt_pk_bf16_f32 v99, v110, v111
    v_add_u32 v108, s49, v249
    s_waitcnt lgkmcnt(4)
    v_mfma_f32_16x16x32_bf16 v[176:179], a[224:227], a[160:163], v[176:179]
    s_add_u32 m0, s47, 71808
    s_mov_b32 s62, 0x00350000
    v_mfma_f32_16x16x32_bf16 v[192:195], a[228:231], a[160:163], v[192:195]
    buffer_load_dwordx4 v245, s[20:23], s62 offen lds
    ds_write_b128 v108, v[96:99] offset:1024
    v_mfma_f32_16x16x32_bf16 v[196:199], a[228:231], a[164:167], v[196:199]
    s_mov_b32 s63, 0x00351be0
    v_mfma_f32_16x16x32_bf16 v[180:183], a[224:227], a[164:167], v[180:183]
    buffer_load_dwordx4 v245, s[20:23], s63 offen offset:1056 lds
    v_mfma_f32_16x16x32_bf16 v[184:187], a[224:227], a[168:171], v[184:187]
    s_waitcnt vmcnt(14) lgkmcnt(0)
    s_barrier
    v_mfma_f32_16x16x32_bf16 v[200:203], a[228:231], a[168:171], v[200:203]
    ds_read_b64_tr_b16 a[240:241], v240
    ds_read_b64_tr_b16 a[242:243], v240 offset:16896
    v_mfma_f32_16x16x32_bf16 v[204:207], a[228:231], a[172:175], v[204:207]
    ds_read_b64_tr_b16 a[244:245], v240 offset:32
    ds_read_b64_tr_b16 a[246:247], v240 offset:16928
    v_mfma_f32_16x16x32_bf16 v[188:191], a[224:227], a[172:175], v[188:191]
    ds_read_b128 a[64:67], v56 offset:16384
    v_mfma_f32_16x16x32_bf16 v[220:223], a[232:235], a[172:175], v[220:223]
    ds_read_b128 a[68:71], v56 offset:17408
    ds_read_b128 a[72:75], v57 offset:16384
    v_mfma_f32_16x16x32_bf16 v[236:239], a[236:239], a[172:175], v[236:239]
    ds_read_b64_tr_b16 a[248:249], v240 offset:64
    ds_read_b64_tr_b16 a[250:251], v240 offset:16960
    s_mov_b32 s62, 0x003537c0
    v_mfma_f32_16x16x32_bf16 v[232:235], a[236:239], a[168:171], v[232:235]
    buffer_load_dwordx4 v245, s[20:23], s62 offen offset:2112 lds
    v_mfma_f32_16x16x32_bf16 v[216:219], a[232:235], a[168:171], v[216:219]
    ds_read_b128 a[76:79], v57 offset:17408
    ds_read_b128 a[80:83], v56 offset:20480
    v_mfma_f32_16x16x32_bf16 v[212:215], a[232:235], a[164:167], v[212:215]
    ds_read_b128 a[84:87], v56 offset:21504
    ds_read_b128 a[88:91], v57 offset:20480
    v_mfma_f32_16x16x32_bf16 v[228:231], a[236:239], a[164:167], v[228:231]
    ds_read_b64_tr_b16 a[224:225], v240 offset:96
    ds_read_b64_tr_b16 a[226:227], v240 offset:16992
    s_mov_b32 s63, 0x003553a0
    v_mfma_f32_16x16x32_bf16 v[224:227], a[236:239], a[160:163], v[224:227]
    buffer_load_dwordx4 v245, s[20:23], s63 offen offset:3168 lds
    v_mfma_f32_16x16x32_bf16 v[208:211], a[232:235], a[160:163], v[208:211]
    ds_read_b128 a[92:95], v57 offset:21504
    s_waitcnt lgkmcnt(12)
    v_mfma_f32_16x16x32_bf16 v[112:115], a[240:243], a[176:179], v[112:115]
    ds_read_b128 a[96:99], v56 offset:24576
    ds_read_b128 a[100:103], v56 offset:25600
    v_mfma_f32_16x16x32_bf16 v[128:131], a[244:247], a[176:179], v[128:131]
    ds_read_b64_tr_b16 a[228:229], v240 offset:128
    ds_read_b64_tr_b16 a[230:231], v240 offset:17024
    s_add_u32 m0, s47, 101376
    s_mov_b32 s62, 0x00000200
    v_mfma_f32_16x16x32_bf16 v[132:135], a[244:247], a[180:183], v[132:135]
    buffer_load_dwordx4 v246, s[32:35], s62 offen lds
    v_mfma_f32_16x16x32_bf16 v[116:119], a[240:243], a[180:183], v[116:119]
    ds_read_b128 a[104:107], v57 offset:24576
    ds_read_b128 a[108:111], v57 offset:25600
    v_mfma_f32_16x16x32_bf16 v[120:123], a[240:243], a[184:187], v[120:123]
    ds_read_b128 a[112:115], v56
    ds_read_b128 a[116:119], v56 offset:1024
    v_mfma_f32_16x16x32_bf16 v[136:139], a[244:247], a[184:187], v[136:139]
    ds_read_b64_tr_b16 a[232:233], v240 offset:160
    ds_read_b64_tr_b16 a[234:235], v240 offset:17056
    s_mov_b32 s63, 0x00000160
    v_mfma_f32_16x16x32_bf16 v[140:143], a[244:247], a[188:191], v[140:143]
    buffer_load_dwordx4 v246, s[32:35], s63 offen offset:1056 lds
    v_mfma_f32_16x16x32_bf16 v[124:127], a[240:243], a[188:191], v[124:127]
    ds_read_b128 a[120:123], v57
    s_waitcnt lgkmcnt(12)
    v_mfma_f32_16x16x32_bf16 v[156:159], a[248:251], a[188:191], v[156:159]
    ds_read_b128 a[124:127], v57 offset:1024
    v_accvgpr_read_b32 v242, a252
    v_mfma_f32_16x16x32_bf16 v[172:175], a[224:227], a[188:191], v[172:175]
    ds_read_b64_tr_b16 a[236:237], v240 offset:192
    ds_read_b64_tr_b16 a[238:239], v240 offset:17088
    s_mov_b32 s62, 0x000000c0
    v_mfma_f32_16x16x32_bf16 v[168:171], a[224:227], a[184:187], v[168:171]
    buffer_load_dwordx4 v246, s[32:35], s62 offen offset:2112 lds
    v_mfma_f32_16x16x32_bf16 v[152:155], a[248:251], a[184:187], v[152:155]
    v_rcp_f32 v242, v242
    v_mfma_f32_16x16x32_bf16 v[148:151], a[248:251], a[180:183], v[148:151]
    v_mul_f32 v242, s56, v242
    v_accvgpr_read_b32 v243, a253
    v_mfma_f32_16x16x32_bf16 v[164:167], a[224:227], a[180:183], v[164:167]
    ds_read_b64_tr_b16 a[240:241], v240 offset:224
    ds_read_b64_tr_b16 a[242:243], v240 offset:17120
    s_mov_b32 s63, 0x00000020
    v_mfma_f32_16x16x32_bf16 v[160:163], a[224:227], a[176:179], v[160:163]
    buffer_load_dwordx4 v246, s[32:35], s63 offen offset:3168 lds
    v_mfma_f32_16x16x32_bf16 v[144:147], a[248:251], a[176:179], v[144:147]
    v_accvgpr_read_b32 v254, a254
    s_waitcnt lgkmcnt(6)
    v_mfma_f32_16x16x32_bf16 v[176:179], a[228:231], a[176:179], v[176:179]
    s_add_u32 m0, s47, 105600
    s_mov_b32 s62, 0x00001000
    v_mfma_f32_16x16x32_bf16 v[192:195], a[232:235], a[176:179], v[192:195]
    buffer_load_dwordx4 v246, s[32:35], s62 offen lds
    v_mfma_f32_16x16x32_bf16 v[196:199], a[232:235], a[180:183], v[196:199]
    v_accvgpr_read_b32 v255, a255
    s_mov_b32 s63, 0x00000f60
    v_mfma_f32_16x16x32_bf16 v[180:183], a[228:231], a[180:183], v[180:183]
    buffer_load_dwordx4 v246, s[32:35], s63 offen offset:1056 lds
    v_mfma_f32_16x16x32_bf16 v[184:187], a[228:231], a[184:187], v[184:187]
    s_waitcnt vmcnt(14) lgkmcnt(0)
    s_barrier
    v_mfma_f32_16x16x32_bf16 v[200:203], a[232:235], a[184:187], v[200:203]
    ds_read_b64_tr_b16 a[244:245], v240 offset:33792
    ds_read_b64_tr_b16 a[246:247], v240 offset:50688
    v_mfma_f32_16x16x32_bf16 v[204:207], a[232:235], a[188:191], v[204:207]
    ds_read_b64_tr_b16 a[248:249], v240 offset:33824
    ds_read_b64_tr_b16 a[250:251], v240 offset:50720
    v_mfma_f32_16x16x32_bf16 v[188:191], a[228:231], a[188:191], v[188:191]
    v_mfma_f32_16x16x32_bf16 v[220:223], a[236:239], a[188:191], v[220:223]
    v_rcp_f32 v243, v243
    v_mfma_f32_16x16x32_bf16 v[236:239], a[240:243], a[188:191], v[236:239]
    ds_read_b64_tr_b16 a[224:225], v240 offset:33856
    ds_read_b64_tr_b16 a[226:227], v240 offset:50752
    s_mov_b32 s62, 0x00000ec0
    v_mfma_f32_16x16x32_bf16 v[232:235], a[240:243], a[184:187], v[232:235]
    buffer_load_dwordx4 v246, s[32:35], s62 offen offset:2112 lds
    v_mfma_f32_16x16x32_bf16 v[216:219], a[236:239], a[184:187], v[216:219]
    v_mul_f32 v243, s56, v243
    v_mfma_f32_16x16x32_bf16 v[212:215], a[236:239], a[180:183], v[212:215]
    v_rcp_f32 v254, v254
    v_mfma_f32_16x16x32_bf16 v[228:231], a[240:243], a[180:183], v[228:231]
    ds_read_b64_tr_b16 a[228:229], v240 offset:33888
    ds_read_b64_tr_b16 a[230:231], v240 offset:50784
    s_mov_b32 s63, 0x00000e20
    v_mfma_f32_16x16x32_bf16 v[224:227], a[240:243], a[176:179], v[224:227]
    buffer_load_dwordx4 v246, s[32:35], s63 offen offset:3168 lds
    v_mfma_f32_16x16x32_bf16 v[208:211], a[236:239], a[176:179], v[208:211]
    v_mul_f32 v254, s56, v254
    s_waitcnt lgkmcnt(4)
    v_mfma_f32_16x16x32_bf16 v[112:115], a[244:247], a[192:195], v[112:115]
    v_rcp_f32 v255, v255
    v_mfma_f32_16x16x32_bf16 v[128:131], a[248:251], a[192:195], v[128:131]
    ds_read_b64_tr_b16 a[232:233], v240 offset:33920
    ds_read_b64_tr_b16 a[234:235], v240 offset:50816
    s_add_u32 m0, s47, 0
    s_mov_b32 s62, 0x00007200
    v_mfma_f32_16x16x32_bf16 v[132:135], a[248:251], a[196:199], v[132:135]
    buffer_load_dwordx4 v246, s[32:35], s62 offen lds
    v_mfma_f32_16x16x32_bf16 v[116:119], a[244:247], a[196:199], v[116:119]
    v_mul_f32 v255, s56, v255
    v_mfma_f32_16x16x32_bf16 v[120:123], a[244:247], a[200:203], v[120:123]
    v_mfma_f32_16x16x32_bf16 v[136:139], a[248:251], a[200:203], v[136:139]
    ds_read_b64_tr_b16 a[236:237], v240 offset:33952
    ds_read_b64_tr_b16 a[238:239], v240 offset:50848
    s_mov_b32 s63, 0x00007160
    v_mfma_f32_16x16x32_bf16 v[140:143], a[248:251], a[204:207], v[140:143]
    buffer_load_dwordx4 v246, s[32:35], s63 offen offset:1056 lds
    v_mfma_f32_16x16x32_bf16 v[124:127], a[244:247], a[204:207], v[124:127]
    s_waitcnt lgkmcnt(4)
    v_mfma_f32_16x16x32_bf16 v[156:159], a[224:227], a[204:207], v[156:159]
    v_mfma_f32_16x16x32_bf16 v[172:175], a[228:231], a[204:207], v[172:175]
    ds_read_b64_tr_b16 a[240:241], v240 offset:33984
    ds_read_b64_tr_b16 a[242:243], v240 offset:50880
    s_mov_b32 s62, 0x000070c0
    v_mfma_f32_16x16x32_bf16 v[168:171], a[228:231], a[200:203], v[168:171]
    buffer_load_dwordx4 v246, s[32:35], s62 offen offset:2112 lds
    v_mfma_f32_16x16x32_bf16 v[152:155], a[224:227], a[200:203], v[152:155]
    v_mfma_f32_16x16x32_bf16 v[148:151], a[224:227], a[196:199], v[148:151]
    v_mfma_f32_16x16x32_bf16 v[164:167], a[228:231], a[196:199], v[164:167]
    ds_read_b64_tr_b16 a[244:245], v240 offset:34016
    ds_read_b64_tr_b16 a[246:247], v240 offset:50912
    s_mov_b32 s63, 0x00007020
    v_mfma_f32_16x16x32_bf16 v[160:163], a[228:231], a[192:195], v[160:163]
    buffer_load_dwordx4 v246, s[32:35], s63 offen offset:3168 lds
    v_mfma_f32_16x16x32_bf16 v[144:147], a[224:227], a[192:195], v[144:147]
    s_waitcnt lgkmcnt(4)
    v_mfma_f32_16x16x32_bf16 v[176:179], a[232:235], a[192:195], v[176:179]
    s_add_u32 m0, s47, 4224
    s_mov_b32 s62, 0x00008000
    v_mfma_f32_16x16x32_bf16 v[192:195], a[236:239], a[192:195], v[192:195]
    buffer_load_dwordx4 v246, s[32:35], s62 offen lds
    v_mfma_f32_16x16x32_bf16 v[196:199], a[236:239], a[196:199], v[196:199]
    s_mov_b32 s63, 0x00007f60
    v_mfma_f32_16x16x32_bf16 v[180:183], a[232:235], a[196:199], v[180:183]
    buffer_load_dwordx4 v246, s[32:35], s63 offen offset:1056 lds
    v_mfma_f32_16x16x32_bf16 v[184:187], a[232:235], a[200:203], v[184:187]
    s_waitcnt vmcnt(14) lgkmcnt(0)
    s_barrier
    v_mfma_f32_16x16x32_bf16 v[200:203], a[236:239], a[200:203], v[200:203]
    ds_read_b64_tr_b16 a[248:249], v241
    ds_read_b64_tr_b16 a[250:251], v241 offset:16896
    v_mfma_f32_16x16x32_bf16 v[204:207], a[236:239], a[204:207], v[204:207]
    ds_read_b64_tr_b16 a[224:225], v241 offset:32
    ds_read_b64_tr_b16 a[226:227], v241 offset:16928
    v_mfma_f32_16x16x32_bf16 v[188:191], a[232:235], a[204:207], v[188:191]
    v_mfma_f32_16x16x32_bf16 v[220:223], a[240:243], a[204:207], v[220:223]
    v_mfma_f32_16x16x32_bf16 v[236:239], a[244:247], a[204:207], v[236:239]
    ds_read_b64_tr_b16 a[228:229], v241 offset:64
    ds_read_b64_tr_b16 a[230:231], v241 offset:16960
    s_mov_b32 s62, 0x00007ec0
    v_mfma_f32_16x16x32_bf16 v[232:235], a[244:247], a[200:203], v[232:235]
    buffer_load_dwordx4 v246, s[32:35], s62 offen offset:2112 lds
    v_mfma_f32_16x16x32_bf16 v[216:219], a[240:243], a[200:203], v[216:219]
    v_mfma_f32_16x16x32_bf16 v[212:215], a[240:243], a[196:199], v[212:215]
    v_mfma_f32_16x16x32_bf16 v[228:231], a[244:247], a[196:199], v[228:231]
    ds_read_b64_tr_b16 a[232:233], v241 offset:96
    ds_read_b64_tr_b16 a[234:235], v241 offset:16992
    s_mov_b32 s63, 0x00007e20
    v_mfma_f32_16x16x32_bf16 v[224:227], a[244:247], a[192:195], v[224:227]
    buffer_load_dwordx4 v246, s[32:35], s63 offen offset:3168 lds
    v_mfma_f32_16x16x32_bf16 v[208:211], a[240:243], a[192:195], v[208:211]
    s_waitcnt lgkmcnt(4)
    v_mfma_f32_16x16x32_bf16 v[112:115], a[248:251], a[208:211], v[112:115]
    s_lshl_b32 s89, s3, 2
    s_add_u32 s89, s89, s44
    s_lshl_b32 s89, s89, 11
    v_mfma_f32_16x16x32_bf16 v[128:131], a[224:227], a[208:211], v[128:131]
    ds_read_b64_tr_b16 a[236:237], v241 offset:128
    ds_read_b64_tr_b16 a[238:239], v241 offset:17024
    s_add_u32 m0, s47, 33792
    s_mov_b32 s62, 0x0000e200
    v_mfma_f32_16x16x32_bf16 v[132:135], a[224:227], a[212:215], v[132:135]
    buffer_load_dwordx4 v246, s[32:35], s62 offen lds
    v_mfma_f32_16x16x32_bf16 v[116:119], a[248:251], a[212:215], v[116:119]
    v_lshlrev_b32 v253, 7, v250
    v_mfma_f32_16x16x32_bf16 v[120:123], a[248:251], a[216:219], v[120:123]
    s_mov_b64 exec, 0x0000ffff
    buffer_load_dword a201, v253, s[12:15], s89 offen offset:128
    s_mov_b64 exec, -1
    v_mfma_f32_16x16x32_bf16 v[136:139], a[224:227], a[216:219], v[136:139]
    ds_read_b64_tr_b16 a[240:241], v241 offset:160
    ds_read_b64_tr_b16 a[242:243], v241 offset:17056
    s_mov_b32 s63, 0x0000e160
    v_mfma_f32_16x16x32_bf16 v[140:143], a[224:227], a[220:223], v[140:143]
    buffer_load_dwordx4 v246, s[32:35], s63 offen offset:1056 lds
    v_mfma_f32_16x16x32_bf16 v[124:127], a[248:251], a[220:223], v[124:127]
    s_waitcnt lgkmcnt(4)
    v_mfma_f32_16x16x32_bf16 v[156:159], a[228:231], a[220:223], v[156:159]
    v_mfma_f32_16x16x32_bf16 v[172:175], a[232:235], a[220:223], v[172:175]
    ds_read_b64_tr_b16 a[244:245], v241 offset:192
    ds_read_b64_tr_b16 a[246:247], v241 offset:17088
    s_mov_b32 s62, 0x0000e0c0
    v_mfma_f32_16x16x32_bf16 v[168:171], a[232:235], a[216:219], v[168:171]
    buffer_load_dwordx4 v246, s[32:35], s62 offen offset:2112 lds
    v_mfma_f32_16x16x32_bf16 v[152:155], a[228:231], a[216:219], v[152:155]
    v_mfma_f32_16x16x32_bf16 v[148:151], a[228:231], a[212:215], v[148:151]
    s_mov_b64 exec, 0x0000ffff
    buffer_load_dword a201, v253, s[16:19], s89 offen offset:128
    s_mov_b64 exec, -1
    v_mfma_f32_16x16x32_bf16 v[164:167], a[232:235], a[212:215], v[164:167]
    ds_read_b64_tr_b16 a[248:249], v241 offset:224
    ds_read_b64_tr_b16 a[250:251], v241 offset:17120
    s_mov_b32 s63, 0x0000e020
    v_mfma_f32_16x16x32_bf16 v[160:163], a[232:235], a[208:211], v[160:163]
    buffer_load_dwordx4 v246, s[32:35], s63 offen offset:3168 lds
    v_mfma_f32_16x16x32_bf16 v[144:147], a[228:231], a[208:211], v[144:147]
    v_lshlrev_b32 v253, 2, v250
    s_waitcnt lgkmcnt(4)
    v_mfma_f32_16x16x32_bf16 v[176:179], a[236:239], a[208:211], v[176:179]
    s_add_u32 m0, s47, 38016
    s_mov_b32 s62, 0x0000f000
    v_mfma_f32_16x16x32_bf16 v[192:195], a[240:243], a[208:211], v[192:195]
    buffer_load_dwordx4 v246, s[32:35], s62 offen lds
    v_mfma_f32_16x16x32_bf16 v[196:199], a[240:243], a[212:215], v[196:199]
    s_mov_b32 s63, 0x0000ef60
    v_mfma_f32_16x16x32_bf16 v[180:183], a[236:239], a[212:215], v[180:183]
    buffer_load_dwordx4 v246, s[32:35], s63 offen offset:1056 lds
    v_mfma_f32_16x16x32_bf16 v[184:187], a[236:239], a[216:219], v[184:187]
    s_waitcnt vmcnt(16) lgkmcnt(0)
    s_barrier
    v_mfma_f32_16x16x32_bf16 v[200:203], a[240:243], a[216:219], v[200:203]
    v_subrev_u32 v241, s50, v241
    ds_read_b64_tr_b16 a[224:225], v241 offset:33792
    v_mfma_f32_16x16x32_bf16 v[204:207], a[240:243], a[220:223], v[204:207]
    ds_read_b64_tr_b16 a[226:227], v241 offset:50688
    ds_read_b64_tr_b16 a[228:229], v241 offset:33824
    v_mfma_f32_16x16x32_bf16 v[188:191], a[236:239], a[220:223], v[188:191]
    ds_read_b64_tr_b16 a[230:231], v241 offset:50720
    v_mfma_f32_16x16x32_bf16 v[220:223], a[244:247], a[220:223], v[220:223]
    buffer_load_dword a200, v253, s[16:19], s89 offen offset:128
    v_mfma_f32_16x16x32_bf16 v[236:239], a[248:251], a[220:223], v[236:239]
    ds_read_b64_tr_b16 a[232:233], v241 offset:33856
    ds_read_b64_tr_b16 a[234:235], v241 offset:50752
    s_mov_b32 s62, 0x0000eec0
    v_mfma_f32_16x16x32_bf16 v[232:235], a[248:251], a[216:219], v[232:235]
    buffer_load_dwordx4 v246, s[32:35], s62 offen offset:2112 lds
    v_mfma_f32_16x16x32_bf16 v[216:219], a[244:247], a[216:219], v[216:219]
    v_mfma_f32_16x16x32_bf16 v[212:215], a[244:247], a[212:215], v[212:215]
    v_mfma_f32_16x16x32_bf16 v[228:231], a[248:251], a[212:215], v[228:231]
    ds_read_b64_tr_b16 a[236:237], v241 offset:33888
    ds_read_b64_tr_b16 a[238:239], v241 offset:50784
    s_mov_b32 s63, 0x0000ee20
    v_mfma_f32_16x16x32_bf16 v[224:227], a[248:251], a[208:211], v[224:227]
    buffer_load_dwordx4 v246, s[32:35], s63 offen offset:3168 lds
    v_mfma_f32_16x16x32_bf16 v[208:211], a[244:247], a[208:211], v[208:211]
    s_waitcnt lgkmcnt(4)
    v_mfma_f32_16x16x32_bf16 v[0:3], a[224:227], a[0:3], 0
    v_mfma_f32_16x16x32_bf16 v[16:19], a[228:231], a[0:3], 0
    ds_read_b64_tr_b16 a[240:241], v241 offset:33920
    ds_read_b64_tr_b16 a[242:243], v241 offset:50816
    s_add_u32 m0, s47, 67584
    s_mov_b32 s62, 0x00015200
    v_mfma_f32_16x16x32_bf16 v[20:23], a[228:231], a[4:7], 0
    buffer_load_dwordx4 v246, s[32:35], s62 offen lds
    v_mfma_f32_16x16x32_bf16 v[4:7], a[224:227], a[4:7], 0
    v_and_b32 v251, 15, v250
    v_lshlrev_b32 v251, 4, v251
    v_mfma_f32_16x16x32_bf16 v[8:11], a[224:227], a[8:11], 0
    v_lshrrev_b32 v252, 5, v250
    v_lshl_add_u32 v251, v252, 8, v251
    v_bfe_u32 v252, v250, 4, 1
    v_mfma_f32_16x16x32_bf16 v[24:27], a[228:231], a[8:11], 0
    ds_read_b64_tr_b16 a[244:245], v241 offset:33952
    ds_read_b64_tr_b16 a[246:247], v241 offset:50848
    s_mov_b32 s63, 0x00015160
    v_mfma_f32_16x16x32_bf16 v[28:31], a[228:231], a[12:15], 0
    buffer_load_dwordx4 v246, s[32:35], s63 offen offset:1056 lds
    v_lshl_add_u32 v251, v252, 3, v251
    v_mfma_f32_16x16x32_bf16 v[12:15], a[224:227], a[12:15], 0
    v_mul_f32 v112, v242, v112
    s_waitcnt lgkmcnt(4)
    s_mov_b32 s62, 0x000150c0
    v_mfma_f32_16x16x32_bf16 v[44:47], a[232:235], a[12:15], 0
    buffer_load_dwordx4 v246, s[32:35], s62 offen offset:2112 lds
    v_mfma_f32_16x16x32_bf16 v[60:63], a[236:239], a[12:15], 0
    ds_read_b64_tr_b16 a[248:249], v241 offset:33984
    ds_read_b64_tr_b16 a[250:251], v241 offset:50880
    v_mul_f32 v113, v242, v113
    v_mfma_f32_16x16x32_bf16 v[56:59], a[236:239], a[8:11], 0
    s_xor_b32 s48, s61, 1
    s_mul_i32 s48, s48, 101376
    s_lshl_b32 s49, s60, 14
    s_add_u32 s49, s48, s49
    s_add_u32 s51, s49, s59
    s_sub_u32 s49, s49, s59
    s_add_u32 s49, s49, 2048
    s_mov_b32 s63, 0x00015020
    v_mfma_f32_16x16x32_bf16 v[40:43], a[232:235], a[8:11], 0
    buffer_load_dwordx4 v246, s[32:35], s63 offen offset:3168 lds
    v_add_u32 v252, s49, v251
    v_mfma_f32_16x16x32_bf16 v[36:39], a[232:235], a[4:7], 0
    v_add_u32 v251, s51, v251
    v_mul_f32 v114, v242, v114
    v_mul_f32 v115, v242, v115
    v_mfma_f32_16x16x32_bf16 v[52:55], a[236:239], a[4:7], 0
    s_add_u32 m0, s47, 71808
    s_mov_b32 s62, 0x00016000
    v_mfma_f32_16x16x32_bf16 v[48:51], a[236:239], a[0:3], 0
    buffer_load_dwordx4 v246, s[32:35], s62 offen lds
    v_cvt_pk_bf16_f32 v112, v112, v113
    v_mfma_f32_16x16x32_bf16 v[32:35], a[232:235], a[0:3], 0
    v_cvt_pk_bf16_f32 v113, v114, v115
    v_mul_f32 v116, v243, v116
    s_waitcnt lgkmcnt(2)
    v_mfma_f32_16x16x32_bf16 v[64:67], a[240:243], a[0:3], 0
    s_waitcnt vmcnt(16) lgkmcnt(0)
    s_barrier
    v_mul_f32 v117, v243, v117
    v_mfma_f32_16x16x32_bf16 v[80:83], a[244:247], a[0:3], 0
    v_subrev_u32 v240, s50, v240
    ds_read_b64_tr_b16 a[224:225], v240
    v_mul_f32 v118, v243, v118
    v_mfma_f32_16x16x32_bf16 v[84:87], a[244:247], a[4:7], 0
    ds_read_b64_tr_b16 a[226:227], v240 offset:16896
    ds_read_b64_tr_b16 a[228:229], v240 offset:32
    v_mfma_f32_16x16x32_bf16 v[68:71], a[240:243], a[4:7], 0
    ds_read_b64_tr_b16 a[230:231], v240 offset:16928
    v_mul_f32 v119, v243, v119
    s_mov_b32 s63, 0x00015f60
    v_mfma_f32_16x16x32_bf16 v[72:75], a[240:243], a[8:11], 0
    buffer_load_dwordx4 v246, s[32:35], s63 offen offset:1056 lds
    v_cvt_pk_bf16_f32 v116, v116, v117
    v_mfma_f32_16x16x32_bf16 v[88:91], a[244:247], a[8:11], 0
    ds_read_b64_tr_b16 a[232:233], v240 offset:64
    ds_read_b64_tr_b16 a[234:235], v240 offset:16960
    s_mov_b32 s62, 0x00015ec0
    v_mfma_f32_16x16x32_bf16 v[92:95], a[244:247], a[12:15], 0
    buffer_load_dwordx4 v246, s[32:35], s62 offen offset:2112 lds
    v_cvt_pk_bf16_f32 v117, v118, v119
    v_mfma_f32_16x16x32_bf16 v[76:79], a[240:243], a[12:15], 0
    v_mul_f32 v120, v254, v120
    v_mfma_f32_16x16x32_bf16 v[108:111], a[248:251], a[12:15], 0
    v_mul_f32 v121, v254, v121
    v_mul_f32 v122, v254, v122
    v_mul_f32 v123, v254, v123
    v_mfma_f32_16x16x32_bf16 v[104:107], a[248:251], a[8:11], 0
    ds_read_b64_tr_b16 a[236:237], v240 offset:96
    ds_read_b64_tr_b16 a[238:239], v240 offset:16992
    s_mov_b32 s63, 0x00015e20
    v_mfma_f32_16x16x32_bf16 v[100:103], a[248:251], a[4:7], 0
    buffer_load_dwordx4 v246, s[32:35], s63 offen offset:3168 lds
    v_cvt_pk_bf16_f32 v120, v120, v121
    v_mfma_f32_16x16x32_bf16 v[96:99], a[248:251], a[0:3], 0
    v_cvt_pk_bf16_f32 v121, v122, v123
    v_mul_f32 v124, v255, v124
    s_waitcnt lgkmcnt(4)
    v_mfma_f32_16x16x32_bf16 v[0:3], a[224:227], a[16:19], v[0:3]
    v_mul_f32 v125, v255, v125
    v_mul_f32 v126, v255, v126
    v_mfma_f32_16x16x32_bf16 v[16:19], a[228:231], a[16:19], v[16:19]
    ds_read_b64_tr_b16 a[240:241], v240 offset:128
    ds_read_b64_tr_b16 a[242:243], v240 offset:17024
    s_add_u32 m0, s47, 101376
    s_mov_b32 s62, 0x0001c200
    v_mfma_f32_16x16x32_bf16 v[20:23], a[228:231], a[20:23], v[20:23]
    buffer_load_dwordx4 v246, s[32:35], s62 offen lds
    v_mul_f32 v127, v255, v127
    v_mfma_f32_16x16x32_bf16 v[4:7], a[224:227], a[20:23], v[4:7]
    v_cvt_pk_bf16_f32 v124, v124, v125
    v_cvt_pk_bf16_f32 v125, v126, v127
    v_mul_f32 v128, v242, v128
    v_mfma_f32_16x16x32_bf16 v[8:11], a[224:227], a[24:27], v[8:11]
    v_mul_f32 v129, v242, v129
    v_mul_f32 v130, v242, v130
    v_mul_f32 v131, v242, v131
    v_mfma_f32_16x16x32_bf16 v[24:27], a[228:231], a[24:27], v[24:27]
    ds_read_b64_tr_b16 a[244:245], v240 offset:160
    ds_read_b64_tr_b16 a[246:247], v240 offset:17056
    s_mov_b32 s63, 0x0001c160
    v_mfma_f32_16x16x32_bf16 v[28:31], a[228:231], a[28:31], v[28:31]
    buffer_load_dwordx4 v246, s[32:35], s63 offen offset:1056 lds
    v_cvt_pk_bf16_f32 v128, v128, v129
    v_mfma_f32_16x16x32_bf16 v[12:15], a[224:227], a[28:31], v[12:15]
    v_cvt_pk_bf16_f32 v129, v130, v131
    s_waitcnt lgkmcnt(4)
    s_mov_b32 s62, 0x0001c0c0
    v_mfma_f32_16x16x32_bf16 v[44:47], a[232:235], a[28:31], v[44:47]
    buffer_load_dwordx4 v246, s[32:35], s62 offen offset:2112 lds
    v_mul_f32 v132, v243, v132
    v_mfma_f32_16x16x32_bf16 v[60:63], a[236:239], a[28:31], v[60:63]
    ds_read_b64_tr_b16 a[248:249], v240 offset:192
    ds_read_b64_tr_b16 a[250:251], v240 offset:17088
    v_mul_f32 v133, v243, v133
    v_mfma_f32_16x16x32_bf16 v[56:59], a[236:239], a[24:27], v[56:59]
    v_mul_f32 v134, v243, v134
    s_mov_b32 s63, 0x0001c020
    v_mfma_f32_16x16x32_bf16 v[40:43], a[232:235], a[24:27], v[40:43]
    buffer_load_dwordx4 v246, s[32:35], s63 offen offset:3168 lds
    v_mul_f32 v135, v243, v135
    v_mfma_f32_16x16x32_bf16 v[36:39], a[232:235], a[20:23], v[36:39]
    v_cvt_pk_bf16_f32 v132, v132, v133
    v_cvt_pk_bf16_f32 v133, v134, v135
    v_mul_f32 v136, v254, v136
    v_mfma_f32_16x16x32_bf16 v[52:55], a[236:239], a[20:23], v[52:55]
    v_mul_f32 v137, v254, v137
    s_add_u32 m0, s47, 105600
    s_mov_b32 s62, 0x0001d000
    v_mfma_f32_16x16x32_bf16 v[48:51], a[236:239], a[16:19], v[48:51]
    buffer_load_dwordx4 v246, s[32:35], s62 offen lds
    v_mul_f32 v138, v254, v138
    v_mfma_f32_16x16x32_bf16 v[32:35], a[232:235], a[16:19], v[32:35]
    v_mul_f32 v139, v254, v139
    s_waitcnt lgkmcnt(2)
    v_mfma_f32_16x16x32_bf16 v[64:67], a[240:243], a[16:19], v[64:67]
    s_waitcnt vmcnt(13) lgkmcnt(0)
    s_barrier
    v_cvt_pk_bf16_f32 v136, v136, v137
    v_mfma_f32_16x16x32_bf16 v[80:83], a[244:247], a[16:19], v[80:83]
    ds_read_b64_tr_b16 a[224:225], v240 offset:33792
    ds_read_b64_tr_b16 a[226:227], v240 offset:50688
    v_cvt_pk_bf16_f32 v137, v138, v139
    v_mfma_f32_16x16x32_bf16 v[84:87], a[244:247], a[20:23], v[84:87]
    ds_read_b64_tr_b16 a[228:229], v240 offset:33824
    ds_read_b64_tr_b16 a[230:231], v240 offset:50720
    s_mov_b32 s63, 0x0001cf60
    v_mfma_f32_16x16x32_bf16 v[68:71], a[240:243], a[20:23], v[68:71]
    buffer_load_dwordx4 v246, s[32:35], s63 offen offset:1056 lds
    v_mul_f32 v140, v255, v140
    v_mfma_f32_16x16x32_bf16 v[72:75], a[240:243], a[24:27], v[72:75]
    v_mul_f32 v141, v255, v141
    v_mul_f32 v142, v255, v142
    v_mfma_f32_16x16x32_bf16 v[88:91], a[244:247], a[24:27], v[88:91]
    ds_read_b64_tr_b16 a[232:233], v240 offset:33856
    ds_read_b64_tr_b16 a[234:235], v240 offset:50752
    s_mov_b32 s62, 0x0001cec0
    v_mfma_f32_16x16x32_bf16 v[92:95], a[244:247], a[28:31], v[92:95]
    buffer_load_dwordx4 v246, s[32:35], s62 offen offset:2112 lds
    v_mul_f32 v143, v255, v143
    v_mfma_f32_16x16x32_bf16 v[76:79], a[240:243], a[28:31], v[76:79]
    v_cvt_pk_bf16_f32 v140, v140, v141
    v_cvt_pk_bf16_f32 v141, v142, v143
    v_mfma_f32_16x16x32_bf16 v[108:111], a[248:251], a[28:31], v[108:111]
    v_mul_f32 v144, v242, v144
    v_mul_f32 v145, v242, v145
    v_mul_f32 v146, v242, v146
    v_mfma_f32_16x16x32_bf16 v[104:107], a[248:251], a[24:27], v[104:107]
    ds_read_b64_tr_b16 a[236:237], v240 offset:33888
    ds_read_b64_tr_b16 a[238:239], v240 offset:50784
    s_mov_b32 s63, 0x0001ce20
    v_mfma_f32_16x16x32_bf16 v[100:103], a[248:251], a[20:23], v[100:103]
    buffer_load_dwordx4 v246, s[32:35], s63 offen offset:3168 lds
    v_mul_f32 v147, v242, v147
    v_mfma_f32_16x16x32_bf16 v[96:99], a[248:251], a[16:19], v[96:99]
    v_cvt_pk_bf16_f32 v144, v144, v145
    v_cvt_pk_bf16_f32 v145, v146, v147
    s_waitcnt lgkmcnt(4)
    v_mfma_f32_16x16x32_bf16 v[0:3], a[224:227], a[32:35], v[0:3]
    v_mul_f32 v148, v243, v148
    v_mul_f32 v149, v243, v149
    v_mul_f32 v150, v243, v150
    v_mfma_f32_16x16x32_bf16 v[16:19], a[228:231], a[32:35], v[16:19]
    ds_read_b64_tr_b16 a[240:241], v240 offset:33920
    ds_read_b64_tr_b16 a[242:243], v240 offset:50816
    s_add_u32 m0, s47, 0
    s_mov_b32 s62, 0x00023200
    v_mfma_f32_16x16x32_bf16 v[20:23], a[228:231], a[36:39], v[20:23]
    buffer_load_dwordx4 v246, s[32:35], s62 offen lds
    v_mfma_f32_16x16x32_bf16 v[4:7], a[224:227], a[36:39], v[4:7]
    v_mul_f32 v151, v243, v151
    v_cvt_pk_bf16_f32 v148, v148, v149
    v_mul_f32 v152, v254, v152
    v_mfma_f32_16x16x32_bf16 v[8:11], a[224:227], a[40:43], v[8:11]
    v_cvt_pk_bf16_f32 v149, v150, v151
    v_mul_f32 v153, v254, v153
    v_mul_f32 v154, v254, v154
    v_mfma_f32_16x16x32_bf16 v[24:27], a[228:231], a[40:43], v[24:27]
    ds_read_b64_tr_b16 a[244:245], v240 offset:33952
    ds_read_b64_tr_b16 a[246:247], v240 offset:50848
    s_mov_b32 s63, 0x00023160
    v_mfma_f32_16x16x32_bf16 v[28:31], a[228:231], a[44:47], v[28:31]
    buffer_load_dwordx4 v246, s[32:35], s63 offen offset:1056 lds
    v_mul_f32 v155, v254, v155
    v_mfma_f32_16x16x32_bf16 v[12:15], a[224:227], a[44:47], v[12:15]
    s_waitcnt lgkmcnt(4)
    s_mov_b32 s62, 0x000230c0
    v_mfma_f32_16x16x32_bf16 v[44:47], a[232:235], a[44:47], v[44:47]
    buffer_load_dwordx4 v246, s[32:35], s62 offen offset:2112 lds
    v_cvt_pk_bf16_f32 v152, v152, v153
    v_mfma_f32_16x16x32_bf16 v[60:63], a[236:239], a[44:47], v[60:63]
    ds_read_b64_tr_b16 a[248:249], v240 offset:33984
    ds_read_b64_tr_b16 a[250:251], v240 offset:50880
    v_cvt_pk_bf16_f32 v153, v154, v155
    v_mfma_f32_16x16x32_bf16 v[56:59], a[236:239], a[40:43], v[56:59]
    v_mul_f32 v156, v255, v156
    v_mul_f32 v157, v255, v157
    s_mov_b32 s63, 0x00023020
    v_mfma_f32_16x16x32_bf16 v[40:43], a[232:235], a[40:43], v[40:43]
    buffer_load_dwordx4 v246, s[32:35], s63 offen offset:3168 lds
    v_mul_f32 v158, v255, v158
    v_mfma_f32_16x16x32_bf16 v[36:39], a[232:235], a[36:39], v[36:39]
    v_mul_f32 v159, v255, v159
    v_cvt_pk_bf16_f32 v156, v156, v157
    v_mfma_f32_16x16x32_bf16 v[52:55], a[236:239], a[36:39], v[52:55]
    v_cvt_pk_bf16_f32 v157, v158, v159
    s_add_u32 m0, s47, 4224
    s_mov_b32 s62, 0x00024000
    v_mfma_f32_16x16x32_bf16 v[48:51], a[236:239], a[32:35], v[48:51]
    buffer_load_dwordx4 v246, s[32:35], s62 offen lds
    v_mul_f32 v160, v242, v160
    v_mfma_f32_16x16x32_bf16 v[32:35], a[232:235], a[32:35], v[32:35]
    v_mul_f32 v161, v242, v161
    v_mul_f32 v162, v242, v162
    s_waitcnt lgkmcnt(2)
    v_mfma_f32_16x16x32_bf16 v[64:67], a[240:243], a[32:35], v[64:67]
    s_waitcnt vmcnt(13) lgkmcnt(0)
    s_barrier
    v_mul_f32 v163, v242, v163
    v_mfma_f32_16x16x32_bf16 v[80:83], a[244:247], a[32:35], v[80:83]
    ds_read_b64_tr_b16 a[224:225], v241
    ds_read_b64_tr_b16 a[226:227], v241 offset:16896
    v_mfma_f32_16x16x32_bf16 v[84:87], a[244:247], a[36:39], v[84:87]
    ds_read_b64_tr_b16 a[228:229], v241 offset:32
    ds_read_b64_tr_b16 a[230:231], v241 offset:16928
    s_mov_b32 s63, 0x00023f60
    v_mfma_f32_16x16x32_bf16 v[68:71], a[240:243], a[36:39], v[68:71]
    buffer_load_dwordx4 v246, s[32:35], s63 offen offset:1056 lds
    v_cvt_pk_bf16_f32 v160, v160, v161
    v_mfma_f32_16x16x32_bf16 v[72:75], a[240:243], a[40:43], v[72:75]
    v_cvt_pk_bf16_f32 v161, v162, v163
    v_mul_f32 v164, v243, v164
    v_mul_f32 v165, v243, v165
    v_mfma_f32_16x16x32_bf16 v[88:91], a[244:247], a[40:43], v[88:91]
    ds_read_b64_tr_b16 a[232:233], v241 offset:64
    ds_read_b64_tr_b16 a[234:235], v241 offset:16960
    s_mov_b32 s62, 0x00023ec0
    v_mfma_f32_16x16x32_bf16 v[92:95], a[244:247], a[44:47], v[92:95]
    buffer_load_dwordx4 v246, s[32:35], s62 offen offset:2112 lds
    v_mfma_f32_16x16x32_bf16 v[76:79], a[240:243], a[44:47], v[76:79]
    v_mul_f32 v166, v243, v166
    v_mul_f32 v167, v243, v167
    v_mfma_f32_16x16x32_bf16 v[108:111], a[248:251], a[44:47], v[108:111]
    v_cvt_pk_bf16_f32 v164, v164, v165
    v_cvt_pk_bf16_f32 v165, v166, v167
    v_mul_f32 v168, v254, v168
    v_mfma_f32_16x16x32_bf16 v[104:107], a[248:251], a[40:43], v[104:107]
    ds_read_b64_tr_b16 a[236:237], v241 offset:96
    ds_read_b64_tr_b16 a[238:239], v241 offset:16992
    s_mov_b32 s63, 0x00023e20
    v_mfma_f32_16x16x32_bf16 v[100:103], a[248:251], a[36:39], v[100:103]
    buffer_load_dwordx4 v246, s[32:35], s63 offen offset:3168 lds
    v_mul_f32 v169, v254, v169
    v_mfma_f32_16x16x32_bf16 v[96:99], a[248:251], a[32:35], v[96:99]
    v_mul_f32 v170, v254, v170
    s_waitcnt lgkmcnt(4)
    v_mfma_f32_16x16x32_bf16 v[0:3], a[224:227], a[48:51], v[0:3]
    v_mul_f32 v171, v254, v171
    v_cvt_pk_bf16_f32 v168, v168, v169
    v_mul_f32 v172, v255, v172
    v_mfma_f32_16x16x32_bf16 v[16:19], a[228:231], a[48:51], v[16:19]
    ds_read_b64_tr_b16 a[240:241], v241 offset:128
    ds_read_b64_tr_b16 a[242:243], v241 offset:17024
    s_add_u32 m0, s47, 33792
    s_mov_b32 s62, 0x0002a200
    v_mfma_f32_16x16x32_bf16 v[20:23], a[228:231], a[52:55], v[20:23]
    buffer_load_dwordx4 v246, s[32:35], s62 offen lds
    v_cvt_pk_bf16_f32 v169, v170, v171
    v_mfma_f32_16x16x32_bf16 v[4:7], a[224:227], a[52:55], v[4:7]
    v_mul_f32 v173, v255, v173
    v_mul_f32 v174, v255, v174
    v_mul_f32 v175, v255, v175
    v_mfma_f32_16x16x32_bf16 v[8:11], a[224:227], a[56:59], v[8:11]
    v_cvt_pk_bf16_f32 v172, v172, v173
    v_cvt_pk_bf16_f32 v173, v174, v175
    v_mfma_f32_16x16x32_bf16 v[24:27], a[228:231], a[56:59], v[24:27]
    ds_read_b64_tr_b16 a[244:245], v241 offset:160
    ds_read_b64_tr_b16 a[246:247], v241 offset:17056
    s_mov_b32 s63, 0x0002a160
    v_mfma_f32_16x16x32_bf16 v[28:31], a[228:231], a[60:63], v[28:31]
    buffer_load_dwordx4 v246, s[32:35], s63 offen offset:1056 lds
    v_mul_f32 v176, v242, v176
    v_mfma_f32_16x16x32_bf16 v[12:15], a[224:227], a[60:63], v[12:15]
    v_mul_f32 v177, v242, v177
    s_waitcnt lgkmcnt(4)
    s_mov_b32 s62, 0x0002a0c0
    v_mfma_f32_16x16x32_bf16 v[44:47], a[232:235], a[60:63], v[44:47]
    buffer_load_dwordx4 v246, s[32:35], s62 offen offset:2112 lds
    v_mul_f32 v178, v242, v178
    v_mfma_f32_16x16x32_bf16 v[60:63], a[236:239], a[60:63], v[60:63]
    ds_read_b64_tr_b16 a[248:249], v241 offset:192
    ds_read_b64_tr_b16 a[250:251], v241 offset:17088
    v_mfma_f32_16x16x32_bf16 v[56:59], a[236:239], a[56:59], v[56:59]
    v_mul_f32 v179, v242, v179
    v_cvt_pk_bf16_f32 v176, v176, v177
    s_mov_b32 s63, 0x0002a020
    v_mfma_f32_16x16x32_bf16 v[40:43], a[232:235], a[56:59], v[40:43]
    buffer_load_dwordx4 v246, s[32:35], s63 offen offset:3168 lds
    v_cvt_pk_bf16_f32 v177, v178, v179
    v_mfma_f32_16x16x32_bf16 v[36:39], a[232:235], a[52:55], v[36:39]
    v_mul_f32 v180, v243, v180
    v_mul_f32 v181, v243, v181
    v_mul_f32 v182, v243, v182
    v_mfma_f32_16x16x32_bf16 v[52:55], a[236:239], a[52:55], v[52:55]
    v_mul_f32 v183, v243, v183
    s_add_u32 m0, s47, 38016
    s_mov_b32 s62, 0x0002b000
    v_mfma_f32_16x16x32_bf16 v[48:51], a[236:239], a[48:51], v[48:51]
    buffer_load_dwordx4 v246, s[32:35], s62 offen lds
    v_mfma_f32_16x16x32_bf16 v[32:35], a[232:235], a[48:51], v[32:35]
    v_cvt_pk_bf16_f32 v180, v180, v181
    v_cvt_pk_bf16_f32 v181, v182, v183
    s_waitcnt lgkmcnt(2)
    v_mfma_f32_16x16x32_bf16 v[64:67], a[240:243], a[48:51], v[64:67]
    s_waitcnt vmcnt(13) lgkmcnt(0)
    s_barrier
    v_mul_f32 v184, v254, v184
    v_mfma_f32_16x16x32_bf16 v[80:83], a[244:247], a[48:51], v[80:83]
    ds_read_b64_tr_b16 a[224:225], v241 offset:33792
    ds_read_b64_tr_b16 a[226:227], v241 offset:50688
    v_mul_f32 v185, v254, v185
    v_mfma_f32_16x16x32_bf16 v[84:87], a[244:247], a[52:55], v[84:87]
    ds_read_b64_tr_b16 a[228:229], v241 offset:33824
    ds_read_b64_tr_b16 a[230:231], v241 offset:50720
    s_mov_b32 s63, 0x0002af60
    v_mfma_f32_16x16x32_bf16 v[68:71], a[240:243], a[52:55], v[68:71]
    buffer_load_dwordx4 v246, s[32:35], s63 offen offset:1056 lds
    v_mfma_f32_16x16x32_bf16 v[72:75], a[240:243], a[56:59], v[72:75]
    v_mul_f32 v186, v254, v186
    v_mul_f32 v187, v254, v187
    v_cvt_pk_bf16_f32 v184, v184, v185
    v_mfma_f32_16x16x32_bf16 v[88:91], a[244:247], a[56:59], v[88:91]
    ds_read_b64_tr_b16 a[232:233], v241 offset:33856
    ds_read_b64_tr_b16 a[234:235], v241 offset:50752
    s_mov_b32 s62, 0x0002aec0
    v_mfma_f32_16x16x32_bf16 v[92:95], a[244:247], a[60:63], v[92:95]
    buffer_load_dwordx4 v246, s[32:35], s62 offen offset:2112 lds
    v_cvt_pk_bf16_f32 v185, v186, v187
    v_mfma_f32_16x16x32_bf16 v[76:79], a[240:243], a[60:63], v[76:79]
    v_mul_f32 v188, v255, v188
    v_mul_f32 v189, v255, v189
    v_mfma_f32_16x16x32_bf16 v[108:111], a[248:251], a[60:63], v[108:111]
    v_mul_f32 v190, v255, v190
    v_mul_f32 v191, v255, v191
    v_mfma_f32_16x16x32_bf16 v[104:107], a[248:251], a[56:59], v[104:107]
    ds_read_b64_tr_b16 a[236:237], v241 offset:33888
    ds_read_b64_tr_b16 a[238:239], v241 offset:50784
    s_mov_b32 s63, 0x0002ae20
    v_mfma_f32_16x16x32_bf16 v[100:103], a[248:251], a[52:55], v[100:103]
    buffer_load_dwordx4 v246, s[32:35], s63 offen offset:3168 lds
    v_cvt_pk_bf16_f32 v188, v188, v189
    v_mfma_f32_16x16x32_bf16 v[96:99], a[248:251], a[48:51], v[96:99]
    v_cvt_pk_bf16_f32 v189, v190, v191
    v_mul_f32 v192, v242, v192
    s_waitcnt lgkmcnt(4)
    v_mfma_f32_16x16x32_bf16 v[0:3], a[224:227], a[64:67], v[0:3]
    v_mul_f32 v193, v242, v193
    v_mul_f32 v194, v242, v194
    v_mul_f32 v195, v242, v195
    v_mfma_f32_16x16x32_bf16 v[16:19], a[228:231], a[64:67], v[16:19]
    ds_read_b64_tr_b16 a[240:241], v241 offset:33920
    ds_read_b64_tr_b16 a[242:243], v241 offset:50816
    s_add_u32 m0, s47, 67584
    s_mov_b32 s62, 0x00031200
    v_mfma_f32_16x16x32_bf16 v[20:23], a[228:231], a[68:71], v[20:23]
    buffer_load_dwordx4 v246, s[32:35], s62 offen lds
    v_cvt_pk_bf16_f32 v192, v192, v193
    v_mfma_f32_16x16x32_bf16 v[4:7], a[224:227], a[68:71], v[4:7]
    v_cvt_pk_bf16_f32 v193, v194, v195
    v_mul_f32 v196, v243, v196
    v_mul_f32 v197, v243, v197
    v_mfma_f32_16x16x32_bf16 v[8:11], a[224:227], a[72:75], v[8:11]
    v_mul_f32 v198, v243, v198
    v_mul_f32 v199, v243, v199
    v_cvt_pk_bf16_f32 v196, v196, v197
    v_mfma_f32_16x16x32_bf16 v[24:27], a[228:231], a[72:75], v[24:27]
    ds_read_b64_tr_b16 a[244:245], v241 offset:33952
    ds_read_b64_tr_b16 a[246:247], v241 offset:50848
    s_mov_b32 s63, 0x00031160
    v_mfma_f32_16x16x32_bf16 v[28:31], a[228:231], a[76:79], v[28:31]
    buffer_load_dwordx4 v246, s[32:35], s63 offen offset:1056 lds
    v_mfma_f32_16x16x32_bf16 v[12:15], a[224:227], a[76:79], v[12:15]
    v_cvt_pk_bf16_f32 v197, v198, v199
    s_waitcnt lgkmcnt(4)
    s_mov_b32 s62, 0x000310c0
    v_mfma_f32_16x16x32_bf16 v[44:47], a[232:235], a[76:79], v[44:47]
    buffer_load_dwordx4 v246, s[32:35], s62 offen offset:2112 lds
    v_mul_f32 v200, v254, v200
    v_mfma_f32_16x16x32_bf16 v[60:63], a[236:239], a[76:79], v[60:63]
    ds_read_b64_tr_b16 a[248:249], v241 offset:33984
    ds_read_b64_tr_b16 a[250:251], v241 offset:50880
    v_mul_f32 v201, v254, v201
    v_mfma_f32_16x16x32_bf16 v[56:59], a[236:239], a[72:75], v[56:59]
    v_mul_f32 v202, v254, v202
    v_mul_f32 v203, v254, v203
    s_mov_b32 s63, 0x00031020
    v_mfma_f32_16x16x32_bf16 v[40:43], a[232:235], a[72:75], v[40:43]
    buffer_load_dwordx4 v246, s[32:35], s63 offen offset:3168 lds
    v_mfma_f32_16x16x32_bf16 v[36:39], a[232:235], a[68:71], v[36:39]
    v_cvt_pk_bf16_f32 v200, v200, v201
    v_cvt_pk_bf16_f32 v201, v202, v203
    v_mul_f32 v204, v255, v204
    v_mfma_f32_16x16x32_bf16 v[52:55], a[236:239], a[68:71], v[52:55]
    v_mul_f32 v205, v255, v205
    s_add_u32 m0, s47, 71808
    s_mov_b32 s62, 0x00032000
    v_mfma_f32_16x16x32_bf16 v[48:51], a[236:239], a[64:67], v[48:51]
    buffer_load_dwordx4 v246, s[32:35], s62 offen lds
    v_mul_f32 v206, v255, v206
    v_mfma_f32_16x16x32_bf16 v[32:35], a[232:235], a[64:67], v[32:35]
    v_mul_f32 v207, v255, v207
    v_cvt_pk_bf16_f32 v204, v204, v205
    s_waitcnt lgkmcnt(2)
    v_mfma_f32_16x16x32_bf16 v[64:67], a[240:243], a[64:67], v[64:67]
    s_waitcnt vmcnt(13) lgkmcnt(0)
    s_barrier
    v_mfma_f32_16x16x32_bf16 v[80:83], a[244:247], a[64:67], v[80:83]
    ds_read_b64_tr_b16 a[224:225], v240
    ds_read_b64_tr_b16 a[226:227], v240 offset:16896
    v_cvt_pk_bf16_f32 v205, v206, v207
    v_mfma_f32_16x16x32_bf16 v[84:87], a[244:247], a[68:71], v[84:87]
    ds_read_b64_tr_b16 a[228:229], v240 offset:32
    ds_read_b64_tr_b16 a[230:231], v240 offset:16928
    s_mov_b32 s63, 0x00031f60
    v_mfma_f32_16x16x32_bf16 v[68:71], a[240:243], a[68:71], v[68:71]
    buffer_load_dwordx4 v246, s[32:35], s63 offen offset:1056 lds
    v_mul_f32 v208, v242, v208
    v_mfma_f32_16x16x32_bf16 v[72:75], a[240:243], a[72:75], v[72:75]
    v_mul_f32 v209, v242, v209
    v_mul_f32 v210, v242, v210
    v_mul_f32 v211, v242, v211
    v_mfma_f32_16x16x32_bf16 v[88:91], a[244:247], a[72:75], v[88:91]
    ds_read_b64_tr_b16 a[232:233], v240 offset:64
    ds_read_b64_tr_b16 a[234:235], v240 offset:16960
    s_mov_b32 s62, 0x00031ec0
    v_mfma_f32_16x16x32_bf16 v[92:95], a[244:247], a[76:79], v[92:95]
    buffer_load_dwordx4 v246, s[32:35], s62 offen offset:2112 lds
    v_cvt_pk_bf16_f32 v208, v208, v209
    v_mfma_f32_16x16x32_bf16 v[76:79], a[240:243], a[76:79], v[76:79]
    v_cvt_pk_bf16_f32 v209, v210, v211
    v_mul_f32 v212, v243, v212
    v_mfma_f32_16x16x32_bf16 v[108:111], a[248:251], a[76:79], v[108:111]
    v_mul_f32 v213, v243, v213
    v_mul_f32 v214, v243, v214
    v_mul_f32 v215, v243, v215
    v_mfma_f32_16x16x32_bf16 v[104:107], a[248:251], a[72:75], v[104:107]
    ds_read_b64_tr_b16 a[236:237], v240 offset:96
    ds_read_b64_tr_b16 a[238:239], v240 offset:16992
    s_mov_b32 s63, 0x00031e20
    v_mfma_f32_16x16x32_bf16 v[100:103], a[248:251], a[68:71], v[100:103]
    buffer_load_dwordx4 v246, s[32:35], s63 offen offset:3168 lds
    v_mfma_f32_16x16x32_bf16 v[96:99], a[248:251], a[64:67], v[96:99]
    v_cvt_pk_bf16_f32 v212, v212, v213
    v_cvt_pk_bf16_f32 v213, v214, v215
    s_waitcnt lgkmcnt(4)
    v_mfma_f32_16x16x32_bf16 v[0:3], a[224:227], a[80:83], v[0:3]
    v_mul_f32 v216, v254, v216
    v_mul_f32 v217, v254, v217
    v_mul_f32 v218, v254, v218
    v_mfma_f32_16x16x32_bf16 v[16:19], a[228:231], a[80:83], v[16:19]
    ds_read_b64_tr_b16 a[240:241], v240 offset:128
    ds_read_b64_tr_b16 a[242:243], v240 offset:17024
    v_mul_f32 v219, v254, v219
    v_mfma_f32_16x16x32_bf16 v[20:23], a[228:231], a[84:87], v[20:23]
    v_cvt_pk_bf16_f32 v216, v216, v217
    v_cvt_pk_bf16_f32 v217, v218, v219
    v_mul_f32 v220, v255, v220
    v_mfma_f32_16x16x32_bf16 v[4:7], a[224:227], a[84:87], v[4:7]
    v_mul_f32 v221, v255, v221
    v_mul_f32 v222, v255, v222
    v_mfma_f32_16x16x32_bf16 v[8:11], a[224:227], a[88:91], v[8:11]
    v_mul_f32 v223, v255, v223
    v_cvt_pk_bf16_f32 v220, v220, v221
    v_mul_f32 v224, v242, v224
    v_mfma_f32_16x16x32_bf16 v[24:27], a[228:231], a[88:91], v[24:27]
    ds_read_b64_tr_b16 a[244:245], v240 offset:160
    ds_read_b64_tr_b16 a[246:247], v240 offset:17056
    v_cvt_pk_bf16_f32 v221, v222, v223
    v_mfma_f32_16x16x32_bf16 v[28:31], a[228:231], a[92:95], v[28:31]
    v_mul_f32 v225, v242, v225
    v_mul_f32 v226, v242, v226
    v_mul_f32 v227, v242, v227
    v_mfma_f32_16x16x32_bf16 v[12:15], a[224:227], a[92:95], v[12:15]
    v_cvt_pk_bf16_f32 v224, v224, v225
    v_cvt_pk_bf16_f32 v225, v226, v227
    s_waitcnt lgkmcnt(4)
    v_mfma_f32_16x16x32_bf16 v[44:47], a[232:235], a[92:95], v[44:47]
    v_mul_f32 v228, v243, v228
    v_mul_f32 v229, v243, v229
    v_mfma_f32_16x16x32_bf16 v[60:63], a[236:239], a[92:95], v[60:63]
    ds_read_b64_tr_b16 a[248:249], v240 offset:192
    ds_read_b64_tr_b16 a[250:251], v240 offset:17088
    v_mul_f32 v230, v243, v230
    v_mfma_f32_16x16x32_bf16 v[56:59], a[236:239], a[88:91], v[56:59]
    v_mul_f32 v231, v243, v231
    v_cvt_pk_bf16_f32 v228, v228, v229
    v_mul_f32 v232, v254, v232
    v_mfma_f32_16x16x32_bf16 v[40:43], a[232:235], a[88:91], v[40:43]
    v_cvt_pk_bf16_f32 v229, v230, v231
    v_mul_f32 v233, v254, v233
    v_mul_f32 v234, v254, v234
    v_mfma_f32_16x16x32_bf16 v[36:39], a[232:235], a[84:87], v[36:39]
    v_mul_f32 v235, v254, v235
    v_cvt_pk_bf16_f32 v232, v232, v233
    v_mul_f32 v236, v255, v236
    v_mfma_f32_16x16x32_bf16 v[52:55], a[236:239], a[84:87], v[52:55]
    v_cvt_pk_bf16_f32 v233, v234, v235
    v_mul_f32 v237, v255, v237
    v_mfma_f32_16x16x32_bf16 v[48:51], a[236:239], a[80:83], v[48:51]
    v_mul_f32 v238, v255, v238
    v_mul_f32 v239, v255, v239
    v_cvt_pk_bf16_f32 v236, v236, v237
    v_mfma_f32_16x16x32_bf16 v[32:35], a[232:235], a[80:83], v[32:35]
    v_cvt_pk_bf16_f32 v237, v238, v239
    s_waitcnt lgkmcnt(2)
    v_mfma_f32_16x16x32_bf16 v[64:67], a[240:243], a[80:83], v[64:67]
    s_waitcnt vmcnt(8) lgkmcnt(0)
    s_barrier
    v_mfma_f32_16x16x32_bf16 v[80:83], a[244:247], a[80:83], v[80:83]
    ds_read_b64_tr_b16 a[224:225], v240 offset:33792
    ds_read_b64_tr_b16 a[226:227], v240 offset:50688
    v_mfma_f32_16x16x32_bf16 v[84:87], a[244:247], a[84:87], v[84:87]
    ds_read_b64_tr_b16 a[228:229], v240 offset:33824
    ds_read_b64_tr_b16 a[230:231], v240 offset:50720
    ds_write_b64 v251, v[112:113]
    v_mfma_f32_16x16x32_bf16 v[68:71], a[240:243], a[84:87], v[68:71]
    s_lshl_b32 s62, s44, 13
    s_add_u32 s62, s62, 128
    v_mfma_f32_16x16x32_bf16 v[72:75], a[240:243], a[88:91], v[72:75]
    v_lshl_add_u32 v244, v250, 4, s62
    ds_write_b64 v251, v[116:117] offset:1024
    v_mfma_f32_16x16x32_bf16 v[88:91], a[244:247], a[88:91], v[88:91]
    ds_read_b64_tr_b16 a[232:233], v240 offset:33856
    ds_read_b64_tr_b16 a[234:235], v240 offset:50752
    v_mfma_f32_16x16x32_bf16 v[92:95], a[244:247], a[92:95], v[92:95]
    v_subrev_u32 v245, 32, v244
    v_subrev_u32 v246, 64, v244
    ds_write_b64 v252, v[120:121]
    v_mfma_f32_16x16x32_bf16 v[76:79], a[240:243], a[92:95], v[76:79]
    v_subrev_u32 v247, 96, v244
    v_mfma_f32_16x16x32_bf16 v[108:111], a[248:251], a[92:95], v[108:111]
    ds_write_b64 v252, v[124:125] offset:1024
    v_mfma_f32_16x16x32_bf16 v[104:107], a[248:251], a[88:91], v[104:107]
    ds_read_b64_tr_b16 a[236:237], v240 offset:33888
    ds_read_b64_tr_b16 a[238:239], v240 offset:50784
    v_mfma_f32_16x16x32_bf16 v[100:103], a[248:251], a[84:87], v[100:103]
    ds_write_b64 v251, v[128:129] offset:512
    v_mfma_f32_16x16x32_bf16 v[96:99], a[248:251], a[80:83], v[96:99]
    s_waitcnt lgkmcnt(9)
    v_mfma_f32_16x16x32_bf16 v[0:3], a[224:227], a[96:99], v[0:3]
    ds_write_b64 v251, v[132:133] offset:1536
    v_mfma_f32_16x16x32_bf16 v[16:19], a[228:231], a[96:99], v[16:19]
    ds_read_b64_tr_b16 a[240:241], v240 offset:33920
    ds_read_b64_tr_b16 a[242:243], v240 offset:50816
    v_mfma_f32_16x16x32_bf16 v[20:23], a[228:231], a[100:103], v[20:23]
    ds_write_b64 v252, v[136:137] offset:512
    v_mfma_f32_16x16x32_bf16 v[4:7], a[224:227], a[100:103], v[4:7]
    v_mfma_f32_16x16x32_bf16 v[8:11], a[224:227], a[104:107], v[8:11]
    ds_write_b64 v252, v[140:141] offset:1536
    v_mfma_f32_16x16x32_bf16 v[24:27], a[228:231], a[104:107], v[24:27]
    ds_read_b64_tr_b16 a[244:245], v240 offset:33952
    ds_read_b64_tr_b16 a[246:247], v240 offset:50848
    v_mfma_f32_16x16x32_bf16 v[28:31], a[228:231], a[108:111], v[28:31]
    ds_write_b64 v251, v[144:145] offset:4096
    v_mfma_f32_16x16x32_bf16 v[12:15], a[224:227], a[108:111], v[12:15]
    s_waitcnt lgkmcnt(9)
    v_mfma_f32_16x16x32_bf16 v[44:47], a[232:235], a[108:111], v[44:47]
    ds_write_b64 v251, v[148:149] offset:5120
    v_mfma_f32_16x16x32_bf16 v[60:63], a[236:239], a[108:111], v[60:63]
    ds_read_b64_tr_b16 a[248:249], v240 offset:33984
    ds_read_b64_tr_b16 a[250:251], v240 offset:50880
    v_mfma_f32_16x16x32_bf16 v[56:59], a[236:239], a[104:107], v[56:59]
    ds_write_b64 v252, v[152:153] offset:4096
    v_mfma_f32_16x16x32_bf16 v[40:43], a[232:235], a[104:107], v[40:43]
    v_mfma_f32_16x16x32_bf16 v[36:39], a[232:235], a[100:103], v[36:39]
    ds_write_b64 v252, v[156:157] offset:5120
    v_mfma_f32_16x16x32_bf16 v[52:55], a[236:239], a[100:103], v[52:55]
    v_mfma_f32_16x16x32_bf16 v[48:51], a[236:239], a[96:99], v[48:51]
    ds_write_b64 v251, v[160:161] offset:4608
    v_mfma_f32_16x16x32_bf16 v[32:35], a[232:235], a[96:99], v[32:35]
    s_waitcnt lgkmcnt(7)
    v_mfma_f32_16x16x32_bf16 v[64:67], a[240:243], a[96:99], v[64:67]
    s_waitcnt vmcnt(0) lgkmcnt(0)
    s_barrier
    ds_write_b64 v251, v[164:165] offset:5632
    v_mfma_f32_16x16x32_bf16 v[80:83], a[244:247], a[96:99], v[80:83]
    ds_read_b64_tr_b16 a[224:225], v241
    ds_read_b64_tr_b16 a[226:227], v241 offset:16896
    v_mfma_f32_16x16x32_bf16 v[84:87], a[244:247], a[100:103], v[84:87]
    ds_read_b64_tr_b16 a[228:229], v241 offset:32
    ds_read_b64_tr_b16 a[230:231], v241 offset:16928
    ds_write_b64 v252, v[168:169] offset:4608
    v_mfma_f32_16x16x32_bf16 v[68:71], a[240:243], a[100:103], v[68:71]
    v_mfma_f32_16x16x32_bf16 v[72:75], a[240:243], a[104:107], v[72:75]
    ds_write_b64 v252, v[172:173] offset:5632
    v_mfma_f32_16x16x32_bf16 v[88:91], a[244:247], a[104:107], v[88:91]
    ds_read_b64_tr_b16 a[232:233], v241 offset:64
    ds_read_b64_tr_b16 a[234:235], v241 offset:16960
    v_mfma_f32_16x16x32_bf16 v[92:95], a[244:247], a[108:111], v[92:95]
    ds_write_b64 v251, v[176:177] offset:8192
    v_mfma_f32_16x16x32_bf16 v[76:79], a[240:243], a[108:111], v[76:79]
    v_mfma_f32_16x16x32_bf16 v[108:111], a[248:251], a[108:111], v[108:111]
    ds_write_b64 v251, v[180:181] offset:9216
    v_mfma_f32_16x16x32_bf16 v[104:107], a[248:251], a[104:107], v[104:107]
    ds_read_b64_tr_b16 a[236:237], v241 offset:96
    ds_read_b64_tr_b16 a[238:239], v241 offset:16992
    v_mfma_f32_16x16x32_bf16 v[100:103], a[248:251], a[100:103], v[100:103]
    ds_write_b64 v252, v[184:185] offset:8192
    v_mfma_f32_16x16x32_bf16 v[96:99], a[248:251], a[96:99], v[96:99]
    s_waitcnt lgkmcnt(9)
    v_mfma_f32_16x16x32_bf16 v[0:3], a[224:227], a[112:115], v[0:3]
    ds_write_b64 v252, v[188:189] offset:9216
    v_mfma_f32_16x16x32_bf16 v[16:19], a[228:231], a[112:115], v[16:19]
    ds_read_b64_tr_b16 a[240:241], v241 offset:128
    ds_read_b64_tr_b16 a[242:243], v241 offset:17024
    s_add_u32 m0, s47, 33792
    v_mfma_f32_16x16x32_bf16 v[20:23], a[228:231], a[116:119], v[20:23]
    buffer_load_dwordx4 v244, s[12:15], s53 offen lds
    ds_write_b64 v251, v[192:193] offset:8704
    v_mfma_f32_16x16x32_bf16 v[4:7], a[224:227], a[116:119], v[4:7]
    v_mfma_f32_16x16x32_bf16 v[8:11], a[224:227], a[120:123], v[8:11]
    ds_write_b64 v251, v[196:197] offset:9728
    v_mfma_f32_16x16x32_bf16 v[24:27], a[228:231], a[120:123], v[24:27]
    ds_read_b64_tr_b16 a[244:245], v241 offset:160
    ds_read_b64_tr_b16 a[246:247], v241 offset:17056
    v_mfma_f32_16x16x32_bf16 v[28:31], a[228:231], a[124:127], v[28:31]
    buffer_load_dwordx4 v245, s[12:15], s53 offen offset:1056 lds
    ds_write_b64 v252, v[200:201] offset:8704
    v_mfma_f32_16x16x32_bf16 v[12:15], a[224:227], a[124:127], v[12:15]
    s_waitcnt lgkmcnt(9)
    v_mfma_f32_16x16x32_bf16 v[44:47], a[232:235], a[124:127], v[44:47]
    buffer_load_dwordx4 v246, s[12:15], s53 offen offset:2112 lds
    ds_write_b64 v252, v[204:205] offset:9728
    v_mfma_f32_16x16x32_bf16 v[60:63], a[236:239], a[124:127], v[60:63]
    ds_read_b64_tr_b16 a[248:249], v241 offset:192
    ds_read_b64_tr_b16 a[250:251], v241 offset:17088
    v_mfma_f32_16x16x32_bf16 v[56:59], a[236:239], a[120:123], v[56:59]
    ds_write_b64 v251, v[208:209] offset:12288
    v_mfma_f32_16x16x32_bf16 v[40:43], a[232:235], a[120:123], v[40:43]
    buffer_load_dwordx4 v247, s[12:15], s53 offen offset:3168 lds
    v_mfma_f32_16x16x32_bf16 v[36:39], a[232:235], a[116:119], v[36:39]
    ds_write_b64 v251, v[212:213] offset:13312
    v_mfma_f32_16x16x32_bf16 v[52:55], a[236:239], a[116:119], v[52:55]
    v_mfma_f32_16x16x32_bf16 v[48:51], a[236:239], a[112:115], v[48:51]
    ds_write_b64 v252, v[216:217] offset:12288
    v_mfma_f32_16x16x32_bf16 v[32:35], a[232:235], a[112:115], v[32:35]
    s_waitcnt lgkmcnt(7)
    s_add_u32 m0, s47, 38016
    s_add_u32 s53, s53, 4096
    v_mfma_f32_16x16x32_bf16 v[64:67], a[240:243], a[112:115], v[64:67]
    buffer_load_dwordx4 v244, s[12:15], s53 offen lds
    ds_write_b64 v252, v[220:221] offset:13312
    v_mfma_f32_16x16x32_bf16 v[80:83], a[244:247], a[112:115], v[80:83]
    v_mfma_f32_16x16x32_bf16 v[84:87], a[244:247], a[116:119], v[84:87]
    buffer_load_dwordx4 v245, s[12:15], s53 offen offset:1056 lds
    ds_write_b64 v251, v[224:225] offset:12800
    v_mfma_f32_16x16x32_bf16 v[68:71], a[240:243], a[116:119], v[68:71]
    v_mfma_f32_16x16x32_bf16 v[72:75], a[240:243], a[120:123], v[72:75]
    ds_write_b64 v251, v[228:229] offset:13824
    v_mfma_f32_16x16x32_bf16 v[88:91], a[244:247], a[120:123], v[88:91]
    buffer_load_dwordx4 v246, s[12:15], s53 offen offset:2112 lds
    v_mfma_f32_16x16x32_bf16 v[92:95], a[244:247], a[124:127], v[92:95]
    ds_write_b64 v252, v[232:233] offset:12800
    v_mfma_f32_16x16x32_bf16 v[76:79], a[240:243], a[124:127], v[76:79]
    s_waitcnt lgkmcnt(7)
    v_mfma_f32_16x16x32_bf16 v[108:111], a[248:251], a[124:127], v[108:111]
    ds_write_b64 v252, v[236:237] offset:13824
    v_mfma_f32_16x16x32_bf16 v[104:107], a[248:251], a[120:123], v[104:107]
    buffer_load_dwordx4 v247, s[12:15], s53 offen offset:3168 lds
    v_mfma_f32_16x16x32_bf16 v[100:103], a[248:251], a[116:119], v[100:103]
    v_mfma_f32_16x16x32_bf16 v[96:99], a[248:251], a[112:115], v[96:99]
    s_nop 7
    s_branch L_join
L_odd:
    s_lshl_b32 s50, s44, 5
    s_mul_i32 s88, s44, 224
    s_lshl_b32 s48, s44, 12
    s_add_u32 s48, s48, 135168
    s_lshl_b32 s49, s61, 12
    s_lshl_b32 s51, s60, 3
    s_add_u32 s49, s49, s51
    s_add_u32 s49, s49, 151552
    ds_read_b64_tr_b16 a[224:225], v240
    ds_read_b64_tr_b16 a[226:227], v240 offset:256
    ds_read_b64_tr_b16 a[228:229], v240 offset:16896
    ds_read_b64_tr_b16 a[230:231], v240 offset:17152
    ds_read_b64_tr_b16 a[232:233], v240 offset:32
    ds_read_b64_tr_b16 a[234:235], v240 offset:288
    ds_read_b64_tr_b16 a[236:237], v240 offset:16928
    ds_read_b64_tr_b16 a[238:239], v240 offset:17184
    v_mfma_f32_16x16x32_bf16 v[136:139], v[176:179], v[176:179], 0
    v_mfma_f32_16x16x32_bf16 v[140:143], v[180:183], v[180:183], 0
    v_mfma_f32_16x16x32_bf16 v[136:139], v[184:187], v[184:187], v[136:139]
    v_mfma_f32_16x16x32_bf16 v[140:143], v[188:191], v[188:191], v[140:143]
    v_mfma_f32_16x16x32_bf16 v[136:139], v[192:195], v[192:195], v[136:139]
    v_mfma_f32_16x16x32_bf16 v[140:143], v[196:199], v[196:199], v[140:143]
    v_mfma_f32_16x16x32_bf16 v[136:139], v[200:203], v[200:203], v[136:139]
    v_mfma_f32_16x16x32_bf16 v[140:143], v[204:207], v[204:207], v[140:143]
    v_mfma_f32_16x16x32_bf16 v[136:139], v[208:211], v[208:211], v[136:139]
    v_mfma_f32_16x16x32_bf16 v[140:143], v[212:215], v[212:215], v[140:143]
    v_mfma_f32_16x16x32_bf16 v[136:139], v[216:219], v[216:219], v[136:139]
    v_mfma_f32_16x16x32_bf16 v[140:143], v[220:223], v[220:223], v[140:143]
    v_mfma_f32_16x16x32_bf16 v[136:139], v[224:227], v[224:227], v[136:139]
    v_mfma_f32_16x16x32_bf16 v[140:143], v[228:231], v[228:231], v[140:143]
    s_waitcnt lgkmcnt(4)
    v_mfma_f32_16x16x32_bf16 v[0:3], a[224:227], a[0:3], 0
    ds_read_b128 a[32:35], v253 offset:8192
    ds_read_b128 a[36:39], v253 offset:9216
    v_mfma_f32_16x16x32_bf16 v[4:7], a[228:231], a[0:3], 0
    ds_read_b64_tr_b16 a[240:241], v240 offset:512
    ds_read_b64_tr_b16 a[242:243], v240 offset:768
    v_mfma_f32_16x16x32_bf16 v[28:31], a[228:231], a[4:7], 0
    ds_read_b128 a[40:43], v254 offset:8192
    ds_read_b128 a[44:47], v254 offset:9216
    v_mfma_f32_16x16x32_bf16 v[24:27], a[224:227], a[4:7], 0
    ds_read_b128 a[48:51], v253 offset:12288
    ds_read_b128 a[52:55], v253 offset:13312
    v_mfma_f32_16x16x32_bf16 v[48:51], a[224:227], a[8:11], 0
    ds_read_b128 a[56:59], v254 offset:12288
    ds_read_b128 a[60:63], v254 offset:13312
    v_mfma_f32_16x16x32_bf16 v[52:55], a[228:231], a[8:11], 0
    ds_read_b64_tr_b16 a[244:245], v240 offset:17408
    ds_read_b64_tr_b16 a[246:247], v240 offset:17664
    v_mfma_f32_16x16x32_bf16 v[76:79], a[228:231], a[12:15], 0
    ds_read_b128 a[64:67], v253 offset:16384
    ds_read_b128 a[68:71], v253 offset:17408
    v_add_f32 v136, v136, v140
    v_mfma_f32_16x16x32_bf16 v[72:75], a[224:227], a[12:15], 0
    ds_read_b128 a[72:75], v254 offset:16384
    s_waitcnt lgkmcnt(15)
    v_mfma_f32_16x16x32_bf16 v[80:83], a[232:235], a[12:15], 0
    ds_read_b128 a[76:79], v254 offset:17408
    ds_read_b128 a[80:83], v253 offset:20480
    v_mfma_f32_16x16x32_bf16 v[84:87], a[236:239], a[12:15], 0
    ds_read_b64_tr_b16 a[248:249], v240 offset:544
    ds_read_b64_tr_b16 a[250:251], v240 offset:800
    v_mfma_f32_16x16x32_bf16 v[60:63], a[236:239], a[8:11], 0
    ds_read_b128 a[84:87], v253 offset:21504
    ds_read_b128 a[88:91], v254 offset:20480
    v_mfma_f32_16x16x32_bf16 v[56:59], a[232:235], a[8:11], 0
    ds_read_b128 a[92:95], v254 offset:21504
    ds_read_b128 a[96:99], v253 offset:24576
    v_add_f32 v137, v137, v141
    v_mfma_f32_16x16x32_bf16 v[32:35], a[232:235], a[4:7], 0
    ds_read_b128 a[100:103], v253 offset:25600
    ds_read_b128 a[104:107], v254 offset:24576
    v_mfma_f32_16x16x32_bf16 v[36:39], a[236:239], a[4:7], 0
    ds_read_b64_tr_b16 a[224:225], v240 offset:17440
    ds_read_b64_tr_b16 a[226:227], v240 offset:17696
    v_mfma_f32_16x16x32_bf16 v[12:15], a[236:239], a[0:3], 0
    ds_read_b128 a[108:111], v254 offset:25600
    ds_read_b128 a[112:115], v253 offset:28672
    v_mfma_f32_16x16x32_bf16 v[8:11], a[232:235], a[0:3], 0
    ds_read_b128 a[116:119], v253 offset:29696
    s_waitcnt lgkmcnt(15)
    v_mfma_f32_16x16x32_bf16 v[0:3], a[240:243], a[16:19], v[0:3]
    ds_read_b128 a[120:123], v254 offset:28672
    ds_read_b128 a[124:127], v254 offset:29696
    v_add_f32 v138, v138, v142
    v_mfma_f32_16x16x32_bf16 v[4:7], a[244:247], a[16:19], v[4:7]
    v_add_f32 v139, v139, v143
    v_mfma_f32_16x16x32_bf16 v[28:31], a[244:247], a[20:23], v[28:31]
    v_and_b32 v144, 3, v250
    v_mfma_f32_16x16x32_bf16 v[24:27], a[240:243], a[20:23], v[24:27]
    v_cmp_eq_u32 vcc, 1, v144
    v_mfma_f32_16x16x32_bf16 v[48:51], a[240:243], a[24:27], v[48:51]
    s_waitcnt vmcnt(10) lgkmcnt(0)
    s_barrier
    v_mfma_f32_16x16x32_bf16 v[52:55], a[244:247], a[24:27], v[52:55]
    ds_read_b64_tr_b16 a[228:229], v240 offset:33792
    ds_read_b64_tr_b16 a[230:231], v240 offset:34048
    v_bfe_u32 v145, v250, 2, 2
    v_mfma_f32_16x16x32_bf16 v[76:79], a[244:247], a[28:31], v[76:79]
    ds_read_b64_tr_b16 a[232:233], v240 offset:50688
    ds_read_b64_tr_b16 a[234:235], v240 offset:50944
    v_mfma_f32_16x16x32_bf16 v[72:75], a[240:243], a[28:31], v[72:75]
    v_add_u32 v253, s52, v253
    v_add_u32 v254, s52, v254
    v_mfma_f32_16x16x32_bf16 v[80:83], a[248:251], a[28:31], v[80:83]
    v_cndmask_b32 v136, v136, v137, vcc
    v_mfma_f32_16x16x32_bf16 v[84:87], a[224:227], a[28:31], v[84:87]
    ds_read_b64_tr_b16 a[236:237], v240 offset:33824
    ds_read_b64_tr_b16 a[238:239], v240 offset:34080
    v_mfma_f32_16x16x32_bf16 v[60:63], a[224:227], a[24:27], v[60:63]
    ds_read_b128 a[128:131], v253 offset:32768
    ds_read_b128 a[132:135], v253 offset:33792
    v_cmp_eq_u32 vcc, 2, v144
    v_mfma_f32_16x16x32_bf16 v[56:59], a[248:251], a[24:27], v[56:59]
    ds_read_b128 a[136:139], v254 offset:32768
    ds_read_b128 a[140:143], v254 offset:33792
    v_mfma_f32_16x16x32_bf16 v[32:35], a[248:251], a[20:23], v[32:35]
    ds_read_b128 a[144:147], v253 offset:36864
    ds_read_b128 a[148:151], v253 offset:37888
    v_mfma_f32_16x16x32_bf16 v[36:39], a[224:227], a[20:23], v[36:39]
    ds_read_b64_tr_b16 a[240:241], v240 offset:50720
    ds_read_b64_tr_b16 a[242:243], v240 offset:50976
    v_mfma_f32_16x16x32_bf16 v[12:15], a[224:227], a[16:19], v[12:15]
    ds_read_b128 a[152:155], v254 offset:36864
    ds_read_b128 a[156:159], v254 offset:37888
    v_mfma_f32_16x16x32_bf16 v[8:11], a[248:251], a[16:19], v[8:11]
    ds_read_b128 a[160:163], v253 offset:40960
    v_lshrrev_b32 v146, 4, v250
    s_waitcnt lgkmcnt(13)
    v_mfma_f32_16x16x32_bf16 v[0:3], a[228:231], a[32:35], v[0:3]
    s_add_u32 m0, s47, 101376
    s_mov_b32 s62, 0x000a8000
    buffer_load_dwordx4 v244, s[28:31], s62 offen lds
    v_mfma_f32_16x16x32_bf16 v[4:7], a[232:235], a[32:35], v[4:7]
    ds_read_b64_tr_b16 a[244:245], v240 offset:34304
    ds_read_b64_tr_b16 a[246:247], v240 offset:34560
    s_mov_b32 s63, 0x000a89e0
    v_mfma_f32_16x16x32_bf16 v[28:31], a[232:235], a[36:39], v[28:31]
    buffer_load_dwordx4 v244, s[28:31], s63 offen offset:1056 lds
    v_mfma_f32_16x16x32_bf16 v[24:27], a[228:231], a[36:39], v[24:27]
    ds_read_b128 a[164:167], v253 offset:41984
    s_mov_b32 s62, 0x000a93c0
    v_mfma_f32_16x16x32_bf16 v[48:51], a[228:231], a[40:43], v[48:51]
    buffer_load_dwordx4 v244, s[28:31], s62 offen offset:2112 lds
    v_cndmask_b32 v136, v136, v138, vcc
    v_mfma_f32_16x16x32_bf16 v[52:55], a[232:235], a[40:43], v[52:55]
    ds_read_b64_tr_b16 a[248:249], v240 offset:51200
    ds_read_b64_tr_b16 a[250:251], v240 offset:51456
    s_mov_b32 s63, 0x000a9da0
    v_mfma_f32_16x16x32_bf16 v[76:79], a[232:235], a[44:47], v[76:79]
    buffer_load_dwordx4 v244, s[28:31], s63 offen offset:3168 lds
    v_mfma_f32_16x16x32_bf16 v[72:75], a[228:231], a[44:47], v[72:75]
    s_waitcnt lgkmcnt(8)
    s_add_u32 m0, s47, 105600
    s_mov_b32 s62, 0x000af000
    v_mfma_f32_16x16x32_bf16 v[80:83], a[236:239], a[44:47], v[80:83]
    buffer_load_dwordx4 v244, s[28:31], s62 offen lds
    v_mfma_f32_16x16x32_bf16 v[84:87], a[240:243], a[44:47], v[84:87]
    ds_read_b64_tr_b16 a[224:225], v240 offset:34336
    ds_read_b64_tr_b16 a[226:227], v240 offset:34592
    s_mov_b32 s63, 0x000af9e0
    v_mfma_f32_16x16x32_bf16 v[60:63], a[240:243], a[40:43], v[60:63]
    buffer_load_dwordx4 v244, s[28:31], s63 offen offset:1056 lds
    v_mfma_f32_16x16x32_bf16 v[56:59], a[236:239], a[40:43], v[56:59]
    ds_read_b128 a[168:171], v254 offset:40960
    s_mov_b32 s62, 0x000b03c0
    v_mfma_f32_16x16x32_bf16 v[32:35], a[236:239], a[36:39], v[32:35]
    buffer_load_dwordx4 v244, s[28:31], s62 offen offset:2112 lds
    v_mfma_f32_16x16x32_bf16 v[36:39], a[240:243], a[36:39], v[36:39]
    ds_read_b64_tr_b16 a[228:229], v240 offset:51232
    ds_read_b64_tr_b16 a[230:231], v240 offset:51488
    s_mov_b32 s63, 0x000b0da0
    v_mfma_f32_16x16x32_bf16 v[12:15], a[240:243], a[32:35], v[12:15]
    buffer_load_dwordx4 v244, s[28:31], s63 offen offset:3168 lds
    v_cmp_eq_u32 vcc, 3, v144
    v_mfma_f32_16x16x32_bf16 v[8:11], a[236:239], a[32:35], v[8:11]
    s_waitcnt lgkmcnt(5)
    s_add_u32 m0, s47, 0
    s_mov_b32 s62, 0x000e0000
    v_mfma_f32_16x16x32_bf16 v[0:3], a[244:247], a[48:51], v[0:3]
    buffer_load_dwordx4 v244, s[28:31], s62 offen lds
    v_mfma_f32_16x16x32_bf16 v[4:7], a[248:251], a[48:51], v[4:7]
    ds_read_b128 a[172:175], v254 offset:41984
    s_mov_b32 s63, 0x000e09e0
    v_mfma_f32_16x16x32_bf16 v[28:31], a[248:251], a[52:55], v[28:31]
    buffer_load_dwordx4 v244, s[28:31], s63 offen offset:1056 lds
    s_mov_b32 s62, 0x000e13c0
    v_mfma_f32_16x16x32_bf16 v[24:27], a[244:247], a[52:55], v[24:27]
    buffer_load_dwordx4 v244, s[28:31], s62 offen offset:2112 lds
    v_mul_f32 v238, v238, v238
    v_mfma_f32_16x16x32_bf16 v[48:51], a[244:247], a[56:59], v[48:51]
    s_waitcnt vmcnt(13) lgkmcnt(0)
    s_barrier
    v_mfma_f32_16x16x32_bf16 v[52:55], a[248:251], a[56:59], v[52:55]
    ds_read_b64_tr_b16 a[232:233], v241
    ds_read_b64_tr_b16 a[234:235], v241 offset:256
    v_mfma_f32_16x16x32_bf16 v[76:79], a[248:251], a[60:63], v[76:79]
    ds_read_b64_tr_b16 a[236:237], v241 offset:16896
    ds_read_b64_tr_b16 a[238:239], v241 offset:17152
    v_mfma_f32_16x16x32_bf16 v[72:75], a[244:247], a[60:63], v[72:75]
    s_mov_b32 s63, 0x000e1da0
    v_mfma_f32_16x16x32_bf16 v[80:83], a[224:227], a[60:63], v[80:83]
    buffer_load_dwordx4 v244, s[28:31], s63 offen offset:3168 lds
    v_cndmask_b32 v136, v136, v139, vcc
    v_mfma_f32_16x16x32_bf16 v[84:87], a[228:231], a[60:63], v[84:87]
    ds_read_b64_tr_b16 a[240:241], v241 offset:32
    ds_read_b64_tr_b16 a[242:243], v241 offset:288
    s_add_u32 m0, s47, 4224
    s_mov_b32 s62, 0x000e7000
    v_mfma_f32_16x16x32_bf16 v[60:63], a[228:231], a[56:59], v[60:63]
    buffer_load_dwordx4 v244, s[28:31], s62 offen lds
    s_mov_b32 s63, 0x000e79e0
    v_mfma_f32_16x16x32_bf16 v[56:59], a[224:227], a[56:59], v[56:59]
    buffer_load_dwordx4 v244, s[28:31], s63 offen offset:1056 lds
    s_mov_b32 s62, 0x000e83c0
    v_mfma_f32_16x16x32_bf16 v[32:35], a[224:227], a[52:55], v[32:35]
    buffer_load_dwordx4 v244, s[28:31], s62 offen offset:2112 lds
    v_mfma_f32_16x16x32_bf16 v[36:39], a[228:231], a[52:55], v[36:39]
    ds_read_b64_tr_b16 a[244:245], v241 offset:16928
    ds_read_b64_tr_b16 a[246:247], v241 offset:17184
    s_mov_b32 s63, 0x000e8da0
    v_mfma_f32_16x16x32_bf16 v[12:15], a[228:231], a[48:51], v[12:15]
    buffer_load_dwordx4 v244, s[28:31], s63 offen offset:3168 lds
    v_mfma_f32_16x16x32_bf16 v[8:11], a[224:227], a[48:51], v[8:11]
    ds_read_b128 a[176:179], v253 offset:45056
    s_waitcnt lgkmcnt(5)
    v_mfma_f32_16x16x32_bf16 v[0:3], a[232:235], a[64:67], v[0:3]
    ds_read_b128 a[180:183], v253 offset:46080
    ds_read_b128 a[184:187], v254 offset:45056
    v_mfma_f32_16x16x32_bf16 v[4:7], a[236:239], a[64:67], v[4:7]
    ds_read_b64_tr_b16 a[248:249], v241 offset:512
    ds_read_b64_tr_b16 a[250:251], v241 offset:768
    s_add_u32 m0, s47, 33792
    s_mov_b32 s62, 0x00118000
    v_mfma_f32_16x16x32_bf16 v[28:31], a[236:239], a[68:71], v[28:31]
    buffer_load_dwordx4 v244, s[28:31], s62 offen lds
    v_cmp_eq_u32 vcc, v145, v146
    v_mfma_f32_16x16x32_bf16 v[24:27], a[232:235], a[68:71], v[24:27]
    ds_read_b128 a[188:191], v254 offset:46080
    ds_read_b128 a[192:195], v253 offset:49152
    v_mfma_f32_16x16x32_bf16 v[48:51], a[232:235], a[72:75], v[48:51]
    ds_read_b128 a[196:199], v253 offset:50176
    ds_read_b128 a[200:203], v254 offset:49152
    v_mfma_f32_16x16x32_bf16 v[52:55], a[236:239], a[72:75], v[52:55]
    ds_read_b64_tr_b16 a[224:225], v241 offset:17408
    ds_read_b64_tr_b16 a[226:227], v241 offset:17664
    s_mov_b32 s63, 0x001189e0
    v_mfma_f32_16x16x32_bf16 v[76:79], a[236:239], a[76:79], v[76:79]
    buffer_load_dwordx4 v244, s[28:31], s63 offen offset:1056 lds
    v_mfma_f32_16x16x32_bf16 v[72:75], a[232:235], a[76:79], v[72:75]
    ds_read_b128 a[204:207], v254 offset:50176
    v_mov_b32 v144, 0x3b124925
    s_waitcnt lgkmcnt(12)
    v_mfma_f32_16x16x32_bf16 v[80:83], a[240:243], a[76:79], v[80:83]
    ds_read_b128 a[208:211], v253 offset:53248
    ds_read_b128 a[212:215], v253 offset:54272
    v_mfma_f32_16x16x32_bf16 v[84:87], a[244:247], a[76:79], v[84:87]
    ds_read_b64_tr_b16 a[228:229], v241 offset:544
    ds_read_b64_tr_b16 a[230:231], v241 offset:800
    s_mov_b32 s62, 0x001193c0
    v_mfma_f32_16x16x32_bf16 v[60:63], a[244:247], a[72:75], v[60:63]
    buffer_load_dwordx4 v244, s[28:31], s62 offen offset:2112 lds
    v_mfma_f32_16x16x32_bf16 v[56:59], a[240:243], a[72:75], v[56:59]
    ds_read_b128 a[216:219], v254 offset:53248
    ds_read_b128 a[220:223], v254 offset:54272
    v_mfma_f32_16x16x32_bf16 v[32:35], a[240:243], a[68:71], v[32:35]
    v_cndmask_b32 v136, 0, v136, vcc
    v_mfma_f32_16x16x32_bf16 v[36:39], a[244:247], a[68:71], v[36:39]
    ds_read_b64_tr_b16 a[232:233], v241 offset:17440
    ds_read_b64_tr_b16 a[234:235], v241 offset:17696
    s_mov_b32 s63, 0x00119da0
    v_mfma_f32_16x16x32_bf16 v[12:15], a[244:247], a[64:67], v[12:15]
    buffer_load_dwordx4 v244, s[28:31], s63 offen offset:3168 lds
    v_mfma_f32_16x16x32_bf16 v[8:11], a[240:243], a[64:67], v[8:11]
    v_mov_b32 v137, v136
    s_waitcnt lgkmcnt(9)
    v_mfma_f32_16x16x32_bf16 v[0:3], a[248:251], a[80:83], v[0:3]
    s_add_u32 m0, s47, 38016
    s_mov_b32 s62, 0x0011f000
    v_mfma_f32_16x16x32_bf16 v[4:7], a[224:227], a[80:83], v[4:7]
    buffer_load_dwordx4 v244, s[28:31], s62 offen lds
    v_permlane32_swap_b32 v136, v137
    v_mfma_f32_16x16x32_bf16 v[28:31], a[224:227], a[84:87], v[28:31]
    v_add_f32 v136, v136, v137
    s_mov_b32 s63, 0x0011f9e0
    v_mfma_f32_16x16x32_bf16 v[24:27], a[248:251], a[84:87], v[24:27]
    buffer_load_dwordx4 v244, s[28:31], s63 offen offset:1056 lds
    v_mfma_f32_16x16x32_bf16 v[48:51], a[248:251], a[88:91], v[48:51]
    s_waitcnt vmcnt(14) lgkmcnt(0)
    s_barrier
    v_mfma_f32_16x16x32_bf16 v[52:55], a[224:227], a[88:91], v[52:55]
    ds_read_b64_tr_b16 a[236:237], v241 offset:33792
    ds_read_b64_tr_b16 a[238:239], v241 offset:34048
    v_mfma_f32_16x16x32_bf16 v[76:79], a[224:227], a[92:95], v[76:79]
    ds_read_b64_tr_b16 a[240:241], v241 offset:50688
    ds_read_b64_tr_b16 a[242:243], v241 offset:50944
    v_mov_b32 v137, v136
    v_mfma_f32_16x16x32_bf16 v[72:75], a[248:251], a[92:95], v[72:75]
    s_nop 0
    v_permlane16_swap_b32 v136, v137
    v_mfma_f32_16x16x32_bf16 v[80:83], a[228:231], a[92:95], v[80:83]
    v_add_f32 v136, v136, v137
    s_mov_b32 s55, 0x5f800000
    v_mfma_f32_16x16x32_bf16 v[84:87], a[232:235], a[92:95], v[84:87]
    ds_read_b64_tr_b16 a[244:245], v241 offset:33824
    ds_read_b64_tr_b16 a[246:247], v241 offset:34080
    s_mov_b32 s62, 0x001203c0
    v_mfma_f32_16x16x32_bf16 v[60:63], a[232:235], a[88:91], v[60:63]
    buffer_load_dwordx4 v244, s[28:31], s62 offen offset:2112 lds
    v_mfma_f32_16x16x32_bf16 v[56:59], a[228:231], a[88:91], v[56:59]
    v_fma_f32 v136, v136, v144, -v238
    s_mov_b32 s53, 0
    v_mfma_f32_16x16x32_bf16 v[32:35], a[228:231], a[84:87], v[32:35]
    v_max_f32 v136, 0, v136
    s_mov_b32 s54, 0
    v_mfma_f32_16x16x32_bf16 v[36:39], a[232:235], a[84:87], v[36:39]
    ds_read_b64_tr_b16 a[248:249], v241 offset:50720
    ds_read_b64_tr_b16 a[250:251], v241 offset:50976
    s_mov_b32 s63, 0x00120da0
    v_mfma_f32_16x16x32_bf16 v[12:15], a[232:235], a[80:83], v[12:15]
    buffer_load_dwordx4 v244, s[28:31], s63 offen offset:3168 lds
    v_mfma_f32_16x16x32_bf16 v[8:11], a[228:231], a[80:83], v[8:11]
    v_cvt_pk_bf16_f32 v136, v136, v136
    s_waitcnt lgkmcnt(4)
    v_mfma_f32_16x16x32_bf16 v[0:3], a[236:239], a[96:99], v[0:3]
    v_and_b32 v136, 0xffff0000, v136
    v_mfma_f32_16x16x32_bf16 v[4:7], a[240:243], a[96:99], v[4:7]
    ds_read_b64_tr_b16 a[224:225], v241 offset:34304
    ds_read_b64_tr_b16 a[226:227], v241 offset:34560
    s_add_u32 m0, s47, 67584
    s_mov_b32 s62, 0x00150000
    v_mfma_f32_16x16x32_bf16 v[28:31], a[240:243], a[100:103], v[28:31]
    buffer_load_dwordx4 v244, s[28:31], s62 offen lds
    v_mfma_f32_16x16x32_bf16 v[24:27], a[236:239], a[100:103], v[24:27]
    v_add_f32 v136, 0x3727c5ac, v136
    v_mfma_f32_16x16x32_bf16 v[48:51], a[236:239], a[104:107], v[48:51]
    v_cvt_pk_bf16_f32 v136, v136, v136
    v_mfma_f32_16x16x32_bf16 v[52:55], a[240:243], a[104:107], v[52:55]
    ds_read_b64_tr_b16 a[228:229], v241 offset:51200
    ds_read_b64_tr_b16 a[230:231], v241 offset:51456
    s_mov_b32 s63, 0x001509e0
    v_mfma_f32_16x16x32_bf16 v[76:79], a[240:243], a[108:111], v[76:79]
    buffer_load_dwordx4 v244, s[28:31], s63 offen offset:1056 lds
    v_mfma_f32_16x16x32_bf16 v[72:75], a[236:239], a[108:111], v[72:75]
    v_and_b32 v136, 0xffff0000, v136
    s_waitcnt lgkmcnt(4)
    v_mfma_f32_16x16x32_bf16 v[80:83], a[244:247], a[108:111], v[80:83]
    v_sqrt_f32 v136, v136
    v_mfma_f32_16x16x32_bf16 v[84:87], a[248:251], a[108:111], v[84:87]
    ds_read_b64_tr_b16 a[232:233], v241 offset:34336
    ds_read_b64_tr_b16 a[234:235], v241 offset:34592
    s_mov_b32 s62, 0x001513c0
    v_mfma_f32_16x16x32_bf16 v[60:63], a[248:251], a[104:107], v[60:63]
    buffer_load_dwordx4 v244, s[28:31], s62 offen offset:2112 lds
    v_cvt_pk_bf16_f32 v136, v136, v136
    v_mfma_f32_16x16x32_bf16 v[56:59], a[244:247], a[104:107], v[56:59]
    v_and_b32 v136, 0xffff0000, v136
    v_mfma_f32_16x16x32_bf16 v[32:35], a[244:247], a[100:103], v[32:35]
    ds_write_b32 v255, v136 offset:57344
    v_mfma_f32_16x16x32_bf16 v[36:39], a[248:251], a[100:103], v[36:39]
    ds_read_b64_tr_b16 a[236:237], v241 offset:51232
    ds_read_b64_tr_b16 a[238:239], v241 offset:51488
    s_mov_b32 s63, 0x00151da0
    v_mfma_f32_16x16x32_bf16 v[12:15], a[248:251], a[96:99], v[12:15]
    buffer_load_dwordx4 v244, s[28:31], s63 offen offset:3168 lds
    v_mfma_f32_16x16x32_bf16 v[8:11], a[244:247], a[96:99], v[8:11]
    s_waitcnt lgkmcnt(5)
    v_mfma_f32_16x16x32_bf16 v[0:3], a[224:227], a[112:115], v[0:3]
    s_add_u32 m0, s47, 71808
    s_mov_b32 s62, 0x00157000
    v_mfma_f32_16x16x32_bf16 v[4:7], a[228:231], a[112:115], v[4:7]
    buffer_load_dwordx4 v244, s[28:31], s62 offen lds
    v_mfma_f32_16x16x32_bf16 v[28:31], a[228:231], a[116:119], v[28:31]
    s_mov_b32 s63, 0x001579e0
    v_mfma_f32_16x16x32_bf16 v[24:27], a[224:227], a[116:119], v[24:27]
    buffer_load_dwordx4 v244, s[28:31], s63 offen offset:1056 lds
    v_mfma_f32_16x16x32_bf16 v[48:51], a[224:227], a[120:123], v[48:51]
    s_waitcnt vmcnt(14) lgkmcnt(0)
    s_barrier
    v_mfma_f32_16x16x32_bf16 v[52:55], a[228:231], a[120:123], v[52:55]
    ds_read_b64_tr_b16 a[240:241], v240
    ds_read_b64_tr_b16 a[242:243], v240 offset:256
    v_mfma_f32_16x16x32_bf16 v[76:79], a[228:231], a[124:127], v[76:79]
    ds_read_b64_tr_b16 a[244:245], v240 offset:16896
    ds_read_b64_tr_b16 a[246:247], v240 offset:17152
    v_mfma_f32_16x16x32_bf16 v[72:75], a[224:227], a[124:127], v[72:75]
    ds_read_b32 a252, v253 offset:57344
    v_mfma_f32_16x16x32_bf16 v[80:83], a[232:235], a[124:127], v[80:83]
    ds_read_b32 a253, v253 offset:58368
    ds_read_b32 a254, v254 offset:57344
    v_mfma_f32_16x16x32_bf16 v[84:87], a[236:239], a[124:127], v[84:87]
    ds_read_b64_tr_b16 a[248:249], v240 offset:32
    ds_read_b64_tr_b16 a[250:251], v240 offset:288
    s_mov_b32 s62, 0x001583c0
    v_mfma_f32_16x16x32_bf16 v[60:63], a[236:239], a[120:123], v[60:63]
    buffer_load_dwordx4 v244, s[28:31], s62 offen offset:2112 lds
    v_mfma_f32_16x16x32_bf16 v[56:59], a[232:235], a[120:123], v[56:59]
    ds_read_b32 a255, v254 offset:58368
    v_mfma_f32_16x16x32_bf16 v[32:35], a[232:235], a[116:119], v[32:35]
    v_mfma_f32_16x16x32_bf16 v[36:39], a[236:239], a[116:119], v[36:39]
    ds_read_b64_tr_b16 a[224:225], v240 offset:16928
    ds_read_b64_tr_b16 a[226:227], v240 offset:17184
    s_mov_b32 s63, 0x00158da0
    v_mfma_f32_16x16x32_bf16 v[12:15], a[236:239], a[112:115], v[12:15]
    buffer_load_dwordx4 v244, s[28:31], s63 offen offset:3168 lds
    v_mfma_f32_16x16x32_bf16 v[8:11], a[232:235], a[112:115], v[8:11]
    s_waitcnt lgkmcnt(8)
    v_mfma_f32_16x16x32_bf16 v[0:3], a[240:243], a[128:131], v[0:3]
    v_mfma_f32_16x16x32_bf16 v[4:7], a[244:247], a[128:131], v[4:7]
    ds_read_b64_tr_b16 a[228:229], v240 offset:512
    ds_read_b64_tr_b16 a[230:231], v240 offset:768
    s_add_u32 m0, s47, 101376
    s_mov_b32 s62, 0x00000100
    v_mfma_f32_16x16x32_bf16 v[28:31], a[244:247], a[132:135], v[28:31]
    buffer_load_dwordx4 v239, s[28:31], s62 offen lds
    v_mfma_f32_16x16x32_bf16 v[24:27], a[240:243], a[132:135], v[24:27]
    v_mfma_f32_16x16x32_bf16 v[48:51], a[240:243], a[136:139], v[48:51]
    v_mfma_f32_16x16x32_bf16 v[52:55], a[244:247], a[136:139], v[52:55]
    ds_read_b64_tr_b16 a[232:233], v240 offset:17408
    ds_read_b64_tr_b16 a[234:235], v240 offset:17664
    s_mov_b32 s63, 0x00000ae0
    v_mfma_f32_16x16x32_bf16 v[76:79], a[244:247], a[140:143], v[76:79]
    buffer_load_dwordx4 v239, s[28:31], s63 offen offset:1056 lds
    v_mfma_f32_16x16x32_bf16 v[72:75], a[240:243], a[140:143], v[72:75]
    s_waitcnt lgkmcnt(4)
    v_mfma_f32_16x16x32_bf16 v[80:83], a[248:251], a[140:143], v[80:83]
    v_mfma_f32_16x16x32_bf16 v[84:87], a[224:227], a[140:143], v[84:87]
    ds_read_b64_tr_b16 a[236:237], v240 offset:544
    ds_read_b64_tr_b16 a[238:239], v240 offset:800
    s_mov_b32 s62, 0x000014c0
    v_mfma_f32_16x16x32_bf16 v[60:63], a[224:227], a[136:139], v[60:63]
    buffer_load_dwordx4 v239, s[28:31], s62 offen offset:2112 lds
    v_mfma_f32_16x16x32_bf16 v[56:59], a[248:251], a[136:139], v[56:59]
    v_mfma_f32_16x16x32_bf16 v[32:35], a[248:251], a[132:135], v[32:35]
    v_mfma_f32_16x16x32_bf16 v[36:39], a[224:227], a[132:135], v[36:39]
    ds_read_b64_tr_b16 a[240:241], v240 offset:17440
    ds_read_b64_tr_b16 a[242:243], v240 offset:17696
    s_mov_b32 s63, 0x00001ea0
    v_mfma_f32_16x16x32_bf16 v[12:15], a[224:227], a[128:131], v[12:15]
    buffer_load_dwordx4 v239, s[28:31], s63 offen offset:3168 lds
    v_mfma_f32_16x16x32_bf16 v[8:11], a[248:251], a[128:131], v[8:11]
    s_waitcnt lgkmcnt(4)
    v_mfma_f32_16x16x32_bf16 v[0:3], a[228:231], a[144:147], v[0:3]
    s_add_u32 m0, s47, 105600
    s_mov_b32 s62, 0x00007100
    v_mfma_f32_16x16x32_bf16 v[4:7], a[232:235], a[144:147], v[4:7]
    buffer_load_dwordx4 v239, s[28:31], s62 offen lds
    v_mfma_f32_16x16x32_bf16 v[28:31], a[232:235], a[148:151], v[28:31]
    s_mov_b32 s63, 0x00007ae0
    v_mfma_f32_16x16x32_bf16 v[24:27], a[228:231], a[148:151], v[24:27]
    buffer_load_dwordx4 v239, s[28:31], s63 offen offset:1056 lds
    v_mfma_f32_16x16x32_bf16 v[48:51], a[228:231], a[152:155], v[48:51]
    s_waitcnt vmcnt(14) lgkmcnt(0)
    s_barrier
    v_mfma_f32_16x16x32_bf16 v[52:55], a[232:235], a[152:155], v[52:55]
    ds_read_b64_tr_b16 a[244:245], v240 offset:33792
    ds_read_b64_tr_b16 a[246:247], v240 offset:34048
    v_mfma_f32_16x16x32_bf16 v[76:79], a[232:235], a[156:159], v[76:79]
    ds_read_b64_tr_b16 a[248:249], v240 offset:50688
    ds_read_b64_tr_b16 a[250:251], v240 offset:50944
    v_mfma_f32_16x16x32_bf16 v[72:75], a[228:231], a[156:159], v[72:75]
    v_accvgpr_read_b32 v255, a252
    v_mfma_f32_16x16x32_bf16 v[80:83], a[236:239], a[156:159], v[80:83]
    v_rcp_f32 v242, v255
    v_mfma_f32_16x16x32_bf16 v[84:87], a[240:243], a[156:159], v[84:87]
    ds_read_b64_tr_b16 a[224:225], v240 offset:33824
    ds_read_b64_tr_b16 a[226:227], v240 offset:34080
    s_mov_b32 s62, 0x000084c0
    v_mfma_f32_16x16x32_bf16 v[60:63], a[240:243], a[152:155], v[60:63]
    buffer_load_dwordx4 v239, s[28:31], s62 offen offset:2112 lds
    v_mfma_f32_16x16x32_bf16 v[56:59], a[236:239], a[152:155], v[56:59]
    v_mul_f32 v255, v255, v255
    v_mfma_f32_16x16x32_bf16 v[32:35], a[236:239], a[148:151], v[32:35]
    v_mul_f32 v243, 0xbdd2d3e8, v242
    v_mfma_f32_16x16x32_bf16 v[36:39], a[240:243], a[148:151], v[36:39]
    ds_read_b64_tr_b16 a[228:229], v240 offset:50720
    ds_read_b64_tr_b16 a[230:231], v240 offset:50976
    s_mov_b32 s63, 0x00008ea0
    v_mfma_f32_16x16x32_bf16 v[12:15], a[240:243], a[144:147], v[12:15]
    buffer_load_dwordx4 v239, s[28:31], s63 offen offset:3168 lds
    v_mfma_f32_16x16x32_bf16 v[8:11], a[236:239], a[144:147], v[8:11]
    v_mul_f32 v243, v243, v242
    s_waitcnt lgkmcnt(4)
    v_mfma_f32_16x16x32_bf16 v[0:3], a[244:247], a[160:163], v[0:3]
    v_mul_f32 v243, v243, v242
    v_mfma_f32_16x16x32_bf16 v[4:7], a[248:251], a[160:163], v[4:7]
    ds_read_b64_tr_b16 a[232:233], v240 offset:34304
    ds_read_b64_tr_b16 a[234:235], v240 offset:34560
    s_add_u32 m0, s47, 0
    s_mov_b32 s62, 0x00070100
    v_mfma_f32_16x16x32_bf16 v[28:31], a[248:251], a[164:167], v[28:31]
    buffer_load_dwordx4 v239, s[28:31], s62 offen lds
    v_mfma_f32_16x16x32_bf16 v[24:27], a[244:247], a[164:167], v[24:27]
    v_mul_f32 v242, 0xc0135761, v242
    v_mfma_f32_16x16x32_bf16 v[48:51], a[244:247], a[168:171], v[48:51]
    v_mfma_f32_16x16x32_bf16 v[52:55], a[248:251], a[168:171], v[52:55]
    ds_read_b64_tr_b16 a[236:237], v240 offset:51200
    ds_read_b64_tr_b16 a[238:239], v240 offset:51456
    s_mov_b32 s63, 0x00070ae0
    v_mfma_f32_16x16x32_bf16 v[76:79], a[248:251], a[172:175], v[76:79]
    buffer_load_dwordx4 v239, s[28:31], s63 offen offset:1056 lds
    v_mfma_f32_16x16x32_bf16 v[72:75], a[244:247], a[172:175], v[72:75]
    s_waitcnt lgkmcnt(4)
    v_mfma_f32_16x16x32_bf16 v[80:83], a[224:227], a[172:175], v[80:83]
    v_mfma_f32_16x16x32_bf16 v[84:87], a[228:231], a[172:175], v[84:87]
    ds_read_b64_tr_b16 a[240:241], v240 offset:34336
    ds_read_b64_tr_b16 a[242:243], v240 offset:34592
    s_mov_b32 s62, 0x000714c0
    v_mfma_f32_16x16x32_bf16 v[60:63], a[228:231], a[168:171], v[60:63]
    buffer_load_dwordx4 v239, s[28:31], s62 offen offset:2112 lds
    v_mfma_f32_16x16x32_bf16 v[56:59], a[224:227], a[168:171], v[56:59]
    v_mfma_f32_16x16x32_bf16 v[32:35], a[224:227], a[164:167], v[32:35]
    v_mfma_f32_16x16x32_bf16 v[36:39], a[228:231], a[164:167], v[36:39]
    ds_read_b64_tr_b16 a[244:245], v240 offset:51232
    ds_read_b64_tr_b16 a[246:247], v240 offset:51488
    s_mov_b32 s63, 0x00071ea0
    v_mfma_f32_16x16x32_bf16 v[12:15], a[228:231], a[160:163], v[12:15]
    buffer_load_dwordx4 v239, s[28:31], s63 offen offset:3168 lds
    v_mfma_f32_16x16x32_bf16 v[8:11], a[224:227], a[160:163], v[8:11]
    s_waitcnt lgkmcnt(4)
    v_mfma_f32_16x16x32_bf16 v[0:3], a[232:235], a[176:179], v[0:3]
    s_add_u32 m0, s47, 4224
    s_mov_b32 s62, 0x00077100
    v_mfma_f32_16x16x32_bf16 v[4:7], a[236:239], a[176:179], v[4:7]
    buffer_load_dwordx4 v239, s[28:31], s62 offen lds
    v_mfma_f32_16x16x32_bf16 v[28:31], a[236:239], a[180:183], v[28:31]
    s_mov_b32 s63, 0x00077ae0
    v_mfma_f32_16x16x32_bf16 v[24:27], a[232:235], a[180:183], v[24:27]
    buffer_load_dwordx4 v239, s[28:31], s63 offen offset:1056 lds
    v_mfma_f32_16x16x32_bf16 v[48:51], a[232:235], a[184:187], v[48:51]
    s_waitcnt vmcnt(14) lgkmcnt(0)
    s_barrier
    v_mfma_f32_16x16x32_bf16 v[52:55], a[236:239], a[184:187], v[52:55]
    ds_read_b64_tr_b16 a[248:249], v241
    ds_read_b64_tr_b16 a[250:251], v241 offset:256
    v_mfma_f32_16x16x32_bf16 v[76:79], a[236:239], a[188:191], v[76:79]
    ds_read_b64_tr_b16 a[224:225], v241 offset:16896
    ds_read_b64_tr_b16 a[226:227], v241 offset:17152
    v_mfma_f32_16x16x32_bf16 v[72:75], a[232:235], a[188:191], v[72:75]
    v_mfma_f32_16x16x32_bf16 v[80:83], a[240:243], a[188:191], v[80:83]
    v_mfma_f32_16x16x32_bf16 v[84:87], a[244:247], a[188:191], v[84:87]
    ds_read_b64_tr_b16 a[228:229], v241 offset:32
    ds_read_b64_tr_b16 a[230:231], v241 offset:288
    s_mov_b32 s62, 0x000784c0
    v_mfma_f32_16x16x32_bf16 v[60:63], a[244:247], a[184:187], v[60:63]
    buffer_load_dwordx4 v239, s[28:31], s62 offen offset:2112 lds
    v_mfma_f32_16x16x32_bf16 v[56:59], a[240:243], a[184:187], v[56:59]
    v_mfma_f32_16x16x32_bf16 v[32:35], a[240:243], a[180:183], v[32:35]
    v_mfma_f32_16x16x32_bf16 v[36:39], a[244:247], a[180:183], v[36:39]
    ds_read_b64_tr_b16 a[232:233], v241 offset:16928
    ds_read_b64_tr_b16 a[234:235], v241 offset:17184
    s_mov_b32 s63, 0x00078ea0
    v_mfma_f32_16x16x32_bf16 v[12:15], a[244:247], a[176:179], v[12:15]
    buffer_load_dwordx4 v239, s[28:31], s63 offen offset:3168 lds
    v_mfma_f32_16x16x32_bf16 v[8:11], a[240:243], a[176:179], v[8:11]
    s_waitcnt lgkmcnt(4)
    v_mfma_f32_16x16x32_bf16 v[0:3], a[248:251], a[192:195], v[0:3]
    v_mfma_f32_16x16x32_bf16 v[4:7], a[224:227], a[192:195], v[4:7]
    ds_read_b64_tr_b16 a[236:237], v241 offset:512
    ds_read_b64_tr_b16 a[238:239], v241 offset:768
    s_add_u32 m0, s47, 33792
    s_mov_b32 s62, 0x000e0100
    v_mfma_f32_16x16x32_bf16 v[28:31], a[224:227], a[196:199], v[28:31]
    buffer_load_dwordx4 v239, s[28:31], s62 offen lds
    v_mfma_f32_16x16x32_bf16 v[24:27], a[248:251], a[196:199], v[24:27]
    v_mfma_f32_16x16x32_bf16 v[48:51], a[248:251], a[200:203], v[48:51]
    v_mfma_f32_16x16x32_bf16 v[52:55], a[224:227], a[200:203], v[52:55]
    ds_read_b64_tr_b16 a[240:241], v241 offset:17408
    ds_read_b64_tr_b16 a[242:243], v241 offset:17664
    s_mov_b32 s63, 0x000e0ae0
    v_mfma_f32_16x16x32_bf16 v[76:79], a[224:227], a[204:207], v[76:79]
    buffer_load_dwordx4 v239, s[28:31], s63 offen offset:1056 lds
    v_mfma_f32_16x16x32_bf16 v[72:75], a[248:251], a[204:207], v[72:75]
    s_waitcnt lgkmcnt(4)
    v_mfma_f32_16x16x32_bf16 v[80:83], a[228:231], a[204:207], v[80:83]
    v_mfma_f32_16x16x32_bf16 v[84:87], a[232:235], a[204:207], v[84:87]
    ds_read_b64_tr_b16 a[244:245], v241 offset:544
    ds_read_b64_tr_b16 a[246:247], v241 offset:800
    s_mov_b32 s62, 0x000e14c0
    v_mfma_f32_16x16x32_bf16 v[60:63], a[232:235], a[200:203], v[60:63]
    buffer_load_dwordx4 v239, s[28:31], s62 offen offset:2112 lds
    v_mfma_f32_16x16x32_bf16 v[56:59], a[228:231], a[200:203], v[56:59]
    v_mfma_f32_16x16x32_bf16 v[32:35], a[228:231], a[196:199], v[32:35]
    v_mfma_f32_16x16x32_bf16 v[36:39], a[232:235], a[196:199], v[36:39]
    ds_read_b64_tr_b16 a[248:249], v241 offset:17440
    ds_read_b64_tr_b16 a[250:251], v241 offset:17696
    s_mov_b32 s63, 0x000e1ea0
    v_mfma_f32_16x16x32_bf16 v[12:15], a[232:235], a[192:195], v[12:15]
    buffer_load_dwordx4 v239, s[28:31], s63 offen offset:3168 lds
    v_mfma_f32_16x16x32_bf16 v[8:11], a[228:231], a[192:195], v[8:11]
    s_waitcnt lgkmcnt(4)
    v_mfma_f32_16x16x32_bf16 v[0:3], a[236:239], a[208:211], v[0:3]
    s_add_u32 m0, s47, 38016
    s_mov_b32 s62, 0x000e7100
    v_mfma_f32_16x16x32_bf16 v[4:7], a[240:243], a[208:211], v[4:7]
    buffer_load_dwordx4 v239, s[28:31], s62 offen lds
    v_mfma_f32_16x16x32_bf16 v[28:31], a[240:243], a[212:215], v[28:31]
    s_mov_b32 s63, 0x000e7ae0
    v_mfma_f32_16x16x32_bf16 v[24:27], a[236:239], a[212:215], v[24:27]
    buffer_load_dwordx4 v239, s[28:31], s63 offen offset:1056 lds
    v_mfma_f32_16x16x32_bf16 v[48:51], a[236:239], a[216:219], v[48:51]
    s_waitcnt vmcnt(14) lgkmcnt(0)
    s_barrier
    v_mfma_f32_16x16x32_bf16 v[52:55], a[240:243], a[216:219], v[52:55]
    v_subrev_u32 v241, s50, v241
    ds_read_b64_tr_b16 a[224:225], v241 offset:33792
    v_mfma_f32_16x16x32_bf16 v[76:79], a[240:243], a[220:223], v[76:79]
    ds_read_b64_tr_b16 a[226:227], v241 offset:33920
    ds_read_b64_tr_b16 a[228:229], v241 offset:50688
    v_mfma_f32_16x16x32_bf16 v[72:75], a[236:239], a[220:223], v[72:75]
    ds_read_b64_tr_b16 a[230:231], v241 offset:50816
    v_mfma_f32_16x16x32_bf16 v[80:83], a[244:247], a[220:223], v[80:83]
    v_mfma_f32_16x16x32_bf16 v[84:87], a[248:251], a[220:223], v[84:87]
    ds_read_b64_tr_b16 a[232:233], v241 offset:34048
    ds_read_b64_tr_b16 a[234:235], v241 offset:34176
    s_mov_b32 s62, 0x000e84c0
    v_mfma_f32_16x16x32_bf16 v[60:63], a[248:251], a[216:219], v[60:63]
    buffer_load_dwordx4 v239, s[28:31], s62 offen offset:2112 lds
    v_mfma_f32_16x16x32_bf16 v[56:59], a[244:247], a[216:219], v[56:59]
    v_mfma_f32_16x16x32_bf16 v[32:35], a[244:247], a[212:215], v[32:35]
    v_mfma_f32_16x16x32_bf16 v[36:39], a[248:251], a[212:215], v[36:39]
    ds_read_b64_tr_b16 a[236:237], v241 offset:50944
    ds_read_b64_tr_b16 a[238:239], v241 offset:51072
    s_mov_b32 s63, 0x000e8ea0
    v_mfma_f32_16x16x32_bf16 v[12:15], a[248:251], a[208:211], v[12:15]
    buffer_load_dwordx4 v239, s[28:31], s63 offen offset:3168 lds
    v_mfma_f32_16x16x32_bf16 v[8:11], a[244:247], a[208:211], v[8:11]
    s_waitcnt lgkmcnt(4)
    v_mfma_f32_16x16x32_bf16 v[16:19], a[224:227], a[0:3], 0
    v_mfma_f32_16x16x32_bf16 v[20:23], a[228:231], a[0:3], 0
    ds_read_b64_tr_b16 a[240:241], v241 offset:34304
    ds_read_b64_tr_b16 a[242:243], v241 offset:34432
    s_add_u32 m0, s47, 67584
    s_mov_b32 s62, 0x00150100
    v_mfma_f32_16x16x32_bf16 v[44:47], a[228:231], a[4:7], 0
    buffer_load_dwordx4 v239, s[28:31], s62 offen lds
    v_mfma_f32_16x16x32_bf16 v[40:43], a[224:227], a[4:7], 0
    v_mul_f32 v251, v0, v0
    v_mul_f32 v252, v1, v1
    v_mfma_f32_16x16x32_bf16 v[64:67], a[224:227], a[8:11], 0
    v_mul_f32 v253, v2, v2
    v_mul_f32 v254, v3, v3
    v_fma_f32 v251, v251, v243, v242
    v_mfma_f32_16x16x32_bf16 v[68:71], a[228:231], a[8:11], 0
    ds_read_b64_tr_b16 a[244:245], v241 offset:51200
    ds_read_b64_tr_b16 a[246:247], v241 offset:51328
    s_mov_b32 s63, 0x00150ae0
    v_mfma_f32_16x16x32_bf16 v[92:95], a[228:231], a[12:15], 0
    buffer_load_dwordx4 v239, s[28:31], s63 offen offset:1056 lds
    v_fma_f32 v252, v252, v243, v242
    v_mfma_f32_16x16x32_bf16 v[88:91], a[224:227], a[12:15], 0
    v_fma_f32 v253, v253, v243, v242
    v_fma_f32 v254, v254, v243, v242
    s_waitcnt lgkmcnt(4)
    v_mfma_f32_16x16x32_bf16 v[88:91], a[232:235], a[28:31], v[88:91]
    v_mul_f32 v251, v251, v0
    v_mul_f32 v252, v252, v1
    v_mfma_f32_16x16x32_bf16 v[92:95], a[236:239], a[28:31], v[92:95]
    ds_read_b64_tr_b16 a[248:249], v241 offset:34560
    ds_read_b64_tr_b16 a[250:251], v241 offset:34688
    s_mov_b32 s62, 0x001514c0
    v_mfma_f32_16x16x32_bf16 v[68:71], a[236:239], a[24:27], v[68:71]
    buffer_load_dwordx4 v239, s[28:31], s62 offen offset:2112 lds
    v_mul_f32 v253, v253, v2
    v_mfma_f32_16x16x32_bf16 v[64:67], a[232:235], a[24:27], v[64:67]
    v_mul_f32 v254, v254, v3
    v_mul_f32 v4, v4, v0
    v_mfma_f32_16x16x32_bf16 v[40:43], a[232:235], a[20:23], v[40:43]
    v_exp_f32 v251, v251
    v_mul_f32 v5, v5, v1
    v_mfma_f32_16x16x32_bf16 v[44:47], a[236:239], a[20:23], v[44:47]
    ds_read_b64_tr_b16 a[224:225], v241 offset:51456
    ds_read_b64_tr_b16 a[226:227], v241 offset:51584
    s_mov_b32 s63, 0x00151ea0
    v_mfma_f32_16x16x32_bf16 v[20:23], a[236:239], a[16:19], v[20:23]
    buffer_load_dwordx4 v239, s[28:31], s63 offen offset:3168 lds
    v_mfma_f32_16x16x32_bf16 v[16:19], a[232:235], a[16:19], v[16:19]
    v_exp_f32 v252, v252
    s_waitcnt lgkmcnt(4)
    v_mfma_f32_16x16x32_bf16 v[16:19], a[240:243], a[32:35], v[16:19]
    v_fma_f32 v251, v251, v255, v255
    s_add_u32 m0, s47, 71808
    s_mov_b32 s62, 0x00157100
    v_mfma_f32_16x16x32_bf16 v[20:23], a[244:247], a[32:35], v[20:23]
    buffer_load_dwordx4 v239, s[28:31], s62 offen lds
    v_mfma_f32_16x16x32_bf16 v[44:47], a[244:247], a[36:39], v[44:47]
    v_exp_f32 v253, v253
    s_mov_b32 s63, 0x00157ae0
    v_mfma_f32_16x16x32_bf16 v[40:43], a[240:243], a[36:39], v[40:43]
    buffer_load_dwordx4 v239, s[28:31], s63 offen offset:1056 lds
    v_fma_f32 v252, v252, v255, v255
    v_mfma_f32_16x16x32_bf16 v[64:67], a[240:243], a[40:43], v[64:67]
    s_waitcnt vmcnt(14) lgkmcnt(0)
    s_barrier
    v_mfma_f32_16x16x32_bf16 v[68:71], a[244:247], a[40:43], v[68:71]
    v_subrev_u32 v240, s50, v240
    ds_read_b64_tr_b16 a[228:229], v240
    v_fma_f32 v253, v253, v255, v255
    v_mfma_f32_16x16x32_bf16 v[92:95], a[244:247], a[44:47], v[92:95]
    ds_read_b64_tr_b16 a[230:231], v240 offset:128
    ds_read_b64_tr_b16 a[232:233], v240 offset:16896
    v_mul_f32 v6, v6, v2
    v_mfma_f32_16x16x32_bf16 v[88:91], a[240:243], a[44:47], v[88:91]
    ds_read_b64_tr_b16 a[234:235], v240 offset:17024
    v_mfma_f32_16x16x32_bf16 v[88:91], a[248:251], a[60:63], v[88:91]
    v_exp_f32 v254, v254
    v_mul_f32 v7, v7, v3
    v_mfma_f32_16x16x32_bf16 v[92:95], a[224:227], a[60:63], v[92:95]
    ds_read_b64_tr_b16 a[236:237], v240 offset:256
    ds_read_b64_tr_b16 a[238:239], v240 offset:384
    s_mov_b32 s62, 0x001584c0
    v_mfma_f32_16x16x32_bf16 v[68:71], a[224:227], a[56:59], v[68:71]
    buffer_load_dwordx4 v239, s[28:31], s62 offen offset:2112 lds
    v_fma_f32 v254, v254, v255, v255
    v_mfma_f32_16x16x32_bf16 v[64:67], a[248:251], a[56:59], v[64:67]
    v_rcp_f32 v251, v251
    v_mfma_f32_16x16x32_bf16 v[40:43], a[248:251], a[52:55], v[40:43]
    v_rcp_f32 v252, v252
    v_mfma_f32_16x16x32_bf16 v[44:47], a[224:227], a[52:55], v[44:47]
    ds_read_b64_tr_b16 a[240:241], v240 offset:17152
    ds_read_b64_tr_b16 a[242:243], v240 offset:17280
    s_mov_b32 s63, 0x00158ea0
    v_mfma_f32_16x16x32_bf16 v[20:23], a[224:227], a[48:51], v[20:23]
    buffer_load_dwordx4 v239, s[28:31], s63 offen offset:3168 lds
    v_mul_f32 v4, v4, v251
    v_mfma_f32_16x16x32_bf16 v[16:19], a[248:251], a[48:51], v[16:19]
    v_mul_f32 v5, v5, v252
    s_waitcnt lgkmcnt(4)
    v_mfma_f32_16x16x32_bf16 v[16:19], a[228:231], a[64:67], v[16:19]
    v_rcp_f32 v253, v253
    v_cvt_pk_bf16_f32 v0, v4, v5
    v_mfma_f32_16x16x32_bf16 v[20:23], a[232:235], a[64:67], v[20:23]
    ds_read_b64_tr_b16 a[244:245], v240 offset:512
    ds_read_b64_tr_b16 a[246:247], v240 offset:640
    s_add_u32 m0, s47, 101376
    s_mov_b32 s62, 0x00000000
    v_mfma_f32_16x16x32_bf16 v[44:47], a[232:235], a[68:71], v[44:47]
    buffer_load_dwordx4 v245, s[20:23], s62 offen lds
    v_mfma_f32_16x16x32_bf16 v[40:43], a[228:231], a[68:71], v[40:43]
    v_rcp_f32 v254, v254
    v_mul_f32 v6, v6, v253
    v_mfma_f32_16x16x32_bf16 v[64:67], a[228:231], a[72:75], v[64:67]
    v_mul_f32 v7, v7, v254
    v_mul_f32 v251, v8, v8
    v_mul_f32 v252, v9, v9
    v_mfma_f32_16x16x32_bf16 v[68:71], a[232:235], a[72:75], v[68:71]
    ds_read_b64_tr_b16 a[248:249], v240 offset:17408
    ds_read_b64_tr_b16 a[250:251], v240 offset:17536
    s_mov_b32 s63, 0x00001be0
    v_mfma_f32_16x16x32_bf16 v[92:95], a[232:235], a[76:79], v[92:95]
    buffer_load_dwordx4 v245, s[20:23], s63 offen offset:1056 lds
    v_cvt_pk_bf16_f32 v1, v6, v7
    v_mfma_f32_16x16x32_bf16 v[88:91], a[228:231], a[76:79], v[88:91]
    v_accvgpr_read_b32 v6, a253
    v_mul_f32 v253, v10, v10
    s_waitcnt lgkmcnt(4)
    v_mfma_f32_16x16x32_bf16 v[88:91], a[236:239], a[92:95], v[88:91]
    v_rcp_f32 v4, v6
    v_mul_f32 v254, v11, v11
    v_mfma_f32_16x16x32_bf16 v[92:95], a[240:243], a[92:95], v[92:95]
    ds_read_b64_tr_b16 a[224:225], v240 offset:768
    ds_read_b64_tr_b16 a[226:227], v240 offset:896
    s_mov_b32 s62, 0x000037c0
    v_mfma_f32_16x16x32_bf16 v[68:71], a[240:243], a[88:91], v[68:71]
    buffer_load_dwordx4 v245, s[20:23], s62 offen offset:2112 lds
    v_mul_f32 v6, v6, v6
    v_mfma_f32_16x16x32_bf16 v[64:67], a[236:239], a[88:91], v[64:67]
    v_mul_f32 v5, 0xbdd2d3e8, v4
    v_fma_f32 v251, v251, v243, v242
    v_mfma_f32_16x16x32_bf16 v[40:43], a[236:239], a[84:87], v[40:43]
    v_mul_f32 v5, v5, v4
    v_fma_f32 v252, v252, v243, v242
    v_fma_f32 v253, v253, v243, v242
    v_mfma_f32_16x16x32_bf16 v[44:47], a[240:243], a[84:87], v[44:47]
    ds_read_b64_tr_b16 a[228:229], v240 offset:17664
    ds_read_b64_tr_b16 a[230:231], v240 offset:17792
    s_mov_b32 s63, 0x000053a0
    v_mfma_f32_16x16x32_bf16 v[20:23], a[240:243], a[80:83], v[20:23]
    buffer_load_dwordx4 v245, s[20:23], s63 offen offset:3168 lds
    v_mul_f32 v5, v5, v4
    v_mfma_f32_16x16x32_bf16 v[16:19], a[236:239], a[80:83], v[16:19]
    v_mul_f32 v4, 0xc0135761, v4
    v_fma_f32 v254, v254, v243, v242
    s_waitcnt lgkmcnt(4)
    v_mfma_f32_16x16x32_bf16 v[16:19], a[244:247], a[96:99], v[16:19]
    s_add_u32 m0, s47, 105600
    s_mov_b32 s62, 0x00010000
    v_mfma_f32_16x16x32_bf16 v[20:23], a[248:251], a[96:99], v[20:23]
    buffer_load_dwordx4 v245, s[20:23], s62 offen lds
    v_mul_f32 v251, v251, v8
    v_mfma_f32_16x16x32_bf16 v[44:47], a[248:251], a[100:103], v[44:47]
    v_mul_f32 v252, v252, v9
    v_mul_f32 v253, v253, v10
    s_mov_b32 s63, 0x00011be0
    v_mfma_f32_16x16x32_bf16 v[40:43], a[244:247], a[100:103], v[40:43]
    buffer_load_dwordx4 v245, s[20:23], s63 offen offset:1056 lds
    v_mfma_f32_16x16x32_bf16 v[64:67], a[244:247], a[104:107], v[64:67]
    s_waitcnt vmcnt(14) lgkmcnt(0)
    s_barrier
    v_mul_f32 v254, v254, v11
    v_mfma_f32_16x16x32_bf16 v[68:71], a[248:251], a[104:107], v[68:71]
    ds_read_b64_tr_b16 a[232:233], v240 offset:33792
    ds_read_b64_tr_b16 a[234:235], v240 offset:33920
    v_mul_f32 v12, v12, v8
    v_mfma_f32_16x16x32_bf16 v[92:95], a[248:251], a[108:111], v[92:95]
    ds_read_b64_tr_b16 a[236:237], v240 offset:50688
    ds_read_b64_tr_b16 a[238:239], v240 offset:50816
    v_mfma_f32_16x16x32_bf16 v[88:91], a[244:247], a[108:111], v[88:91]
    v_exp_f32 v251, v251
    v_mfma_f32_16x16x32_bf16 v[88:91], a[224:227], a[124:127], v[88:91]
    v_exp_f32 v252, v252
    v_fma_f32 v251, v251, v255, v255
    v_mfma_f32_16x16x32_bf16 v[92:95], a[228:231], a[124:127], v[92:95]
    ds_read_b64_tr_b16 a[240:241], v240 offset:34048
    ds_read_b64_tr_b16 a[242:243], v240 offset:34176
    s_mov_b32 s62, 0x000137c0
    v_mfma_f32_16x16x32_bf16 v[68:71], a[228:231], a[120:123], v[68:71]
    buffer_load_dwordx4 v245, s[20:23], s62 offen offset:2112 lds
    v_fma_f32 v252, v252, v255, v255
    v_mfma_f32_16x16x32_bf16 v[64:67], a[224:227], a[120:123], v[64:67]
    v_exp_f32 v253, v253
    v_mul_f32 v13, v13, v9
    v_mfma_f32_16x16x32_bf16 v[40:43], a[224:227], a[116:119], v[40:43]
    v_exp_f32 v254, v254
    v_mfma_f32_16x16x32_bf16 v[44:47], a[228:231], a[116:119], v[44:47]
    ds_read_b64_tr_b16 a[244:245], v240 offset:50944
    ds_read_b64_tr_b16 a[246:247], v240 offset:51072
    s_mov_b32 s63, 0x000153a0
    v_mfma_f32_16x16x32_bf16 v[20:23], a[228:231], a[112:115], v[20:23]
    buffer_load_dwordx4 v245, s[20:23], s63 offen offset:3168 lds
    v_fma_f32 v253, v253, v255, v255
    v_mfma_f32_16x16x32_bf16 v[16:19], a[224:227], a[112:115], v[16:19]
    v_fma_f32 v254, v254, v255, v255
    s_waitcnt lgkmcnt(4)
    v_mfma_f32_16x16x32_bf16 v[16:19], a[232:235], a[128:131], v[16:19]
    v_rcp_f32 v251, v251
    v_mul_f32 v14, v14, v10
    v_mfma_f32_16x16x32_bf16 v[20:23], a[236:239], a[128:131], v[20:23]
    ds_read_b64_tr_b16 a[248:249], v240 offset:34304
    ds_read_b64_tr_b16 a[250:251], v240 offset:34432
    s_add_u32 m0, s47, 0
    s_mov_b32 s62, 0x00040000
    v_mfma_f32_16x16x32_bf16 v[44:47], a[236:239], a[132:135], v[44:47]
    buffer_load_dwordx4 v245, s[20:23], s62 offen lds
    v_mul_f32 v15, v15, v11
    v_mfma_f32_16x16x32_bf16 v[40:43], a[232:235], a[132:135], v[40:43]
    v_rcp_f32 v252, v252
    v_mul_f32 v12, v12, v251
    v_mfma_f32_16x16x32_bf16 v[64:67], a[232:235], a[136:139], v[64:67]
    v_rcp_f32 v253, v253
    v_mfma_f32_16x16x32_bf16 v[68:71], a[236:239], a[136:139], v[68:71]
    ds_read_b64_tr_b16 a[224:225], v240 offset:51200
    ds_read_b64_tr_b16 a[226:227], v240 offset:51328
    s_mov_b32 s63, 0x00041be0
    v_mfma_f32_16x16x32_bf16 v[92:95], a[236:239], a[140:143], v[92:95]
    buffer_load_dwordx4 v245, s[20:23], s63 offen offset:1056 lds
    v_mul_f32 v13, v13, v252
    v_mfma_f32_16x16x32_bf16 v[88:91], a[232:235], a[140:143], v[88:91]
    v_mul_f32 v14, v14, v253
    s_waitcnt lgkmcnt(4)
    v_mfma_f32_16x16x32_bf16 v[88:91], a[240:243], a[156:159], v[88:91]
    v_rcp_f32 v254, v254
    v_cvt_pk_bf16_f32 v2, v12, v13
    v_mfma_f32_16x16x32_bf16 v[92:95], a[244:247], a[156:159], v[92:95]
    ds_read_b64_tr_b16 a[228:229], v240 offset:34560
    ds_read_b64_tr_b16 a[230:231], v240 offset:34688
    s_mov_b32 s62, 0x000437c0
    v_mfma_f32_16x16x32_bf16 v[68:71], a[244:247], a[152:155], v[68:71]
    buffer_load_dwordx4 v245, s[20:23], s62 offen offset:2112 lds
    v_mfma_f32_16x16x32_bf16 v[64:67], a[240:243], a[152:155], v[64:67]
    v_mul_f32 v15, v15, v254
    v_add_u32 v12, s48, v248
    v_mul_f32 v251, v24, v24
    v_mfma_f32_16x16x32_bf16 v[40:43], a[240:243], a[148:151], v[40:43]
    v_cvt_pk_bf16_f32 v3, v14, v15
    v_mul_f32 v252, v25, v25
    v_mul_f32 v253, v26, v26
    v_mfma_f32_16x16x32_bf16 v[44:47], a[244:247], a[148:151], v[44:47]
    ds_read_b64_tr_b16 a[232:233], v240 offset:51456
    ds_read_b64_tr_b16 a[234:235], v240 offset:51584
    s_mov_b32 s63, 0x000453a0
    v_mfma_f32_16x16x32_bf16 v[20:23], a[244:247], a[144:147], v[20:23]
    buffer_load_dwordx4 v245, s[20:23], s63 offen offset:3168 lds
    ds_write_b128 v12, v[0:3]
    v_mfma_f32_16x16x32_bf16 v[16:19], a[240:243], a[144:147], v[16:19]
    v_mul_f32 v254, v27, v27
    v_fma_f32 v251, v251, v5, v4
    s_waitcnt lgkmcnt(5)
    v_mfma_f32_16x16x32_bf16 v[16:19], a[248:251], a[160:163], v[16:19]
    s_add_u32 m0, s47, 4224
    s_mov_b32 s62, 0x00050000
    v_mfma_f32_16x16x32_bf16 v[20:23], a[224:227], a[160:163], v[20:23]
    buffer_load_dwordx4 v245, s[20:23], s62 offen lds
    v_fma_f32 v252, v252, v5, v4
    v_mfma_f32_16x16x32_bf16 v[44:47], a[224:227], a[164:167], v[44:47]
    v_fma_f32 v253, v253, v5, v4
    v_fma_f32 v254, v254, v5, v4
    s_mov_b32 s63, 0x00051be0
    v_mfma_f32_16x16x32_bf16 v[40:43], a[248:251], a[164:167], v[40:43]
    buffer_load_dwordx4 v245, s[20:23], s63 offen offset:1056 lds
    v_mfma_f32_16x16x32_bf16 v[64:67], a[248:251], a[168:171], v[64:67]
    s_waitcnt vmcnt(14) lgkmcnt(0)
    s_barrier
    v_mul_f32 v251, v251, v24
    v_mfma_f32_16x16x32_bf16 v[68:71], a[224:227], a[168:171], v[68:71]
    ds_read_b64_tr_b16 a[236:237], v241
    ds_read_b64_tr_b16 a[238:239], v241 offset:128
    v_mfma_f32_16x16x32_bf16 v[92:95], a[224:227], a[172:175], v[92:95]
    ds_read_b64_tr_b16 a[240:241], v241 offset:16896
    ds_read_b64_tr_b16 a[242:243], v241 offset:17024
    v_mul_f32 v252, v252, v25
    v_mfma_f32_16x16x32_bf16 v[88:91], a[248:251], a[172:175], v[88:91]
    v_mul_f32 v253, v253, v26
    v_mul_f32 v254, v254, v27
    v_mfma_f32_16x16x32_bf16 v[88:91], a[228:231], a[188:191], v[88:91]
    v_exp_f32 v251, v251
    v_mfma_f32_16x16x32_bf16 v[92:95], a[232:235], a[188:191], v[92:95]
    ds_read_b64_tr_b16 a[244:245], v241 offset:256
    ds_read_b64_tr_b16 a[246:247], v241 offset:384
    s_mov_b32 s62, 0x000537c0
    v_mfma_f32_16x16x32_bf16 v[68:71], a[232:235], a[184:187], v[68:71]
    buffer_load_dwordx4 v245, s[20:23], s62 offen offset:2112 lds
    v_fma_f32 v251, v251, v6, v6
    v_mfma_f32_16x16x32_bf16 v[64:67], a[228:231], a[184:187], v[64:67]
    v_exp_f32 v252, v252
    v_mfma_f32_16x16x32_bf16 v[40:43], a[228:231], a[180:183], v[40:43]
    v_exp_f32 v253, v253
    v_fma_f32 v252, v252, v6, v6
    v_mfma_f32_16x16x32_bf16 v[44:47], a[232:235], a[180:183], v[44:47]
    ds_read_b64_tr_b16 a[248:249], v241 offset:17152
    ds_read_b64_tr_b16 a[250:251], v241 offset:17280
    s_mov_b32 s63, 0x000553a0
    v_mfma_f32_16x16x32_bf16 v[20:23], a[232:235], a[176:179], v[20:23]
    buffer_load_dwordx4 v245, s[20:23], s63 offen offset:3168 lds
    v_mfma_f32_16x16x32_bf16 v[16:19], a[228:231], a[176:179], v[16:19]
    v_exp_f32 v254, v254
    s_waitcnt lgkmcnt(4)
    v_mfma_f32_16x16x32_bf16 v[16:19], a[236:239], a[192:195], v[16:19]
    s_add_u32 m0, s47, 33792
    s_mov_b32 s62, 0x00080000
    buffer_load_dwordx4 v245, s[20:23], s62 offen lds
    v_mfma_f32_16x16x32_bf16 v[20:23], a[240:243], a[192:195], v[20:23]
    v_fma_f32 v253, v253, v6, v6
    s_mov_b32 s63, 0x00081be0
    v_mfma_f32_16x16x32_bf16 v[44:47], a[240:243], a[196:199], v[44:47]
    buffer_load_dwordx4 v245, s[20:23], s63 offen offset:1056 lds
    s_mov_b32 s62, 0x000837c0
    v_mfma_f32_16x16x32_bf16 v[40:43], a[236:239], a[196:199], v[40:43]
    buffer_load_dwordx4 v245, s[20:23], s62 offen offset:2112 lds
    v_fma_f32 v254, v254, v6, v6
    v_mfma_f32_16x16x32_bf16 v[64:67], a[236:239], a[200:203], v[64:67]
    s_waitcnt vmcnt(11) lgkmcnt(0)
    s_barrier
    v_mfma_f32_16x16x32_bf16 v[68:71], a[240:243], a[200:203], v[68:71]
    v_add_u32 v241, s88, v241
    ds_read_b64_tr_b16 a[224:225], v241 offset:33792
    v_mul_f32 v28, v28, v24
    v_mfma_f32_16x16x32_bf16 v[92:95], a[240:243], a[204:207], v[92:95]
    ds_read_b64_tr_b16 a[226:227], v241 offset:50688
    ds_read_b64_tr_b16 a[228:229], v241 offset:33824
    v_mul_f32 v29, v29, v25
    v_mfma_f32_16x16x32_bf16 v[88:91], a[236:239], a[204:207], v[88:91]
    ds_read_b64_tr_b16 a[230:231], v241 offset:50720
    s_mov_b32 s63, 0x000853a0
    v_mfma_f32_16x16x32_bf16 v[88:91], a[244:247], a[220:223], v[88:91]
    buffer_load_dwordx4 v245, s[20:23], s63 offen offset:3168 lds
    v_mul_f32 v30, v30, v26
    v_mfma_f32_16x16x32_bf16 v[92:95], a[248:251], a[220:223], v[92:95]
    ds_read_b64_tr_b16 a[232:233], v241 offset:33856
    ds_read_b64_tr_b16 a[234:235], v241 offset:50752
    s_add_u32 m0, s47, 38016
    s_mov_b32 s62, 0x00090000
    v_mfma_f32_16x16x32_bf16 v[68:71], a[248:251], a[216:219], v[68:71]
    buffer_load_dwordx4 v245, s[20:23], s62 offen lds
    s_mov_b32 s63, 0x00091be0
    v_mfma_f32_16x16x32_bf16 v[64:67], a[244:247], a[216:219], v[64:67]
    buffer_load_dwordx4 v245, s[20:23], s63 offen offset:1056 lds
    s_mov_b32 s62, 0x000937c0
    v_mfma_f32_16x16x32_bf16 v[40:43], a[244:247], a[212:215], v[40:43]
    buffer_load_dwordx4 v245, s[20:23], s62 offen offset:2112 lds
    v_mfma_f32_16x16x32_bf16 v[44:47], a[248:251], a[212:215], v[44:47]
    ds_read_b64_tr_b16 a[236:237], v241 offset:33888
    ds_read_b64_tr_b16 a[238:239], v241 offset:50784
    s_mov_b32 s63, 0x000953a0
    v_mfma_f32_16x16x32_bf16 v[20:23], a[248:251], a[208:211], v[20:23]
    buffer_load_dwordx4 v245, s[20:23], s63 offen offset:3168 lds
    v_mul_f32 v31, v31, v27
    v_mfma_f32_16x16x32_bf16 v[16:19], a[244:247], a[208:211], v[16:19]
    s_waitcnt lgkmcnt(4)
    v_mfma_f32_16x16x32_bf16 v[112:115], a[224:227], a[0:3], 0
    v_rcp_f32 v251, v251
    v_mfma_f32_16x16x32_bf16 v[128:131], a[228:231], a[0:3], 0
    ds_read_b64_tr_b16 a[240:241], v241 offset:33920
    ds_read_b64_tr_b16 a[242:243], v241 offset:50816
    s_add_u32 m0, s47, 67584
    s_mov_b32 s62, 0x000c0000
    v_mfma_f32_16x16x32_bf16 v[132:135], a[228:231], a[4:7], 0
    buffer_load_dwordx4 v245, s[20:23], s62 offen lds
    v_mfma_f32_16x16x32_bf16 v[116:119], a[224:227], a[4:7], 0
    v_rcp_f32 v252, v252
    v_mul_f32 v28, v28, v251
    v_mfma_f32_16x16x32_bf16 v[120:123], a[224:227], a[8:11], 0
    v_rcp_f32 v253, v253
    v_mul_f32 v29, v29, v252
    v_mfma_f32_16x16x32_bf16 v[136:139], a[228:231], a[8:11], 0
    ds_read_b64_tr_b16 a[244:245], v241 offset:33952
    ds_read_b64_tr_b16 a[246:247], v241 offset:50848
    s_mov_b32 s63, 0x000c1be0
    v_mfma_f32_16x16x32_bf16 v[140:143], a[228:231], a[12:15], 0
    buffer_load_dwordx4 v245, s[20:23], s63 offen offset:1056 lds
    v_mul_f32 v30, v30, v253
    v_mfma_f32_16x16x32_bf16 v[124:127], a[224:227], a[12:15], 0
    v_rcp_f32 v254, v254
    s_waitcnt lgkmcnt(4)
    v_mfma_f32_16x16x32_bf16 v[156:159], a[232:235], a[12:15], 0
    v_mul_f32 v31, v31, v254
    v_cvt_pk_bf16_f32 v24, v28, v29
    v_mfma_f32_16x16x32_bf16 v[172:175], a[236:239], a[12:15], 0
    ds_read_b64_tr_b16 a[248:249], v241 offset:33984
    ds_read_b64_tr_b16 a[250:251], v241 offset:50880
    s_mov_b32 s62, 0x000c37c0
    v_mfma_f32_16x16x32_bf16 v[168:171], a[236:239], a[8:11], 0
    buffer_load_dwordx4 v245, s[20:23], s62 offen offset:2112 lds
    v_cvt_pk_bf16_f32 v25, v30, v31
    v_mfma_f32_16x16x32_bf16 v[152:155], a[232:235], a[8:11], 0
    v_accvgpr_read_b32 v30, a254
    v_mul_f32 v251, v32, v32
    v_mfma_f32_16x16x32_bf16 v[148:151], a[232:235], a[4:7], 0
    v_rcp_f32 v28, v30
    v_mul_f32 v252, v33, v33
    v_mul_f32 v253, v34, v34
    v_mfma_f32_16x16x32_bf16 v[164:167], a[236:239], a[4:7], 0
    ds_read_b64_tr_b16 a[224:225], v241 offset:34016
    ds_read_b64_tr_b16 a[226:227], v241 offset:50912
    s_mov_b32 s63, 0x000c53a0
    v_mfma_f32_16x16x32_bf16 v[160:163], a[236:239], a[0:3], 0
    buffer_load_dwordx4 v245, s[20:23], s63 offen offset:3168 lds
    v_mul_f32 v30, v30, v30
    v_mfma_f32_16x16x32_bf16 v[144:147], a[232:235], a[0:3], 0
    v_mul_f32 v29, 0xbdd2d3e8, v28
    v_mul_f32 v254, v35, v35
    s_waitcnt lgkmcnt(4)
    v_mfma_f32_16x16x32_bf16 v[176:179], a[240:243], a[0:3], 0
    s_add_u32 m0, s47, 71808
    s_mov_b32 s62, 0x000d0000
    v_mfma_f32_16x16x32_bf16 v[192:195], a[244:247], a[0:3], 0
    buffer_load_dwordx4 v245, s[20:23], s62 offen lds
    v_mul_f32 v29, v29, v28
    v_mfma_f32_16x16x32_bf16 v[196:199], a[244:247], a[4:7], 0
    v_mul_f32 v29, v29, v28
    v_fma_f32 v251, v251, v5, v4
    s_mov_b32 s63, 0x000d1be0
    v_mfma_f32_16x16x32_bf16 v[180:183], a[240:243], a[4:7], 0
    buffer_load_dwordx4 v245, s[20:23], s63 offen offset:1056 lds
    v_mfma_f32_16x16x32_bf16 v[184:187], a[240:243], a[8:11], 0
    s_waitcnt vmcnt(14) lgkmcnt(0)
    s_barrier
    v_mul_f32 v28, 0xc0135761, v28
    v_mfma_f32_16x16x32_bf16 v[200:203], a[244:247], a[8:11], 0
    v_add_u32 v240, s88, v240
    ds_read_b64_tr_b16 a[228:229], v240
    v_fma_f32 v252, v252, v5, v4
    v_mfma_f32_16x16x32_bf16 v[204:207], a[244:247], a[12:15], 0
    ds_read_b64_tr_b16 a[230:231], v240 offset:16896
    ds_read_b64_tr_b16 a[232:233], v240 offset:32
    v_mfma_f32_16x16x32_bf16 v[188:191], a[240:243], a[12:15], 0
    ds_read_b64_tr_b16 a[234:235], v240 offset:16928
    v_fma_f32 v253, v253, v5, v4
    v_mfma_f32_16x16x32_bf16 v[220:223], a[248:251], a[12:15], 0
    v_fma_f32 v254, v254, v5, v4
    v_mul_f32 v251, v251, v32
    v_mul_f32 v252, v252, v33
    v_mfma_f32_16x16x32_bf16 v[236:239], a[224:227], a[12:15], 0
    ds_read_b64_tr_b16 a[236:237], v240 offset:64
    ds_read_b64_tr_b16 a[238:239], v240 offset:16960
    s_mov_b32 s62, 0x000d37c0
    v_mfma_f32_16x16x32_bf16 v[232:235], a[224:227], a[8:11], 0
    buffer_load_dwordx4 v245, s[20:23], s62 offen offset:2112 lds
    v_mul_f32 v253, v253, v34
    v_mfma_f32_16x16x32_bf16 v[216:219], a[248:251], a[8:11], 0
    v_mul_f32 v254, v254, v35
    v_exp_f32 v251, v251
    v_mfma_f32_16x16x32_bf16 v[212:215], a[248:251], a[4:7], 0
    v_exp_f32 v252, v252
    v_mfma_f32_16x16x32_bf16 v[228:231], a[224:227], a[4:7], 0
    ds_read_b64_tr_b16 a[240:241], v240 offset:96
    ds_read_b64_tr_b16 a[242:243], v240 offset:16992
    s_mov_b32 s63, 0x000d53a0
    v_mfma_f32_16x16x32_bf16 v[224:227], a[224:227], a[0:3], 0
    buffer_load_dwordx4 v245, s[20:23], s63 offen offset:3168 lds
    v_fma_f32 v251, v251, v6, v6
    v_mfma_f32_16x16x32_bf16 v[208:211], a[248:251], a[0:3], 0
    v_fma_f32 v252, v252, v6, v6
    s_waitcnt lgkmcnt(4)
    v_mfma_f32_16x16x32_bf16 v[112:115], a[228:231], a[16:19], v[112:115]
    v_exp_f32 v253, v253
    v_mul_f32 v36, v36, v32
    v_mfma_f32_16x16x32_bf16 v[128:131], a[232:235], a[16:19], v[128:131]
    ds_read_b64_tr_b16 a[244:245], v240 offset:128
    ds_read_b64_tr_b16 a[246:247], v240 offset:17024
    s_add_u32 m0, s47, 101376
    s_mov_b32 s62, 0x00100000
    v_mfma_f32_16x16x32_bf16 v[132:135], a[232:235], a[20:23], v[132:135]
    buffer_load_dwordx4 v245, s[20:23], s62 offen lds
    v_fma_f32 v253, v253, v6, v6
    v_mfma_f32_16x16x32_bf16 v[116:119], a[228:231], a[20:23], v[116:119]
    v_exp_f32 v254, v254
    v_mul_f32 v37, v37, v33
    v_mfma_f32_16x16x32_bf16 v[120:123], a[228:231], a[24:27], v[120:123]
    v_fma_f32 v254, v254, v6, v6
    v_mul_f32 v38, v38, v34
    v_mfma_f32_16x16x32_bf16 v[136:139], a[232:235], a[24:27], v[136:139]
    ds_read_b64_tr_b16 a[248:249], v240 offset:160
    ds_read_b64_tr_b16 a[250:251], v240 offset:17056
    s_mov_b32 s63, 0x00101be0
    v_mfma_f32_16x16x32_bf16 v[140:143], a[232:235], a[28:31], v[140:143]
    buffer_load_dwordx4 v245, s[20:23], s63 offen offset:1056 lds
    v_mul_f32 v39, v39, v35
    v_mfma_f32_16x16x32_bf16 v[124:127], a[228:231], a[28:31], v[124:127]
    s_waitcnt lgkmcnt(4)
    v_mfma_f32_16x16x32_bf16 v[156:159], a[236:239], a[28:31], v[156:159]
    v_rcp_f32 v251, v251
    v_mfma_f32_16x16x32_bf16 v[172:175], a[240:243], a[28:31], v[172:175]
    ds_read_b64_tr_b16 a[224:225], v240 offset:192
    ds_read_b64_tr_b16 a[226:227], v240 offset:17088
    s_mov_b32 s62, 0x001037c0
    v_mfma_f32_16x16x32_bf16 v[168:171], a[240:243], a[24:27], v[168:171]
    buffer_load_dwordx4 v245, s[20:23], s62 offen offset:2112 lds
    v_mfma_f32_16x16x32_bf16 v[152:155], a[236:239], a[24:27], v[152:155]
    v_rcp_f32 v252, v252
    v_mul_f32 v36, v36, v251
    v_mfma_f32_16x16x32_bf16 v[148:151], a[236:239], a[20:23], v[148:151]
    v_rcp_f32 v253, v253
    v_mul_f32 v37, v37, v252
    v_mfma_f32_16x16x32_bf16 v[164:167], a[240:243], a[20:23], v[164:167]
    ds_read_b64_tr_b16 a[228:229], v240 offset:224
    ds_read_b64_tr_b16 a[230:231], v240 offset:17120
    s_mov_b32 s63, 0x001053a0
    v_mfma_f32_16x16x32_bf16 v[160:163], a[240:243], a[16:19], v[160:163]
    buffer_load_dwordx4 v245, s[20:23], s63 offen offset:3168 lds
    v_mul_f32 v38, v38, v253
    v_mfma_f32_16x16x32_bf16 v[144:147], a[236:239], a[16:19], v[144:147]
    v_rcp_f32 v254, v254
    s_waitcnt lgkmcnt(4)
    v_mfma_f32_16x16x32_bf16 v[176:179], a[244:247], a[16:19], v[176:179]
    s_add_u32 m0, s47, 105600
    s_mov_b32 s62, 0x00110000
    v_mfma_f32_16x16x32_bf16 v[192:195], a[248:251], a[16:19], v[192:195]
    buffer_load_dwordx4 v245, s[20:23], s62 offen lds
    v_mul_f32 v39, v39, v254
    v_mfma_f32_16x16x32_bf16 v[196:199], a[248:251], a[20:23], v[196:199]
    v_cvt_pk_bf16_f32 v26, v36, v37
    v_cvt_pk_bf16_f32 v27, v38, v39
    s_mov_b32 s63, 0x00111be0
    v_mfma_f32_16x16x32_bf16 v[180:183], a[244:247], a[20:23], v[180:183]
    buffer_load_dwordx4 v245, s[20:23], s63 offen offset:1056 lds
    v_mfma_f32_16x16x32_bf16 v[184:187], a[244:247], a[24:27], v[184:187]
    s_waitcnt vmcnt(14) lgkmcnt(0)
    s_barrier
    v_add_u32 v36, s48, v248
    v_mfma_f32_16x16x32_bf16 v[200:203], a[248:251], a[24:27], v[200:203]
    ds_read_b64_tr_b16 a[232:233], v240 offset:33792
    ds_read_b64_tr_b16 a[234:235], v240 offset:50688
    v_mfma_f32_16x16x32_bf16 v[204:207], a[248:251], a[28:31], v[204:207]
    ds_read_b64_tr_b16 a[236:237], v240 offset:33824
    ds_read_b64_tr_b16 a[238:239], v240 offset:50720
    ds_write_b128 v36, v[24:27] offset:1024
    v_mfma_f32_16x16x32_bf16 v[188:191], a[244:247], a[28:31], v[188:191]
    v_mul_f32 v251, v48, v48
    v_mul_f32 v252, v49, v49
    v_mfma_f32_16x16x32_bf16 v[220:223], a[224:227], a[28:31], v[220:223]
    v_mul_f32 v253, v50, v50
    v_mul_f32 v254, v51, v51
    v_mfma_f32_16x16x32_bf16 v[236:239], a[228:231], a[28:31], v[236:239]
    ds_read_b64_tr_b16 a[240:241], v240 offset:33856
    ds_read_b64_tr_b16 a[242:243], v240 offset:50752
    s_mov_b32 s62, 0x001137c0
    v_mfma_f32_16x16x32_bf16 v[232:235], a[228:231], a[24:27], v[232:235]
    buffer_load_dwordx4 v245, s[20:23], s62 offen offset:2112 lds
    v_fma_f32 v251, v251, v29, v28
    v_mfma_f32_16x16x32_bf16 v[216:219], a[224:227], a[24:27], v[216:219]
    v_fma_f32 v252, v252, v29, v28
    v_fma_f32 v253, v253, v29, v28
    v_mfma_f32_16x16x32_bf16 v[212:215], a[224:227], a[20:23], v[212:215]
    v_fma_f32 v254, v254, v29, v28
    v_mul_f32 v251, v251, v48
    v_mul_f32 v252, v252, v49
    v_mfma_f32_16x16x32_bf16 v[228:231], a[228:231], a[20:23], v[228:231]
    ds_read_b64_tr_b16 a[244:245], v240 offset:33888
    ds_read_b64_tr_b16 a[246:247], v240 offset:50784
    s_mov_b32 s63, 0x001153a0
    v_mfma_f32_16x16x32_bf16 v[224:227], a[228:231], a[16:19], v[224:227]
    buffer_load_dwordx4 v245, s[20:23], s63 offen offset:3168 lds
    v_mfma_f32_16x16x32_bf16 v[208:211], a[224:227], a[16:19], v[208:211]
    v_mul_f32 v253, v253, v50
    v_mul_f32 v254, v254, v51
    s_waitcnt lgkmcnt(5)
    v_mfma_f32_16x16x32_bf16 v[112:115], a[232:235], a[32:35], v[112:115]
    v_exp_f32 v251, v251
    v_mul_f32 v52, v52, v48
    v_mfma_f32_16x16x32_bf16 v[128:131], a[236:239], a[32:35], v[128:131]
    ds_read_b64_tr_b16 a[248:249], v240 offset:33920
    ds_read_b64_tr_b16 a[250:251], v240 offset:50816
    s_add_u32 m0, s47, 0
    s_mov_b32 s62, 0x00140000
    v_mfma_f32_16x16x32_bf16 v[132:135], a[236:239], a[36:39], v[132:135]
    buffer_load_dwordx4 v245, s[20:23], s62 offen lds
    v_fma_f32 v251, v251, v30, v30
    v_mfma_f32_16x16x32_bf16 v[116:119], a[232:235], a[36:39], v[116:119]
    v_exp_f32 v252, v252
    v_mul_f32 v53, v53, v49
    v_mfma_f32_16x16x32_bf16 v[120:123], a[232:235], a[40:43], v[120:123]
    v_exp_f32 v253, v253
    v_mfma_f32_16x16x32_bf16 v[136:139], a[236:239], a[40:43], v[136:139]
    ds_read_b64_tr_b16 a[224:225], v240 offset:33952
    ds_read_b64_tr_b16 a[226:227], v240 offset:50848
    s_mov_b32 s63, 0x00141be0
    v_mfma_f32_16x16x32_bf16 v[140:143], a[236:239], a[44:47], v[140:143]
    buffer_load_dwordx4 v245, s[20:23], s63 offen offset:1056 lds
    v_fma_f32 v252, v252, v30, v30
    v_mfma_f32_16x16x32_bf16 v[124:127], a[232:235], a[44:47], v[124:127]
    v_fma_f32 v253, v253, v30, v30
    s_waitcnt lgkmcnt(4)
    v_mfma_f32_16x16x32_bf16 v[156:159], a[240:243], a[44:47], v[156:159]
    v_exp_f32 v254, v254
    v_mul_f32 v54, v54, v50
    v_mfma_f32_16x16x32_bf16 v[172:175], a[244:247], a[44:47], v[172:175]
    ds_read_b64_tr_b16 a[228:229], v240 offset:33984
    ds_read_b64_tr_b16 a[230:231], v240 offset:50880
    s_mov_b32 s62, 0x001437c0
    v_mfma_f32_16x16x32_bf16 v[168:171], a[244:247], a[40:43], v[168:171]
    buffer_load_dwordx4 v245, s[20:23], s62 offen offset:2112 lds
    v_fma_f32 v254, v254, v30, v30
    v_mfma_f32_16x16x32_bf16 v[152:155], a[240:243], a[40:43], v[152:155]
    v_rcp_f32 v251, v251
    v_mul_f32 v55, v55, v51
    v_mfma_f32_16x16x32_bf16 v[148:151], a[240:243], a[36:39], v[148:151]
    v_rcp_f32 v252, v252
    v_mfma_f32_16x16x32_bf16 v[164:167], a[244:247], a[36:39], v[164:167]
    ds_read_b64_tr_b16 a[232:233], v240 offset:34016
    ds_read_b64_tr_b16 a[234:235], v240 offset:50912
    s_mov_b32 s63, 0x001453a0
    v_mfma_f32_16x16x32_bf16 v[160:163], a[244:247], a[32:35], v[160:163]
    buffer_load_dwordx4 v245, s[20:23], s63 offen offset:3168 lds
    v_mul_f32 v52, v52, v251
    v_mfma_f32_16x16x32_bf16 v[144:147], a[240:243], a[32:35], v[144:147]
    v_mul_f32 v53, v53, v252
    s_waitcnt lgkmcnt(4)
    v_mfma_f32_16x16x32_bf16 v[176:179], a[248:251], a[32:35], v[176:179]
    v_cvt_pk_bf16_f32 v48, v52, v53
    s_add_u32 m0, s47, 4224
    s_mov_b32 s62, 0x00150000
    v_mfma_f32_16x16x32_bf16 v[192:195], a[224:227], a[32:35], v[192:195]
    buffer_load_dwordx4 v245, s[20:23], s62 offen lds
    v_mul_f32 v251, v56, v56
    v_mfma_f32_16x16x32_bf16 v[196:199], a[224:227], a[36:39], v[196:199]
    v_mul_f32 v252, v57, v57
    s_mov_b32 s63, 0x00151be0
    v_mfma_f32_16x16x32_bf16 v[180:183], a[248:251], a[36:39], v[180:183]
    buffer_load_dwordx4 v245, s[20:23], s63 offen offset:1056 lds
    v_fma_f32 v251, v251, v29, v28
    v_mfma_f32_16x16x32_bf16 v[184:187], a[248:251], a[40:43], v[184:187]
    s_waitcnt vmcnt(14) lgkmcnt(0)
    s_barrier
    v_fma_f32 v252, v252, v29, v28
    v_mfma_f32_16x16x32_bf16 v[200:203], a[224:227], a[40:43], v[200:203]
    ds_read_b64_tr_b16 a[236:237], v241
    ds_read_b64_tr_b16 a[238:239], v241 offset:16896
    v_mfma_f32_16x16x32_bf16 v[204:207], a[224:227], a[44:47], v[204:207]
    ds_read_b64_tr_b16 a[240:241], v241 offset:32
    ds_read_b64_tr_b16 a[242:243], v241 offset:16928
    v_mul_f32 v251, v251, v56
    v_mfma_f32_16x16x32_bf16 v[188:191], a[248:251], a[44:47], v[188:191]
    v_rcp_f32 v253, v253
    v_mfma_f32_16x16x32_bf16 v[220:223], a[228:231], a[44:47], v[220:223]
    v_rcp_f32 v254, v254
    v_mfma_f32_16x16x32_bf16 v[236:239], a[232:235], a[44:47], v[236:239]
    ds_read_b64_tr_b16 a[244:245], v241 offset:64
    ds_read_b64_tr_b16 a[246:247], v241 offset:16960
    s_mov_b32 s62, 0x001537c0
    v_mfma_f32_16x16x32_bf16 v[232:235], a[232:235], a[40:43], v[232:235]
    buffer_load_dwordx4 v245, s[20:23], s62 offen offset:2112 lds
    v_mul_f32 v54, v54, v253
    v_mfma_f32_16x16x32_bf16 v[216:219], a[228:231], a[40:43], v[216:219]
    v_mul_f32 v55, v55, v254
    v_mul_f32 v253, v58, v58
    v_mfma_f32_16x16x32_bf16 v[212:215], a[228:231], a[36:39], v[212:215]
    v_cvt_pk_bf16_f32 v49, v54, v55
    v_accvgpr_read_b32 v54, a255
    v_mul_f32 v254, v59, v59
    v_mfma_f32_16x16x32_bf16 v[228:231], a[232:235], a[36:39], v[228:231]
    ds_read_b64_tr_b16 a[248:249], v241 offset:96
    ds_read_b64_tr_b16 a[250:251], v241 offset:16992
    s_mov_b32 s63, 0x001553a0
    v_mfma_f32_16x16x32_bf16 v[224:227], a[232:235], a[32:35], v[224:227]
    buffer_load_dwordx4 v245, s[20:23], s63 offen offset:3168 lds
    v_rcp_f32 v52, v54
    v_mfma_f32_16x16x32_bf16 v[208:211], a[228:231], a[32:35], v[208:211]
    v_mul_f32 v54, v54, v54
    v_fma_f32 v253, v253, v29, v28
    s_waitcnt lgkmcnt(4)
    v_mfma_f32_16x16x32_bf16 v[112:115], a[236:239], a[48:51], v[112:115]
    v_mul_f32 v53, 0xbdd2d3e8, v52
    v_fma_f32 v254, v254, v29, v28
    v_mfma_f32_16x16x32_bf16 v[128:131], a[240:243], a[48:51], v[128:131]
    ds_read_b64_tr_b16 a[224:225], v241 offset:128
    ds_read_b64_tr_b16 a[226:227], v241 offset:17024
    s_add_u32 m0, s47, 33792
    s_mov_b32 s62, 0x00180000
    v_mfma_f32_16x16x32_bf16 v[132:135], a[240:243], a[52:55], v[132:135]
    buffer_load_dwordx4 v245, s[20:23], s62 offen lds
    v_mul_f32 v53, v53, v52
    v_mfma_f32_16x16x32_bf16 v[116:119], a[236:239], a[52:55], v[116:119]
    v_mul_f32 v53, v53, v52
    v_mul_f32 v252, v252, v57
    v_mfma_f32_16x16x32_bf16 v[120:123], a[236:239], a[56:59], v[120:123]
    v_mul_f32 v52, 0xc0135761, v52
    v_mul_f32 v253, v253, v58
    v_mul_f32 v254, v254, v59
    v_mfma_f32_16x16x32_bf16 v[136:139], a[240:243], a[56:59], v[136:139]
    ds_read_b64_tr_b16 a[228:229], v241 offset:160
    ds_read_b64_tr_b16 a[230:231], v241 offset:17056
    s_mov_b32 s63, 0x00181be0
    v_mfma_f32_16x16x32_bf16 v[140:143], a[240:243], a[60:63], v[140:143]
    buffer_load_dwordx4 v245, s[20:23], s63 offen offset:1056 lds
    v_mfma_f32_16x16x32_bf16 v[124:127], a[236:239], a[60:63], v[124:127]
    v_exp_f32 v251, v251
    s_waitcnt lgkmcnt(4)
    v_mfma_f32_16x16x32_bf16 v[156:159], a[244:247], a[60:63], v[156:159]
    v_exp_f32 v252, v252
    v_fma_f32 v251, v251, v30, v30
    v_mfma_f32_16x16x32_bf16 v[172:175], a[248:251], a[60:63], v[172:175]
    ds_read_b64_tr_b16 a[232:233], v241 offset:192
    ds_read_b64_tr_b16 a[234:235], v241 offset:17088
    s_mov_b32 s62, 0x001837c0
    v_mfma_f32_16x16x32_bf16 v[168:171], a[248:251], a[56:59], v[168:171]
    buffer_load_dwordx4 v245, s[20:23], s62 offen offset:2112 lds
    v_fma_f32 v252, v252, v30, v30
    v_mfma_f32_16x16x32_bf16 v[152:155], a[244:247], a[56:59], v[152:155]
    v_exp_f32 v253, v253
    v_mul_f32 v60, v60, v56
    v_mfma_f32_16x16x32_bf16 v[148:151], a[244:247], a[52:55], v[148:151]
    v_exp_f32 v254, v254
    v_mfma_f32_16x16x32_bf16 v[164:167], a[248:251], a[52:55], v[164:167]
    ds_read_b64_tr_b16 a[236:237], v241 offset:224
    ds_read_b64_tr_b16 a[238:239], v241 offset:17120
    s_mov_b32 s63, 0x001853a0
    v_mfma_f32_16x16x32_bf16 v[160:163], a[248:251], a[48:51], v[160:163]
    buffer_load_dwordx4 v245, s[20:23], s63 offen offset:3168 lds
    v_fma_f32 v253, v253, v30, v30
    v_mfma_f32_16x16x32_bf16 v[144:147], a[244:247], a[48:51], v[144:147]
    v_fma_f32 v254, v254, v30, v30
    s_waitcnt lgkmcnt(4)
    v_mfma_f32_16x16x32_bf16 v[176:179], a[224:227], a[48:51], v[176:179]
    v_mul_f32 v61, v61, v57
    s_add_u32 m0, s47, 38016
    s_mov_b32 s62, 0x00190000
    v_mfma_f32_16x16x32_bf16 v[192:195], a[228:231], a[48:51], v[192:195]
    buffer_load_dwordx4 v245, s[20:23], s62 offen lds
    v_mfma_f32_16x16x32_bf16 v[196:199], a[228:231], a[52:55], v[196:199]
    v_rcp_f32 v251, v251
    s_mov_b32 s63, 0x00191be0
    v_mfma_f32_16x16x32_bf16 v[180:183], a[224:227], a[52:55], v[180:183]
    buffer_load_dwordx4 v245, s[20:23], s63 offen offset:1056 lds
    v_mul_f32 v62, v62, v58
    v_mfma_f32_16x16x32_bf16 v[184:187], a[224:227], a[56:59], v[184:187]
    s_waitcnt vmcnt(14) lgkmcnt(0)
    s_barrier
    v_mfma_f32_16x16x32_bf16 v[200:203], a[228:231], a[56:59], v[200:203]
    ds_read_b64_tr_b16 a[240:241], v241 offset:33792
    ds_read_b64_tr_b16 a[242:243], v241 offset:50688
    v_mul_f32 v63, v63, v59
    v_mfma_f32_16x16x32_bf16 v[204:207], a[228:231], a[60:63], v[204:207]
    ds_read_b64_tr_b16 a[244:245], v241 offset:33824
    ds_read_b64_tr_b16 a[246:247], v241 offset:50720
    v_mul_f32 v60, v60, v251
    v_mfma_f32_16x16x32_bf16 v[188:191], a[224:227], a[60:63], v[188:191]
    v_mul_f32 v251, v72, v72
    v_mfma_f32_16x16x32_bf16 v[220:223], a[232:235], a[60:63], v[220:223]
    v_rcp_f32 v252, v252
    v_fma_f32 v251, v251, v53, v52
    v_mfma_f32_16x16x32_bf16 v[236:239], a[236:239], a[60:63], v[236:239]
    ds_read_b64_tr_b16 a[248:249], v241 offset:33856
    ds_read_b64_tr_b16 a[250:251], v241 offset:50752
    s_mov_b32 s62, 0x001937c0
    v_mfma_f32_16x16x32_bf16 v[232:235], a[236:239], a[56:59], v[232:235]
    buffer_load_dwordx4 v245, s[20:23], s62 offen offset:2112 lds
    v_mfma_f32_16x16x32_bf16 v[216:219], a[232:235], a[56:59], v[216:219]
    v_rcp_f32 v253, v253
    v_mul_f32 v61, v61, v252
    v_mfma_f32_16x16x32_bf16 v[212:215], a[232:235], a[52:55], v[212:215]
    v_rcp_f32 v254, v254
    v_mul_f32 v62, v62, v253
    v_mfma_f32_16x16x32_bf16 v[228:231], a[236:239], a[52:55], v[228:231]
    ds_read_b64_tr_b16 a[224:225], v241 offset:33888
    ds_read_b64_tr_b16 a[226:227], v241 offset:50784
    s_mov_b32 s63, 0x001953a0
    v_mfma_f32_16x16x32_bf16 v[224:227], a[236:239], a[48:51], v[224:227]
    buffer_load_dwordx4 v245, s[20:23], s63 offen offset:3168 lds
    v_mul_f32 v63, v63, v254
    v_mfma_f32_16x16x32_bf16 v[208:211], a[232:235], a[48:51], v[208:211]
    v_cvt_pk_bf16_f32 v50, v60, v61
    v_cvt_pk_bf16_f32 v51, v62, v63
    s_waitcnt lgkmcnt(4)
    v_mfma_f32_16x16x32_bf16 v[112:115], a[240:243], a[64:67], v[112:115]
    v_add_u32 v60, s48, v249
    v_mul_f32 v252, v73, v73
    v_mfma_f32_16x16x32_bf16 v[128:131], a[244:247], a[64:67], v[128:131]
    ds_read_b64_tr_b16 a[228:229], v241 offset:33920
    ds_read_b64_tr_b16 a[230:231], v241 offset:50816
    s_add_u32 m0, s47, 67584
    s_mov_b32 s62, 0x001c0000
    v_mfma_f32_16x16x32_bf16 v[132:135], a[244:247], a[68:71], v[132:135]
    buffer_load_dwordx4 v245, s[20:23], s62 offen lds
    ds_write_b128 v60, v[48:51]
    v_mfma_f32_16x16x32_bf16 v[116:119], a[240:243], a[68:71], v[116:119]
    v_mul_f32 v253, v74, v74
    v_mul_f32 v254, v75, v75
    v_mfma_f32_16x16x32_bf16 v[120:123], a[240:243], a[72:75], v[120:123]
    v_fma_f32 v252, v252, v53, v52
    v_fma_f32 v253, v253, v53, v52
    v_fma_f32 v254, v254, v53, v52
    v_mfma_f32_16x16x32_bf16 v[136:139], a[244:247], a[72:75], v[136:139]
    ds_read_b64_tr_b16 a[232:233], v241 offset:33952
    ds_read_b64_tr_b16 a[234:235], v241 offset:50848
    s_mov_b32 s63, 0x001c1be0
    v_mfma_f32_16x16x32_bf16 v[140:143], a[244:247], a[76:79], v[140:143]
    buffer_load_dwordx4 v245, s[20:23], s63 offen offset:1056 lds
    v_mul_f32 v251, v251, v72
    v_mfma_f32_16x16x32_bf16 v[124:127], a[240:243], a[76:79], v[124:127]
    v_mul_f32 v252, v252, v73
    v_mul_f32 v253, v253, v74
    s_waitcnt lgkmcnt(5)
    v_mfma_f32_16x16x32_bf16 v[156:159], a[248:251], a[76:79], v[156:159]
    v_mul_f32 v254, v254, v75
    v_mul_f32 v76, v76, v72
    v_mfma_f32_16x16x32_bf16 v[172:175], a[224:227], a[76:79], v[172:175]
    ds_read_b64_tr_b16 a[236:237], v241 offset:33984
    ds_read_b64_tr_b16 a[238:239], v241 offset:50880
    s_mov_b32 s62, 0x001c37c0
    v_mfma_f32_16x16x32_bf16 v[168:171], a[224:227], a[72:75], v[168:171]
    buffer_load_dwordx4 v245, s[20:23], s62 offen offset:2112 lds
    v_mul_f32 v77, v77, v73
    v_mfma_f32_16x16x32_bf16 v[152:155], a[248:251], a[72:75], v[152:155]
    v_exp_f32 v251, v251
    v_mfma_f32_16x16x32_bf16 v[148:151], a[248:251], a[68:71], v[148:151]
    v_exp_f32 v252, v252
    v_fma_f32 v251, v251, v54, v54
    v_mfma_f32_16x16x32_bf16 v[164:167], a[224:227], a[68:71], v[164:167]
    ds_read_b64_tr_b16 a[240:241], v241 offset:34016
    ds_read_b64_tr_b16 a[242:243], v241 offset:50912
    s_mov_b32 s63, 0x001c53a0
    v_mfma_f32_16x16x32_bf16 v[160:163], a[224:227], a[64:67], v[160:163]
    buffer_load_dwordx4 v245, s[20:23], s63 offen offset:3168 lds
    v_mfma_f32_16x16x32_bf16 v[144:147], a[248:251], a[64:67], v[144:147]
    v_exp_f32 v253, v253
    s_waitcnt lgkmcnt(4)
    v_mfma_f32_16x16x32_bf16 v[176:179], a[228:231], a[64:67], v[176:179]
    v_fma_f32 v252, v252, v54, v54
    s_add_u32 m0, s47, 71808
    s_mov_b32 s62, 0x001d0000
    v_mfma_f32_16x16x32_bf16 v[192:195], a[232:235], a[64:67], v[192:195]
    buffer_load_dwordx4 v245, s[20:23], s62 offen lds
    v_mfma_f32_16x16x32_bf16 v[196:199], a[232:235], a[68:71], v[196:199]
    v_exp_f32 v254, v254
    s_mov_b32 s63, 0x001d1be0
    v_mfma_f32_16x16x32_bf16 v[180:183], a[228:231], a[68:71], v[180:183]
    buffer_load_dwordx4 v245, s[20:23], s63 offen offset:1056 lds
    v_fma_f32 v253, v253, v54, v54
    v_mfma_f32_16x16x32_bf16 v[184:187], a[228:231], a[72:75], v[184:187]
    s_waitcnt vmcnt(14) lgkmcnt(0)
    s_barrier
    v_mfma_f32_16x16x32_bf16 v[200:203], a[232:235], a[72:75], v[200:203]
    ds_read_b64_tr_b16 a[244:245], v240
    ds_read_b64_tr_b16 a[246:247], v240 offset:16896
    v_fma_f32 v254, v254, v54, v54
    v_mfma_f32_16x16x32_bf16 v[204:207], a[232:235], a[76:79], v[204:207]
    ds_read_b64_tr_b16 a[248:249], v240 offset:32
    ds_read_b64_tr_b16 a[250:251], v240 offset:16928
    v_mul_f32 v78, v78, v74
    v_mfma_f32_16x16x32_bf16 v[188:191], a[228:231], a[76:79], v[188:191]
    v_mul_f32 v79, v79, v75
    v_mfma_f32_16x16x32_bf16 v[220:223], a[236:239], a[76:79], v[220:223]
    v_rcp_f32 v251, v251
    v_mfma_f32_16x16x32_bf16 v[236:239], a[240:243], a[76:79], v[236:239]
    ds_read_b64_tr_b16 a[224:225], v240 offset:64
    ds_read_b64_tr_b16 a[226:227], v240 offset:16960
    s_mov_b32 s62, 0x001d37c0
    v_mfma_f32_16x16x32_bf16 v[232:235], a[240:243], a[72:75], v[232:235]
    buffer_load_dwordx4 v245, s[20:23], s62 offen offset:2112 lds
    v_mul_f32 v76, v76, v251
    v_mfma_f32_16x16x32_bf16 v[216:219], a[236:239], a[72:75], v[216:219]
    v_rcp_f32 v252, v252
    v_mul_f32 v251, v80, v80
    v_mfma_f32_16x16x32_bf16 v[212:215], a[236:239], a[68:71], v[212:215]
    v_rcp_f32 v253, v253
    v_mfma_f32_16x16x32_bf16 v[228:231], a[240:243], a[68:71], v[228:231]
    ds_read_b64_tr_b16 a[228:229], v240 offset:96
    ds_read_b64_tr_b16 a[230:231], v240 offset:16992
    s_mov_b32 s63, 0x001d53a0
    v_mfma_f32_16x16x32_bf16 v[224:227], a[240:243], a[64:67], v[224:227]
    buffer_load_dwordx4 v245, s[20:23], s63 offen offset:3168 lds
    v_mul_f32 v77, v77, v252
    v_mfma_f32_16x16x32_bf16 v[208:211], a[236:239], a[64:67], v[208:211]
    v_mul_f32 v78, v78, v253
    s_waitcnt lgkmcnt(4)
    v_mfma_f32_16x16x32_bf16 v[112:115], a[244:247], a[80:83], v[112:115]
    v_rcp_f32 v254, v254
    v_cvt_pk_bf16_f32 v72, v76, v77
    v_mfma_f32_16x16x32_bf16 v[128:131], a[248:251], a[80:83], v[128:131]
    ds_read_b64_tr_b16 a[232:233], v240 offset:128
    ds_read_b64_tr_b16 a[234:235], v240 offset:17024
    s_add_u32 m0, s47, 101376
    s_mov_b32 s62, 0x00200000
    v_mfma_f32_16x16x32_bf16 v[132:135], a[248:251], a[84:87], v[132:135]
    buffer_load_dwordx4 v245, s[20:23], s62 offen lds
    v_mfma_f32_16x16x32_bf16 v[116:119], a[244:247], a[84:87], v[116:119]
    v_mul_f32 v79, v79, v254
    v_mul_f32 v252, v81, v81
    v_mul_f32 v253, v82, v82
    v_mfma_f32_16x16x32_bf16 v[120:123], a[244:247], a[88:91], v[120:123]
    v_cvt_pk_bf16_f32 v73, v78, v79
    v_mul_f32 v254, v83, v83
    v_fma_f32 v251, v251, v53, v52
    v_mfma_f32_16x16x32_bf16 v[136:139], a[248:251], a[88:91], v[136:139]
    ds_read_b64_tr_b16 a[236:237], v240 offset:160
    ds_read_b64_tr_b16 a[238:239], v240 offset:17056
    s_mov_b32 s63, 0x00201be0
    v_mfma_f32_16x16x32_bf16 v[140:143], a[248:251], a[92:95], v[140:143]
    buffer_load_dwordx4 v245, s[20:23], s63 offen offset:1056 lds
    v_fma_f32 v252, v252, v53, v52
    v_mfma_f32_16x16x32_bf16 v[124:127], a[244:247], a[92:95], v[124:127]
    v_fma_f32 v253, v253, v53, v52
    v_fma_f32 v254, v254, v53, v52
    s_waitcnt lgkmcnt(4)
    v_mfma_f32_16x16x32_bf16 v[156:159], a[224:227], a[92:95], v[156:159]
    v_mul_f32 v251, v251, v80
    v_mul_f32 v252, v252, v81
    v_mfma_f32_16x16x32_bf16 v[172:175], a[228:231], a[92:95], v[172:175]
    ds_read_b64_tr_b16 a[240:241], v240 offset:192
    ds_read_b64_tr_b16 a[242:243], v240 offset:17088
    s_mov_b32 s62, 0x002037c0
    v_mfma_f32_16x16x32_bf16 v[168:171], a[228:231], a[88:91], v[168:171]
    buffer_load_dwordx4 v245, s[20:23], s62 offen offset:2112 lds
    v_mul_f32 v253, v253, v82
    v_mfma_f32_16x16x32_bf16 v[152:155], a[224:227], a[88:91], v[152:155]
    v_mul_f32 v254, v254, v83
    v_mul_f32 v84, v84, v80
    v_mfma_f32_16x16x32_bf16 v[148:151], a[224:227], a[84:87], v[148:151]
    v_exp_f32 v251, v251
    v_mul_f32 v85, v85, v81
    v_mfma_f32_16x16x32_bf16 v[164:167], a[228:231], a[84:87], v[164:167]
    ds_read_b64_tr_b16 a[244:245], v240 offset:224
    ds_read_b64_tr_b16 a[246:247], v240 offset:17120
    s_mov_b32 s63, 0x002053a0
    v_mfma_f32_16x16x32_bf16 v[160:163], a[228:231], a[80:83], v[160:163]
    buffer_load_dwordx4 v245, s[20:23], s63 offen offset:3168 lds
    v_fma_f32 v251, v251, v54, v54
    v_mfma_f32_16x16x32_bf16 v[144:147], a[224:227], a[80:83], v[144:147]
    v_exp_f32 v252, v252
    s_waitcnt lgkmcnt(4)
    v_mfma_f32_16x16x32_bf16 v[176:179], a[232:235], a[80:83], v[176:179]
    s_add_u32 m0, s47, 105600
    s_mov_b32 s62, 0x00210000
    v_mfma_f32_16x16x32_bf16 v[192:195], a[236:239], a[80:83], v[192:195]
    buffer_load_dwordx4 v245, s[20:23], s62 offen lds
    v_fma_f32 v252, v252, v54, v54
    v_mfma_f32_16x16x32_bf16 v[196:199], a[236:239], a[84:87], v[196:199]
    v_exp_f32 v253, v253
    s_mov_b32 s63, 0x00211be0
    v_mfma_f32_16x16x32_bf16 v[180:183], a[232:235], a[84:87], v[180:183]
    buffer_load_dwordx4 v245, s[20:23], s63 offen offset:1056 lds
    v_mfma_f32_16x16x32_bf16 v[184:187], a[232:235], a[88:91], v[184:187]
    s_waitcnt vmcnt(14) lgkmcnt(0)
    s_barrier
    v_fma_f32 v253, v253, v54, v54
    v_mfma_f32_16x16x32_bf16 v[200:203], a[236:239], a[88:91], v[200:203]
    ds_read_b64_tr_b16 a[248:249], v240 offset:33792
    ds_read_b64_tr_b16 a[250:251], v240 offset:50688
    v_mul_f32 v86, v86, v82
    v_mfma_f32_16x16x32_bf16 v[204:207], a[236:239], a[92:95], v[204:207]
    ds_read_b64_tr_b16 a[224:225], v240 offset:33824
    ds_read_b64_tr_b16 a[226:227], v240 offset:50720
    v_mfma_f32_16x16x32_bf16 v[188:191], a[232:235], a[92:95], v[188:191]
    v_exp_f32 v254, v254
    v_mfma_f32_16x16x32_bf16 v[220:223], a[240:243], a[92:95], v[220:223]
    v_fma_f32 v254, v254, v54, v54
    v_rcp_f32 v251, v251
    v_mfma_f32_16x16x32_bf16 v[236:239], a[244:247], a[92:95], v[236:239]
    ds_read_b64_tr_b16 a[228:229], v240 offset:33856
    ds_read_b64_tr_b16 a[230:231], v240 offset:50752
    s_mov_b32 s62, 0x002137c0
    v_mfma_f32_16x16x32_bf16 v[232:235], a[244:247], a[88:91], v[232:235]
    buffer_load_dwordx4 v245, s[20:23], s62 offen offset:2112 lds
    v_mul_f32 v87, v87, v83
    v_mfma_f32_16x16x32_bf16 v[216:219], a[240:243], a[88:91], v[216:219]
    v_rcp_f32 v252, v252
    v_mul_f32 v84, v84, v251
    v_mfma_f32_16x16x32_bf16 v[212:215], a[240:243], a[84:87], v[212:215]
    v_rcp_f32 v253, v253
    v_mfma_f32_16x16x32_bf16 v[228:231], a[244:247], a[84:87], v[228:231]
    ds_read_b64_tr_b16 a[232:233], v240 offset:33888
    ds_read_b64_tr_b16 a[234:235], v240 offset:50784
    s_mov_b32 s63, 0x002153a0
    v_mfma_f32_16x16x32_bf16 v[224:227], a[244:247], a[80:83], v[224:227]
    buffer_load_dwordx4 v245, s[20:23], s63 offen offset:3168 lds
    v_mul_f32 v85, v85, v252
    v_mfma_f32_16x16x32_bf16 v[208:211], a[240:243], a[80:83], v[208:211]
    v_mul_f32 v86, v86, v253
    s_waitcnt lgkmcnt(4)
    v_mfma_f32_16x16x32_bf16 v[112:115], a[248:251], a[96:99], v[112:115]
    v_rcp_f32 v254, v254
    v_cvt_pk_bf16_f32 v74, v84, v85
    v_mfma_f32_16x16x32_bf16 v[128:131], a[224:227], a[96:99], v[128:131]
    ds_read_b64_tr_b16 a[236:237], v240 offset:33920
    ds_read_b64_tr_b16 a[238:239], v240 offset:50816
    s_add_u32 m0, s47, 0
    s_mov_b32 s62, 0x00240000
    v_mfma_f32_16x16x32_bf16 v[132:135], a[224:227], a[100:103], v[132:135]
    buffer_load_dwordx4 v245, s[20:23], s62 offen lds
    v_mul_f32 v87, v87, v254
    v_mfma_f32_16x16x32_bf16 v[116:119], a[248:251], a[100:103], v[116:119]
    v_cvt_pk_bf16_f32 v75, v86, v87
    v_add_u32 v84, s48, v249
    v_mul_f32 v251, v16, v16
    v_mfma_f32_16x16x32_bf16 v[120:123], a[248:251], a[104:107], v[120:123]
    ds_write_b128 v84, v[72:75] offset:1024
    v_mul_f32 v252, v17, v17
    v_mfma_f32_16x16x32_bf16 v[136:139], a[224:227], a[104:107], v[136:139]
    ds_read_b64_tr_b16 a[240:241], v240 offset:33952
    ds_read_b64_tr_b16 a[242:243], v240 offset:50848
    s_mov_b32 s63, 0x00241be0
    v_mfma_f32_16x16x32_bf16 v[140:143], a[224:227], a[108:111], v[140:143]
    buffer_load_dwordx4 v245, s[20:23], s63 offen offset:1056 lds
    v_mul_f32 v253, v18, v18
    v_mfma_f32_16x16x32_bf16 v[124:127], a[248:251], a[108:111], v[124:127]
    v_mul_f32 v254, v19, v19
    s_waitcnt lgkmcnt(5)
    v_mfma_f32_16x16x32_bf16 v[156:159], a[228:231], a[108:111], v[156:159]
    v_fma_f32 v251, v251, v243, v242
    v_fma_f32 v252, v252, v243, v242
    v_fma_f32 v253, v253, v243, v242
    v_mfma_f32_16x16x32_bf16 v[172:175], a[232:235], a[108:111], v[172:175]
    ds_read_b64_tr_b16 a[244:245], v240 offset:33984
    ds_read_b64_tr_b16 a[246:247], v240 offset:50880
    s_mov_b32 s62, 0x002437c0
    v_mfma_f32_16x16x32_bf16 v[168:171], a[232:235], a[104:107], v[168:171]
    buffer_load_dwordx4 v245, s[20:23], s62 offen offset:2112 lds
    v_mfma_f32_16x16x32_bf16 v[152:155], a[228:231], a[104:107], v[152:155]
    v_fma_f32 v254, v254, v243, v242
    v_mul_f32 v251, v251, v16
    v_mul_f32 v252, v252, v17
    v_mfma_f32_16x16x32_bf16 v[148:151], a[228:231], a[100:103], v[148:151]
    v_mul_f32 v253, v253, v18
    v_mul_f32 v254, v254, v19
    v_mul_f32 v20, v20, v16
    v_mfma_f32_16x16x32_bf16 v[164:167], a[232:235], a[100:103], v[164:167]
    ds_read_b64_tr_b16 a[248:249], v240 offset:34016
    ds_read_b64_tr_b16 a[250:251], v240 offset:50912
    s_mov_b32 s63, 0x002453a0
    v_mfma_f32_16x16x32_bf16 v[160:163], a[232:235], a[96:99], v[160:163]
    buffer_load_dwordx4 v245, s[20:23], s63 offen offset:3168 lds
    v_mul_f32 v21, v21, v17
    v_mfma_f32_16x16x32_bf16 v[144:147], a[228:231], a[96:99], v[144:147]
    v_exp_f32 v251, v251
    s_waitcnt lgkmcnt(4)
    v_mfma_f32_16x16x32_bf16 v[176:179], a[236:239], a[96:99], v[176:179]
    s_add_u32 m0, s47, 4224
    s_mov_b32 s62, 0x00250000
    v_mfma_f32_16x16x32_bf16 v[192:195], a[240:243], a[96:99], v[192:195]
    buffer_load_dwordx4 v245, s[20:23], s62 offen lds
    v_fma_f32 v251, v251, v255, v255
    v_mfma_f32_16x16x32_bf16 v[196:199], a[240:243], a[100:103], v[196:199]
    v_exp_f32 v252, v252
    s_mov_b32 s63, 0x00251be0
    v_mfma_f32_16x16x32_bf16 v[180:183], a[236:239], a[100:103], v[180:183]
    buffer_load_dwordx4 v245, s[20:23], s63 offen offset:1056 lds
    v_mfma_f32_16x16x32_bf16 v[184:187], a[236:239], a[104:107], v[184:187]
    s_waitcnt vmcnt(14) lgkmcnt(0)
    s_barrier
    v_fma_f32 v252, v252, v255, v255
    v_mfma_f32_16x16x32_bf16 v[200:203], a[240:243], a[104:107], v[200:203]
    ds_read_b64_tr_b16 a[224:225], v241
    ds_read_b64_tr_b16 a[226:227], v241 offset:16896
    v_mfma_f32_16x16x32_bf16 v[204:207], a[240:243], a[108:111], v[204:207]
    ds_read_b64_tr_b16 a[228:229], v241 offset:32
    ds_read_b64_tr_b16 a[230:231], v241 offset:16928
    v_mul_f32 v22, v22, v18
    v_mfma_f32_16x16x32_bf16 v[188:191], a[236:239], a[108:111], v[188:191]
    v_exp_f32 v253, v253
    v_mfma_f32_16x16x32_bf16 v[220:223], a[244:247], a[108:111], v[220:223]
    v_exp_f32 v254, v254
    v_mfma_f32_16x16x32_bf16 v[236:239], a[248:251], a[108:111], v[236:239]
    ds_read_b64_tr_b16 a[232:233], v241 offset:64
    ds_read_b64_tr_b16 a[234:235], v241 offset:16960
    s_mov_b32 s62, 0x002537c0
    v_mfma_f32_16x16x32_bf16 v[232:235], a[248:251], a[104:107], v[232:235]
    buffer_load_dwordx4 v245, s[20:23], s62 offen offset:2112 lds
    v_fma_f32 v253, v253, v255, v255
    v_mfma_f32_16x16x32_bf16 v[216:219], a[244:247], a[104:107], v[216:219]
    v_fma_f32 v254, v254, v255, v255
    v_mul_f32 v23, v23, v19
    v_mfma_f32_16x16x32_bf16 v[212:215], a[244:247], a[100:103], v[212:215]
    v_rcp_f32 v251, v251
    v_mfma_f32_16x16x32_bf16 v[228:231], a[248:251], a[100:103], v[228:231]
    ds_read_b64_tr_b16 a[236:237], v241 offset:96
    ds_read_b64_tr_b16 a[238:239], v241 offset:16992
    s_mov_b32 s63, 0x002553a0
    v_mfma_f32_16x16x32_bf16 v[224:227], a[248:251], a[96:99], v[224:227]
    buffer_load_dwordx4 v245, s[20:23], s63 offen offset:3168 lds
    v_mfma_f32_16x16x32_bf16 v[208:211], a[244:247], a[96:99], v[208:211]
    v_rcp_f32 v252, v252
    s_waitcnt lgkmcnt(4)
    v_mfma_f32_16x16x32_bf16 v[112:115], a[224:227], a[112:115], v[112:115]
    v_rcp_f32 v253, v253
    v_mul_f32 v20, v20, v251
    v_mfma_f32_16x16x32_bf16 v[128:131], a[228:231], a[112:115], v[128:131]
    ds_read_b64_tr_b16 a[240:241], v241 offset:128
    ds_read_b64_tr_b16 a[242:243], v241 offset:17024
    s_add_u32 m0, s47, 33792
    s_mov_b32 s62, 0x00280000
    v_mfma_f32_16x16x32_bf16 v[132:135], a[228:231], a[116:119], v[132:135]
    buffer_load_dwordx4 v245, s[20:23], s62 offen lds
    v_mul_f32 v21, v21, v252
    v_mfma_f32_16x16x32_bf16 v[116:119], a[224:227], a[116:119], v[116:119]
    v_rcp_f32 v254, v254
    v_mul_f32 v22, v22, v253
    v_mfma_f32_16x16x32_bf16 v[120:123], a[224:227], a[120:123], v[120:123]
    v_mul_f32 v23, v23, v254
    v_cvt_pk_bf16_f32 v16, v20, v21
    v_mfma_f32_16x16x32_bf16 v[136:139], a[228:231], a[120:123], v[136:139]
    ds_read_b64_tr_b16 a[244:245], v241 offset:160
    ds_read_b64_tr_b16 a[246:247], v241 offset:17056
    s_mov_b32 s63, 0x00281be0
    v_mfma_f32_16x16x32_bf16 v[140:143], a[228:231], a[124:127], v[140:143]
    buffer_load_dwordx4 v245, s[20:23], s63 offen offset:1056 lds
    v_cvt_pk_bf16_f32 v17, v22, v23
    v_mfma_f32_16x16x32_bf16 v[124:127], a[224:227], a[124:127], v[124:127]
    v_add_u32 v20, s49, v248
    s_waitcnt lgkmcnt(4)
    v_mfma_f32_16x16x32_bf16 v[156:159], a[232:235], a[124:127], v[156:159]
    ds_write_b64 v20, v[16:17]
    v_mul_f32 v251, v40, v40
    v_mul_f32 v252, v41, v41
    v_mfma_f32_16x16x32_bf16 v[172:175], a[236:239], a[124:127], v[172:175]
    ds_read_b64_tr_b16 a[248:249], v241 offset:192
    ds_read_b64_tr_b16 a[250:251], v241 offset:17088
    s_mov_b32 s62, 0x002837c0
    v_mfma_f32_16x16x32_bf16 v[168:171], a[236:239], a[120:123], v[168:171]
    buffer_load_dwordx4 v245, s[20:23], s62 offen offset:2112 lds
    v_mul_f32 v253, v42, v42
    v_mfma_f32_16x16x32_bf16 v[152:155], a[232:235], a[120:123], v[152:155]
    v_mul_f32 v254, v43, v43
    v_fma_f32 v251, v251, v5, v4
    v_fma_f32 v252, v252, v5, v4
    v_mfma_f32_16x16x32_bf16 v[148:151], a[232:235], a[116:119], v[148:151]
    v_fma_f32 v253, v253, v5, v4
    v_fma_f32 v254, v254, v5, v4
    v_mfma_f32_16x16x32_bf16 v[164:167], a[236:239], a[116:119], v[164:167]
    ds_read_b64_tr_b16 a[224:225], v241 offset:224
    ds_read_b64_tr_b16 a[226:227], v241 offset:17120
    s_mov_b32 s63, 0x002853a0
    v_mfma_f32_16x16x32_bf16 v[160:163], a[236:239], a[112:115], v[160:163]
    buffer_load_dwordx4 v245, s[20:23], s63 offen offset:3168 lds
    v_mul_f32 v251, v251, v40
    v_mfma_f32_16x16x32_bf16 v[144:147], a[232:235], a[112:115], v[144:147]
    v_mul_f32 v252, v252, v41
    s_waitcnt lgkmcnt(5)
    v_mfma_f32_16x16x32_bf16 v[176:179], a[240:243], a[112:115], v[176:179]
    v_mul_f32 v253, v253, v42
    s_add_u32 m0, s47, 38016
    s_mov_b32 s62, 0x00290000
    v_mfma_f32_16x16x32_bf16 v[192:195], a[244:247], a[112:115], v[192:195]
    buffer_load_dwordx4 v245, s[20:23], s62 offen lds
    v_mul_f32 v254, v254, v43
    v_mfma_f32_16x16x32_bf16 v[196:199], a[244:247], a[116:119], v[196:199]
    v_mul_f32 v44, v44, v40
    s_mov_b32 s63, 0x00291be0
    v_mfma_f32_16x16x32_bf16 v[180:183], a[240:243], a[116:119], v[180:183]
    buffer_load_dwordx4 v245, s[20:23], s63 offen offset:1056 lds
    v_mul_f32 v45, v45, v41
    v_mfma_f32_16x16x32_bf16 v[184:187], a[240:243], a[120:123], v[184:187]
    s_waitcnt vmcnt(14) lgkmcnt(0)
    s_barrier
    v_mul_f32 v46, v46, v42
    v_mfma_f32_16x16x32_bf16 v[200:203], a[244:247], a[120:123], v[200:203]
    ds_read_b64_tr_b16 a[228:229], v241 offset:33792
    ds_read_b64_tr_b16 a[230:231], v241 offset:50688
    v_mfma_f32_16x16x32_bf16 v[204:207], a[244:247], a[124:127], v[204:207]
    ds_read_b64_tr_b16 a[232:233], v241 offset:33824
    ds_read_b64_tr_b16 a[234:235], v241 offset:50720
    v_mul_f32 v47, v47, v43
    v_mfma_f32_16x16x32_bf16 v[188:191], a[240:243], a[124:127], v[188:191]
    v_exp_f32 v251, v251
    v_mfma_f32_16x16x32_bf16 v[220:223], a[248:251], a[124:127], v[220:223]
    v_exp_f32 v252, v252
    v_mfma_f32_16x16x32_bf16 v[236:239], a[224:227], a[124:127], v[236:239]
    ds_read_b64_tr_b16 a[236:237], v241 offset:33856
    ds_read_b64_tr_b16 a[238:239], v241 offset:50752
    s_mov_b32 s62, 0x002937c0
    v_mfma_f32_16x16x32_bf16 v[232:235], a[224:227], a[120:123], v[232:235]
    buffer_load_dwordx4 v245, s[20:23], s62 offen offset:2112 lds
    v_fma_f32 v251, v251, v6, v6
    v_mfma_f32_16x16x32_bf16 v[216:219], a[248:251], a[120:123], v[216:219]
    v_exp_f32 v253, v253
    v_mfma_f32_16x16x32_bf16 v[212:215], a[248:251], a[116:119], v[212:215]
    v_exp_f32 v254, v254
    v_fma_f32 v252, v252, v6, v6
    v_mfma_f32_16x16x32_bf16 v[228:231], a[224:227], a[116:119], v[228:231]
    ds_read_b64_tr_b16 a[240:241], v241 offset:33888
    ds_read_b64_tr_b16 a[242:243], v241 offset:50784
    s_mov_b32 s63, 0x002953a0
    v_mfma_f32_16x16x32_bf16 v[224:227], a[224:227], a[112:115], v[224:227]
    buffer_load_dwordx4 v245, s[20:23], s63 offen offset:3168 lds
    v_fma_f32 v253, v253, v6, v6
    v_mfma_f32_16x16x32_bf16 v[208:211], a[248:251], a[112:115], v[208:211]
    v_fma_f32 v254, v254, v6, v6
    s_waitcnt lgkmcnt(4)
    v_mfma_f32_16x16x32_bf16 v[112:115], a[228:231], a[128:131], v[112:115]
    v_rcp_f32 v251, v251
    v_mfma_f32_16x16x32_bf16 v[128:131], a[232:235], a[128:131], v[128:131]
    ds_read_b64_tr_b16 a[244:245], v241 offset:33920
    ds_read_b64_tr_b16 a[246:247], v241 offset:50816
    s_add_u32 m0, s47, 67584
    s_mov_b32 s62, 0x002c0000
    v_mfma_f32_16x16x32_bf16 v[132:135], a[232:235], a[132:135], v[132:135]
    buffer_load_dwordx4 v245, s[20:23], s62 offen lds
    v_mul_f32 v44, v44, v251
    v_mfma_f32_16x16x32_bf16 v[116:119], a[228:231], a[132:135], v[116:119]
    v_rcp_f32 v252, v252
    v_mfma_f32_16x16x32_bf16 v[120:123], a[228:231], a[136:139], v[120:123]
    v_rcp_f32 v253, v253
    v_mul_f32 v45, v45, v252
    v_mfma_f32_16x16x32_bf16 v[136:139], a[232:235], a[136:139], v[136:139]
    ds_read_b64_tr_b16 a[248:249], v241 offset:33952
    ds_read_b64_tr_b16 a[250:251], v241 offset:50848
    s_mov_b32 s63, 0x002c1be0
    v_mfma_f32_16x16x32_bf16 v[140:143], a[232:235], a[140:143], v[140:143]
    buffer_load_dwordx4 v245, s[20:23], s63 offen offset:1056 lds
    v_mfma_f32_16x16x32_bf16 v[124:127], a[228:231], a[140:143], v[124:127]
    v_rcp_f32 v254, v254
    s_waitcnt lgkmcnt(4)
    v_mfma_f32_16x16x32_bf16 v[156:159], a[236:239], a[140:143], v[156:159]
    v_mul_f32 v46, v46, v253
    v_mul_f32 v47, v47, v254
    v_cvt_pk_bf16_f32 v40, v44, v45
    v_mfma_f32_16x16x32_bf16 v[172:175], a[240:243], a[140:143], v[172:175]
    ds_read_b64_tr_b16 a[224:225], v241 offset:33984
    ds_read_b64_tr_b16 a[226:227], v241 offset:50880
    s_mov_b32 s62, 0x002c37c0
    v_mfma_f32_16x16x32_bf16 v[168:171], a[240:243], a[136:139], v[168:171]
    buffer_load_dwordx4 v245, s[20:23], s62 offen offset:2112 lds
    v_cvt_pk_bf16_f32 v41, v46, v47
    v_mfma_f32_16x16x32_bf16 v[152:155], a[236:239], a[136:139], v[152:155]
    v_add_u32 v44, s49, v248
    v_mul_f32 v251, v64, v64
    v_mul_f32 v252, v65, v65
    v_mfma_f32_16x16x32_bf16 v[148:151], a[236:239], a[132:135], v[148:151]
    ds_write_b64 v44, v[40:41] offset:1024
    v_mul_f32 v253, v66, v66
    v_mfma_f32_16x16x32_bf16 v[164:167], a[240:243], a[132:135], v[164:167]
    ds_read_b64_tr_b16 a[228:229], v241 offset:34016
    ds_read_b64_tr_b16 a[230:231], v241 offset:50912
    s_mov_b32 s63, 0x002c53a0
    v_mfma_f32_16x16x32_bf16 v[160:163], a[240:243], a[128:131], v[160:163]
    buffer_load_dwordx4 v245, s[20:23], s63 offen offset:3168 lds
    v_mul_f32 v254, v67, v67
    v_mfma_f32_16x16x32_bf16 v[144:147], a[236:239], a[128:131], v[144:147]
    v_fma_f32 v251, v251, v29, v28
    s_waitcnt lgkmcnt(5)
    v_mfma_f32_16x16x32_bf16 v[176:179], a[244:247], a[128:131], v[176:179]
    v_fma_f32 v252, v252, v29, v28
    s_add_u32 m0, s47, 71808
    s_mov_b32 s62, 0x002d0000
    v_mfma_f32_16x16x32_bf16 v[192:195], a[248:251], a[128:131], v[192:195]
    buffer_load_dwordx4 v245, s[20:23], s62 offen lds
    v_mfma_f32_16x16x32_bf16 v[196:199], a[248:251], a[132:135], v[196:199]
    v_fma_f32 v253, v253, v29, v28
    v_fma_f32 v254, v254, v29, v28
    s_mov_b32 s63, 0x002d1be0
    v_mfma_f32_16x16x32_bf16 v[180:183], a[244:247], a[132:135], v[180:183]
    buffer_load_dwordx4 v245, s[20:23], s63 offen offset:1056 lds
    v_mul_f32 v251, v251, v64
    v_mfma_f32_16x16x32_bf16 v[184:187], a[244:247], a[136:139], v[184:187]
    s_waitcnt vmcnt(14) lgkmcnt(0)
    s_barrier
    v_mfma_f32_16x16x32_bf16 v[200:203], a[248:251], a[136:139], v[200:203]
    ds_read_b64_tr_b16 a[232:233], v240
    ds_read_b64_tr_b16 a[234:235], v240 offset:16896
    v_mul_f32 v252, v252, v65
    v_mfma_f32_16x16x32_bf16 v[204:207], a[248:251], a[140:143], v[204:207]
    ds_read_b64_tr_b16 a[236:237], v240 offset:32
    ds_read_b64_tr_b16 a[238:239], v240 offset:16928
    v_mul_f32 v253, v253, v66
    v_mfma_f32_16x16x32_bf16 v[188:191], a[244:247], a[140:143], v[188:191]
    v_mul_f32 v254, v254, v67
    v_mfma_f32_16x16x32_bf16 v[220:223], a[224:227], a[140:143], v[220:223]
    v_exp_f32 v251, v251
    v_mul_f32 v68, v68, v64
    v_mfma_f32_16x16x32_bf16 v[236:239], a[228:231], a[140:143], v[236:239]
    ds_read_b64_tr_b16 a[240:241], v240 offset:64
    ds_read_b64_tr_b16 a[242:243], v240 offset:16960
    s_mov_b32 s62, 0x002d37c0
    v_mfma_f32_16x16x32_bf16 v[232:235], a[228:231], a[136:139], v[232:235]
    buffer_load_dwordx4 v245, s[20:23], s62 offen offset:2112 lds
    v_mfma_f32_16x16x32_bf16 v[216:219], a[224:227], a[136:139], v[216:219]
    v_exp_f32 v252, v252
    v_fma_f32 v251, v251, v30, v30
    v_mfma_f32_16x16x32_bf16 v[212:215], a[224:227], a[132:135], v[212:215]
    v_exp_f32 v253, v253
    v_fma_f32 v252, v252, v30, v30
    v_mfma_f32_16x16x32_bf16 v[228:231], a[228:231], a[132:135], v[228:231]
    ds_read_b64_tr_b16 a[244:245], v240 offset:96
    ds_read_b64_tr_b16 a[246:247], v240 offset:16992
    s_mov_b32 s63, 0x002d53a0
    v_mfma_f32_16x16x32_bf16 v[224:227], a[228:231], a[128:131], v[224:227]
    buffer_load_dwordx4 v245, s[20:23], s63 offen offset:3168 lds
    v_fma_f32 v253, v253, v30, v30
    v_mfma_f32_16x16x32_bf16 v[208:211], a[224:227], a[128:131], v[208:211]
    v_exp_f32 v254, v254
    s_waitcnt lgkmcnt(4)
    v_mfma_f32_16x16x32_bf16 v[112:115], a[232:235], a[144:147], v[112:115]
    v_fma_f32 v254, v254, v30, v30
    v_mul_f32 v69, v69, v65
    v_mfma_f32_16x16x32_bf16 v[128:131], a[236:239], a[144:147], v[128:131]
    ds_read_b64_tr_b16 a[248:249], v240 offset:128
    ds_read_b64_tr_b16 a[250:251], v240 offset:17024
    s_add_u32 m0, s47, 101376
    s_mov_b32 s62, 0x00300000
    v_mfma_f32_16x16x32_bf16 v[132:135], a[236:239], a[148:151], v[132:135]
    buffer_load_dwordx4 v245, s[20:23], s62 offen lds
    v_mul_f32 v70, v70, v66
    v_mfma_f32_16x16x32_bf16 v[116:119], a[232:235], a[148:151], v[116:119]
    v_rcp_f32 v251, v251
    v_mfma_f32_16x16x32_bf16 v[120:123], a[232:235], a[152:155], v[120:123]
    v_rcp_f32 v252, v252
    v_mul_f32 v71, v71, v67
    v_mfma_f32_16x16x32_bf16 v[136:139], a[236:239], a[152:155], v[136:139]
    ds_read_b64_tr_b16 a[224:225], v240 offset:160
    ds_read_b64_tr_b16 a[226:227], v240 offset:17056
    s_mov_b32 s63, 0x00301be0
    v_mfma_f32_16x16x32_bf16 v[140:143], a[236:239], a[156:159], v[140:143]
    buffer_load_dwordx4 v245, s[20:23], s63 offen offset:1056 lds
    v_mul_f32 v68, v68, v251
    v_mfma_f32_16x16x32_bf16 v[124:127], a[232:235], a[156:159], v[124:127]
    v_rcp_f32 v253, v253
    s_waitcnt lgkmcnt(4)
    v_mfma_f32_16x16x32_bf16 v[156:159], a[240:243], a[156:159], v[156:159]
    v_rcp_f32 v254, v254
    v_mfma_f32_16x16x32_bf16 v[172:175], a[244:247], a[156:159], v[172:175]
    ds_read_b64_tr_b16 a[228:229], v240 offset:192
    ds_read_b64_tr_b16 a[230:231], v240 offset:17088
    s_mov_b32 s62, 0x003037c0
    v_mfma_f32_16x16x32_bf16 v[168:171], a[244:247], a[152:155], v[168:171]
    buffer_load_dwordx4 v245, s[20:23], s62 offen offset:2112 lds
    v_mul_f32 v69, v69, v252
    v_mfma_f32_16x16x32_bf16 v[152:155], a[240:243], a[152:155], v[152:155]
    v_mul_f32 v70, v70, v253
    v_mul_f32 v71, v71, v254
    v_mfma_f32_16x16x32_bf16 v[148:151], a[240:243], a[148:151], v[148:151]
    v_cvt_pk_bf16_f32 v64, v68, v69
    v_cvt_pk_bf16_f32 v65, v70, v71
    v_add_u32 v68, s49, v249
    v_mfma_f32_16x16x32_bf16 v[164:167], a[244:247], a[148:151], v[164:167]
    ds_read_b64_tr_b16 a[232:233], v240 offset:224
    ds_read_b64_tr_b16 a[234:235], v240 offset:17120
    s_mov_b32 s63, 0x003053a0
    v_mfma_f32_16x16x32_bf16 v[160:163], a[244:247], a[144:147], v[160:163]
    buffer_load_dwordx4 v245, s[20:23], s63 offen offset:3168 lds
    v_mfma_f32_16x16x32_bf16 v[144:147], a[240:243], a[144:147], v[144:147]
    ds_write_b64 v68, v[64:65]
    v_mul_f32 v251, v88, v88
    s_waitcnt lgkmcnt(5)
    v_mfma_f32_16x16x32_bf16 v[176:179], a[248:251], a[144:147], v[176:179]
    v_mul_f32 v252, v89, v89
    s_add_u32 m0, s47, 105600
    s_mov_b32 s62, 0x00310000
    v_mfma_f32_16x16x32_bf16 v[192:195], a[224:227], a[144:147], v[192:195]
    buffer_load_dwordx4 v245, s[20:23], s62 offen lds
    v_mfma_f32_16x16x32_bf16 v[196:199], a[224:227], a[148:151], v[196:199]
    v_mul_f32 v253, v90, v90
    v_mul_f32 v254, v91, v91
    s_mov_b32 s63, 0x00311be0
    v_mfma_f32_16x16x32_bf16 v[180:183], a[248:251], a[148:151], v[180:183]
    buffer_load_dwordx4 v245, s[20:23], s63 offen offset:1056 lds
    v_fma_f32 v251, v251, v53, v52
    v_mfma_f32_16x16x32_bf16 v[184:187], a[248:251], a[152:155], v[184:187]
    s_waitcnt vmcnt(14) lgkmcnt(0)
    s_barrier
    v_mfma_f32_16x16x32_bf16 v[200:203], a[224:227], a[152:155], v[200:203]
    ds_read_b64_tr_b16 a[236:237], v240 offset:33792
    ds_read_b64_tr_b16 a[238:239], v240 offset:50688
    v_fma_f32 v252, v252, v53, v52
    v_mfma_f32_16x16x32_bf16 v[204:207], a[224:227], a[156:159], v[204:207]
    ds_read_b64_tr_b16 a[240:241], v240 offset:33824
    ds_read_b64_tr_b16 a[242:243], v240 offset:50720
    v_fma_f32 v253, v253, v53, v52
    v_mfma_f32_16x16x32_bf16 v[188:191], a[248:251], a[156:159], v[188:191]
    v_fma_f32 v254, v254, v53, v52
    v_mfma_f32_16x16x32_bf16 v[220:223], a[228:231], a[156:159], v[220:223]
    v_mul_f32 v251, v251, v88
    v_mul_f32 v252, v252, v89
    v_mul_f32 v253, v253, v90
    v_mfma_f32_16x16x32_bf16 v[236:239], a[232:235], a[156:159], v[236:239]
    ds_read_b64_tr_b16 a[244:245], v240 offset:33856
    ds_read_b64_tr_b16 a[246:247], v240 offset:50752
    s_mov_b32 s62, 0x003137c0
    v_mfma_f32_16x16x32_bf16 v[232:235], a[232:235], a[152:155], v[232:235]
    buffer_load_dwordx4 v245, s[20:23], s62 offen offset:2112 lds
    v_mul_f32 v254, v254, v91
    v_mfma_f32_16x16x32_bf16 v[216:219], a[228:231], a[152:155], v[216:219]
    v_exp_f32 v251, v251
    v_mul_f32 v92, v92, v88
    v_mfma_f32_16x16x32_bf16 v[212:215], a[228:231], a[148:151], v[212:215]
    v_exp_f32 v252, v252
    v_mfma_f32_16x16x32_bf16 v[228:231], a[232:235], a[148:151], v[228:231]
    ds_read_b64_tr_b16 a[248:249], v240 offset:33888
    ds_read_b64_tr_b16 a[250:251], v240 offset:50784
    s_mov_b32 s63, 0x003153a0
    v_mfma_f32_16x16x32_bf16 v[224:227], a[232:235], a[144:147], v[224:227]
    buffer_load_dwordx4 v245, s[20:23], s63 offen offset:3168 lds
    v_fma_f32 v251, v251, v54, v54
    v_mfma_f32_16x16x32_bf16 v[208:211], a[228:231], a[144:147], v[208:211]
    v_fma_f32 v252, v252, v54, v54
    s_waitcnt lgkmcnt(4)
    v_mfma_f32_16x16x32_bf16 v[112:115], a[236:239], a[160:163], v[112:115]
    v_exp_f32 v253, v253
    v_mul_f32 v93, v93, v89
    v_mfma_f32_16x16x32_bf16 v[128:131], a[240:243], a[160:163], v[128:131]
    ds_read_b64_tr_b16 a[224:225], v240 offset:33920
    ds_read_b64_tr_b16 a[226:227], v240 offset:50816
    s_add_u32 m0, s47, 0
    s_mov_b32 s62, 0x00340000
    v_mfma_f32_16x16x32_bf16 v[132:135], a[240:243], a[164:167], v[132:135]
    buffer_load_dwordx4 v245, s[20:23], s62 offen lds
    v_mfma_f32_16x16x32_bf16 v[116:119], a[236:239], a[164:167], v[116:119]
    v_exp_f32 v254, v254
    v_fma_f32 v253, v253, v54, v54
    v_mfma_f32_16x16x32_bf16 v[120:123], a[236:239], a[168:171], v[120:123]
    v_fma_f32 v254, v254, v54, v54
    v_rcp_f32 v251, v251
    v_mfma_f32_16x16x32_bf16 v[136:139], a[240:243], a[168:171], v[136:139]
    ds_read_b64_tr_b16 a[228:229], v240 offset:33952
    ds_read_b64_tr_b16 a[230:231], v240 offset:50848
    s_mov_b32 s63, 0x00341be0
    v_mfma_f32_16x16x32_bf16 v[140:143], a[240:243], a[172:175], v[140:143]
    buffer_load_dwordx4 v245, s[20:23], s63 offen offset:1056 lds
    v_mul_f32 v94, v94, v90
    v_mfma_f32_16x16x32_bf16 v[124:127], a[236:239], a[172:175], v[124:127]
    v_rcp_f32 v252, v252
    s_waitcnt lgkmcnt(4)
    v_mfma_f32_16x16x32_bf16 v[156:159], a[244:247], a[172:175], v[156:159]
    v_rcp_f32 v253, v253
    v_mfma_f32_16x16x32_bf16 v[172:175], a[248:251], a[172:175], v[172:175]
    ds_read_b64_tr_b16 a[232:233], v240 offset:33984
    ds_read_b64_tr_b16 a[234:235], v240 offset:50880
    s_mov_b32 s62, 0x003437c0
    v_mfma_f32_16x16x32_bf16 v[168:171], a[248:251], a[168:171], v[168:171]
    buffer_load_dwordx4 v245, s[20:23], s62 offen offset:2112 lds
    v_mul_f32 v95, v95, v91
    v_mfma_f32_16x16x32_bf16 v[152:155], a[244:247], a[168:171], v[152:155]
    v_rcp_f32 v254, v254
    v_mfma_f32_16x16x32_bf16 v[148:151], a[244:247], a[164:167], v[148:151]
    v_mul_f32 v92, v92, v251
    v_mul_f32 v93, v93, v252
    v_mul_f32 v94, v94, v253
    v_mfma_f32_16x16x32_bf16 v[164:167], a[248:251], a[164:167], v[164:167]
    ds_read_b64_tr_b16 a[236:237], v240 offset:34016
    ds_read_b64_tr_b16 a[238:239], v240 offset:50912
    s_mov_b32 s63, 0x003453a0
    v_mfma_f32_16x16x32_bf16 v[160:163], a[248:251], a[160:163], v[160:163]
    buffer_load_dwordx4 v245, s[20:23], s63 offen offset:3168 lds
    v_mul_f32 v95, v95, v254
    v_mfma_f32_16x16x32_bf16 v[144:147], a[244:247], a[160:163], v[144:147]
    v_cvt_pk_bf16_f32 v88, v92, v93
    v_cvt_pk_bf16_f32 v89, v94, v95
    s_waitcnt lgkmcnt(4)
    v_mfma_f32_16x16x32_bf16 v[176:179], a[224:227], a[160:163], v[176:179]
    s_add_u32 m0, s47, 4224
    s_mov_b32 s62, 0x00350000
    v_mfma_f32_16x16x32_bf16 v[192:195], a[228:231], a[160:163], v[192:195]
    buffer_load_dwordx4 v245, s[20:23], s62 offen lds
    v_add_u32 v92, s49, v249
    v_mfma_f32_16x16x32_bf16 v[196:199], a[228:231], a[164:167], v[196:199]
    ds_write_b64 v92, v[88:89] offset:1024
    s_mov_b32 s63, 0x00351be0
    v_mfma_f32_16x16x32_bf16 v[180:183], a[224:227], a[164:167], v[180:183]
    buffer_load_dwordx4 v245, s[20:23], s63 offen offset:1056 lds
    v_mfma_f32_16x16x32_bf16 v[184:187], a[224:227], a[168:171], v[184:187]
    s_waitcnt vmcnt(14) lgkmcnt(0)
    s_barrier
    v_mfma_f32_16x16x32_bf16 v[200:203], a[228:231], a[168:171], v[200:203]
    ds_read_b64_tr_b16 a[240:241], v241
    ds_read_b64_tr_b16 a[242:243], v241 offset:16896
    v_mfma_f32_16x16x32_bf16 v[204:207], a[228:231], a[172:175], v[204:207]
    ds_read_b64_tr_b16 a[244:245], v241 offset:32
    ds_read_b64_tr_b16 a[246:247], v241 offset:16928
    v_mfma_f32_16x16x32_bf16 v[188:191], a[224:227], a[172:175], v[188:191]
    v_add_u32 v56, 135168, v248
    v_mfma_f32_16x16x32_bf16 v[220:223], a[232:235], a[172:175], v[220:223]
    v_add_u32 v57, 135168, v249
    v_accvgpr_read_b32 v242, a252
    v_mfma_f32_16x16x32_bf16 v[236:239], a[236:239], a[172:175], v[236:239]
    ds_read_b64_tr_b16 a[248:249], v241 offset:64
    ds_read_b64_tr_b16 a[250:251], v241 offset:16960
    s_mov_b32 s62, 0x003537c0
    v_mfma_f32_16x16x32_bf16 v[232:235], a[236:239], a[168:171], v[232:235]
    buffer_load_dwordx4 v245, s[20:23], s62 offen offset:2112 lds
    v_mfma_f32_16x16x32_bf16 v[216:219], a[232:235], a[168:171], v[216:219]
    ds_read_b128 a[0:3], v56
    ds_read_b128 a[4:7], v56 offset:1024
    v_mfma_f32_16x16x32_bf16 v[212:215], a[232:235], a[164:167], v[212:215]
    ds_read_b128 a[8:11], v57
    ds_read_b128 a[12:15], v57 offset:1024
    v_mfma_f32_16x16x32_bf16 v[228:231], a[236:239], a[164:167], v[228:231]
    ds_read_b64_tr_b16 a[224:225], v241 offset:96
    ds_read_b64_tr_b16 a[226:227], v241 offset:16992
    s_mov_b32 s63, 0x003553a0
    v_mfma_f32_16x16x32_bf16 v[224:227], a[236:239], a[160:163], v[224:227]
    buffer_load_dwordx4 v245, s[20:23], s63 offen offset:3168 lds
    v_mfma_f32_16x16x32_bf16 v[208:211], a[232:235], a[160:163], v[208:211]
    ds_read_b128 a[16:19], v56 offset:4096
    s_waitcnt lgkmcnt(9)
    v_mfma_f32_16x16x32_bf16 v[112:115], a[240:243], a[176:179], v[112:115]
    ds_read_b128 a[20:23], v56 offset:5120
    ds_read_b128 a[24:27], v57 offset:4096
    v_mfma_f32_16x16x32_bf16 v[128:131], a[244:247], a[176:179], v[128:131]
    ds_read_b64_tr_b16 a[228:229], v241 offset:128
    ds_read_b64_tr_b16 a[230:231], v241 offset:17024
    s_add_u32 m0, s47, 33792
    s_mov_b32 s62, 0x00000200
    v_mfma_f32_16x16x32_bf16 v[132:135], a[244:247], a[180:183], v[132:135]
    buffer_load_dwordx4 v246, s[32:35], s62 offen lds
    v_mfma_f32_16x16x32_bf16 v[116:119], a[240:243], a[180:183], v[116:119]
    ds_read_b128 a[28:31], v57 offset:5120
    ds_read_b128 a[32:35], v56 offset:8192
    v_mfma_f32_16x16x32_bf16 v[120:123], a[240:243], a[184:187], v[120:123]
    ds_read_b128 a[36:39], v56 offset:9216
    ds_read_b128 a[40:43], v57 offset:8192
    v_mfma_f32_16x16x32_bf16 v[136:139], a[244:247], a[184:187], v[136:139]
    ds_read_b64_tr_b16 a[232:233], v241 offset:160
    ds_read_b64_tr_b16 a[234:235], v241 offset:17056
    s_mov_b32 s63, 0x00000160
    v_mfma_f32_16x16x32_bf16 v[140:143], a[244:247], a[188:191], v[140:143]
    buffer_load_dwordx4 v246, s[32:35], s63 offen offset:1056 lds
    v_mfma_f32_16x16x32_bf16 v[124:127], a[240:243], a[188:191], v[124:127]
    ds_read_b128 a[44:47], v57 offset:9216
    s_waitcnt lgkmcnt(12)
    v_mfma_f32_16x16x32_bf16 v[156:159], a[248:251], a[188:191], v[156:159]
    ds_read_b128 a[48:51], v56 offset:12288
    ds_read_b128 a[52:55], v56 offset:13312
    v_mfma_f32_16x16x32_bf16 v[172:175], a[224:227], a[188:191], v[172:175]
    ds_read_b64_tr_b16 a[236:237], v241 offset:192
    ds_read_b64_tr_b16 a[238:239], v241 offset:17088
    s_mov_b32 s62, 0x000000c0
    v_mfma_f32_16x16x32_bf16 v[168:171], a[224:227], a[184:187], v[168:171]
    buffer_load_dwordx4 v246, s[32:35], s62 offen offset:2112 lds
    v_mfma_f32_16x16x32_bf16 v[152:155], a[248:251], a[184:187], v[152:155]
    ds_read_b128 a[56:59], v57 offset:12288
    ds_read_b128 a[60:63], v57 offset:13312
    v_mfma_f32_16x16x32_bf16 v[148:151], a[248:251], a[180:183], v[148:151]
    ds_read_b128 a[64:67], v56 offset:16384
    ds_read_b128 a[68:71], v56 offset:17408
    v_mfma_f32_16x16x32_bf16 v[164:167], a[224:227], a[180:183], v[164:167]
    ds_read_b64_tr_b16 a[240:241], v241 offset:224
    ds_read_b64_tr_b16 a[242:243], v241 offset:17120
    s_mov_b32 s63, 0x00000020
    v_mfma_f32_16x16x32_bf16 v[160:163], a[224:227], a[176:179], v[160:163]
    buffer_load_dwordx4 v246, s[32:35], s63 offen offset:3168 lds
    v_mfma_f32_16x16x32_bf16 v[144:147], a[248:251], a[176:179], v[144:147]
    ds_read_b128 a[72:75], v57 offset:16384
    s_waitcnt lgkmcnt(12)
    v_mfma_f32_16x16x32_bf16 v[176:179], a[228:231], a[176:179], v[176:179]
    s_add_u32 m0, s47, 38016
    s_mov_b32 s62, 0x00001000
    v_mfma_f32_16x16x32_bf16 v[192:195], a[232:235], a[176:179], v[192:195]
    buffer_load_dwordx4 v246, s[32:35], s62 offen lds
    v_mfma_f32_16x16x32_bf16 v[196:199], a[232:235], a[180:183], v[196:199]
    ds_read_b128 a[76:79], v57 offset:17408
    s_mov_b32 s63, 0x00000f60
    v_mfma_f32_16x16x32_bf16 v[180:183], a[228:231], a[180:183], v[180:183]
    buffer_load_dwordx4 v246, s[32:35], s63 offen offset:1056 lds
    v_mfma_f32_16x16x32_bf16 v[184:187], a[228:231], a[184:187], v[184:187]
    s_waitcnt vmcnt(14) lgkmcnt(0)
    s_barrier
    v_mfma_f32_16x16x32_bf16 v[200:203], a[232:235], a[184:187], v[200:203]
    ds_read_b64_tr_b16 a[244:245], v241 offset:33792
    ds_read_b64_tr_b16 a[246:247], v241 offset:50688
    v_mfma_f32_16x16x32_bf16 v[204:207], a[232:235], a[188:191], v[204:207]
    ds_read_b64_tr_b16 a[248:249], v241 offset:33824
    ds_read_b64_tr_b16 a[250:251], v241 offset:50720
    v_mfma_f32_16x16x32_bf16 v[188:191], a[228:231], a[188:191], v[188:191]
    ds_read_b128 a[80:83], v56 offset:20480
    v_mfma_f32_16x16x32_bf16 v[220:223], a[236:239], a[188:191], v[220:223]
    ds_read_b128 a[84:87], v56 offset:21504
    ds_read_b128 a[88:91], v57 offset:20480
    v_mfma_f32_16x16x32_bf16 v[236:239], a[240:243], a[188:191], v[236:239]
    ds_read_b64_tr_b16 a[224:225], v241 offset:33856
    ds_read_b64_tr_b16 a[226:227], v241 offset:50752
    s_mov_b32 s62, 0x00000ec0
    v_mfma_f32_16x16x32_bf16 v[232:235], a[240:243], a[184:187], v[232:235]
    buffer_load_dwordx4 v246, s[32:35], s62 offen offset:2112 lds
    v_mfma_f32_16x16x32_bf16 v[216:219], a[236:239], a[184:187], v[216:219]
    ds_read_b128 a[92:95], v57 offset:21504
    v_accvgpr_read_b32 v243, a253
    v_mfma_f32_16x16x32_bf16 v[212:215], a[236:239], a[180:183], v[212:215]
    v_rcp_f32 v242, v242
    v_mfma_f32_16x16x32_bf16 v[228:231], a[240:243], a[180:183], v[228:231]
    ds_read_b64_tr_b16 a[228:229], v241 offset:33888
    ds_read_b64_tr_b16 a[230:231], v241 offset:50784
    s_mov_b32 s63, 0x00000e20
    v_mfma_f32_16x16x32_bf16 v[224:227], a[240:243], a[176:179], v[224:227]
    buffer_load_dwordx4 v246, s[32:35], s63 offen offset:3168 lds
    v_mfma_f32_16x16x32_bf16 v[208:211], a[236:239], a[176:179], v[208:211]
    v_mul_f32 v242, s56, v242
    s_waitcnt lgkmcnt(8)
    v_mfma_f32_16x16x32_bf16 v[112:115], a[244:247], a[192:195], v[112:115]
    v_rcp_f32 v243, v243
    v_mfma_f32_16x16x32_bf16 v[128:131], a[248:251], a[192:195], v[128:131]
    ds_read_b64_tr_b16 a[232:233], v241 offset:33920
    ds_read_b64_tr_b16 a[234:235], v241 offset:50816
    s_add_u32 m0, s47, 67584
    s_mov_b32 s62, 0x00007200
    v_mfma_f32_16x16x32_bf16 v[132:135], a[248:251], a[196:199], v[132:135]
    buffer_load_dwordx4 v246, s[32:35], s62 offen lds
    v_mfma_f32_16x16x32_bf16 v[116:119], a[244:247], a[196:199], v[116:119]
    v_mul_f32 v243, s56, v243
    v_accvgpr_read_b32 v254, a254
    v_mfma_f32_16x16x32_bf16 v[120:123], a[244:247], a[200:203], v[120:123]
    v_rcp_f32 v254, v254
    v_mfma_f32_16x16x32_bf16 v[136:139], a[248:251], a[200:203], v[136:139]
    ds_read_b64_tr_b16 a[236:237], v241 offset:33952
    ds_read_b64_tr_b16 a[238:239], v241 offset:50848
    s_mov_b32 s63, 0x00007160
    v_mfma_f32_16x16x32_bf16 v[140:143], a[248:251], a[204:207], v[140:143]
    buffer_load_dwordx4 v246, s[32:35], s63 offen offset:1056 lds
    v_mfma_f32_16x16x32_bf16 v[124:127], a[244:247], a[204:207], v[124:127]
    v_mul_f32 v254, s56, v254
    s_waitcnt lgkmcnt(4)
    v_mfma_f32_16x16x32_bf16 v[156:159], a[224:227], a[204:207], v[156:159]
    v_accvgpr_read_b32 v255, a255
    v_mfma_f32_16x16x32_bf16 v[172:175], a[228:231], a[204:207], v[172:175]
    ds_read_b64_tr_b16 a[240:241], v241 offset:33984
    ds_read_b64_tr_b16 a[242:243], v241 offset:50880
    s_mov_b32 s62, 0x000070c0
    v_mfma_f32_16x16x32_bf16 v[168:171], a[228:231], a[200:203], v[168:171]
    buffer_load_dwordx4 v246, s[32:35], s62 offen offset:2112 lds
    v_mfma_f32_16x16x32_bf16 v[152:155], a[224:227], a[200:203], v[152:155]
    v_rcp_f32 v255, v255
    v_mfma_f32_16x16x32_bf16 v[148:151], a[224:227], a[196:199], v[148:151]
    v_mul_f32 v255, s56, v255
    v_mfma_f32_16x16x32_bf16 v[164:167], a[228:231], a[196:199], v[164:167]
    ds_read_b64_tr_b16 a[244:245], v241 offset:34016
    ds_read_b64_tr_b16 a[246:247], v241 offset:50912
    s_mov_b32 s63, 0x00007020
    v_mfma_f32_16x16x32_bf16 v[160:163], a[228:231], a[192:195], v[160:163]
    buffer_load_dwordx4 v246, s[32:35], s63 offen offset:3168 lds
    v_mfma_f32_16x16x32_bf16 v[144:147], a[224:227], a[192:195], v[144:147]
    s_waitcnt lgkmcnt(4)
    v_mfma_f32_16x16x32_bf16 v[176:179], a[232:235], a[192:195], v[176:179]
    s_add_u32 m0, s47, 71808
    s_mov_b32 s62, 0x00008000
    v_mfma_f32_16x16x32_bf16 v[192:195], a[236:239], a[192:195], v[192:195]
    buffer_load_dwordx4 v246, s[32:35], s62 offen lds
    v_mfma_f32_16x16x32_bf16 v[196:199], a[236:239], a[196:199], v[196:199]
    s_mov_b32 s63, 0x00007f60
    v_mfma_f32_16x16x32_bf16 v[180:183], a[232:235], a[196:199], v[180:183]
    buffer_load_dwordx4 v246, s[32:35], s63 offen offset:1056 lds
    v_mfma_f32_16x16x32_bf16 v[184:187], a[232:235], a[200:203], v[184:187]
    s_waitcnt vmcnt(14) lgkmcnt(0)
    s_barrier
    v_mfma_f32_16x16x32_bf16 v[200:203], a[236:239], a[200:203], v[200:203]
    ds_read_b64_tr_b16 a[248:249], v240
    ds_read_b64_tr_b16 a[250:251], v240 offset:16896
    v_mfma_f32_16x16x32_bf16 v[204:207], a[236:239], a[204:207], v[204:207]
    ds_read_b64_tr_b16 a[224:225], v240 offset:32
    ds_read_b64_tr_b16 a[226:227], v240 offset:16928
    v_mfma_f32_16x16x32_bf16 v[188:191], a[232:235], a[204:207], v[188:191]
    v_mfma_f32_16x16x32_bf16 v[220:223], a[240:243], a[204:207], v[220:223]
    v_mfma_f32_16x16x32_bf16 v[236:239], a[244:247], a[204:207], v[236:239]
    ds_read_b64_tr_b16 a[228:229], v240 offset:64
    ds_read_b64_tr_b16 a[230:231], v240 offset:16960
    s_mov_b32 s62, 0x00007ec0
    v_mfma_f32_16x16x32_bf16 v[232:235], a[244:247], a[200:203], v[232:235]
    buffer_load_dwordx4 v246, s[32:35], s62 offen offset:2112 lds
    v_mfma_f32_16x16x32_bf16 v[216:219], a[240:243], a[200:203], v[216:219]
    v_mfma_f32_16x16x32_bf16 v[212:215], a[240:243], a[196:199], v[212:215]
    v_mfma_f32_16x16x32_bf16 v[228:231], a[244:247], a[196:199], v[228:231]
    ds_read_b64_tr_b16 a[232:233], v240 offset:96
    ds_read_b64_tr_b16 a[234:235], v240 offset:16992
    s_mov_b32 s63, 0x00007e20
    v_mfma_f32_16x16x32_bf16 v[224:227], a[244:247], a[192:195], v[224:227]
    buffer_load_dwordx4 v246, s[32:35], s63 offen offset:3168 lds
    v_mfma_f32_16x16x32_bf16 v[208:211], a[240:243], a[192:195], v[208:211]
    s_waitcnt lgkmcnt(4)
    v_mfma_f32_16x16x32_bf16 v[112:115], a[248:251], a[208:211], v[112:115]
    s_lshl_b32 s89, s3, 2
    s_add_u32 s89, s89, s44
    s_lshl_b32 s89, s89, 11
    v_mfma_f32_16x16x32_bf16 v[128:131], a[224:227], a[208:211], v[128:131]
    ds_read_b64_tr_b16 a[236:237], v240 offset:128
    ds_read_b64_tr_b16 a[238:239], v240 offset:17024
    s_add_u32 m0, s47, 101376
    s_mov_b32 s62, 0x0000e200
    v_mfma_f32_16x16x32_bf16 v[132:135], a[224:227], a[212:215], v[132:135]
    buffer_load_dwordx4 v246, s[32:35], s62 offen lds
    v_mfma_f32_16x16x32_bf16 v[116:119], a[248:251], a[212:215], v[116:119]
    v_lshlrev_b32 v253, 7, v250
    v_mfma_f32_16x16x32_bf16 v[120:123], a[248:251], a[216:219], v[120:123]
    s_mov_b64 exec, 0x0000ffff
    buffer_load_dword a201, v253, s[12:15], s89 offen offset:128
    s_mov_b64 exec, -1
    v_mfma_f32_16x16x32_bf16 v[136:139], a[224:227], a[216:219], v[136:139]
    ds_read_b64_tr_b16 a[240:241], v240 offset:160
    ds_read_b64_tr_b16 a[242:243], v240 offset:17056
    s_mov_b32 s63, 0x0000e160
    v_mfma_f32_16x16x32_bf16 v[140:143], a[224:227], a[220:223], v[140:143]
    buffer_load_dwordx4 v246, s[32:35], s63 offen offset:1056 lds
    v_mfma_f32_16x16x32_bf16 v[124:127], a[248:251], a[220:223], v[124:127]
    s_waitcnt lgkmcnt(4)
    v_mfma_f32_16x16x32_bf16 v[156:159], a[228:231], a[220:223], v[156:159]
    v_mfma_f32_16x16x32_bf16 v[172:175], a[232:235], a[220:223], v[172:175]
    ds_read_b64_tr_b16 a[244:245], v240 offset:192
    ds_read_b64_tr_b16 a[246:247], v240 offset:17088
    s_mov_b32 s62, 0x0000e0c0
    v_mfma_f32_16x16x32_bf16 v[168:171], a[232:235], a[216:219], v[168:171]
    buffer_load_dwordx4 v246, s[32:35], s62 offen offset:2112 lds
    v_mfma_f32_16x16x32_bf16 v[152:155], a[228:231], a[216:219], v[152:155]
    v_mfma_f32_16x16x32_bf16 v[148:151], a[228:231], a[212:215], v[148:151]
    s_mov_b64 exec, 0x0000ffff
    buffer_load_dword a201, v253, s[16:19], s89 offen offset:128
    s_mov_b64 exec, -1
    v_mfma_f32_16x16x32_bf16 v[164:167], a[232:235], a[212:215], v[164:167]
    ds_read_b64_tr_b16 a[248:249], v240 offset:224
    ds_read_b64_tr_b16 a[250:251], v240 offset:17120
    s_mov_b32 s63, 0x0000e020
    v_mfma_f32_16x16x32_bf16 v[160:163], a[232:235], a[208:211], v[160:163]
    buffer_load_dwordx4 v246, s[32:35], s63 offen offset:3168 lds
    v_mfma_f32_16x16x32_bf16 v[144:147], a[228:231], a[208:211], v[144:147]
    v_lshlrev_b32 v253, 2, v250
    s_waitcnt lgkmcnt(4)
    v_mfma_f32_16x16x32_bf16 v[176:179], a[236:239], a[208:211], v[176:179]
    s_add_u32 m0, s47, 105600
    s_mov_b32 s62, 0x0000f000
    v_mfma_f32_16x16x32_bf16 v[192:195], a[240:243], a[208:211], v[192:195]
    buffer_load_dwordx4 v246, s[32:35], s62 offen lds
    v_mfma_f32_16x16x32_bf16 v[196:199], a[240:243], a[212:215], v[196:199]
    s_mov_b32 s63, 0x0000ef60
    v_mfma_f32_16x16x32_bf16 v[180:183], a[236:239], a[212:215], v[180:183]
    buffer_load_dwordx4 v246, s[32:35], s63 offen offset:1056 lds
    v_mfma_f32_16x16x32_bf16 v[184:187], a[236:239], a[216:219], v[184:187]
    s_waitcnt vmcnt(16) lgkmcnt(0)
    s_barrier
    v_mfma_f32_16x16x32_bf16 v[200:203], a[240:243], a[216:219], v[200:203]
    v_subrev_u32 v240, s50, v240
    ds_read_b64_tr_b16 a[224:225], v240 offset:33792
    v_mfma_f32_16x16x32_bf16 v[204:207], a[240:243], a[220:223], v[204:207]
    ds_read_b64_tr_b16 a[226:227], v240 offset:50688
    ds_read_b64_tr_b16 a[228:229], v240 offset:33824
    v_mfma_f32_16x16x32_bf16 v[188:191], a[236:239], a[220:223], v[188:191]
    ds_read_b64_tr_b16 a[230:231], v240 offset:50720
    v_mfma_f32_16x16x32_bf16 v[220:223], a[244:247], a[220:223], v[220:223]
    buffer_load_dword a200, v253, s[16:19], s89 offen offset:128
    v_mfma_f32_16x16x32_bf16 v[236:239], a[248:251], a[220:223], v[236:239]
    ds_read_b64_tr_b16 a[232:233], v240 offset:33856
    ds_read_b64_tr_b16 a[234:235], v240 offset:50752
    s_mov_b32 s62, 0x0000eec0
    v_mfma_f32_16x16x32_bf16 v[232:235], a[248:251], a[216:219], v[232:235]
    buffer_load_dwordx4 v246, s[32:35], s62 offen offset:2112 lds
    v_mfma_f32_16x16x32_bf16 v[216:219], a[244:247], a[216:219], v[216:219]
    v_mfma_f32_16x16x32_bf16 v[212:215], a[244:247], a[212:215], v[212:215]
    v_mfma_f32_16x16x32_bf16 v[228:231], a[248:251], a[212:215], v[228:231]
    ds_read_b64_tr_b16 a[236:237], v240 offset:33888
    ds_read_b64_tr_b16 a[238:239], v240 offset:50784
    s_mov_b32 s63, 0x0000ee20
    v_mfma_f32_16x16x32_bf16 v[224:227], a[248:251], a[208:211], v[224:227]
    buffer_load_dwordx4 v246, s[32:35], s63 offen offset:3168 lds
    v_mfma_f32_16x16x32_bf16 v[208:211], a[244:247], a[208:211], v[208:211]
    s_waitcnt lgkmcnt(4)
    v_mfma_f32_16x16x32_bf16 v[0:3], a[224:227], a[0:3], 0
    v_mfma_f32_16x16x32_bf16 v[16:19], a[228:231], a[0:3], 0
    ds_read_b64_tr_b16 a[240:241], v240 offset:33920
    ds_read_b64_tr_b16 a[242:243], v240 offset:50816
    s_add_u32 m0, s47, 0
    s_mov_b32 s62, 0x00015200
    v_mfma_f32_16x16x32_bf16 v[20:23], a[228:231], a[4:7], 0
    buffer_load_dwordx4 v246, s[32:35], s62 offen lds
    v_mfma_f32_16x16x32_bf16 v[4:7], a[224:227], a[4:7], 0
    v_and_b32 v251, 15, v250
    v_lshlrev_b32 v251, 4, v251
    v_mfma_f32_16x16x32_bf16 v[8:11], a[224:227], a[8:11], 0
    v_lshrrev_b32 v252, 5, v250
    v_lshl_add_u32 v251, v252, 8, v251
    v_bfe_u32 v252, v250, 4, 1
    v_mfma_f32_16x16x32_bf16 v[24:27], a[228:231], a[8:11], 0
    ds_read_b64_tr_b16 a[244:245], v240 offset:33952
    ds_read_b64_tr_b16 a[246:247], v240 offset:50848
    s_mov_b32 s63, 0x00015160
    v_mfma_f32_16x16x32_bf16 v[28:31], a[228:231], a[12:15], 0
    buffer_load_dwordx4 v246, s[32:35], s63 offen offset:1056 lds
    v_lshl_add_u32 v251, v252, 3, v251
    v_mfma_f32_16x16x32_bf16 v[12:15], a[224:227], a[12:15], 0
    v_mul_f32 v112, v242, v112
    s_waitcnt lgkmcnt(4)
    s_mov_b32 s62, 0x000150c0
    v_mfma_f32_16x16x32_bf16 v[44:47], a[232:235], a[12:15], 0
    buffer_load_dwordx4 v246, s[32:35], s62 offen offset:2112 lds
    v_mul_f32 v113, v242, v113
    v_mfma_f32_16x16x32_bf16 v[60:63], a[236:239], a[12:15], 0
    ds_read_b64_tr_b16 a[248:249], v240 offset:33984
    ds_read_b64_tr_b16 a[250:251], v240 offset:50880
    v_mul_f32 v114, v242, v114
    v_mfma_f32_16x16x32_bf16 v[56:59], a[236:239], a[8:11], 0
    s_xor_b32 s48, s61, 1
    s_mul_i32 s48, s48, 101376
    s_lshl_b32 s49, s60, 14
    s_add_u32 s49, s48, s49
    s_add_u32 s51, s49, s59
    s_sub_u32 s49, s49, s59
    s_add_u32 s49, s49, 2048
    s_mov_b32 s63, 0x00015020
    v_mfma_f32_16x16x32_bf16 v[40:43], a[232:235], a[8:11], 0
    buffer_load_dwordx4 v246, s[32:35], s63 offen offset:3168 lds
    v_add_u32 v252, s49, v251
    v_mfma_f32_16x16x32_bf16 v[36:39], a[232:235], a[4:7], 0
    v_add_u32 v251, s51, v251
    v_mul_f32 v115, v242, v115
    v_cvt_pk_bf16_f32 v112, v112, v113
    v_mfma_f32_16x16x32_bf16 v[52:55], a[236:239], a[4:7], 0
    s_add_u32 m0, s47, 4224
    s_mov_b32 s62, 0x00016000
    v_mfma_f32_16x16x32_bf16 v[48:51], a[236:239], a[0:3], 0
    buffer_load_dwordx4 v246, s[32:35], s62 offen lds
    v_cvt_pk_bf16_f32 v113, v114, v115
    v_mfma_f32_16x16x32_bf16 v[32:35], a[232:235], a[0:3], 0
    v_mul_f32 v116, v243, v116
    v_mul_f32 v117, v243, v117
    s_waitcnt lgkmcnt(2)
    v_mfma_f32_16x16x32_bf16 v[64:67], a[240:243], a[0:3], 0
    s_waitcnt vmcnt(16) lgkmcnt(0)
    s_barrier
    v_mul_f32 v118, v243, v118
    v_mfma_f32_16x16x32_bf16 v[80:83], a[244:247], a[0:3], 0
    v_subrev_u32 v241, s50, v241
    ds_read_b64_tr_b16 a[224:225], v241
    v_mul_f32 v119, v243, v119
    v_mfma_f32_16x16x32_bf16 v[84:87], a[244:247], a[4:7], 0
    ds_read_b64_tr_b16 a[226:227], v241 offset:16896
    ds_read_b64_tr_b16 a[228:229], v241 offset:32
    v_cvt_pk_bf16_f32 v116, v116, v117
    v_mfma_f32_16x16x32_bf16 v[68:71], a[240:243], a[4:7], 0
    ds_read_b64_tr_b16 a[230:231], v241 offset:16928
    v_cvt_pk_bf16_f32 v117, v118, v119
    s_mov_b32 s63, 0x00015f60
    v_mfma_f32_16x16x32_bf16 v[72:75], a[240:243], a[8:11], 0
    buffer_load_dwordx4 v246, s[32:35], s63 offen offset:1056 lds
    v_mul_f32 v120, v254, v120
    v_mfma_f32_16x16x32_bf16 v[88:91], a[244:247], a[8:11], 0
    ds_read_b64_tr_b16 a[232:233], v241 offset:64
    ds_read_b64_tr_b16 a[234:235], v241 offset:16960
    s_mov_b32 s62, 0x00015ec0
    v_mfma_f32_16x16x32_bf16 v[92:95], a[244:247], a[12:15], 0
    buffer_load_dwordx4 v246, s[32:35], s62 offen offset:2112 lds
    v_mul_f32 v121, v254, v121
    v_mfma_f32_16x16x32_bf16 v[76:79], a[240:243], a[12:15], 0
    v_mul_f32 v122, v254, v122
    v_mfma_f32_16x16x32_bf16 v[108:111], a[248:251], a[12:15], 0
    v_mul_f32 v123, v254, v123
    v_cvt_pk_bf16_f32 v120, v120, v121
    v_mul_f32 v124, v255, v124
    v_mfma_f32_16x16x32_bf16 v[104:107], a[248:251], a[8:11], 0
    ds_read_b64_tr_b16 a[236:237], v241 offset:96
    ds_read_b64_tr_b16 a[238:239], v241 offset:16992
    s_mov_b32 s63, 0x00015e20
    v_mfma_f32_16x16x32_bf16 v[100:103], a[248:251], a[4:7], 0
    buffer_load_dwordx4 v246, s[32:35], s63 offen offset:3168 lds
    v_cvt_pk_bf16_f32 v121, v122, v123
    v_mfma_f32_16x16x32_bf16 v[96:99], a[248:251], a[0:3], 0
    v_mul_f32 v125, v255, v125
    v_mul_f32 v126, v255, v126
    s_waitcnt lgkmcnt(4)
    v_mfma_f32_16x16x32_bf16 v[0:3], a[224:227], a[16:19], v[0:3]
    v_mul_f32 v127, v255, v127
    v_cvt_pk_bf16_f32 v124, v124, v125
    v_mul_f32 v128, v242, v128
    v_mfma_f32_16x16x32_bf16 v[16:19], a[228:231], a[16:19], v[16:19]
    ds_read_b64_tr_b16 a[240:241], v241 offset:128
    ds_read_b64_tr_b16 a[242:243], v241 offset:17024
    s_add_u32 m0, s47, 33792
    s_mov_b32 s62, 0x0001c200
    v_mfma_f32_16x16x32_bf16 v[20:23], a[228:231], a[20:23], v[20:23]
    buffer_load_dwordx4 v246, s[32:35], s62 offen lds
    v_cvt_pk_bf16_f32 v125, v126, v127
    v_mfma_f32_16x16x32_bf16 v[4:7], a[224:227], a[20:23], v[4:7]
    v_mul_f32 v129, v242, v129
    v_mul_f32 v130, v242, v130
    v_mul_f32 v131, v242, v131
    v_mfma_f32_16x16x32_bf16 v[8:11], a[224:227], a[24:27], v[8:11]
    v_cvt_pk_bf16_f32 v128, v128, v129
    v_cvt_pk_bf16_f32 v129, v130, v131
    v_mul_f32 v132, v243, v132
    v_mfma_f32_16x16x32_bf16 v[24:27], a[228:231], a[24:27], v[24:27]
    ds_read_b64_tr_b16 a[244:245], v241 offset:160
    ds_read_b64_tr_b16 a[246:247], v241 offset:17056
    s_mov_b32 s63, 0x0001c160
    v_mfma_f32_16x16x32_bf16 v[28:31], a[228:231], a[28:31], v[28:31]
    buffer_load_dwordx4 v246, s[32:35], s63 offen offset:1056 lds
    v_mul_f32 v133, v243, v133
    v_mfma_f32_16x16x32_bf16 v[12:15], a[224:227], a[28:31], v[12:15]
    v_mul_f32 v134, v243, v134
    s_waitcnt lgkmcnt(4)
    s_mov_b32 s62, 0x0001c0c0
    v_mfma_f32_16x16x32_bf16 v[44:47], a[232:235], a[28:31], v[44:47]
    buffer_load_dwordx4 v246, s[32:35], s62 offen offset:2112 lds
    v_mul_f32 v135, v243, v135
    v_mfma_f32_16x16x32_bf16 v[60:63], a[236:239], a[28:31], v[60:63]
    ds_read_b64_tr_b16 a[248:249], v241 offset:192
    ds_read_b64_tr_b16 a[250:251], v241 offset:17088
    v_cvt_pk_bf16_f32 v132, v132, v133
    v_mfma_f32_16x16x32_bf16 v[56:59], a[236:239], a[24:27], v[56:59]
    v_cvt_pk_bf16_f32 v133, v134, v135
    v_mul_f32 v136, v254, v136
    s_mov_b32 s63, 0x0001c020
    v_mfma_f32_16x16x32_bf16 v[40:43], a[232:235], a[24:27], v[40:43]
    buffer_load_dwordx4 v246, s[32:35], s63 offen offset:3168 lds
    v_mul_f32 v137, v254, v137
    v_mfma_f32_16x16x32_bf16 v[36:39], a[232:235], a[20:23], v[36:39]
    v_mul_f32 v138, v254, v138
    v_mul_f32 v139, v254, v139
    v_cvt_pk_bf16_f32 v136, v136, v137
    v_mfma_f32_16x16x32_bf16 v[52:55], a[236:239], a[20:23], v[52:55]
    v_cvt_pk_bf16_f32 v137, v138, v139
    s_add_u32 m0, s47, 38016
    s_mov_b32 s62, 0x0001d000
    v_mfma_f32_16x16x32_bf16 v[48:51], a[236:239], a[16:19], v[48:51]
    buffer_load_dwordx4 v246, s[32:35], s62 offen lds
    v_mul_f32 v140, v255, v140
    v_mfma_f32_16x16x32_bf16 v[32:35], a[232:235], a[16:19], v[32:35]
    v_mul_f32 v141, v255, v141
    s_waitcnt lgkmcnt(2)
    v_mfma_f32_16x16x32_bf16 v[64:67], a[240:243], a[16:19], v[64:67]
    s_waitcnt vmcnt(13) lgkmcnt(0)
    s_barrier
    v_mul_f32 v142, v255, v142
    v_mfma_f32_16x16x32_bf16 v[80:83], a[244:247], a[16:19], v[80:83]
    ds_read_b64_tr_b16 a[224:225], v241 offset:33792
    ds_read_b64_tr_b16 a[226:227], v241 offset:50688
    v_mul_f32 v143, v255, v143
    v_mfma_f32_16x16x32_bf16 v[84:87], a[244:247], a[20:23], v[84:87]
    ds_read_b64_tr_b16 a[228:229], v241 offset:33824
    ds_read_b64_tr_b16 a[230:231], v241 offset:50720
    s_mov_b32 s63, 0x0001cf60
    v_mfma_f32_16x16x32_bf16 v[68:71], a[240:243], a[20:23], v[68:71]
    buffer_load_dwordx4 v246, s[32:35], s63 offen offset:1056 lds
    v_cvt_pk_bf16_f32 v140, v140, v141
    v_mfma_f32_16x16x32_bf16 v[72:75], a[240:243], a[24:27], v[72:75]
    v_cvt_pk_bf16_f32 v141, v142, v143
    v_mul_f32 v144, v242, v144
    v_mul_f32 v145, v242, v145
    v_mfma_f32_16x16x32_bf16 v[88:91], a[244:247], a[24:27], v[88:91]
    ds_read_b64_tr_b16 a[232:233], v241 offset:33856
    ds_read_b64_tr_b16 a[234:235], v241 offset:50752
    s_mov_b32 s62, 0x0001cec0
    v_mfma_f32_16x16x32_bf16 v[92:95], a[244:247], a[28:31], v[92:95]
    buffer_load_dwordx4 v246, s[32:35], s62 offen offset:2112 lds
    v_mul_f32 v146, v242, v146
    v_mfma_f32_16x16x32_bf16 v[76:79], a[240:243], a[28:31], v[76:79]
    v_mul_f32 v147, v242, v147
    v_cvt_pk_bf16_f32 v144, v144, v145
    v_mfma_f32_16x16x32_bf16 v[108:111], a[248:251], a[28:31], v[108:111]
    v_cvt_pk_bf16_f32 v145, v146, v147
    v_mul_f32 v148, v243, v148
    v_mul_f32 v149, v243, v149
    v_mfma_f32_16x16x32_bf16 v[104:107], a[248:251], a[24:27], v[104:107]
    ds_read_b64_tr_b16 a[236:237], v241 offset:33888
    ds_read_b64_tr_b16 a[238:239], v241 offset:50784
    s_mov_b32 s63, 0x0001ce20
    v_mfma_f32_16x16x32_bf16 v[100:103], a[248:251], a[20:23], v[100:103]
    buffer_load_dwordx4 v246, s[32:35], s63 offen offset:3168 lds
    v_mul_f32 v150, v243, v150
    v_mfma_f32_16x16x32_bf16 v[96:99], a[248:251], a[16:19], v[96:99]
    v_mul_f32 v151, v243, v151
    v_cvt_pk_bf16_f32 v148, v148, v149
    s_waitcnt lgkmcnt(4)
    v_mfma_f32_16x16x32_bf16 v[0:3], a[224:227], a[32:35], v[0:3]
    v_cvt_pk_bf16_f32 v149, v150, v151
    v_mul_f32 v152, v254, v152
    v_mul_f32 v153, v254, v153
    v_mfma_f32_16x16x32_bf16 v[16:19], a[228:231], a[32:35], v[16:19]
    ds_read_b64_tr_b16 a[240:241], v241 offset:33920
    ds_read_b64_tr_b16 a[242:243], v241 offset:50816
    s_add_u32 m0, s47, 67584
    s_mov_b32 s62, 0x00023200
    v_mfma_f32_16x16x32_bf16 v[20:23], a[228:231], a[36:39], v[20:23]
    buffer_load_dwordx4 v246, s[32:35], s62 offen lds
    v_mul_f32 v154, v254, v154
    v_mfma_f32_16x16x32_bf16 v[4:7], a[224:227], a[36:39], v[4:7]
    v_mul_f32 v155, v254, v155
    v_cvt_pk_bf16_f32 v152, v152, v153
    v_mul_f32 v156, v255, v156
    v_mfma_f32_16x16x32_bf16 v[8:11], a[224:227], a[40:43], v[8:11]
    v_cvt_pk_bf16_f32 v153, v154, v155
    v_mul_f32 v157, v255, v157
    v_mul_f32 v158, v255, v158
    v_mfma_f32_16x16x32_bf16 v[24:27], a[228:231], a[40:43], v[24:27]
    ds_read_b64_tr_b16 a[244:245], v241 offset:33952
    ds_read_b64_tr_b16 a[246:247], v241 offset:50848
    s_mov_b32 s63, 0x00023160
    v_mfma_f32_16x16x32_bf16 v[28:31], a[228:231], a[44:47], v[28:31]
    buffer_load_dwordx4 v246, s[32:35], s63 offen offset:1056 lds
    v_mul_f32 v159, v255, v159
    v_mfma_f32_16x16x32_bf16 v[12:15], a[224:227], a[44:47], v[12:15]
    s_waitcnt lgkmcnt(4)
    s_mov_b32 s62, 0x000230c0
    v_mfma_f32_16x16x32_bf16 v[44:47], a[232:235], a[44:47], v[44:47]
    buffer_load_dwordx4 v246, s[32:35], s62 offen offset:2112 lds
    v_cvt_pk_bf16_f32 v156, v156, v157
    v_mfma_f32_16x16x32_bf16 v[60:63], a[236:239], a[44:47], v[60:63]
    ds_read_b64_tr_b16 a[248:249], v241 offset:33984
    ds_read_b64_tr_b16 a[250:251], v241 offset:50880
    v_cvt_pk_bf16_f32 v157, v158, v159
    v_mfma_f32_16x16x32_bf16 v[56:59], a[236:239], a[40:43], v[56:59]
    v_mul_f32 v160, v242, v160
    v_mul_f32 v161, v242, v161
    s_mov_b32 s63, 0x00023020
    v_mfma_f32_16x16x32_bf16 v[40:43], a[232:235], a[40:43], v[40:43]
    buffer_load_dwordx4 v246, s[32:35], s63 offen offset:3168 lds
    v_mul_f32 v162, v242, v162
    v_mfma_f32_16x16x32_bf16 v[36:39], a[232:235], a[36:39], v[36:39]
    v_mul_f32 v163, v242, v163
    v_cvt_pk_bf16_f32 v160, v160, v161
    v_mul_f32 v164, v243, v164
    v_mfma_f32_16x16x32_bf16 v[52:55], a[236:239], a[36:39], v[52:55]
    v_cvt_pk_bf16_f32 v161, v162, v163
    s_add_u32 m0, s47, 71808
    s_mov_b32 s62, 0x00024000
    v_mfma_f32_16x16x32_bf16 v[48:51], a[236:239], a[32:35], v[48:51]
    buffer_load_dwordx4 v246, s[32:35], s62 offen lds
    v_mul_f32 v165, v243, v165
    v_mfma_f32_16x16x32_bf16 v[32:35], a[232:235], a[32:35], v[32:35]
    v_mul_f32 v166, v243, v166
    v_mul_f32 v167, v243, v167
    s_waitcnt lgkmcnt(2)
    v_mfma_f32_16x16x32_bf16 v[64:67], a[240:243], a[32:35], v[64:67]
    s_waitcnt vmcnt(13) lgkmcnt(0)
    s_barrier
    v_cvt_pk_bf16_f32 v164, v164, v165
    v_mfma_f32_16x16x32_bf16 v[80:83], a[244:247], a[32:35], v[80:83]
    ds_read_b64_tr_b16 a[224:225], v240
    ds_read_b64_tr_b16 a[226:227], v240 offset:16896
    v_mfma_f32_16x16x32_bf16 v[84:87], a[244:247], a[36:39], v[84:87]
    ds_read_b64_tr_b16 a[228:229], v240 offset:32
    ds_read_b64_tr_b16 a[230:231], v240 offset:16928
    s_mov_b32 s63, 0x00023f60
    v_mfma_f32_16x16x32_bf16 v[68:71], a[240:243], a[36:39], v[68:71]
    buffer_load_dwordx4 v246, s[32:35], s63 offen offset:1056 lds
    v_cvt_pk_bf16_f32 v165, v166, v167
    v_mfma_f32_16x16x32_bf16 v[72:75], a[240:243], a[40:43], v[72:75]
    v_mul_f32 v168, v254, v168
    v_mul_f32 v169, v254, v169
    v_mul_f32 v170, v254, v170
    v_mfma_f32_16x16x32_bf16 v[88:91], a[244:247], a[40:43], v[88:91]
    ds_read_b64_tr_b16 a[232:233], v240 offset:64
    ds_read_b64_tr_b16 a[234:235], v240 offset:16960
    s_mov_b32 s62, 0x00023ec0
    v_mfma_f32_16x16x32_bf16 v[92:95], a[244:247], a[44:47], v[92:95]
    buffer_load_dwordx4 v246, s[32:35], s62 offen offset:2112 lds
    v_mul_f32 v171, v254, v171
    v_mfma_f32_16x16x32_bf16 v[76:79], a[240:243], a[44:47], v[76:79]
    v_cvt_pk_bf16_f32 v168, v168, v169
    v_cvt_pk_bf16_f32 v169, v170, v171
    v_mfma_f32_16x16x32_bf16 v[108:111], a[248:251], a[44:47], v[108:111]
    v_mul_f32 v172, v255, v172
    v_mul_f32 v173, v255, v173
    v_mul_f32 v174, v255, v174
    v_mfma_f32_16x16x32_bf16 v[104:107], a[248:251], a[40:43], v[104:107]
    ds_read_b64_tr_b16 a[236:237], v240 offset:96
    ds_read_b64_tr_b16 a[238:239], v240 offset:16992
    s_mov_b32 s63, 0x00023e20
    v_mfma_f32_16x16x32_bf16 v[100:103], a[248:251], a[36:39], v[100:103]
    buffer_load_dwordx4 v246, s[32:35], s63 offen offset:3168 lds
    v_mul_f32 v175, v255, v175
    v_mfma_f32_16x16x32_bf16 v[96:99], a[248:251], a[32:35], v[96:99]
    v_cvt_pk_bf16_f32 v172, v172, v173
    s_waitcnt lgkmcnt(4)
    v_mfma_f32_16x16x32_bf16 v[0:3], a[224:227], a[48:51], v[0:3]
    v_cvt_pk_bf16_f32 v173, v174, v175
    v_mul_f32 v176, v242, v176
    v_mul_f32 v177, v242, v177
    v_mfma_f32_16x16x32_bf16 v[16:19], a[228:231], a[48:51], v[16:19]
    ds_read_b64_tr_b16 a[240:241], v240 offset:128
    ds_read_b64_tr_b16 a[242:243], v240 offset:17024
    v_mul_f32 v178, v242, v178
    v_mfma_f32_16x16x32_bf16 v[20:23], a[228:231], a[52:55], v[20:23]
    v_mul_f32 v179, v242, v179
    v_cvt_pk_bf16_f32 v176, v176, v177
    v_mul_f32 v180, v243, v180
    v_mfma_f32_16x16x32_bf16 v[4:7], a[224:227], a[52:55], v[4:7]
    v_cvt_pk_bf16_f32 v177, v178, v179
    v_mul_f32 v181, v243, v181
    v_mul_f32 v182, v243, v182
    v_mfma_f32_16x16x32_bf16 v[8:11], a[224:227], a[56:59], v[8:11]
    v_mul_f32 v183, v243, v183
    v_cvt_pk_bf16_f32 v180, v180, v181
    v_mul_f32 v184, v254, v184
    v_mfma_f32_16x16x32_bf16 v[24:27], a[228:231], a[56:59], v[24:27]
    ds_read_b64_tr_b16 a[244:245], v240 offset:160
    ds_read_b64_tr_b16 a[246:247], v240 offset:17056
    v_cvt_pk_bf16_f32 v181, v182, v183
    v_mfma_f32_16x16x32_bf16 v[28:31], a[228:231], a[60:63], v[28:31]
    v_mul_f32 v185, v254, v185
    v_mul_f32 v186, v254, v186
    v_mul_f32 v187, v254, v187
    v_mfma_f32_16x16x32_bf16 v[12:15], a[224:227], a[60:63], v[12:15]
    v_cvt_pk_bf16_f32 v184, v184, v185
    v_cvt_pk_bf16_f32 v185, v186, v187
    s_waitcnt lgkmcnt(4)
    v_mfma_f32_16x16x32_bf16 v[44:47], a[232:235], a[60:63], v[44:47]
    v_mul_f32 v188, v255, v188
    v_mul_f32 v189, v255, v189
    v_mul_f32 v190, v255, v190
    v_mfma_f32_16x16x32_bf16 v[60:63], a[236:239], a[60:63], v[60:63]
    ds_read_b64_tr_b16 a[248:249], v240 offset:192
    ds_read_b64_tr_b16 a[250:251], v240 offset:17088
    s_lshl_b32 s62, s44, 13
    s_add_u32 s62, s62, 128
    v_mfma_f32_16x16x32_bf16 v[56:59], a[236:239], a[56:59], v[56:59]
    v_mul_f32 v191, v255, v191
    v_cvt_pk_bf16_f32 v188, v188, v189
    v_mul_f32 v192, v242, v192
    v_mfma_f32_16x16x32_bf16 v[40:43], a[232:235], a[56:59], v[40:43]
    v_cvt_pk_bf16_f32 v189, v190, v191
    v_mul_f32 v193, v242, v193
    v_mul_f32 v194, v242, v194
    v_mfma_f32_16x16x32_bf16 v[36:39], a[232:235], a[52:55], v[36:39]
    v_mul_f32 v195, v242, v195
    v_cvt_pk_bf16_f32 v192, v192, v193
    v_mul_f32 v196, v243, v196
    v_mfma_f32_16x16x32_bf16 v[52:55], a[236:239], a[52:55], v[52:55]
    v_cvt_pk_bf16_f32 v193, v194, v195
    v_mul_f32 v197, v243, v197
    v_mul_f32 v198, v243, v198
    v_mfma_f32_16x16x32_bf16 v[48:51], a[236:239], a[48:51], v[48:51]
    v_mul_f32 v199, v243, v199
    v_cvt_pk_bf16_f32 v196, v196, v197
    v_mul_f32 v200, v254, v200
    v_lshl_add_u32 v244, v250, 4, s62
    v_mfma_f32_16x16x32_bf16 v[32:35], a[232:235], a[48:51], v[32:35]
    v_cvt_pk_bf16_f32 v197, v198, v199
    v_mul_f32 v201, v254, v201
    s_waitcnt lgkmcnt(2)
    v_mfma_f32_16x16x32_bf16 v[64:67], a[240:243], a[48:51], v[64:67]
    s_waitcnt vmcnt(8) lgkmcnt(0)
    s_barrier
    v_mul_f32 v202, v254, v202
    v_mfma_f32_16x16x32_bf16 v[80:83], a[244:247], a[48:51], v[80:83]
    ds_read_b64_tr_b16 a[224:225], v240 offset:33792
    ds_read_b64_tr_b16 a[226:227], v240 offset:50688
    v_mul_f32 v203, v254, v203
    v_mfma_f32_16x16x32_bf16 v[84:87], a[244:247], a[52:55], v[84:87]
    ds_read_b64_tr_b16 a[228:229], v240 offset:33824
    ds_read_b64_tr_b16 a[230:231], v240 offset:50720
    v_cvt_pk_bf16_f32 v200, v200, v201
    ds_write_b64 v251, v[112:113]
    v_mfma_f32_16x16x32_bf16 v[68:71], a[240:243], a[52:55], v[68:71]
    v_cvt_pk_bf16_f32 v201, v202, v203
    v_mul_f32 v204, v255, v204
    v_subrev_u32 v245, 32, v244
    v_subrev_u32 v246, 64, v244
    v_mfma_f32_16x16x32_bf16 v[72:75], a[240:243], a[56:59], v[72:75]
    v_mul_f32 v205, v255, v205
    v_mul_f32 v206, v255, v206
    v_mul_f32 v207, v255, v207
    ds_write_b64 v251, v[116:117] offset:1024
    v_mfma_f32_16x16x32_bf16 v[88:91], a[244:247], a[56:59], v[88:91]
    ds_read_b64_tr_b16 a[232:233], v240 offset:33856
    ds_read_b64_tr_b16 a[234:235], v240 offset:50752
    v_cvt_pk_bf16_f32 v204, v204, v205
    v_mfma_f32_16x16x32_bf16 v[92:95], a[244:247], a[60:63], v[92:95]
    v_cvt_pk_bf16_f32 v205, v206, v207
    v_mul_f32 v208, v242, v208
    v_mul_f32 v209, v242, v209
    ds_write_b64 v252, v[120:121]
    v_mfma_f32_16x16x32_bf16 v[76:79], a[240:243], a[60:63], v[76:79]
    v_mul_f32 v210, v242, v210
    v_mul_f32 v211, v242, v211
    v_mfma_f32_16x16x32_bf16 v[108:111], a[248:251], a[60:63], v[108:111]
    v_cvt_pk_bf16_f32 v208, v208, v209
    v_cvt_pk_bf16_f32 v209, v210, v211
    v_mul_f32 v212, v243, v212
    v_subrev_u32 v247, 96, v244
    v_mfma_f32_16x16x32_bf16 v[104:107], a[248:251], a[56:59], v[104:107]
    ds_read_b64_tr_b16 a[236:237], v240 offset:33888
    ds_read_b64_tr_b16 a[238:239], v240 offset:50784
    v_mul_f32 v213, v243, v213
    v_mfma_f32_16x16x32_bf16 v[100:103], a[248:251], a[52:55], v[100:103]
    v_mul_f32 v214, v243, v214
    v_mul_f32 v215, v243, v215
    v_cvt_pk_bf16_f32 v212, v212, v213
    ds_write_b64 v252, v[124:125] offset:1024
    v_mfma_f32_16x16x32_bf16 v[96:99], a[248:251], a[48:51], v[96:99]
    v_cvt_pk_bf16_f32 v213, v214, v215
    v_mul_f32 v216, v254, v216
    s_waitcnt lgkmcnt(8)
    v_mfma_f32_16x16x32_bf16 v[0:3], a[224:227], a[64:67], v[0:3]
    v_mul_f32 v217, v254, v217
    v_mul_f32 v218, v254, v218
    v_mul_f32 v219, v254, v219
    ds_write_b64 v251, v[128:129] offset:512
    v_mfma_f32_16x16x32_bf16 v[16:19], a[228:231], a[64:67], v[16:19]
    ds_read_b64_tr_b16 a[240:241], v240 offset:33920
    ds_read_b64_tr_b16 a[242:243], v240 offset:50816
    v_mfma_f32_16x16x32_bf16 v[20:23], a[228:231], a[68:71], v[20:23]
    v_cvt_pk_bf16_f32 v216, v216, v217
    v_cvt_pk_bf16_f32 v217, v218, v219
    v_mul_f32 v220, v255, v220
    ds_write_b64 v251, v[132:133] offset:1536
    v_mfma_f32_16x16x32_bf16 v[4:7], a[224:227], a[68:71], v[4:7]
    v_mul_f32 v221, v255, v221
    v_mul_f32 v222, v255, v222
    v_mul_f32 v223, v255, v223
    v_mfma_f32_16x16x32_bf16 v[8:11], a[224:227], a[72:75], v[8:11]
    v_cvt_pk_bf16_f32 v220, v220, v221
    v_cvt_pk_bf16_f32 v221, v222, v223
    v_mul_f32 v224, v242, v224
    ds_write_b64 v252, v[136:137] offset:512
    v_mfma_f32_16x16x32_bf16 v[24:27], a[228:231], a[72:75], v[24:27]
    ds_read_b64_tr_b16 a[244:245], v240 offset:33952
    ds_read_b64_tr_b16 a[246:247], v240 offset:50848
    v_mul_f32 v225, v242, v225
    v_mfma_f32_16x16x32_bf16 v[28:31], a[228:231], a[76:79], v[28:31]
    v_mul_f32 v226, v242, v226
    v_mul_f32 v227, v242, v227
    v_cvt_pk_bf16_f32 v224, v224, v225
    ds_write_b64 v252, v[140:141] offset:1536
    v_mfma_f32_16x16x32_bf16 v[12:15], a[224:227], a[76:79], v[12:15]
    v_cvt_pk_bf16_f32 v225, v226, v227
    v_mul_f32 v228, v243, v228
    s_waitcnt lgkmcnt(9)
    v_mfma_f32_16x16x32_bf16 v[44:47], a[232:235], a[76:79], v[44:47]
    v_mul_f32 v229, v243, v229
    v_mul_f32 v230, v243, v230
    v_mul_f32 v231, v243, v231
    ds_write_b64 v251, v[144:145] offset:4096
    v_mfma_f32_16x16x32_bf16 v[60:63], a[236:239], a[76:79], v[60:63]
    ds_read_b64_tr_b16 a[248:249], v240 offset:33984
    ds_read_b64_tr_b16 a[250:251], v240 offset:50880
    v_cvt_pk_bf16_f32 v228, v228, v229
    v_mfma_f32_16x16x32_bf16 v[56:59], a[236:239], a[72:75], v[56:59]
    v_cvt_pk_bf16_f32 v229, v230, v231
    v_mul_f32 v232, v254, v232
    v_mul_f32 v233, v254, v233
    ds_write_b64 v251, v[148:149] offset:5120
    v_mfma_f32_16x16x32_bf16 v[40:43], a[232:235], a[72:75], v[40:43]
    v_mul_f32 v234, v254, v234
    v_mul_f32 v235, v254, v235
    v_mfma_f32_16x16x32_bf16 v[36:39], a[232:235], a[68:71], v[36:39]
    v_cvt_pk_bf16_f32 v232, v232, v233
    v_cvt_pk_bf16_f32 v233, v234, v235
    v_mul_f32 v236, v255, v236
    ds_write_b64 v252, v[152:153] offset:4096
    v_mfma_f32_16x16x32_bf16 v[52:55], a[236:239], a[68:71], v[52:55]
    v_mul_f32 v237, v255, v237
    v_mul_f32 v238, v255, v238
    v_mul_f32 v239, v255, v239
    v_mfma_f32_16x16x32_bf16 v[48:51], a[236:239], a[64:67], v[48:51]
    v_cvt_pk_bf16_f32 v236, v236, v237
    v_cvt_pk_bf16_f32 v237, v238, v239
    ds_write_b64 v252, v[156:157] offset:5120
    v_mfma_f32_16x16x32_bf16 v[32:35], a[232:235], a[64:67], v[32:35]
    s_waitcnt lgkmcnt(7)
    v_mfma_f32_16x16x32_bf16 v[64:67], a[240:243], a[64:67], v[64:67]
    s_waitcnt vmcnt(0) lgkmcnt(0)
    s_barrier
    ds_write_b64 v251, v[160:161] offset:4608
    v_mfma_f32_16x16x32_bf16 v[80:83], a[244:247], a[64:67], v[80:83]
    ds_read_b64_tr_b16 a[224:225], v241
    ds_read_b64_tr_b16 a[226:227], v241 offset:16896
    v_mfma_f32_16x16x32_bf16 v[84:87], a[244:247], a[68:71], v[84:87]
    ds_read_b64_tr_b16 a[228:229], v241 offset:32
    ds_read_b64_tr_b16 a[230:231], v241 offset:16928
    ds_write_b64 v251, v[164:165] offset:5632
    v_mfma_f32_16x16x32_bf16 v[68:71], a[240:243], a[68:71], v[68:71]
    v_mfma_f32_16x16x32_bf16 v[72:75], a[240:243], a[72:75], v[72:75]
    ds_write_b64 v252, v[168:169] offset:4608
    v_mfma_f32_16x16x32_bf16 v[88:91], a[244:247], a[72:75], v[88:91]
    ds_read_b64_tr_b16 a[232:233], v241 offset:64
    ds_read_b64_tr_b16 a[234:235], v241 offset:16960
    v_mfma_f32_16x16x32_bf16 v[92:95], a[244:247], a[76:79], v[92:95]
    ds_write_b64 v252, v[172:173] offset:5632
    v_mfma_f32_16x16x32_bf16 v[76:79], a[240:243], a[76:79], v[76:79]
    v_mfma_f32_16x16x32_bf16 v[108:111], a[248:251], a[76:79], v[108:111]
    ds_write_b64 v251, v[176:177] offset:8192
    v_mfma_f32_16x16x32_bf16 v[104:107], a[248:251], a[72:75], v[104:107]
    ds_read_b64_tr_b16 a[236:237], v241 offset:96
    ds_read_b64_tr_b16 a[238:239], v241 offset:16992
    v_mfma_f32_16x16x32_bf16 v[100:103], a[248:251], a[68:71], v[100:103]
    ds_write_b64 v251, v[180:181] offset:9216
    v_mfma_f32_16x16x32_bf16 v[96:99], a[248:251], a[64:67], v[96:99]
    s_waitcnt lgkmcnt(9)
    v_mfma_f32_16x16x32_bf16 v[0:3], a[224:227], a[80:83], v[0:3]
    ds_write_b64 v252, v[184:185] offset:8192
    v_mfma_f32_16x16x32_bf16 v[16:19], a[228:231], a[80:83], v[16:19]
    ds_read_b64_tr_b16 a[240:241], v241 offset:128
    ds_read_b64_tr_b16 a[242:243], v241 offset:17024
    s_add_u32 m0, s47, 33792
    v_mfma_f32_16x16x32_bf16 v[20:23], a[228:231], a[84:87], v[20:23]
    buffer_load_dwordx4 v244, s[12:15], s53 offen lds
    ds_write_b64 v252, v[188:189] offset:9216
    v_mfma_f32_16x16x32_bf16 v[4:7], a[224:227], a[84:87], v[4:7]
    v_mfma_f32_16x16x32_bf16 v[8:11], a[224:227], a[88:91], v[8:11]
    ds_write_b64 v251, v[192:193] offset:8704
    v_mfma_f32_16x16x32_bf16 v[24:27], a[228:231], a[88:91], v[24:27]
    ds_read_b64_tr_b16 a[244:245], v241 offset:160
    ds_read_b64_tr_b16 a[246:247], v241 offset:17056
    v_mfma_f32_16x16x32_bf16 v[28:31], a[228:231], a[92:95], v[28:31]
    buffer_load_dwordx4 v245, s[12:15], s53 offen offset:1056 lds
    ds_write_b64 v251, v[196:197] offset:9728
    v_mfma_f32_16x16x32_bf16 v[12:15], a[224:227], a[92:95], v[12:15]
    s_waitcnt lgkmcnt(9)
    v_mfma_f32_16x16x32_bf16 v[44:47], a[232:235], a[92:95], v[44:47]
    buffer_load_dwordx4 v246, s[12:15], s53 offen offset:2112 lds
    ds_write_b64 v252, v[200:201] offset:8704
    v_mfma_f32_16x16x32_bf16 v[60:63], a[236:239], a[92:95], v[60:63]
    ds_read_b64_tr_b16 a[248:249], v241 offset:192
    ds_read_b64_tr_b16 a[250:251], v241 offset:17088
    v_mfma_f32_16x16x32_bf16 v[56:59], a[236:239], a[88:91], v[56:59]
    ds_write_b64 v252, v[204:205] offset:9728
    v_mfma_f32_16x16x32_bf16 v[40:43], a[232:235], a[88:91], v[40:43]
    buffer_load_dwordx4 v247, s[12:15], s53 offen offset:3168 lds
    v_mfma_f32_16x16x32_bf16 v[36:39], a[232:235], a[84:87], v[36:39]
    ds_write_b64 v251, v[208:209] offset:12288
    v_mfma_f32_16x16x32_bf16 v[52:55], a[236:239], a[84:87], v[52:55]
    v_mfma_f32_16x16x32_bf16 v[48:51], a[236:239], a[80:83], v[48:51]
    ds_write_b64 v251, v[212:213] offset:13312
    v_mfma_f32_16x16x32_bf16 v[32:35], a[232:235], a[80:83], v[32:35]
    s_waitcnt lgkmcnt(7)
    s_add_u32 m0, s47, 38016
    s_add_u32 s53, s53, 4096
    v_mfma_f32_16x16x32_bf16 v[64:67], a[240:243], a[80:83], v[64:67]
    buffer_load_dwordx4 v244, s[12:15], s53 offen lds
    ds_write_b64 v252, v[216:217] offset:12288
    v_mfma_f32_16x16x32_bf16 v[80:83], a[244:247], a[80:83], v[80:83]
    v_mfma_f32_16x16x32_bf16 v[84:87], a[244:247], a[84:87], v[84:87]
    buffer_load_dwordx4 v245, s[12:15], s53 offen offset:1056 lds
    ds_write_b64 v252, v[220:221] offset:13312
    v_mfma_f32_16x16x32_bf16 v[68:71], a[240:243], a[84:87], v[68:71]
    v_mfma_f32_16x16x32_bf16 v[72:75], a[240:243], a[88:91], v[72:75]
    ds_write_b64 v251, v[224:225] offset:12800
    v_mfma_f32_16x16x32_bf16 v[88:91], a[244:247], a[88:91], v[88:91]
    buffer_load_dwordx4 v246, s[12:15], s53 offen offset:2112 lds
    v_mfma_f32_16x16x32_bf16 v[92:95], a[244:247], a[92:95], v[92:95]
    ds_write_b64 v251, v[228:229] offset:13824
    v_mfma_f32_16x16x32_bf16 v[76:79], a[240:243], a[92:95], v[76:79]
    s_waitcnt lgkmcnt(7)
    v_mfma_f32_16x16x32_bf16 v[108:111], a[248:251], a[92:95], v[108:111]
    ds_write_b64 v252, v[232:233] offset:12800
    v_mfma_f32_16x16x32_bf16 v[104:107], a[248:251], a[88:91], v[104:107]
    buffer_load_dwordx4 v247, s[12:15], s53 offen offset:3168 lds
    v_mfma_f32_16x16x32_bf16 v[100:103], a[248:251], a[84:87], v[100:103]
    ds_write_b64 v252, v[236:237] offset:13824
    v_mfma_f32_16x16x32_bf16 v[96:99], a[248:251], a[80:83], v[96:99]
L_join:
    v_add_u32 v251, s48, v248
    v_add_u32 v252, s48, v249
    s_waitcnt lgkmcnt(0)
    s_barrier
    s_add_u32 m0, s47, 67584
    s_add_u32 s53, s53, 28672
    v_cvt_pk_bf16_f32 v112, v0, v1
    buffer_load_dwordx4 v244, s[12:15], s53 offen lds
    ds_read_b128 a[0:3], v251
    v_cvt_pk_bf16_f32 v113, v2, v3
    v_cvt_pk_bf16_f32 v114, v4, v5
    ds_read_b128 a[4:7], v251 offset:1024
    v_cvt_pk_bf16_f32 v115, v6, v7
    v_cvt_pk_bf16_f32 v116, v8, v9
    ds_read_b128 a[8:11], v252
    v_cvt_pk_bf16_f32 v117, v10, v11
    v_cvt_pk_bf16_f32 v118, v12, v13
    ds_read_b128 a[12:15], v252 offset:1024
    v_cvt_pk_bf16_f32 v119, v14, v15
    v_cvt_pk_bf16_f32 v120, v16, v17
    v_cvt_pk_bf16_f32 v121, v18, v19
    buffer_load_dwordx4 v245, s[12:15], s53 offen offset:1056 lds
    ds_read_b128 a[16:19], v251 offset:4096
    v_cvt_pk_bf16_f32 v122, v20, v21
    v_cvt_pk_bf16_f32 v123, v22, v23
    ds_read_b128 a[20:23], v251 offset:5120
    v_cvt_pk_bf16_f32 v124, v24, v25
    v_cvt_pk_bf16_f32 v125, v26, v27
    ds_read_b128 a[24:27], v252 offset:4096
    v_cvt_pk_bf16_f32 v126, v28, v29
    v_cvt_pk_bf16_f32 v127, v30, v31
    ds_read_b128 a[28:31], v252 offset:5120
    v_cvt_pk_bf16_f32 v128, v32, v33
    v_cvt_pk_bf16_f32 v129, v34, v35
    v_cvt_pk_bf16_f32 v130, v36, v37
    buffer_load_dwordx4 v246, s[12:15], s53 offen offset:2112 lds
    ds_read_b128 a[32:35], v251 offset:8192
    v_cvt_pk_bf16_f32 v131, v38, v39
    v_cvt_pk_bf16_f32 v132, v40, v41
    ds_read_b128 a[36:39], v251 offset:9216
    v_cvt_pk_bf16_f32 v133, v42, v43
    v_cvt_pk_bf16_f32 v134, v44, v45
    ds_read_b128 a[40:43], v252 offset:8192
    v_cvt_pk_bf16_f32 v135, v46, v47
    v_cvt_pk_bf16_f32 v136, v48, v49
    ds_read_b128 a[44:47], v252 offset:9216
    v_cvt_pk_bf16_f32 v137, v50, v51
    v_cvt_pk_bf16_f32 v138, v52, v53
    v_cvt_pk_bf16_f32 v139, v54, v55
    buffer_load_dwordx4 v247, s[12:15], s53 offen offset:3168 lds
    ds_read_b128 a[48:51], v251 offset:12288
    v_cvt_pk_bf16_f32 v140, v56, v57
    v_cvt_pk_bf16_f32 v141, v58, v59
    ds_read_b128 a[52:55], v251 offset:13312
    v_cvt_pk_bf16_f32 v142, v60, v61
    v_cvt_pk_bf16_f32 v143, v62, v63
    ds_read_b128 a[56:59], v252 offset:12288
    v_cvt_pk_bf16_f32 v144, v64, v65
    v_cvt_pk_bf16_f32 v145, v66, v67
    ds_read_b128 a[60:63], v252 offset:13312
    v_cvt_pk_bf16_f32 v146, v68, v69
    v_cvt_pk_bf16_f32 v147, v70, v71
    s_add_u32 m0, s47, 71808
    s_add_u32 s53, s53, 4096
    v_cvt_pk_bf16_f32 v148, v72, v73
    buffer_load_dwordx4 v244, s[12:15], s53 offen lds
    ds_read_b128 a[64:67], v251 offset:16384
    v_cvt_pk_bf16_f32 v149, v74, v75
    v_cvt_pk_bf16_f32 v150, v76, v77
    ds_read_b128 a[68:71], v251 offset:17408
    v_cvt_pk_bf16_f32 v151, v78, v79
    v_cvt_pk_bf16_f32 v152, v80, v81
    ds_read_b128 a[72:75], v252 offset:16384
    v_cvt_pk_bf16_f32 v153, v82, v83
    v_cvt_pk_bf16_f32 v154, v84, v85
    ds_read_b128 a[76:79], v252 offset:17408
    v_cvt_pk_bf16_f32 v155, v86, v87
    v_cvt_pk_bf16_f32 v156, v88, v89
    v_cvt_pk_bf16_f32 v157, v90, v91
    buffer_load_dwordx4 v245, s[12:15], s53 offen offset:1056 lds
    ds_read_b128 a[80:83], v251 offset:20480
    v_cvt_pk_bf16_f32 v158, v92, v93
    v_cvt_pk_bf16_f32 v159, v94, v95
    ds_read_b128 a[84:87], v251 offset:21504
    v_cvt_pk_bf16_f32 v160, v96, v97
    v_cvt_pk_bf16_f32 v161, v98, v99
    ds_read_b128 a[88:91], v252 offset:20480
    v_cvt_pk_bf16_f32 v162, v100, v101
    v_cvt_pk_bf16_f32 v163, v102, v103
    ds_read_b128 a[92:95], v252 offset:21504
    v_cvt_pk_bf16_f32 v164, v104, v105
    v_cvt_pk_bf16_f32 v165, v106, v107
    v_cvt_pk_bf16_f32 v166, v108, v109
    buffer_load_dwordx4 v246, s[12:15], s53 offen offset:2112 lds
    ds_read_b128 a[96:99], v251 offset:24576
    v_cvt_pk_bf16_f32 v167, v110, v111
    v_bfe_u32 v99, v250, 2, 2
    ds_read_b128 a[100:103], v251 offset:25600
    v_mul_u32_u24 v99, 57344, v99
    v_lshrrev_b32 v169, 4, v250
    ds_read_b128 a[104:107], v252 offset:24576
    v_lshl_add_u32 v99, v169, 6, v99
    v_and_b32 v169, 3, v250
    ds_read_b128 a[108:111], v252 offset:25600
    v_lshl_add_u32 v99, v169, 4, v99
    v_and_b32 v242, 15, v250
    v_mul_u32_u24 v242, 1056, v242
    buffer_load_dwordx4 v247, s[12:15], s53 offen offset:3168 lds
    ds_read_b128 a[112:115], v251 offset:28672
    v_lshrrev_b32 v243, 4, v250
    s_mul_i32 s49, s60, 16896
    ds_read_b128 a[116:119], v251 offset:29696
    v_lshl_add_u32 v242, v243, 4, v242
    v_add_u32 v242, s49, v242
    ds_read_b128 a[120:123], v252 offset:28672
    v_add_u32 v243, 67584, v242
    s_mul_i32 s56, s44, 1792
    ds_read_b128 a[124:127], v252 offset:29696
    s_add_u32 s56, s56, 16777216
    s_add_u32 s78, s58, s56
    s_add_u32 s56, s57, s56
    s_mul_i32 s49, s44, 7168
    s_add_u32 s49, s49, 135168
    v_lshl_add_u32 v98, v250, 4, s49
    ds_write_b128 v98, v[116:119]
    ds_write_b128 v98, v[124:127] offset:1024
    ds_write_b128 v98, v[132:135] offset:2048
    ds_write_b128 v98, v[140:143] offset:3072
    ds_write_b128 v98, v[148:151] offset:4096
    ds_write_b128 v98, v[156:159] offset:5120
    ds_write_b128 v98, v[164:167] offset:6144
    s_mul_i32 s48, s44, 224
    s_mul_i32 s49, s60, 16896
    s_sub_u32 s48, s49, s48
    v_add_u32 v240, s48, v240
    v_add_u32 v241, s48, v241
    s_waitcnt vmcnt(8) lgkmcnt(0)
    s_barrier
    ds_read_b128 v[80:83], v242 offset:33792
    ds_read_b128 v[84:87], v242 offset:33856
    ds_read_b128 v[88:91], v242 offset:33920
    s_waitcnt lgkmcnt(2)
    v_mfma_f32_16x16x32_bf16 v[0:3], v[80:83], a[0:3], 0
    s_add_u32 m0, s47, 101376
    s_nop 0
    buffer_load_dwordx4 v244, s[16:19], s54 offen lds
    v_mfma_f32_16x16x32_bf16 v[8:11], v[80:83], a[4:7], 0
    ds_read_b128 v[92:95], v242 offset:33984
    v_accvgpr_read_b32 v65, a200
    v_mfma_f32_16x16x32_bf16 v[16:19], v[80:83], a[8:11], 0
    buffer_load_dwordx4 v245, s[16:19], s54 offen offset:1056 lds
    v_mfma_f32_16x16x32_bf16 v[24:27], v[80:83], a[12:15], 0
    v_lshlrev_b32 v66, 16, v65
    s_waitcnt lgkmcnt(2)
    v_mfma_f32_16x16x32_bf16 v[0:3], v[84:87], a[16:19], v[0:3]
    buffer_load_dwordx4 v246, s[16:19], s54 offen offset:2112 lds
    v_mfma_f32_16x16x32_bf16 v[8:11], v[84:87], a[20:23], v[8:11]
    ds_read_b128 v[80:83], v242 offset:34048
    v_max_f32 v65, |v65|, |v66|
    v_mfma_f32_16x16x32_bf16 v[16:19], v[84:87], a[24:27], v[16:19]
    buffer_load_dwordx4 v247, s[16:19], s54 offen offset:3168 lds
    v_log_f32 v65, v65
    v_mfma_f32_16x16x32_bf16 v[24:27], v[84:87], a[28:31], v[24:27]
    s_waitcnt lgkmcnt(2)
    s_add_u32 m0, s47, 105600
    s_add_u32 s54, s54, 4096
    v_mfma_f32_16x16x32_bf16 v[0:3], v[88:91], a[32:35], v[0:3]
    buffer_load_dwordx4 v244, s[16:19], s54 offen lds
    v_mfma_f32_16x16x32_bf16 v[8:11], v[88:91], a[36:39], v[8:11]
    ds_read_b128 v[84:87], v242 offset:34112
    v_add_f32 v65, 0x41000000, v65
    v_mfma_f32_16x16x32_bf16 v[16:19], v[88:91], a[40:43], v[16:19]
    buffer_load_dwordx4 v245, s[16:19], s54 offen offset:1056 lds
    v_mfma_f32_16x16x32_bf16 v[24:27], v[88:91], a[44:47], v[24:27]
    v_max_f32 v65, 0xc2b40000, v65
    s_waitcnt lgkmcnt(2)
    v_mfma_f32_16x16x32_bf16 v[0:3], v[92:95], a[48:51], v[0:3]
    buffer_load_dwordx4 v246, s[16:19], s54 offen offset:2112 lds
    v_mfma_f32_16x16x32_bf16 v[8:11], v[92:95], a[52:55], v[8:11]
    ds_read_b128 v[88:91], v242 offset:34176
    v_min_f32 v65, 0, v65
    s_mov_b32 s52, 0
    v_mfma_f32_16x16x32_bf16 v[16:19], v[92:95], a[56:59], v[16:19]
    buffer_load_dwordx4 v247, s[16:19], s54 offen offset:3168 lds
    v_mfma_f32_16x16x32_bf16 v[24:27], v[92:95], a[60:63], v[24:27]
    s_waitcnt lgkmcnt(2)
    s_add_u32 m0, s47, 0
    s_add_u32 s53, s53, 28672
    v_mfma_f32_16x16x32_bf16 v[0:3], v[80:83], a[64:67], v[0:3]
    buffer_load_dwordx4 v244, s[12:15], s53 offen lds
    v_mfma_f32_16x16x32_bf16 v[8:11], v[80:83], a[68:71], v[8:11]
    ds_read_b128 v[92:95], v242 offset:34240
    v_mov_b32 v97, 0x40000000
    v_mfma_f32_16x16x32_bf16 v[16:19], v[80:83], a[72:75], v[16:19]
    buffer_load_dwordx4 v245, s[12:15], s53 offen offset:1056 lds
    v_mfma_f32_16x16x32_bf16 v[24:27], v[80:83], a[76:79], v[24:27]
    s_lshr_b32 s89, s89, 2
    s_add_u32 s89, s89, 159872
    s_waitcnt lgkmcnt(2)
    v_mfma_f32_16x16x32_bf16 v[0:3], v[84:87], a[80:83], v[0:3]
    buffer_load_dwordx4 v246, s[12:15], s53 offen offset:2112 lds
    v_mfma_f32_16x16x32_bf16 v[8:11], v[84:87], a[84:87], v[8:11]
    ds_read_b128 v[80:83], v242 offset:34304
    buffer_load_dwordx4 v247, s[12:15], s53 offen offset:3168 lds
    s_add_u32 m0, s47, 4224
    s_add_u32 s53, s53, 4096
    v_mfma_f32_16x16x32_bf16 v[16:19], v[84:87], a[88:91], v[16:19]
    buffer_load_dwordx4 v244, s[12:15], s53 offen lds
    v_mfma_f32_16x16x32_bf16 v[24:27], v[84:87], a[92:95], v[24:27]
    v_lshl_add_u32 v96, v250, 7, s89
    s_waitcnt lgkmcnt(2)
    v_mfma_f32_16x16x32_bf16 v[0:3], v[88:91], a[96:99], v[0:3]
    buffer_load_dwordx4 v245, s[12:15], s53 offen offset:1056 lds
    v_mfma_f32_16x16x32_bf16 v[8:11], v[88:91], a[100:103], v[8:11]
    ds_read_b128 v[84:87], v242 offset:34368
    buffer_load_dwordx4 v246, s[12:15], s53 offen offset:2112 lds
    buffer_load_dwordx4 v247, s[12:15], s53 offen offset:3168 lds
    v_mfma_f32_16x16x32_bf16 v[16:19], v[88:91], a[104:107], v[16:19]
    v_cmp_lt_u32 s[50:51], 3, v250
    s_sub_u32 s28, s24, 618624
    s_subb_u32 s29, s25, 0
    s_mov_b32 s30, 4288640
    s_mul_i32 s88, s45, 458752
    v_mfma_f32_16x16x32_bf16 v[24:27], v[88:91], a[108:111], v[24:27]
    v_cndmask_b32 v96, v96, v97, s[50:51]
    s_waitcnt lgkmcnt(2)
    v_mfma_f32_16x16x32_bf16 v[0:3], v[92:95], a[112:115], v[0:3]
    v_and_b32 v251, 15, v250
    v_mul_u32_u24 v251, 1056, v251
    v_mfma_f32_16x16x32_bf16 v[8:11], v[92:95], a[116:119], v[8:11]
    ds_read_b128 v[88:91], v242 offset:34432
    s_mul_i32 s48, s44, 16896
    s_xor_b32 s49, s44, 1
    v_mfma_f32_16x16x32_bf16 v[16:19], v[92:95], a[120:123], v[16:19]
    s_mul_i32 s49, s49, 16896
    v_add_u32 v252, s49, v251
    v_mfma_f32_16x16x32_bf16 v[24:27], v[92:95], a[124:127], v[24:27]
    v_add_u32 v251, s48, v251
    s_waitcnt lgkmcnt(2)
    v_mfma_f32_16x16x32_bf16 v[4:7], v[80:83], a[0:3], 0
    v_max3_f32 v108, v0, v1, v2
    v_max3_f32 v109, v8, v9, v10
    v_mfma_f32_16x16x32_bf16 v[12:15], v[80:83], a[4:7], 0
    ds_read_b128 v[92:95], v242 offset:34496
    v_max3_f32 v110, v16, v17, v18
    v_max_f32 v108, v108, v3
    v_mfma_f32_16x16x32_bf16 v[20:23], v[80:83], a[8:11], 0
    buffer_store_dwordx4 v[112:115], v99, s[36:39], s78 offen sc1
    v_mfma_f32_16x16x32_bf16 v[28:31], v[80:83], a[12:15], 0
    v_max3_f32 v111, v24, v25, v26
    s_waitcnt lgkmcnt(2)
    v_mfma_f32_16x16x32_bf16 v[4:7], v[84:87], a[16:19], v[4:7]
    v_max_f32 v109, v109, v11
    v_max_f32 v110, v110, v19
    v_mfma_f32_16x16x32_bf16 v[12:15], v[84:87], a[20:23], v[12:15]
    ds_read_b128 v[80:83], v242 offset:34560
    v_max_f32 v111, v111, v27
    v_add_f32 v108, v108, v65
    v_mfma_f32_16x16x32_bf16 v[20:23], v[84:87], a[24:27], v[20:23]
    v_add_f32 v109, v109, v65
    v_add_f32 v110, v110, v65
    v_mfma_f32_16x16x32_bf16 v[28:31], v[84:87], a[28:31], v[28:31]
    v_add_f32 v111, v111, v65
    s_waitcnt lgkmcnt(2)
    v_mfma_f32_16x16x32_bf16 v[4:7], v[88:91], a[32:35], v[4:7]
    v_mov_b32 v104, v108
    v_mov_b32 v105, v109
    v_mfma_f32_16x16x32_bf16 v[12:15], v[88:91], a[36:39], v[12:15]
    ds_read_b128 v[84:87], v242 offset:34624
    v_mov_b32 v106, v110
    v_mov_b32 v107, v111
    v_mfma_f32_16x16x32_bf16 v[20:23], v[88:91], a[40:43], v[20:23]
    v_permlane32_swap_b32 v108, v104
    v_permlane32_swap_b32 v109, v105
    v_mfma_f32_16x16x32_bf16 v[28:31], v[88:91], a[44:47], v[28:31]
    v_permlane32_swap_b32 v110, v106
    s_waitcnt lgkmcnt(2)
    v_mfma_f32_16x16x32_bf16 v[4:7], v[92:95], a[48:51], v[4:7]
    v_permlane32_swap_b32 v111, v107
    v_max_f32 v108, v108, v104
    v_mfma_f32_16x16x32_bf16 v[12:15], v[92:95], a[52:55], v[12:15]
    ds_read_b128 v[88:91], v242 offset:34688
    v_max_f32 v109, v109, v105
    v_max_f32 v110, v110, v106
    v_mfma_f32_16x16x32_bf16 v[20:23], v[92:95], a[56:59], v[20:23]
    buffer_store_dwordx4 v[120:123], v99, s[36:39], s78 offen offset:256 sc1
    v_mfma_f32_16x16x32_bf16 v[28:31], v[92:95], a[60:63], v[28:31]
    v_max_f32 v111, v111, v107
    s_waitcnt lgkmcnt(2)
    v_mfma_f32_16x16x32_bf16 v[4:7], v[80:83], a[64:67], v[4:7]
    v_mov_b32 v104, v108
    v_mov_b32 v105, v109
    v_mfma_f32_16x16x32_bf16 v[12:15], v[80:83], a[68:71], v[12:15]
    ds_read_b128 v[92:95], v242 offset:34752
    v_mov_b32 v106, v110
    v_mov_b32 v107, v111
    v_mfma_f32_16x16x32_bf16 v[20:23], v[80:83], a[72:75], v[20:23]
    v_permlane16_swap_b32 v108, v104
    v_permlane16_swap_b32 v109, v105
    v_mfma_f32_16x16x32_bf16 v[28:31], v[80:83], a[76:79], v[28:31]
    v_permlane16_swap_b32 v110, v106
    s_waitcnt lgkmcnt(2)
    v_mfma_f32_16x16x32_bf16 v[4:7], v[84:87], a[80:83], v[4:7]
    v_permlane16_swap_b32 v111, v107
    v_max_f32 v108, v108, v104
    v_mfma_f32_16x16x32_bf16 v[12:15], v[84:87], a[84:87], v[12:15]
    v_max_f32 v109, v109, v105
    v_max_f32 v110, v110, v106
    v_max_f32 v111, v111, v107
    v_mfma_f32_16x16x32_bf16 v[20:23], v[84:87], a[88:91], v[20:23]
    ds_write_b128 v251, v[108:111] offset:1024
    v_mfma_f32_16x16x32_bf16 v[28:31], v[84:87], a[92:95], v[28:31]
    s_waitcnt lgkmcnt(2)
    v_mfma_f32_16x16x32_bf16 v[4:7], v[88:91], a[96:99], v[4:7]
    s_waitcnt vmcnt(18) lgkmcnt(0)
    s_barrier
    v_mfma_f32_16x16x32_bf16 v[12:15], v[88:91], a[100:103], v[12:15]
    ds_read_b128 v[80:83], v243
    ds_read_b128 v[104:107], v252 offset:1024
    v_mfma_f32_16x16x32_bf16 v[20:23], v[88:91], a[104:107], v[20:23]
    ds_read_b128 v[84:87], v243 offset:512
    v_mfma_f32_16x16x32_bf16 v[28:31], v[88:91], a[108:111], v[28:31]
    v_mfma_f32_16x16x32_bf16 v[4:7], v[92:95], a[112:115], v[4:7]
    buffer_store_dwordx4 v[128:131], v99, s[36:39], s78 offen offset:512 sc1
    v_mfma_f32_16x16x32_bf16 v[12:15], v[92:95], a[116:119], v[12:15]
    ds_read_b128 v[88:91], v243 offset:64
    v_mfma_f32_16x16x32_bf16 v[20:23], v[92:95], a[120:123], v[20:23]
    s_waitcnt lgkmcnt(2)
    v_max_f32 v108, v108, v106
    v_max_f32 v109, v109, v107
    v_max_f32 v110, v110, v104
    v_mfma_f32_16x16x32_bf16 v[28:31], v[92:95], a[124:127], v[28:31]
    v_sub_f32 v64, 0xc2ca0000, v108
    v_sub_f32 v68, 0xc2ca0000, v109
    v_sub_f32 v72, 0xc2ca0000, v110
    v_mfma_f32_16x16x32_bf16 v[32:35], v[80:83], a[0:3], 0
    v_floor_f32 v64, v64
    v_floor_f32 v68, v68
    v_floor_f32 v72, v72
    v_max_f32 v111, v111, v105
    v_mfma_f32_16x16x32_bf16 v[40:43], v[80:83], a[4:7], 0
    ds_read_b128 v[92:95], v243 offset:576
    v_sub_f32 v76, 0xc2ca0000, v111
    v_mfma_f32_16x16x32_bf16 v[48:51], v[80:83], a[8:11], 0
    v_floor_f32 v76, v76
    v_add_f32 v0, v0, v64
    v_add_f32 v1, v1, v64
    v_add_f32 v2, v2, v64
    v_mfma_f32_16x16x32_bf16 v[56:59], v[80:83], a[12:15], 0
    v_add_f32 v3, v3, v64
    s_waitcnt lgkmcnt(2)
    s_add_u32 m0, s47, 33792
    s_add_u32 s54, s54, 28672
    v_mfma_f32_16x16x32_bf16 v[36:39], v[84:87], a[0:3], 0
    buffer_load_dwordx4 v244, s[16:19], s54 offen lds
    v_add_f32 v4, v4, v64
    v_add_f32 v5, v5, v64
    v_mfma_f32_16x16x32_bf16 v[44:47], v[84:87], a[4:7], 0
    ds_read_b128 v[80:83], v243 offset:128
    v_add_f32 v6, v6, v64
    v_add_f32 v7, v7, v64
    v_mfma_f32_16x16x32_bf16 v[52:55], v[84:87], a[8:11], 0
    buffer_load_dword v97, v96, s[16:19], s54 offen
    v_exp_f32 v0, v0
    v_mfma_f32_16x16x32_bf16 v[60:63], v[84:87], a[12:15], 0
    v_exp_f32 v1, v1
    v_add_f32 v8, v8, v68
    s_waitcnt lgkmcnt(2)
    v_mfma_f32_16x16x32_bf16 v[32:35], v[88:91], a[16:19], v[32:35]
    v_exp_f32 v2, v2
    v_exp_f32 v3, v3
    v_mfma_f32_16x16x32_bf16 v[40:43], v[88:91], a[20:23], v[40:43]
    ds_read_b128 v[84:87], v243 offset:640
    v_add_f32 v108, v0, v1
    v_cvt_pk_bf16_f32 v0, v0, v1
    v_mfma_f32_16x16x32_bf16 v[48:51], v[88:91], a[24:27], v[48:51]
    buffer_store_dwordx4 v[136:139], v99, s[36:39], s78 offen offset:768 sc1
    v_add_f32 v108, v108, v2
    v_cvt_pk_bf16_f32 v1, v2, v3
    v_mfma_f32_16x16x32_bf16 v[56:59], v[88:91], a[28:31], v[56:59]
    v_add_f32 v108, v108, v3
    v_exp_f32 v4, v4
    s_waitcnt lgkmcnt(2)
    v_mfma_f32_16x16x32_bf16 v[36:39], v[92:95], a[16:19], v[36:39]
    buffer_load_dwordx4 v245, s[16:19], s54 offen offset:1056 lds
    v_exp_f32 v5, v5
    v_mfma_f32_16x16x32_bf16 v[44:47], v[92:95], a[20:23], v[44:47]
    ds_read_b128 v[88:91], v243 offset:192
    v_add_f32 v108, v108, v4
    v_add_f32 v9, v9, v68
    v_mfma_f32_16x16x32_bf16 v[52:55], v[92:95], a[24:27], v[52:55]
    v_add_f32 v108, v108, v5
    v_cvt_pk_bf16_f32 v2, v4, v5
    v_exp_f32 v6, v6
    v_mfma_f32_16x16x32_bf16 v[60:63], v[92:95], a[28:31], v[60:63]
    v_exp_f32 v7, v7
    v_add_f32 v10, v10, v68
    s_waitcnt lgkmcnt(2)
    v_mfma_f32_16x16x32_bf16 v[32:35], v[80:83], a[32:35], v[32:35]
    v_add_f32 v108, v108, v6
    v_add_f32 v11, v11, v68
    v_add_f32 v12, v12, v68
    v_add_f32 v13, v13, v68
    v_mfma_f32_16x16x32_bf16 v[40:43], v[80:83], a[36:39], v[40:43]
    ds_read_b128 v[92:95], v243 offset:704
    v_add_f32 v108, v108, v7
    v_cvt_pk_bf16_f32 v3, v6, v7
    v_mfma_f32_16x16x32_bf16 v[48:51], v[80:83], a[40:43], v[48:51]
    v_add_f32 v14, v14, v68
    v_add_f32 v15, v15, v68
    v_exp_f32 v8, v8
    v_mfma_f32_16x16x32_bf16 v[56:59], v[80:83], a[44:47], v[56:59]
    v_exp_f32 v9, v9
    v_add_f32 v16, v16, v72
    s_waitcnt lgkmcnt(2)
    v_mfma_f32_16x16x32_bf16 v[36:39], v[84:87], a[32:35], v[36:39]
    buffer_load_dwordx4 v246, s[16:19], s54 offen offset:2112 lds
    v_exp_f32 v10, v10
    v_mfma_f32_16x16x32_bf16 v[44:47], v[84:87], a[36:39], v[44:47]
    ds_read_b128 v[80:83], v243 offset:256
    v_add_f32 v109, v8, v9
    v_cvt_pk_bf16_f32 v8, v8, v9
    v_mfma_f32_16x16x32_bf16 v[52:55], v[84:87], a[40:43], v[52:55]
    buffer_store_dwordx4 v[144:147], v99, s[36:39], s78 offen offset:1024 sc1
    v_add_f32 v109, v109, v10
    v_add_f32 v17, v17, v72
    v_mfma_f32_16x16x32_bf16 v[60:63], v[84:87], a[44:47], v[60:63]
    v_exp_f32 v11, v11
    v_add_f32 v18, v18, v72
    s_waitcnt lgkmcnt(2)
    v_mfma_f32_16x16x32_bf16 v[32:35], v[88:91], a[48:51], v[32:35]
    v_exp_f32 v12, v12
    v_exp_f32 v13, v13
    v_mfma_f32_16x16x32_bf16 v[40:43], v[88:91], a[52:55], v[40:43]
    ds_read_b128 v[84:87], v243 offset:768
    v_add_f32 v109, v109, v11
    v_cvt_pk_bf16_f32 v9, v10, v11
    v_mfma_f32_16x16x32_bf16 v[48:51], v[88:91], a[56:59], v[48:51]
    v_add_f32 v109, v109, v12
    v_cvt_pk_bf16_f32 v10, v12, v13
    v_exp_f32 v14, v14
    v_mfma_f32_16x16x32_bf16 v[56:59], v[88:91], a[60:63], v[56:59]
    v_add_f32 v109, v109, v13
    v_exp_f32 v15, v15
    s_waitcnt lgkmcnt(2)
    v_mfma_f32_16x16x32_bf16 v[36:39], v[92:95], a[48:51], v[36:39]
    buffer_load_dwordx4 v247, s[16:19], s54 offen offset:3168 lds
    v_add_f32 v109, v109, v14
    v_add_f32 v19, v19, v72
    v_mfma_f32_16x16x32_bf16 v[44:47], v[92:95], a[52:55], v[44:47]
    ds_read_b128 v[88:91], v243 offset:320
    v_add_f32 v109, v109, v15
    v_cvt_pk_bf16_f32 v11, v14, v15
    v_mfma_f32_16x16x32_bf16 v[52:55], v[92:95], a[56:59], v[52:55]
    v_add_f32 v20, v20, v72
    v_add_f32 v21, v21, v72
    v_add_f32 v22, v22, v72
    v_add_f32 v23, v23, v72
    v_mfma_f32_16x16x32_bf16 v[60:63], v[92:95], a[60:63], v[60:63]
    v_exp_f32 v16, v16
    v_add_f32 v24, v24, v76
    s_waitcnt lgkmcnt(2)
    v_mfma_f32_16x16x32_bf16 v[32:35], v[80:83], a[64:67], v[32:35]
    v_exp_f32 v17, v17
    v_exp_f32 v18, v18
    v_mfma_f32_16x16x32_bf16 v[40:43], v[80:83], a[68:71], v[40:43]
    ds_read_b128 v[92:95], v243 offset:832
    v_exp_f32 v19, v19
    v_mfma_f32_16x16x32_bf16 v[48:51], v[80:83], a[72:75], v[48:51]
    v_add_f32 v110, v16, v17
    v_cvt_pk_bf16_f32 v16, v16, v17
    v_exp_f32 v20, v20
    v_mfma_f32_16x16x32_bf16 v[56:59], v[80:83], a[76:79], v[56:59]
    v_add_f32 v110, v110, v18
    s_waitcnt lgkmcnt(2)
    s_add_u32 m0, s47, 38016
    s_add_u32 s54, s54, 4096
    v_mfma_f32_16x16x32_bf16 v[36:39], v[84:87], a[64:67], v[36:39]
    buffer_load_dwordx4 v244, s[16:19], s54 offen lds
    v_add_f32 v110, v110, v19
    v_cvt_pk_bf16_f32 v17, v18, v19
    v_mfma_f32_16x16x32_bf16 v[44:47], v[84:87], a[68:71], v[44:47]
    ds_read_b128 v[80:83], v243 offset:384
    v_add_f32 v110, v110, v20
    v_add_f32 v25, v25, v76
    v_mfma_f32_16x16x32_bf16 v[52:55], v[84:87], a[72:75], v[52:55]
    buffer_store_dwordx4 v[152:155], v99, s[36:39], s78 offen offset:1280 sc1
    v_exp_f32 v21, v21
    v_mfma_f32_16x16x32_bf16 v[60:63], v[84:87], a[76:79], v[60:63]
    v_exp_f32 v22, v22
    v_add_f32 v26, v26, v76
    s_waitcnt lgkmcnt(2)
    v_mfma_f32_16x16x32_bf16 v[32:35], v[88:91], a[80:83], v[32:35]
    v_add_f32 v110, v110, v21
    v_cvt_pk_bf16_f32 v18, v20, v21
    v_exp_f32 v23, v23
    v_mfma_f32_16x16x32_bf16 v[40:43], v[88:91], a[84:87], v[40:43]
    ds_read_b128 v[84:87], v243 offset:896
    v_add_f32 v110, v110, v22
    v_add_f32 v27, v27, v76
    v_mfma_f32_16x16x32_bf16 v[48:51], v[88:91], a[88:91], v[48:51]
    v_add_f32 v110, v110, v23
    v_cvt_pk_bf16_f32 v19, v22, v23
    v_add_f32 v28, v28, v76
    v_add_f32 v29, v29, v76
    v_mfma_f32_16x16x32_bf16 v[56:59], v[88:91], a[92:95], v[56:59]
    v_add_f32 v30, v30, v76
    v_add_f32 v31, v31, v76
    v_mov_b32 v65, v64
    s_waitcnt lgkmcnt(2)
    v_mfma_f32_16x16x32_bf16 v[36:39], v[92:95], a[80:83], v[36:39]
    buffer_load_dwordx4 v245, s[16:19], s54 offen offset:1056 lds
    v_exp_f32 v24, v24
    v_mfma_f32_16x16x32_bf16 v[44:47], v[92:95], a[84:87], v[44:47]
    ds_read_b128 v[88:91], v243 offset:448
    v_exp_f32 v25, v25
    v_mfma_f32_16x16x32_bf16 v[52:55], v[92:95], a[88:91], v[52:55]
    v_exp_f32 v26, v26
    v_exp_f32 v27, v27
    v_mfma_f32_16x16x32_bf16 v[60:63], v[92:95], a[92:95], v[60:63]
    v_add_f32 v111, v24, v25
    v_cvt_pk_bf16_f32 v24, v24, v25
    v_mov_b32 v66, v64
    s_waitcnt lgkmcnt(2)
    v_mfma_f32_16x16x32_bf16 v[32:35], v[80:83], a[96:99], v[32:35]
    v_add_f32 v111, v111, v26
    v_cvt_pk_bf16_f32 v25, v26, v27
    v_exp_f32 v28, v28
    v_mfma_f32_16x16x32_bf16 v[40:43], v[80:83], a[100:103], v[40:43]
    ds_read_b128 v[92:95], v243 offset:960
    v_add_f32 v111, v111, v27
    v_mov_b32 v67, v64
    v_mfma_f32_16x16x32_bf16 v[48:51], v[80:83], a[104:107], v[48:51]
    buffer_store_dwordx4 v[160:163], v99, s[36:39], s78 offen offset:1536 sc1
    v_add_f32 v111, v111, v28
    v_mov_b32 v69, v68
    v_mfma_f32_16x16x32_bf16 v[56:59], v[80:83], a[108:111], v[56:59]
    v_exp_f32 v29, v29
    v_mov_b32 v70, v68
    s_waitcnt lgkmcnt(2)
    v_mfma_f32_16x16x32_bf16 v[36:39], v[84:87], a[96:99], v[36:39]
    buffer_load_dwordx4 v246, s[16:19], s54 offen offset:2112 lds
    v_exp_f32 v30, v30
    v_mfma_f32_16x16x32_bf16 v[44:47], v[84:87], a[100:103], v[44:47]
    v_add_f32 v111, v111, v29
    v_cvt_pk_bf16_f32 v26, v28, v29
    v_mov_b32 v71, v68
    v_mfma_f32_16x16x32_bf16 v[52:55], v[84:87], a[104:107], v[52:55]
    v_add_f32 v111, v111, v30
    v_exp_f32 v31, v31
    v_mov_b32 v73, v72
    v_mfma_f32_16x16x32_bf16 v[60:63], v[84:87], a[108:111], v[60:63]
    v_mov_b32 v74, v72
    v_mov_b32 v75, v72
    v_mov_b32 v77, v76
    s_waitcnt lgkmcnt(1)
    v_mfma_f32_16x16x32_bf16 v[32:35], v[88:91], a[112:115], v[32:35]
    s_waitcnt vmcnt(23) lgkmcnt(0)
    s_barrier
    v_add_f32 v111, v111, v31
    v_cvt_pk_bf16_f32 v27, v30, v31
    v_mfma_f32_16x16x32_bf16 v[40:43], v[88:91], a[116:119], v[40:43]
    ds_read_b64_tr_b16 v[80:81], v241 offset:33792
    ds_read_b64_tr_b16 v[82:83], v241 offset:34304
    v_mov_b32 v78, v76
    v_mfma_f32_16x16x32_bf16 v[48:51], v[88:91], a[120:123], v[48:51]
    ds_read_b64_tr_b16 v[84:85], v241 offset:33824
    ds_read_b64_tr_b16 v[86:87], v241 offset:34336
    v_mov_b32 v79, v76
    v_mov_b32 v104, 0
    v_mfma_f32_16x16x32_bf16 v[56:59], v[88:91], a[124:127], v[56:59]
    v_mov_b32 v105, 0
    v_mov_b32 v106, 0
    v_mov_b32 v107, 0
    v_mfma_f32_16x16x32_bf16 v[36:39], v[92:95], a[112:115], v[36:39]
    buffer_load_dwordx4 v247, s[16:19], s54 offen offset:3168 lds
    v_max3_f32 v251, v108, v109, v110
    v_mfma_f32_16x16x32_bf16 v[44:47], v[92:95], a[116:119], v[44:47]
    ds_read_b64_tr_b16 v[88:89], v241 offset:33856
    ds_read_b64_tr_b16 v[90:91], v241 offset:34368
    v_max_f32 v251, v251, v111
    v_mfma_f32_16x16x32_bf16 v[52:55], v[92:95], a[120:123], v[52:55]
    v_cmp_nge_f32 vcc, s55, v251
    v_mfma_f32_16x16x32_bf16 v[60:63], v[92:95], a[124:127], v[60:63]
    s_waitcnt lgkmcnt(4)
    s_cbranch_vccnz L_slow_u0
L_ret_u0:
    v_mfma_f32_16x16x32_bf16 a[128:131], v[80:83], v[0:3], 0
    v_add_f32 v104, v104, v108
    v_add_f32 v105, v105, v109
    v_mfma_f32_16x16x32_bf16 a[132:135], v[80:83], v[8:11], 0
    ds_read_b64_tr_b16 v[92:93], v241 offset:33888
    ds_read_b64_tr_b16 v[94:95], v241 offset:34400
    v_mfma_f32_16x16x32_bf16 v[112:115], v[80:83], v[16:19], 0
    v_add_f32 v106, v106, v110
    v_add_f32 v107, v107, v111
    v_add_f32 v32, v32, v64
    v_mfma_f32_16x16x32_bf16 v[116:119], v[80:83], v[24:27], 0
    s_waitcnt lgkmcnt(4)
    s_add_u32 m0, s47, 67584
    s_add_u32 s53, s53, 28672
    v_mfma_f32_16x16x32_bf16 v[124:127], v[84:87], v[24:27], 0
    buffer_load_dwordx4 v244, s[12:15], s53 offen lds
    v_mfma_f32_16x16x32_bf16 v[120:123], v[84:87], v[16:19], 0
    ds_read_b64_tr_b16 v[80:81], v241 offset:33920
    ds_read_b64_tr_b16 v[82:83], v241 offset:34432
    v_add_f32 v33, v33, v64
    v_mfma_f32_16x16x32_bf16 a[140:143], v[84:87], v[8:11], 0
    v_exp_f32 v32, v32
    v_mfma_f32_16x16x32_bf16 a[136:139], v[84:87], v[0:3], 0
    v_add_f32 v34, v34, v64
    s_waitcnt lgkmcnt(4)
    v_mfma_f32_16x16x32_bf16 a[144:147], v[88:91], v[0:3], 0
    v_exp_f32 v33, v33
    v_add_f32 v35, v35, v64
    v_mfma_f32_16x16x32_bf16 a[148:151], v[88:91], v[8:11], 0
    ds_read_b64_tr_b16 v[84:85], v241 offset:33952
    ds_read_b64_tr_b16 v[86:87], v241 offset:34464
    v_mfma_f32_16x16x32_bf16 v[128:131], v[88:91], v[16:19], 0
    v_exp_f32 v34, v34
    v_mfma_f32_16x16x32_bf16 v[132:135], v[88:91], v[24:27], 0
    v_exp_f32 v35, v35
    s_waitcnt lgkmcnt(4)
    v_mfma_f32_16x16x32_bf16 v[140:143], v[92:95], v[24:27], 0
    buffer_load_dwordx4 v245, s[12:15], s53 offen offset:1056 lds
    v_mfma_f32_16x16x32_bf16 v[136:139], v[92:95], v[16:19], 0
    ds_read_b64_tr_b16 v[88:89], v241 offset:33984
    ds_read_b64_tr_b16 v[90:91], v241 offset:34496
    v_mfma_f32_16x16x32_bf16 a[156:159], v[92:95], v[8:11], 0
    v_add_f32 v36, v36, v64
    v_add_f32 v37, v37, v64
    v_add_f32 v38, v38, v64
    v_mfma_f32_16x16x32_bf16 a[152:155], v[92:95], v[0:3], 0
    v_add_f32 v39, v39, v64
    s_waitcnt lgkmcnt(4)
    v_mfma_f32_16x16x32_bf16 a[160:163], v[80:83], v[0:3], 0
    v_exp_f32 v36, v36
    v_mfma_f32_16x16x32_bf16 a[164:167], v[80:83], v[8:11], 0
    ds_read_b64_tr_b16 v[92:93], v241 offset:34016
    ds_read_b64_tr_b16 v[94:95], v241 offset:34528
    v_add_f32 v108, v32, v33
    v_mfma_f32_16x16x32_bf16 v[144:147], v[80:83], v[16:19], 0
    v_exp_f32 v37, v37
    v_mfma_f32_16x16x32_bf16 v[148:151], v[80:83], v[24:27], 0
    v_exp_f32 v38, v38
    s_waitcnt lgkmcnt(4)
    v_mfma_f32_16x16x32_bf16 v[156:159], v[84:87], v[24:27], 0
    buffer_load_dwordx4 v246, s[12:15], s53 offen offset:2112 lds
    v_mfma_f32_16x16x32_bf16 v[152:155], v[84:87], v[16:19], 0
    ds_read_b64_tr_b16 v[80:81], v241 offset:34048
    ds_read_b64_tr_b16 v[82:83], v241 offset:34560
    v_mfma_f32_16x16x32_bf16 a[172:175], v[84:87], v[8:11], 0
    v_exp_f32 v39, v39
    v_cvt_pk_bf16_f32 v32, v32, v33
    v_mfma_f32_16x16x32_bf16 a[168:171], v[84:87], v[0:3], 0
    v_add_f32 v108, v108, v34
    s_waitcnt lgkmcnt(4)
    v_mfma_f32_16x16x32_bf16 a[176:179], v[88:91], v[0:3], 0
    v_add_f32 v108, v108, v35
    v_cvt_pk_bf16_f32 v33, v34, v35
    v_mfma_f32_16x16x32_bf16 a[180:183], v[88:91], v[8:11], 0
    ds_read_b64_tr_b16 v[84:85], v241 offset:34080
    ds_read_b64_tr_b16 v[86:87], v241 offset:34592
    v_add_f32 v108, v108, v36
    v_mfma_f32_16x16x32_bf16 v[160:163], v[88:91], v[16:19], 0
    v_add_f32 v108, v108, v37
    v_cvt_pk_bf16_f32 v34, v36, v37
    v_mfma_f32_16x16x32_bf16 v[164:167], v[88:91], v[24:27], 0
    v_add_f32 v108, v108, v38
    s_waitcnt lgkmcnt(4)
    v_mfma_f32_16x16x32_bf16 v[172:175], v[92:95], v[24:27], 0
    buffer_load_dwordx4 v247, s[12:15], s53 offen offset:3168 lds
    v_add_f32 v108, v108, v39
    v_mfma_f32_16x16x32_bf16 v[168:171], v[92:95], v[16:19], 0
    ds_read_b64_tr_b16 v[88:89], v241 offset:34112
    ds_read_b64_tr_b16 v[90:91], v241 offset:34624
    v_mfma_f32_16x16x32_bf16 a[188:191], v[92:95], v[8:11], 0
    v_cvt_pk_bf16_f32 v35, v38, v39
    v_add_f32 v40, v40, v68
    v_mfma_f32_16x16x32_bf16 a[184:187], v[92:95], v[0:3], 0
    v_exp_f32 v40, v40
    s_waitcnt lgkmcnt(4)
    v_mfma_f32_16x16x32_bf16 a[192:195], v[80:83], v[0:3], 0
    v_add_f32 v41, v41, v68
    v_add_f32 v42, v42, v68
    v_mfma_f32_16x16x32_bf16 a[196:199], v[80:83], v[8:11], 0
    ds_read_b64_tr_b16 v[92:93], v241 offset:34144
    ds_read_b64_tr_b16 v[94:95], v241 offset:34656
    v_mfma_f32_16x16x32_bf16 v[176:179], v[80:83], v[16:19], 0
    v_exp_f32 v41, v41
    v_add_f32 v43, v43, v68
    v_mfma_f32_16x16x32_bf16 v[180:183], v[80:83], v[24:27], 0
    s_waitcnt lgkmcnt(4)
    s_add_u32 m0, s47, 71808
    s_add_u32 s53, s53, 4096
    v_mfma_f32_16x16x32_bf16 v[188:191], v[84:87], v[24:27], 0
    buffer_load_dwordx4 v244, s[12:15], s53 offen lds
    v_mfma_f32_16x16x32_bf16 v[184:187], v[84:87], v[16:19], 0
    ds_read_b64_tr_b16 v[80:81], v241 offset:34176
    ds_read_b64_tr_b16 v[82:83], v241 offset:34688
    v_add_f32 v44, v44, v68
    v_mfma_f32_16x16x32_bf16 a[204:207], v[84:87], v[8:11], 0
    v_exp_f32 v42, v42
    v_mfma_f32_16x16x32_bf16 a[200:203], v[84:87], v[0:3], 0
    v_exp_f32 v43, v43
    s_waitcnt lgkmcnt(4)
    v_mfma_f32_16x16x32_bf16 a[208:211], v[88:91], v[0:3], 0
    v_exp_f32 v44, v44
    v_mfma_f32_16x16x32_bf16 a[212:215], v[88:91], v[8:11], 0
    ds_read_b64_tr_b16 v[84:85], v241 offset:34208
    ds_read_b64_tr_b16 v[86:87], v241 offset:34720
    v_mfma_f32_16x16x32_bf16 v[192:195], v[88:91], v[16:19], 0
    v_add_f32 v45, v45, v68
    v_add_f32 v46, v46, v68
    v_add_f32 v47, v47, v68
    v_mfma_f32_16x16x32_bf16 v[196:199], v[88:91], v[24:27], 0
    v_add_f32 v109, v40, v41
    s_waitcnt lgkmcnt(4)
    v_mfma_f32_16x16x32_bf16 v[204:207], v[92:95], v[24:27], 0
    buffer_load_dwordx4 v245, s[12:15], s53 offen offset:1056 lds
    v_mfma_f32_16x16x32_bf16 v[200:203], v[92:95], v[16:19], 0
    ds_read_b64_tr_b16 v[88:89], v241 offset:34240
    ds_read_b64_tr_b16 v[90:91], v241 offset:34752
    v_cvt_pk_bf16_f32 v40, v40, v41
    v_mfma_f32_16x16x32_bf16 a[220:223], v[92:95], v[8:11], 0
    v_exp_f32 v45, v45
    v_mfma_f32_16x16x32_bf16 a[216:219], v[92:95], v[0:3], 0
    v_add_f32 v109, v109, v42
    s_waitcnt lgkmcnt(4)
    v_mfma_f32_16x16x32_bf16 a[224:227], v[80:83], v[0:3], 0
    v_exp_f32 v46, v46
    v_add_f32 v109, v109, v43
    v_mfma_f32_16x16x32_bf16 a[228:231], v[80:83], v[8:11], 0
    ds_read_b64_tr_b16 v[92:93], v241 offset:34272
    ds_read_b64_tr_b16 v[94:95], v241 offset:34784
    v_mfma_f32_16x16x32_bf16 v[208:211], v[80:83], v[16:19], 0
    v_exp_f32 v47, v47
    v_mfma_f32_16x16x32_bf16 v[212:215], v[80:83], v[24:27], 0
    v_cvt_pk_bf16_f32 v41, v42, v43
    v_add_f32 v109, v109, v44
    s_waitcnt lgkmcnt(4)
    v_mfma_f32_16x16x32_bf16 v[220:223], v[84:87], v[24:27], 0
    buffer_load_dwordx4 v246, s[12:15], s53 offen offset:2112 lds
    v_mfma_f32_16x16x32_bf16 v[216:219], v[84:87], v[16:19], 0
    v_add_f32 v109, v109, v45
    v_cvt_pk_bf16_f32 v42, v44, v45
    v_mfma_f32_16x16x32_bf16 a[236:239], v[84:87], v[8:11], 0
    v_add_f32 v109, v109, v46
    v_cvt_pk_bf16_f32 v43, v46, v47
    v_add_f32 v48, v48, v72
    v_mfma_f32_16x16x32_bf16 a[232:235], v[84:87], v[0:3], 0
    v_add_f32 v109, v109, v47
    s_waitcnt lgkmcnt(2)
    v_mfma_f32_16x16x32_bf16 a[240:243], v[88:91], v[0:3], 0
    s_waitcnt vmcnt(23) lgkmcnt(0)
    s_barrier
    v_mfma_f32_16x16x32_bf16 a[244:247], v[88:91], v[8:11], 0
    ds_read_b128 v[80:83], v242
    v_exp_f32 v48, v48
    v_mfma_f32_16x16x32_bf16 v[224:227], v[88:91], v[16:19], 0
    ds_read_b128 v[84:87], v242 offset:512
    v_add_f32 v49, v49, v72
    v_mfma_f32_16x16x32_bf16 v[228:231], v[88:91], v[24:27], 0
    v_exp_f32 v49, v49
    v_mfma_f32_16x16x32_bf16 v[236:239], v[92:95], v[24:27], 0
    buffer_load_dwordx4 v247, s[12:15], s53 offen offset:3168 lds
    v_mfma_f32_16x16x32_bf16 v[232:235], v[92:95], v[16:19], 0
    ds_read_b128 v[88:91], v242 offset:64
    v_add_f32 v50, v50, v72
    v_mfma_f32_16x16x32_bf16 a[252:255], v[92:95], v[8:11], 0
    v_exp_f32 v50, v50
    v_add_f32 v51, v51, v72
    v_mfma_f32_16x16x32_bf16 a[248:251], v[92:95], v[0:3], 0
    v_add_f32 v52, v52, v72
    s_waitcnt lgkmcnt(2)
    v_mfma_f32_16x16x32_bf16 v[0:3], v[80:83], a[0:3], v[64:67]
    v_mov_b32 v252, -1
    v_mov_b32 v253, -1
    v_mfma_f32_16x16x32_bf16 v[8:11], v[80:83], a[4:7], v[68:71]
    ds_read_b128 v[92:95], v242 offset:576
    v_mov_b32 v254, -1
    v_add_f32 v53, v53, v72
    v_mfma_f32_16x16x32_bf16 v[16:19], v[80:83], a[8:11], v[72:75]
    v_mov_b32 v255, -1
    v_add_f32 v54, v54, v72
    v_mfma_f32_16x16x32_bf16 v[24:27], v[80:83], a[12:15], v[76:79]
    s_waitcnt lgkmcnt(2)
    s_add_u32 m0, s47, 101376
    s_add_u32 s54, s54, 28672
    v_mfma_f32_16x16x32_bf16 v[28:31], v[84:87], a[12:15], v[76:79]
    buffer_load_dwordx4 v244, s[16:19], s54 offen lds
    v_add_f32 v55, v55, v72
    v_mfma_f32_16x16x32_bf16 v[20:23], v[84:87], a[8:11], v[72:75]
    ds_read_b128 v[80:83], v242 offset:128
    v_add_f32 v110, v48, v49
    v_mfma_f32_16x16x32_bf16 v[12:15], v[84:87], a[4:7], v[68:71]
    buffer_load_dword v97, v96, s[12:15], s53 offen
    v_mfma_f32_16x16x32_bf16 v[4:7], v[84:87], a[0:3], v[64:67]
    v_exp_f32 v51, v51
    s_waitcnt lgkmcnt(2)
    v_mfma_f32_16x16x32_bf16 v[0:3], v[88:91], a[16:19], v[0:3]
    s_lshl_b32 s62, s44, 8
    s_add_u32 s62, s62, s57
    v_mfma_f32_16x16x32_bf16 v[8:11], v[88:91], a[20:23], v[8:11]
    ds_read_b128 v[84:87], v242 offset:640
    v_cvt_pk_bf16_f32 v48, v48, v49
    v_mfma_f32_16x16x32_bf16 v[16:19], v[88:91], a[24:27], v[16:19]
    s_add_u32 s62, s62, 3072
    s_sub_u32 s63, s58, s57
    v_add_f32 v110, v110, v50
    v_mfma_f32_16x16x32_bf16 v[24:27], v[88:91], a[28:31], v[24:27]
    s_add_u32 s63, s63, 1024
    s_waitcnt lgkmcnt(2)
    v_mfma_f32_16x16x32_bf16 v[28:31], v[92:95], a[28:31], v[28:31]
    buffer_load_dwordx4 v245, s[16:19], s54 offen offset:1056 lds
    v_mfma_f32_16x16x32_bf16 v[20:23], v[92:95], a[24:27], v[20:23]
    ds_read_b128 v[88:91], v242 offset:192
    v_exp_f32 v52, v52
    v_mfma_f32_16x16x32_bf16 v[12:15], v[92:95], a[20:23], v[12:15]
    s_mul_i32 s89, s2, 57344
    s_lshl_b32 s48, s44, 11
    v_mfma_f32_16x16x32_bf16 v[4:7], v[92:95], a[16:19], v[4:7]
    v_exp_f32 v53, v53
    s_waitcnt lgkmcnt(2)
    v_mfma_f32_16x16x32_bf16 v[0:3], v[80:83], a[32:35], v[0:3]
    s_add_u32 s89, s89, s48
    s_add_u32 s89, s89, 16719872
    v_mfma_f32_16x16x32_bf16 v[8:11], v[80:83], a[36:39], v[8:11]
    ds_read_b128 v[92:95], v242 offset:704
    v_add_f32 v110, v110, v51
    v_mfma_f32_16x16x32_bf16 v[16:19], v[80:83], a[40:43], v[16:19]
    s_lshl_b32 s83, s46, 4
    s_lshr_b32 s48, s45, 2
    v_cvt_pk_bf16_f32 v49, v50, v51
    v_mfma_f32_16x16x32_bf16 v[24:27], v[80:83], a[44:47], v[24:27]
    v_add_f32 v110, v110, v52
    s_waitcnt lgkmcnt(2)
    v_mfma_f32_16x16x32_bf16 v[28:31], v[84:87], a[44:47], v[28:31]
    buffer_load_dwordx4 v246, s[16:19], s54 offen offset:2112 lds
    v_mfma_f32_16x16x32_bf16 v[20:23], v[84:87], a[40:43], v[20:23]
    ds_read_b128 v[80:83], v242 offset:256
    v_exp_f32 v54, v54
    v_mfma_f32_16x16x32_bf16 v[12:15], v[84:87], a[36:39], v[12:15]
    s_lshl_b32 s48, s48, 3
    s_add_u32 s83, s83, s48
    v_mfma_f32_16x16x32_bf16 v[4:7], v[84:87], a[32:35], v[4:7]
    v_add_f32 v110, v110, v53
    s_waitcnt lgkmcnt(2)
    v_mfma_f32_16x16x32_bf16 v[0:3], v[88:91], a[48:51], v[0:3]
    s_and_b32 s48, s45, 3
    s_add_u32 s83, s83, s48
    v_cvt_pk_bf16_f32 v50, v52, v53
    v_mfma_f32_16x16x32_bf16 v[8:11], v[88:91], a[52:55], v[8:11]
    ds_read_b128 v[84:87], v242 offset:768
    v_add_f32 v110, v110, v54
    v_mfma_f32_16x16x32_bf16 v[16:19], v[88:91], a[56:59], v[16:19]
    s_mul_i32 s83, s83, 3584
    s_lshl_b32 s48, s44, 5
    v_mfma_f32_16x16x32_bf16 v[24:27], v[88:91], a[60:63], v[24:27]
    v_exp_f32 v55, v55
    s_waitcnt lgkmcnt(2)
    v_mfma_f32_16x16x32_bf16 v[28:31], v[92:95], a[60:63], v[28:31]
    buffer_load_dwordx4 v247, s[16:19], s54 offen offset:3168 lds
    v_mfma_f32_16x16x32_bf16 v[20:23], v[92:95], a[56:59], v[20:23]
    ds_read_b128 v[88:91], v242 offset:320
    v_add_f32 v110, v110, v55
    v_mfma_f32_16x16x32_bf16 v[12:15], v[92:95], a[52:55], v[12:15]
    s_lshl_b32 s20, s44, 12
    s_add_u32 s20, s20, s2
    v_cvt_pk_bf16_f32 v51, v54, v55
    v_mfma_f32_16x16x32_bf16 v[4:7], v[92:95], a[48:51], v[4:7]
    s_add_u32 s83, s83, s48
    s_waitcnt lgkmcnt(2)
    v_mfma_f32_16x16x32_bf16 v[0:3], v[80:83], a[64:67], v[0:3]
    v_add_f32 v56, v56, v76
    v_add_f32 v57, v57, v76
    v_mfma_f32_16x16x32_bf16 v[8:11], v[80:83], a[68:71], v[8:11]
    ds_read_b128 v[92:95], v242 offset:832
    v_exp_f32 v56, v56
    v_mfma_f32_16x16x32_bf16 v[16:19], v[80:83], a[72:75], v[16:19]
    v_exp_f32 v57, v57
    v_mfma_f32_16x16x32_bf16 v[24:27], v[80:83], a[76:79], v[24:27]
    s_waitcnt lgkmcnt(2)
    s_add_u32 m0, s47, 105600
    s_add_u32 s54, s54, 4096
    v_mfma_f32_16x16x32_bf16 v[28:31], v[84:87], a[76:79], v[28:31]
    buffer_load_dwordx4 v244, s[16:19], s54 offen lds
    v_mfma_f32_16x16x32_bf16 v[20:23], v[84:87], a[72:75], v[20:23]
    ds_read_b128 v[80:83], v242 offset:384
    v_add_f32 v58, v58, v76
    v_mfma_f32_16x16x32_bf16 v[12:15], v[84:87], a[68:71], v[12:15]
    v_exp_f32 v58, v58
    v_add_f32 v59, v59, v76
    v_mfma_f32_16x16x32_bf16 v[4:7], v[84:87], a[64:67], v[4:7]
    v_add_f32 v60, v60, v76
    s_waitcnt lgkmcnt(2)
    v_mfma_f32_16x16x32_bf16 v[0:3], v[88:91], a[80:83], v[0:3]
    v_exp_f32 v59, v59
    v_mfma_f32_16x16x32_bf16 v[8:11], v[88:91], a[84:87], v[8:11]
    ds_read_b128 v[84:87], v242 offset:896
    v_exp_f32 v60, v60
    v_mfma_f32_16x16x32_bf16 v[16:19], v[88:91], a[88:91], v[16:19]
    v_add_f32 v61, v61, v76
    v_add_f32 v62, v62, v76
    v_mfma_f32_16x16x32_bf16 v[24:27], v[88:91], a[92:95], v[24:27]
    v_add_f32 v63, v63, v76
    s_waitcnt lgkmcnt(2)
    v_mfma_f32_16x16x32_bf16 v[28:31], v[92:95], a[92:95], v[28:31]
    buffer_load_dwordx4 v245, s[16:19], s54 offen offset:1056 lds
    v_add_f32 v111, v56, v57
    v_mfma_f32_16x16x32_bf16 v[20:23], v[92:95], a[88:91], v[20:23]
    ds_read_b128 v[88:91], v242 offset:448
    v_cvt_pk_bf16_f32 v56, v56, v57
    v_mfma_f32_16x16x32_bf16 v[12:15], v[92:95], a[84:87], v[12:15]
    v_exp_f32 v61, v61
    v_mfma_f32_16x16x32_bf16 v[4:7], v[92:95], a[80:83], v[4:7]
    v_exp_f32 v62, v62
    s_waitcnt lgkmcnt(2)
    v_mfma_f32_16x16x32_bf16 v[0:3], v[80:83], a[96:99], v[0:3]
    v_exp_f32 v63, v63
    v_mfma_f32_16x16x32_bf16 v[8:11], v[80:83], a[100:103], v[8:11]
    ds_read_b128 v[92:95], v242 offset:960
    v_add_f32 v111, v111, v58
    v_mfma_f32_16x16x32_bf16 v[16:19], v[80:83], a[104:107], v[16:19]
    v_add_f32 v111, v111, v59
    v_cvt_pk_bf16_f32 v57, v58, v59
    v_cvt_pk_bf16_f32 v58, v60, v61
    v_mfma_f32_16x16x32_bf16 v[24:27], v[80:83], a[108:111], v[24:27]
    v_add_f32 v111, v111, v60
    s_waitcnt lgkmcnt(2)
    v_mfma_f32_16x16x32_bf16 v[28:31], v[84:87], a[108:111], v[28:31]
    buffer_load_dwordx4 v246, s[16:19], s54 offen offset:2112 lds
    v_mfma_f32_16x16x32_bf16 v[20:23], v[84:87], a[104:107], v[20:23]
    v_add_f32 v111, v111, v61
    v_cvt_pk_bf16_f32 v59, v62, v63
    v_max3_f32 v251, v108, v109, v110
    v_mfma_f32_16x16x32_bf16 v[12:15], v[84:87], a[100:103], v[12:15]
    v_add_f32 v111, v111, v62
    v_mfma_f32_16x16x32_bf16 v[4:7], v[84:87], a[96:99], v[4:7]
    v_add_f32 v111, v111, v63
    s_waitcnt lgkmcnt(1)
    v_mfma_f32_16x16x32_bf16 v[0:3], v[88:91], a[112:115], v[0:3]
    s_waitcnt vmcnt(16) lgkmcnt(0)
    s_barrier
    v_mfma_f32_16x16x32_bf16 v[8:11], v[88:91], a[116:119], v[8:11]
    ds_read_b64_tr_b16 v[80:81], v240 offset:33792
    ds_read_b64_tr_b16 v[82:83], v240 offset:34304
    v_mfma_f32_16x16x32_bf16 v[16:19], v[88:91], a[120:123], v[16:19]
    ds_read_b64_tr_b16 v[84:85], v240 offset:33824
    ds_read_b64_tr_b16 v[86:87], v240 offset:34336
    v_max_f32 v251, v251, v111
    v_mfma_f32_16x16x32_bf16 v[24:27], v[88:91], a[124:127], v[24:27]
    v_cmp_nge_f32 vcc, s55, v251
    v_mfma_f32_16x16x32_bf16 v[28:31], v[92:95], a[124:127], v[28:31]
    buffer_load_dwordx4 v247, s[16:19], s54 offen offset:3168 lds
    v_mfma_f32_16x16x32_bf16 v[20:23], v[92:95], a[120:123], v[20:23]
    ds_read_b64_tr_b16 v[88:89], v240 offset:33856
    ds_read_b64_tr_b16 v[90:91], v240 offset:34368
    v_mfma_f32_16x16x32_bf16 v[12:15], v[92:95], a[116:119], v[12:15]
    v_mfma_f32_16x16x32_bf16 v[4:7], v[92:95], a[112:115], v[4:7]
    s_waitcnt lgkmcnt(4)
    s_cbranch_vccnz L_slow_u1
L_ret_u1:
L_loop:
    v_mfma_f32_16x16x32_bf16 a[128:131], v[80:83], v[32:35], a[128:131]
    v_exp_f32 v0, v0
    v_mfma_f32_16x16x32_bf16 a[132:135], v[80:83], v[40:43], a[132:135]
    ds_read_b64_tr_b16 v[92:93], v240 offset:33888
    ds_read_b64_tr_b16 v[94:95], v240 offset:34400
    v_mfma_f32_16x16x32_bf16 v[112:115], v[80:83], v[48:51], v[112:115]
    v_exp_f32 v1, v1
    v_mfma_f32_16x16x32_bf16 v[116:119], v[80:83], v[56:59], v[116:119]
    s_waitcnt lgkmcnt(4)
    s_add_u32 m0, s47, 0
    s_add_u32 s53, s53, 28672
    v_mfma_f32_16x16x32_bf16 v[124:127], v[84:87], v[56:59], v[124:127]
    buffer_load_dwordx4 v244, s[12:15], s53 offen lds
    v_mfma_f32_16x16x32_bf16 v[120:123], v[84:87], v[48:51], v[120:123]
    ds_read_b64_tr_b16 v[80:81], v240 offset:33920
    ds_read_b64_tr_b16 v[82:83], v240 offset:34432
    v_mfma_f32_16x16x32_bf16 a[140:143], v[84:87], v[40:43], a[140:143]
    v_exp_f32 v2, v2
    v_mfma_f32_16x16x32_bf16 a[136:139], v[84:87], v[32:35], a[136:139]
    v_add_f32 v104, v104, v108
    s_waitcnt lgkmcnt(4)
    v_mfma_f32_16x16x32_bf16 a[144:147], v[88:91], v[32:35], a[144:147]
    v_exp_f32 v3, v3
    v_mfma_f32_16x16x32_bf16 a[148:151], v[88:91], v[40:43], a[148:151]
    ds_read_b64_tr_b16 v[84:85], v240 offset:33952
    ds_read_b64_tr_b16 v[86:87], v240 offset:34464
    v_mfma_f32_16x16x32_bf16 v[128:131], v[88:91], v[48:51], v[128:131]
    v_exp_f32 v4, v4
    v_mfma_f32_16x16x32_bf16 v[132:135], v[88:91], v[56:59], v[132:135]
    v_add_f32 v105, v105, v109
    s_waitcnt lgkmcnt(4)
    v_mfma_f32_16x16x32_bf16 v[140:143], v[92:95], v[56:59], v[140:143]
    buffer_load_dwordx4 v245, s[12:15], s53 offen offset:1056 lds
    v_mfma_f32_16x16x32_bf16 v[136:139], v[92:95], v[48:51], v[136:139]
    ds_read_b64_tr_b16 v[88:89], v240 offset:33984
    ds_read_b64_tr_b16 v[90:91], v240 offset:34496
    v_mfma_f32_16x16x32_bf16 a[156:159], v[92:95], v[40:43], a[156:159]
    v_exp_f32 v5, v5
    v_mfma_f32_16x16x32_bf16 a[152:155], v[92:95], v[32:35], a[152:155]
    v_add_f32 v106, v106, v110
    s_waitcnt lgkmcnt(4)
    v_mfma_f32_16x16x32_bf16 a[160:163], v[80:83], v[32:35], a[160:163]
    v_exp_f32 v6, v6
    v_mfma_f32_16x16x32_bf16 a[164:167], v[80:83], v[40:43], a[164:167]
    ds_read_b64_tr_b16 v[92:93], v240 offset:34016
    ds_read_b64_tr_b16 v[94:95], v240 offset:34528
    v_mfma_f32_16x16x32_bf16 v[144:147], v[80:83], v[48:51], v[144:147]
    v_exp_f32 v7, v7
    v_mfma_f32_16x16x32_bf16 v[148:151], v[80:83], v[56:59], v[148:151]
    v_add_f32 v107, v107, v111
    s_waitcnt lgkmcnt(4)
    v_mfma_f32_16x16x32_bf16 v[156:159], v[84:87], v[56:59], v[156:159]
    buffer_load_dwordx4 v246, s[12:15], s53 offen offset:2112 lds
    v_mfma_f32_16x16x32_bf16 v[152:155], v[84:87], v[48:51], v[152:155]
    ds_read_b64_tr_b16 v[80:81], v240 offset:34048
    ds_read_b64_tr_b16 v[82:83], v240 offset:34560
    v_mfma_f32_16x16x32_bf16 a[172:175], v[84:87], v[40:43], a[172:175]
    v_exp_f32 v8, v8
    v_mfma_f32_16x16x32_bf16 a[168:171], v[84:87], v[32:35], a[168:171]
    v_add_f32 v108, v0, v1
    s_waitcnt lgkmcnt(4)
    v_mfma_f32_16x16x32_bf16 a[176:179], v[88:91], v[32:35], a[176:179]
    v_exp_f32 v9, v9
    v_mfma_f32_16x16x32_bf16 a[180:183], v[88:91], v[40:43], a[180:183]
    ds_read_b64_tr_b16 v[84:85], v240 offset:34080
    ds_read_b64_tr_b16 v[86:87], v240 offset:34592
    v_mfma_f32_16x16x32_bf16 v[160:163], v[88:91], v[48:51], v[160:163]
    s_cmp_lt_u32 s52, 7
    s_cselect_b32 s48, s62, 0x7f000000
    v_mfma_f32_16x16x32_bf16 v[164:167], v[88:91], v[56:59], v[164:167]
    s_cselect_b32 s49, 0x7f000000, s89
    s_waitcnt lgkmcnt(4)
    v_mfma_f32_16x16x32_bf16 v[172:175], v[92:95], v[56:59], v[172:175]
    buffer_load_dwordx4 v247, s[12:15], s53 offen offset:3168 lds
    v_mfma_f32_16x16x32_bf16 v[168:171], v[92:95], v[48:51], v[168:171]
    ds_read_b64_tr_b16 v[88:89], v240 offset:34112
    ds_read_b64_tr_b16 v[90:91], v240 offset:34624
    v_mfma_f32_16x16x32_bf16 a[188:191], v[92:95], v[40:43], a[188:191]
    buffer_store_dwordx4 v[252:255], v99, s[36:39], s48 offen sc1
    v_mfma_f32_16x16x32_bf16 a[184:187], v[92:95], v[32:35], a[184:187]
    s_add_u32 s62, s62, s63
    s_waitcnt lgkmcnt(4)
    v_mfma_f32_16x16x32_bf16 a[192:195], v[80:83], v[32:35], a[192:195]
    s_sub_u32 s63, 1024, s63
    s_add_u32 s89, s89, 8192
    v_mfma_f32_16x16x32_bf16 a[196:199], v[80:83], v[40:43], a[196:199]
    ds_read_b64_tr_b16 v[92:93], v240 offset:34144
    ds_read_b64_tr_b16 v[94:95], v240 offset:34656
    v_mfma_f32_16x16x32_bf16 v[176:179], v[80:83], v[48:51], v[176:179]
    v_exp_f32 v10, v10
    v_mfma_f32_16x16x32_bf16 v[180:183], v[80:83], v[56:59], v[180:183]
    s_waitcnt lgkmcnt(4)
    s_add_u32 m0, s47, 4224
    s_add_u32 s53, s53, 4096
    v_mfma_f32_16x16x32_bf16 v[188:191], v[84:87], v[56:59], v[188:191]
    buffer_load_dwordx4 v244, s[12:15], s53 offen lds
    v_mfma_f32_16x16x32_bf16 v[184:187], v[84:87], v[48:51], v[184:187]
    ds_read_b64_tr_b16 v[80:81], v240 offset:34176
    ds_read_b64_tr_b16 v[82:83], v240 offset:34688
    v_mfma_f32_16x16x32_bf16 a[204:207], v[84:87], v[40:43], a[204:207]
    v_exp_f32 v11, v11
    v_mfma_f32_16x16x32_bf16 a[200:203], v[84:87], v[32:35], a[200:203]
    v_cvt_pk_bf16_f32 v0, v0, v1
    s_waitcnt lgkmcnt(4)
    v_mfma_f32_16x16x32_bf16 a[208:211], v[88:91], v[32:35], a[208:211]
    v_exp_f32 v12, v12
    v_mfma_f32_16x16x32_bf16 a[212:215], v[88:91], v[40:43], a[212:215]
    ds_read_b64_tr_b16 v[84:85], v240 offset:34208
    ds_read_b64_tr_b16 v[86:87], v240 offset:34720
    v_mfma_f32_16x16x32_bf16 v[192:195], v[88:91], v[48:51], v[192:195]
    v_exp_f32 v13, v13
    v_mfma_f32_16x16x32_bf16 v[196:199], v[88:91], v[56:59], v[196:199]
    v_add_f32 v108, v108, v2
    s_waitcnt lgkmcnt(4)
    v_mfma_f32_16x16x32_bf16 v[204:207], v[92:95], v[56:59], v[204:207]
    buffer_load_dwordx4 v245, s[12:15], s53 offen offset:1056 lds
    v_mfma_f32_16x16x32_bf16 v[200:203], v[92:95], v[48:51], v[200:203]
    ds_read_b64_tr_b16 v[88:89], v240 offset:34240
    ds_read_b64_tr_b16 v[90:91], v240 offset:34752
    v_mfma_f32_16x16x32_bf16 a[220:223], v[92:95], v[40:43], a[220:223]
    v_exp_f32 v14, v14
    v_mfma_f32_16x16x32_bf16 a[216:219], v[92:95], v[32:35], a[216:219]
    v_add_f32 v108, v108, v3
    s_waitcnt lgkmcnt(4)
    v_mfma_f32_16x16x32_bf16 a[224:227], v[80:83], v[32:35], a[224:227]
    v_exp_f32 v15, v15
    v_mfma_f32_16x16x32_bf16 a[228:231], v[80:83], v[40:43], a[228:231]
    ds_read_b64_tr_b16 v[92:93], v240 offset:34272
    ds_read_b64_tr_b16 v[94:95], v240 offset:34784
    v_mfma_f32_16x16x32_bf16 v[208:211], v[80:83], v[48:51], v[208:211]
    v_exp_f32 v16, v16
    v_mfma_f32_16x16x32_bf16 v[212:215], v[80:83], v[56:59], v[212:215]
    v_cvt_pk_bf16_f32 v1, v2, v3
    s_waitcnt lgkmcnt(4)
    v_mfma_f32_16x16x32_bf16 v[220:223], v[84:87], v[56:59], v[220:223]
    buffer_load_dwordx4 v246, s[12:15], s53 offen offset:2112 lds
    v_mfma_f32_16x16x32_bf16 v[216:219], v[84:87], v[48:51], v[216:219]
    v_exp_f32 v17, v17
    v_mfma_f32_16x16x32_bf16 a[236:239], v[84:87], v[40:43], a[236:239]
    v_exp_f32 v18, v18
    v_mfma_f32_16x16x32_bf16 a[232:235], v[84:87], v[32:35], a[232:235]
    v_add_f32 v108, v108, v4
    s_waitcnt lgkmcnt(2)
    v_mfma_f32_16x16x32_bf16 a[240:243], v[88:91], v[32:35], a[240:243]
    s_waitcnt vmcnt(17) lgkmcnt(0)
    s_barrier
    v_mfma_f32_16x16x32_bf16 a[244:247], v[88:91], v[40:43], a[244:247]
    ds_read_b128 v[80:83], v243
    v_add_f32 v108, v108, v5
    v_mfma_f32_16x16x32_bf16 v[224:227], v[88:91], v[48:51], v[224:227]
    ds_read_b128 v[84:87], v243 offset:512
    v_cvt_pk_bf16_f32 v2, v4, v5
    v_mfma_f32_16x16x32_bf16 v[228:231], v[88:91], v[56:59], v[228:231]
    v_add_f32 v108, v108, v6
    v_mfma_f32_16x16x32_bf16 v[236:239], v[92:95], v[56:59], v[236:239]
    buffer_load_dwordx4 v247, s[12:15], s53 offen offset:3168 lds
    v_mfma_f32_16x16x32_bf16 v[232:235], v[92:95], v[48:51], v[232:235]
    ds_read_b128 v[88:91], v243 offset:64
    v_add_f32 v108, v108, v7
    v_mfma_f32_16x16x32_bf16 a[252:255], v[92:95], v[40:43], a[252:255]
    s_cmp_eq_u32 s52, 8
    s_cselect_b32 s48, s20, 0x7f000000
    v_mfma_f32_16x16x32_bf16 a[248:251], v[92:95], v[32:35], a[248:251]
    v_cvt_pk_bf16_f32 v3, v6, v7
    s_waitcnt lgkmcnt(2)
    v_mfma_f32_16x16x32_bf16 v[32:35], v[80:83], a[0:3], v[64:67]
    buffer_store_byte v252, off, s[4:7], s48 sc1
    v_mfma_f32_16x16x32_bf16 v[40:43], v[80:83], a[4:7], v[68:71]
    ds_read_b128 v[92:95], v243 offset:576
    v_add_f32 v109, v8, v9
    v_mfma_f32_16x16x32_bf16 v[48:51], v[80:83], a[8:11], v[72:75]
    v_exp_f32 v19, v19
    v_mfma_f32_16x16x32_bf16 v[56:59], v[80:83], a[12:15], v[76:79]
    s_waitcnt lgkmcnt(2)
    s_add_u32 m0, s47, 33792
    s_add_u32 s54, s54, 28672
    v_mfma_f32_16x16x32_bf16 v[60:63], v[84:87], a[12:15], v[76:79]
    buffer_load_dwordx4 v244, s[16:19], s54 offen lds
    v_mfma_f32_16x16x32_bf16 v[52:55], v[84:87], a[8:11], v[72:75]
    ds_read_b128 v[80:83], v243 offset:128
    v_cvt_pk_bf16_f32 v8, v8, v9
    v_mfma_f32_16x16x32_bf16 v[44:47], v[84:87], a[4:7], v[68:71]
    buffer_load_dword v97, v96, s[16:19], s54 offen
    v_mfma_f32_16x16x32_bf16 v[36:39], v[84:87], a[0:3], v[64:67]
    v_add_f32 v109, v109, v10
    s_waitcnt lgkmcnt(2)
    v_mfma_f32_16x16x32_bf16 v[32:35], v[88:91], a[16:19], v[32:35]
    v_exp_f32 v20, v20
    v_mfma_f32_16x16x32_bf16 v[40:43], v[88:91], a[20:23], v[40:43]
    ds_read_b128 v[84:87], v243 offset:640
    v_add_f32 v109, v109, v11
    v_mfma_f32_16x16x32_bf16 v[48:51], v[88:91], a[24:27], v[48:51]
    v_exp_f32 v21, v21
    v_mfma_f32_16x16x32_bf16 v[56:59], v[88:91], a[28:31], v[56:59]
    v_cvt_pk_bf16_f32 v9, v10, v11
    s_waitcnt lgkmcnt(2)
    v_mfma_f32_16x16x32_bf16 v[60:63], v[92:95], a[28:31], v[60:63]
    buffer_load_dwordx4 v245, s[16:19], s54 offen offset:1056 lds
    v_mfma_f32_16x16x32_bf16 v[52:55], v[92:95], a[24:27], v[52:55]
    ds_read_b128 v[88:91], v243 offset:192
    v_add_f32 v109, v109, v12
    v_mfma_f32_16x16x32_bf16 v[44:47], v[92:95], a[20:23], v[44:47]
    v_exp_f32 v22, v22
    v_mfma_f32_16x16x32_bf16 v[36:39], v[92:95], a[16:19], v[36:39]
    v_add_f32 v109, v109, v13
    s_waitcnt lgkmcnt(2)
    v_mfma_f32_16x16x32_bf16 v[32:35], v[80:83], a[32:35], v[32:35]
    v_lshlrev_b32 v251, 5, v250
    v_cvt_pk_bf16_f32 v10, v12, v13
    v_mfma_f32_16x16x32_bf16 v[40:43], v[80:83], a[36:39], v[40:43]
    ds_read_b128 v[92:95], v243 offset:704
    v_add_f32 v109, v109, v14
    v_mfma_f32_16x16x32_bf16 v[48:51], v[80:83], a[40:43], v[48:51]
    buffer_load_dword v97, v251, s[36:39], s49 offen sc1
    v_mfma_f32_16x16x32_bf16 v[56:59], v[80:83], a[44:47], v[56:59]
    v_add_f32 v109, v109, v15
    s_waitcnt lgkmcnt(2)
    v_mfma_f32_16x16x32_bf16 v[60:63], v[84:87], a[44:47], v[60:63]
    buffer_load_dwordx4 v246, s[16:19], s54 offen offset:2112 lds
    v_mfma_f32_16x16x32_bf16 v[52:55], v[84:87], a[40:43], v[52:55]
    ds_read_b128 v[80:83], v243 offset:256
    v_cvt_pk_bf16_f32 v11, v14, v15
    v_mfma_f32_16x16x32_bf16 v[44:47], v[84:87], a[36:39], v[44:47]
    v_exp_f32 v23, v23
    v_mfma_f32_16x16x32_bf16 v[36:39], v[84:87], a[32:35], v[36:39]
    v_add_f32 v110, v16, v17
    s_waitcnt lgkmcnt(2)
    v_mfma_f32_16x16x32_bf16 v[32:35], v[88:91], a[48:51], v[32:35]
    v_exp_f32 v24, v24
    v_mfma_f32_16x16x32_bf16 v[40:43], v[88:91], a[52:55], v[40:43]
    ds_read_b128 v[84:87], v243 offset:768
    v_cvt_pk_bf16_f32 v16, v16, v17
    v_mfma_f32_16x16x32_bf16 v[48:51], v[88:91], a[56:59], v[48:51]
    v_exp_f32 v25, v25
    v_mfma_f32_16x16x32_bf16 v[56:59], v[88:91], a[60:63], v[56:59]
    v_add_f32 v110, v110, v18
    s_waitcnt lgkmcnt(2)
    v_mfma_f32_16x16x32_bf16 v[60:63], v[92:95], a[60:63], v[60:63]
    buffer_load_dwordx4 v247, s[16:19], s54 offen offset:3168 lds
    v_mfma_f32_16x16x32_bf16 v[52:55], v[92:95], a[56:59], v[52:55]
    ds_read_b128 v[88:91], v243 offset:320
    v_add_f32 v110, v110, v19
    v_mfma_f32_16x16x32_bf16 v[44:47], v[92:95], a[52:55], v[44:47]
    v_exp_f32 v26, v26
    v_mfma_f32_16x16x32_bf16 v[36:39], v[92:95], a[48:51], v[36:39]
    v_cvt_pk_bf16_f32 v17, v18, v19
    s_waitcnt lgkmcnt(2)
    v_mfma_f32_16x16x32_bf16 v[32:35], v[80:83], a[64:67], v[32:35]
    v_exp_f32 v27, v27
    v_mfma_f32_16x16x32_bf16 v[40:43], v[80:83], a[68:71], v[40:43]
    ds_read_b128 v[92:95], v243 offset:832
    v_add_f32 v110, v110, v20
    v_mfma_f32_16x16x32_bf16 v[48:51], v[80:83], a[72:75], v[48:51]
    v_exp_f32 v28, v28
    v_mfma_f32_16x16x32_bf16 v[56:59], v[80:83], a[76:79], v[56:59]
    s_waitcnt lgkmcnt(2)
    s_add_u32 m0, s47, 38016
    s_add_u32 s54, s54, 4096
    v_mfma_f32_16x16x32_bf16 v[60:63], v[84:87], a[76:79], v[60:63]
    buffer_load_dwordx4 v244, s[16:19], s54 offen lds
    v_mfma_f32_16x16x32_bf16 v[52:55], v[84:87], a[72:75], v[52:55]
    ds_read_b128 v[80:83], v243 offset:384
    v_add_f32 v110, v110, v21
    v_mfma_f32_16x16x32_bf16 v[44:47], v[84:87], a[68:71], v[44:47]
    v_exp_f32 v29, v29
    v_mfma_f32_16x16x32_bf16 v[36:39], v[84:87], a[64:67], v[36:39]
    v_cvt_pk_bf16_f32 v18, v20, v21
    s_waitcnt lgkmcnt(2)
    v_mfma_f32_16x16x32_bf16 v[32:35], v[88:91], a[80:83], v[32:35]
    v_exp_f32 v30, v30
    v_mfma_f32_16x16x32_bf16 v[40:43], v[88:91], a[84:87], v[40:43]
    ds_read_b128 v[84:87], v243 offset:896
    v_add_f32 v110, v110, v22
    v_mfma_f32_16x16x32_bf16 v[48:51], v[88:91], a[88:91], v[48:51]
    v_exp_f32 v31, v31
    v_mfma_f32_16x16x32_bf16 v[56:59], v[88:91], a[92:95], v[56:59]
    v_add_f32 v110, v110, v23
    s_waitcnt lgkmcnt(2)
    v_mfma_f32_16x16x32_bf16 v[60:63], v[92:95], a[92:95], v[60:63]
    buffer_load_dwordx4 v245, s[16:19], s54 offen offset:1056 lds
    v_mfma_f32_16x16x32_bf16 v[52:55], v[92:95], a[88:91], v[52:55]
    ds_read_b128 v[88:91], v243 offset:448
    v_cvt_pk_bf16_f32 v19, v22, v23
    v_mfma_f32_16x16x32_bf16 v[44:47], v[92:95], a[84:87], v[44:47]
    v_add_f32 v111, v24, v25
    v_cvt_pk_bf16_f32 v24, v24, v25
    v_mfma_f32_16x16x32_bf16 v[36:39], v[92:95], a[80:83], v[36:39]
    v_add_f32 v111, v111, v26
    s_waitcnt lgkmcnt(2)
    v_mfma_f32_16x16x32_bf16 v[32:35], v[80:83], a[96:99], v[32:35]
    v_add_f32 v111, v111, v27
    v_cvt_pk_bf16_f32 v25, v26, v27
    v_mfma_f32_16x16x32_bf16 v[40:43], v[80:83], a[100:103], v[40:43]
    ds_read_b128 v[92:95], v243 offset:960
    v_add_f32 v111, v111, v28
    v_mfma_f32_16x16x32_bf16 v[48:51], v[80:83], a[104:107], v[48:51]
    v_add_f32 v111, v111, v29
    v_cvt_pk_bf16_f32 v26, v28, v29
    v_mfma_f32_16x16x32_bf16 v[56:59], v[80:83], a[108:111], v[56:59]
    v_add_f32 v111, v111, v30
    s_waitcnt lgkmcnt(2)
    v_mfma_f32_16x16x32_bf16 v[60:63], v[84:87], a[108:111], v[60:63]
    buffer_load_dwordx4 v246, s[16:19], s54 offen offset:2112 lds
    v_mfma_f32_16x16x32_bf16 v[52:55], v[84:87], a[104:107], v[52:55]
    v_add_f32 v111, v111, v31
    v_cvt_pk_bf16_f32 v27, v30, v31
    v_mfma_f32_16x16x32_bf16 v[44:47], v[84:87], a[100:103], v[44:47]
    v_max3_f32 v251, v108, v109, v110
    v_mfma_f32_16x16x32_bf16 v[36:39], v[84:87], a[96:99], v[36:39]
    v_max_f32 v251, v251, v111
    s_waitcnt lgkmcnt(1)
    v_mfma_f32_16x16x32_bf16 v[32:35], v[88:91], a[112:115], v[32:35]
    s_waitcnt vmcnt(19) lgkmcnt(0)
    s_barrier
    v_mfma_f32_16x16x32_bf16 v[40:43], v[88:91], a[116:119], v[40:43]
    ds_read_b64_tr_b16 v[80:81], v241 offset:33792
    ds_read_b64_tr_b16 v[82:83], v241 offset:34304
    v_mfma_f32_16x16x32_bf16 v[48:51], v[88:91], a[120:123], v[48:51]
    ds_read_b64_tr_b16 v[84:85], v241 offset:33824
    ds_read_b64_tr_b16 v[86:87], v241 offset:34336
    v_mfma_f32_16x16x32_bf16 v[56:59], v[88:91], a[124:127], v[56:59]
    v_cmp_nge_f32 vcc, s55, v251
    v_mfma_f32_16x16x32_bf16 v[60:63], v[92:95], a[124:127], v[60:63]
    buffer_load_dwordx4 v247, s[16:19], s54 offen offset:3168 lds
    v_mfma_f32_16x16x32_bf16 v[52:55], v[92:95], a[120:123], v[52:55]
    ds_read_b64_tr_b16 v[88:89], v241 offset:33856
    ds_read_b64_tr_b16 v[90:91], v241 offset:34368
    v_mfma_f32_16x16x32_bf16 v[44:47], v[92:95], a[116:119], v[44:47]
    v_mfma_f32_16x16x32_bf16 v[36:39], v[92:95], a[112:115], v[36:39]
    s_waitcnt lgkmcnt(4)
    s_cbranch_vccnz L_slow_l0
L_ret_l0:
    v_mfma_f32_16x16x32_bf16 a[128:131], v[80:83], v[0:3], a[128:131]
    v_exp_f32 v32, v32
    v_mfma_f32_16x16x32_bf16 a[132:135], v[80:83], v[8:11], a[132:135]
    ds_read_b64_tr_b16 v[92:93], v241 offset:33888
    ds_read_b64_tr_b16 v[94:95], v241 offset:34400
    v_mfma_f32_16x16x32_bf16 v[112:115], v[80:83], v[16:19], v[112:115]
    v_exp_f32 v33, v33
    v_mfma_f32_16x16x32_bf16 v[116:119], v[80:83], v[24:27], v[116:119]
    s_waitcnt lgkmcnt(4)
    s_add_u32 m0, s47, 67584
    s_add_u32 s53, s53, 28672
    v_mfma_f32_16x16x32_bf16 v[124:127], v[84:87], v[24:27], v[124:127]
    buffer_load_dwordx4 v244, s[12:15], s53 offen lds
    v_mfma_f32_16x16x32_bf16 v[120:123], v[84:87], v[16:19], v[120:123]
    ds_read_b64_tr_b16 v[80:81], v241 offset:33920
    ds_read_b64_tr_b16 v[82:83], v241 offset:34432
    v_mfma_f32_16x16x32_bf16 a[140:143], v[84:87], v[8:11], a[140:143]
    v_exp_f32 v34, v34
    v_mfma_f32_16x16x32_bf16 a[136:139], v[84:87], v[0:3], a[136:139]
    v_add_f32 v104, v104, v108
    s_waitcnt lgkmcnt(4)
    v_mfma_f32_16x16x32_bf16 a[144:147], v[88:91], v[0:3], a[144:147]
    v_exp_f32 v35, v35
    v_mfma_f32_16x16x32_bf16 a[148:151], v[88:91], v[8:11], a[148:151]
    ds_read_b64_tr_b16 v[84:85], v241 offset:33952
    ds_read_b64_tr_b16 v[86:87], v241 offset:34464
    v_mfma_f32_16x16x32_bf16 v[128:131], v[88:91], v[16:19], v[128:131]
    v_exp_f32 v36, v36
    v_mfma_f32_16x16x32_bf16 v[132:135], v[88:91], v[24:27], v[132:135]
    v_add_f32 v105, v105, v109
    s_waitcnt lgkmcnt(4)
    v_mfma_f32_16x16x32_bf16 v[140:143], v[92:95], v[24:27], v[140:143]
    buffer_load_dwordx4 v245, s[12:15], s53 offen offset:1056 lds
    v_mfma_f32_16x16x32_bf16 v[136:139], v[92:95], v[16:19], v[136:139]
    ds_read_b64_tr_b16 v[88:89], v241 offset:33984
    ds_read_b64_tr_b16 v[90:91], v241 offset:34496
    v_mfma_f32_16x16x32_bf16 a[156:159], v[92:95], v[8:11], a[156:159]
    v_exp_f32 v37, v37
    v_mfma_f32_16x16x32_bf16 a[152:155], v[92:95], v[0:3], a[152:155]
    v_add_f32 v106, v106, v110
    s_waitcnt lgkmcnt(4)
    v_mfma_f32_16x16x32_bf16 a[160:163], v[80:83], v[0:3], a[160:163]
    v_exp_f32 v38, v38
    v_mfma_f32_16x16x32_bf16 a[164:167], v[80:83], v[8:11], a[164:167]
    ds_read_b64_tr_b16 v[92:93], v241 offset:34016
    ds_read_b64_tr_b16 v[94:95], v241 offset:34528
    v_mfma_f32_16x16x32_bf16 v[144:147], v[80:83], v[16:19], v[144:147]
    v_exp_f32 v39, v39
    v_mfma_f32_16x16x32_bf16 v[148:151], v[80:83], v[24:27], v[148:151]
    v_add_f32 v107, v107, v111
    s_waitcnt lgkmcnt(4)
    v_mfma_f32_16x16x32_bf16 v[156:159], v[84:87], v[24:27], v[156:159]
    buffer_load_dwordx4 v246, s[12:15], s53 offen offset:2112 lds
    v_mfma_f32_16x16x32_bf16 v[152:155], v[84:87], v[16:19], v[152:155]
    ds_read_b64_tr_b16 v[80:81], v241 offset:34048
    ds_read_b64_tr_b16 v[82:83], v241 offset:34560
    v_mfma_f32_16x16x32_bf16 a[172:175], v[84:87], v[8:11], a[172:175]
    ds_read_b128 v[100:103], v98
    v_add_f32 v108, v32, v33
    v_mfma_f32_16x16x32_bf16 a[168:171], v[84:87], v[0:3], a[168:171]
    v_cvt_pk_bf16_f32 v32, v32, v33
    s_waitcnt lgkmcnt(5)
    v_mfma_f32_16x16x32_bf16 a[176:179], v[88:91], v[0:3], a[176:179]
    v_exp_f32 v40, v40
    v_mfma_f32_16x16x32_bf16 a[180:183], v[88:91], v[8:11], a[180:183]
    ds_read_b64_tr_b16 v[84:85], v241 offset:34080
    ds_read_b64_tr_b16 v[86:87], v241 offset:34592
    v_mfma_f32_16x16x32_bf16 v[160:163], v[88:91], v[16:19], v[160:163]
    s_cmp_lt_u32 s52, 7
    s_cselect_b32 s48, s56, 0x7f000000
    s_cselect_b32 s49, 0x7f000000, s88
    v_mfma_f32_16x16x32_bf16 v[164:167], v[88:91], v[24:27], v[164:167]
    v_add_f32 v108, v108, v34
    s_waitcnt lgkmcnt(5)
    v_mfma_f32_16x16x32_bf16 v[172:175], v[92:95], v[24:27], v[172:175]
    buffer_load_dwordx4 v247, s[12:15], s53 offen offset:3168 lds
    v_mfma_f32_16x16x32_bf16 v[168:171], v[92:95], v[16:19], v[168:171]
    ds_read_b64_tr_b16 v[88:89], v241 offset:34112
    ds_read_b64_tr_b16 v[90:91], v241 offset:34624
    v_mfma_f32_16x16x32_bf16 a[188:191], v[92:95], v[8:11], a[188:191]
    v_add_u32 v98, 1024, v98
    s_add_u32 s56, s56, 256
    v_mfma_f32_16x16x32_bf16 a[184:187], v[92:95], v[0:3], a[184:187]
    v_add_f32 v108, v108, v35
    s_waitcnt lgkmcnt(5)
    v_mfma_f32_16x16x32_bf16 a[192:195], v[80:83], v[0:3], a[192:195]
    v_exp_f32 v41, v41
    v_mfma_f32_16x16x32_bf16 a[196:199], v[80:83], v[8:11], a[196:199]
    ds_read_b64_tr_b16 v[92:93], v241 offset:34144
    ds_read_b64_tr_b16 v[94:95], v241 offset:34656
    v_mfma_f32_16x16x32_bf16 v[176:179], v[80:83], v[16:19], v[176:179]
    v_exp_f32 v42, v42
    v_mfma_f32_16x16x32_bf16 v[180:183], v[80:83], v[24:27], v[180:183]
    s_waitcnt lgkmcnt(4)
    s_add_u32 m0, s47, 71808
    s_add_u32 s53, s53, 4096
    v_mfma_f32_16x16x32_bf16 v[188:191], v[84:87], v[24:27], v[188:191]
    buffer_load_dwordx4 v244, s[12:15], s53 offen lds
    v_mfma_f32_16x16x32_bf16 v[184:187], v[84:87], v[16:19], v[184:187]
    ds_read_b64_tr_b16 v[80:81], v241 offset:34176
    ds_read_b64_tr_b16 v[82:83], v241 offset:34688
    v_mfma_f32_16x16x32_bf16 a[204:207], v[84:87], v[8:11], a[204:207]
    buffer_store_dwordx4 v[100:103], v99, s[36:39], s48 offen sc1
    v_mfma_f32_16x16x32_bf16 a[200:203], v[84:87], v[0:3], a[200:203]
    v_cvt_pk_bf16_f32 v33, v34, v35
    s_waitcnt lgkmcnt(4)
    v_mfma_f32_16x16x32_bf16 a[208:211], v[88:91], v[0:3], a[208:211]
    v_exp_f32 v43, v43
    v_mfma_f32_16x16x32_bf16 a[212:215], v[88:91], v[8:11], a[212:215]
    ds_read_b64_tr_b16 v[84:85], v241 offset:34208
    ds_read_b64_tr_b16 v[86:87], v241 offset:34720
    v_mfma_f32_16x16x32_bf16 v[192:195], v[88:91], v[16:19], v[192:195]
    v_exp_f32 v44, v44
    v_mfma_f32_16x16x32_bf16 v[196:199], v[88:91], v[24:27], v[196:199]
    v_add_f32 v108, v108, v36
    s_waitcnt lgkmcnt(4)
    v_mfma_f32_16x16x32_bf16 v[204:207], v[92:95], v[24:27], v[204:207]
    buffer_load_dwordx4 v245, s[12:15], s53 offen offset:1056 lds
    v_mfma_f32_16x16x32_bf16 v[200:203], v[92:95], v[16:19], v[200:203]
    ds_read_b64_tr_b16 v[88:89], v241 offset:34240
    ds_read_b64_tr_b16 v[90:91], v241 offset:34752
    v_mfma_f32_16x16x32_bf16 a[220:223], v[92:95], v[8:11], a[220:223]
    buffer_load_dword v97, v96, s[28:31], s49 offen
    s_add_u32 s88, s88, 65536
    v_mfma_f32_16x16x32_bf16 a[216:219], v[92:95], v[0:3], a[216:219]
    v_add_f32 v108, v108, v37
    s_waitcnt lgkmcnt(4)
    v_mfma_f32_16x16x32_bf16 a[224:227], v[80:83], v[0:3], a[224:227]
    v_exp_f32 v45, v45
    v_mfma_f32_16x16x32_bf16 a[228:231], v[80:83], v[8:11], a[228:231]
    ds_read_b64_tr_b16 v[92:93], v241 offset:34272
    ds_read_b64_tr_b16 v[94:95], v241 offset:34784
    v_mfma_f32_16x16x32_bf16 v[208:211], v[80:83], v[16:19], v[208:211]
    v_exp_f32 v46, v46
    v_mfma_f32_16x16x32_bf16 v[212:215], v[80:83], v[24:27], v[212:215]
    v_cvt_pk_bf16_f32 v34, v36, v37
    s_waitcnt lgkmcnt(4)
    v_mfma_f32_16x16x32_bf16 v[220:223], v[84:87], v[24:27], v[220:223]
    buffer_load_dwordx4 v246, s[12:15], s53 offen offset:2112 lds
    v_mfma_f32_16x16x32_bf16 v[216:219], v[84:87], v[16:19], v[216:219]
    v_exp_f32 v47, v47
    v_mfma_f32_16x16x32_bf16 a[236:239], v[84:87], v[8:11], a[236:239]
    v_exp_f32 v48, v48
    v_mfma_f32_16x16x32_bf16 a[232:235], v[84:87], v[0:3], a[232:235]
    v_add_f32 v108, v108, v38
    s_waitcnt lgkmcnt(2)
    v_mfma_f32_16x16x32_bf16 a[240:243], v[88:91], v[0:3], a[240:243]
    s_waitcnt vmcnt(20) lgkmcnt(0)
    s_barrier
    v_mfma_f32_16x16x32_bf16 a[244:247], v[88:91], v[8:11], a[244:247]
    ds_read_b128 v[80:83], v242
    v_add_f32 v108, v108, v39
    v_mfma_f32_16x16x32_bf16 v[224:227], v[88:91], v[16:19], v[224:227]
    ds_read_b128 v[84:87], v242 offset:512
    v_cvt_pk_bf16_f32 v35, v38, v39
    v_mfma_f32_16x16x32_bf16 v[228:231], v[88:91], v[24:27], v[228:231]
    v_add_f32 v109, v40, v41
    v_mfma_f32_16x16x32_bf16 v[236:239], v[92:95], v[24:27], v[236:239]
    buffer_load_dwordx4 v247, s[12:15], s53 offen offset:3168 lds
    v_mfma_f32_16x16x32_bf16 v[232:235], v[92:95], v[16:19], v[232:235]
    ds_read_b128 v[88:91], v242 offset:64
    v_cvt_pk_bf16_f32 v40, v40, v41
    v_mfma_f32_16x16x32_bf16 a[252:255], v[92:95], v[8:11], a[252:255]
    v_exp_f32 v49, v49
    v_mfma_f32_16x16x32_bf16 a[248:251], v[92:95], v[0:3], a[248:251]
    v_add_f32 v109, v109, v42
    s_waitcnt lgkmcnt(2)
    v_mfma_f32_16x16x32_bf16 v[0:3], v[80:83], a[0:3], v[64:67]
    v_exp_f32 v50, v50
    v_mfma_f32_16x16x32_bf16 v[8:11], v[80:83], a[4:7], v[68:71]
    ds_read_b128 v[92:95], v242 offset:576
    v_add_f32 v109, v109, v43
    v_mfma_f32_16x16x32_bf16 v[16:19], v[80:83], a[8:11], v[72:75]
    v_exp_f32 v51, v51
    v_mfma_f32_16x16x32_bf16 v[24:27], v[80:83], a[12:15], v[76:79]
    s_waitcnt lgkmcnt(2)
    s_add_u32 m0, s47, 101376
    s_add_u32 s54, s54, 28672
    v_mfma_f32_16x16x32_bf16 v[28:31], v[84:87], a[12:15], v[76:79]
    buffer_load_dwordx4 v244, s[16:19], s54 offen lds
    v_mfma_f32_16x16x32_bf16 v[20:23], v[84:87], a[8:11], v[72:75]
    ds_read_b128 v[80:83], v242 offset:128
    v_cvt_pk_bf16_f32 v41, v42, v43
    v_mfma_f32_16x16x32_bf16 v[12:15], v[84:87], a[4:7], v[68:71]
    buffer_load_dword v97, v96, s[12:15], s53 offen
    v_mfma_f32_16x16x32_bf16 v[4:7], v[84:87], a[0:3], v[64:67]
    v_add_f32 v109, v109, v44
    s_waitcnt lgkmcnt(2)
    v_mfma_f32_16x16x32_bf16 v[0:3], v[88:91], a[16:19], v[0:3]
    v_exp_f32 v52, v52
    v_mfma_f32_16x16x32_bf16 v[8:11], v[88:91], a[20:23], v[8:11]
    ds_read_b128 v[84:87], v242 offset:640
    v_add_f32 v109, v109, v45
    v_mfma_f32_16x16x32_bf16 v[16:19], v[88:91], a[24:27], v[16:19]
    v_exp_f32 v53, v53
    v_mfma_f32_16x16x32_bf16 v[24:27], v[88:91], a[28:31], v[24:27]
    v_cvt_pk_bf16_f32 v42, v44, v45
    s_waitcnt lgkmcnt(2)
    v_mfma_f32_16x16x32_bf16 v[28:31], v[92:95], a[28:31], v[28:31]
    buffer_load_dwordx4 v245, s[16:19], s54 offen offset:1056 lds
    v_mfma_f32_16x16x32_bf16 v[20:23], v[92:95], a[24:27], v[20:23]
    ds_read_b128 v[88:91], v242 offset:192
    v_add_f32 v109, v109, v46
    v_mfma_f32_16x16x32_bf16 v[12:15], v[92:95], a[20:23], v[12:15]
    v_exp_f32 v54, v54
    v_mfma_f32_16x16x32_bf16 v[4:7], v[92:95], a[16:19], v[4:7]
    v_add_f32 v109, v109, v47
    s_waitcnt lgkmcnt(2)
    v_mfma_f32_16x16x32_bf16 v[0:3], v[80:83], a[32:35], v[0:3]
    v_exp_f32 v55, v55
    v_mfma_f32_16x16x32_bf16 v[8:11], v[80:83], a[36:39], v[8:11]
    ds_read_b128 v[92:95], v242 offset:704
    v_cvt_pk_bf16_f32 v43, v46, v47
    v_mfma_f32_16x16x32_bf16 v[16:19], v[80:83], a[40:43], v[16:19]
    v_exp_f32 v56, v56
    v_mfma_f32_16x16x32_bf16 v[24:27], v[80:83], a[44:47], v[24:27]
    v_add_f32 v110, v48, v49
    s_waitcnt lgkmcnt(2)
    v_mfma_f32_16x16x32_bf16 v[28:31], v[84:87], a[44:47], v[28:31]
    buffer_load_dwordx4 v246, s[16:19], s54 offen offset:2112 lds
    v_mfma_f32_16x16x32_bf16 v[20:23], v[84:87], a[40:43], v[20:23]
    ds_read_b128 v[80:83], v242 offset:256
    v_cvt_pk_bf16_f32 v48, v48, v49
    v_mfma_f32_16x16x32_bf16 v[12:15], v[84:87], a[36:39], v[12:15]
    v_exp_f32 v57, v57
    v_mfma_f32_16x16x32_bf16 v[4:7], v[84:87], a[32:35], v[4:7]
    v_add_f32 v110, v110, v50
    s_waitcnt lgkmcnt(2)
    v_mfma_f32_16x16x32_bf16 v[0:3], v[88:91], a[48:51], v[0:3]
    v_exp_f32 v58, v58
    v_mfma_f32_16x16x32_bf16 v[8:11], v[88:91], a[52:55], v[8:11]
    ds_read_b128 v[84:87], v242 offset:768
    v_add_f32 v110, v110, v51
    v_mfma_f32_16x16x32_bf16 v[16:19], v[88:91], a[56:59], v[16:19]
    v_exp_f32 v59, v59
    v_mfma_f32_16x16x32_bf16 v[24:27], v[88:91], a[60:63], v[24:27]
    v_cvt_pk_bf16_f32 v49, v50, v51
    s_waitcnt lgkmcnt(2)
    v_mfma_f32_16x16x32_bf16 v[28:31], v[92:95], a[60:63], v[28:31]
    buffer_load_dwordx4 v247, s[16:19], s54 offen offset:3168 lds
    v_mfma_f32_16x16x32_bf16 v[20:23], v[92:95], a[56:59], v[20:23]
    ds_read_b128 v[88:91], v242 offset:320
    v_add_f32 v110, v110, v52
    v_mfma_f32_16x16x32_bf16 v[12:15], v[92:95], a[52:55], v[12:15]
    v_exp_f32 v60, v60
    v_mfma_f32_16x16x32_bf16 v[4:7], v[92:95], a[48:51], v[4:7]
    v_add_f32 v110, v110, v53
    s_waitcnt lgkmcnt(2)
    v_mfma_f32_16x16x32_bf16 v[0:3], v[80:83], a[64:67], v[0:3]
    v_exp_f32 v61, v61
    v_mfma_f32_16x16x32_bf16 v[8:11], v[80:83], a[68:71], v[8:11]
    ds_read_b128 v[92:95], v242 offset:832
    v_cvt_pk_bf16_f32 v50, v52, v53
    v_mfma_f32_16x16x32_bf16 v[16:19], v[80:83], a[72:75], v[16:19]
    v_exp_f32 v62, v62
    v_mfma_f32_16x16x32_bf16 v[24:27], v[80:83], a[76:79], v[24:27]
    s_waitcnt lgkmcnt(2)
    s_add_u32 m0, s47, 105600
    s_add_u32 s54, s54, 4096
    v_mfma_f32_16x16x32_bf16 v[28:31], v[84:87], a[76:79], v[28:31]
    buffer_load_dwordx4 v244, s[16:19], s54 offen lds
    v_mfma_f32_16x16x32_bf16 v[20:23], v[84:87], a[72:75], v[20:23]
    ds_read_b128 v[80:83], v242 offset:384
    v_add_f32 v110, v110, v54
    v_mfma_f32_16x16x32_bf16 v[12:15], v[84:87], a[68:71], v[12:15]
    v_exp_f32 v63, v63
    v_mfma_f32_16x16x32_bf16 v[4:7], v[84:87], a[64:67], v[4:7]
    v_add_f32 v110, v110, v55
    s_waitcnt lgkmcnt(2)
    v_mfma_f32_16x16x32_bf16 v[0:3], v[88:91], a[80:83], v[0:3]
    v_cvt_pk_bf16_f32 v51, v54, v55
    v_add_f32 v111, v56, v57
    v_mfma_f32_16x16x32_bf16 v[8:11], v[88:91], a[84:87], v[8:11]
    ds_read_b128 v[84:87], v242 offset:896
    v_cvt_pk_bf16_f32 v56, v56, v57
    v_mfma_f32_16x16x32_bf16 v[16:19], v[88:91], a[88:91], v[16:19]
    v_add_f32 v111, v111, v58
    v_cvt_pk_bf16_f32 v57, v58, v59
    v_mfma_f32_16x16x32_bf16 v[24:27], v[88:91], a[92:95], v[24:27]
    v_add_f32 v111, v111, v59
    s_waitcnt lgkmcnt(2)
    v_mfma_f32_16x16x32_bf16 v[28:31], v[92:95], a[92:95], v[28:31]
    buffer_load_dwordx4 v245, s[16:19], s54 offen offset:1056 lds
    v_mfma_f32_16x16x32_bf16 v[20:23], v[92:95], a[88:91], v[20:23]
    ds_read_b128 v[88:91], v242 offset:448
    v_add_f32 v111, v111, v60
    v_mfma_f32_16x16x32_bf16 v[12:15], v[92:95], a[84:87], v[12:15]
    v_add_f32 v111, v111, v61
    v_cvt_pk_bf16_f32 v58, v60, v61
    v_mfma_f32_16x16x32_bf16 v[4:7], v[92:95], a[80:83], v[4:7]
    v_add_f32 v111, v111, v62
    s_waitcnt lgkmcnt(2)
    v_mfma_f32_16x16x32_bf16 v[0:3], v[80:83], a[96:99], v[0:3]
    v_add_f32 v111, v111, v63
    v_cvt_pk_bf16_f32 v59, v62, v63
    v_mfma_f32_16x16x32_bf16 v[8:11], v[80:83], a[100:103], v[8:11]
    ds_read_b128 v[92:95], v242 offset:960
    v_max3_f32 v251, v108, v109, v110
    v_mfma_f32_16x16x32_bf16 v[16:19], v[80:83], a[104:107], v[16:19]
    v_max_f32 v251, v251, v111
    v_mfma_f32_16x16x32_bf16 v[24:27], v[80:83], a[108:111], v[24:27]
    v_cmp_nge_f32 vcc, s55, v251
    s_waitcnt lgkmcnt(2)
    v_mfma_f32_16x16x32_bf16 v[28:31], v[84:87], a[108:111], v[28:31]
    buffer_load_dwordx4 v246, s[16:19], s54 offen offset:2112 lds
    v_mfma_f32_16x16x32_bf16 v[20:23], v[84:87], a[104:107], v[20:23]
    v_mfma_f32_16x16x32_bf16 v[12:15], v[84:87], a[100:103], v[12:15]
    v_mfma_f32_16x16x32_bf16 v[4:7], v[84:87], a[96:99], v[4:7]
    s_waitcnt lgkmcnt(1)
    v_mfma_f32_16x16x32_bf16 v[0:3], v[88:91], a[112:115], v[0:3]
    s_waitcnt vmcnt(18) lgkmcnt(0)
    s_barrier
    s_add_u32 s52, s52, 1
    v_mfma_f32_16x16x32_bf16 v[8:11], v[88:91], a[116:119], v[8:11]
    ds_read_b64_tr_b16 v[80:81], v240 offset:33792
    ds_read_b64_tr_b16 v[82:83], v240 offset:34304
    v_mfma_f32_16x16x32_bf16 v[16:19], v[88:91], a[120:123], v[16:19]
    ds_read_b64_tr_b16 v[84:85], v240 offset:33824
    ds_read_b64_tr_b16 v[86:87], v240 offset:34336
    v_mfma_f32_16x16x32_bf16 v[24:27], v[88:91], a[124:127], v[24:27]
    v_mfma_f32_16x16x32_bf16 v[28:31], v[92:95], a[124:127], v[28:31]
    buffer_load_dwordx4 v247, s[16:19], s54 offen offset:3168 lds
    s_cmp_lt_u32 s52, 14
    v_mfma_f32_16x16x32_bf16 v[20:23], v[92:95], a[120:123], v[20:23]
    ds_read_b64_tr_b16 v[88:89], v240 offset:33856
    ds_read_b64_tr_b16 v[90:91], v240 offset:34368
    v_mfma_f32_16x16x32_bf16 v[12:15], v[92:95], a[116:119], v[12:15]
    v_mfma_f32_16x16x32_bf16 v[4:7], v[92:95], a[112:115], v[4:7]
    s_waitcnt lgkmcnt(4)
    s_cbranch_vccnz L_slow_l1
L_ret_l1:
    s_cbranch_scc1 L_loop
    v_mfma_f32_16x16x32_bf16 a[128:131], v[80:83], v[32:35], a[128:131]
    v_and_b32 v98, 4, v250
    v_lshrrev_b32 v252, 3, v250
    v_mfma_f32_16x16x32_bf16 a[132:135], v[80:83], v[40:43], a[132:135]
    ds_read_b64_tr_b16 v[92:93], v240 offset:33888
    ds_read_b64_tr_b16 v[94:95], v240 offset:34400
    v_mfma_f32_16x16x32_bf16 v[112:115], v[80:83], v[48:51], v[112:115]
    s_lshl_b32 s48, s46, 3
    v_mul_u32_u24 v252, 896, v252
    v_add_f32 v104, v104, v108
    v_mfma_f32_16x16x32_bf16 v[116:119], v[80:83], v[56:59], v[116:119]
    v_lshrrev_b32 v254, 3, v250
    s_waitcnt lgkmcnt(4)
    v_mfma_f32_16x16x32_bf16 v[124:127], v[84:87], v[56:59], v[124:127]
    buffer_load_dword v97, v98, s[4:7], s48 offen sc1
    v_mfma_f32_16x16x32_bf16 v[120:123], v[84:87], v[48:51], v[120:123]
    ds_read_b64_tr_b16 v[80:81], v240 offset:33920
    ds_read_b64_tr_b16 v[82:83], v240 offset:34432
    v_add_f32 v105, v105, v109
    v_mfma_f32_16x16x32_bf16 a[140:143], v[84:87], v[40:43], a[140:143]
    v_xor_b32 v254, v254, v250
    v_and_b32 v254, 6, v254
    v_mfma_f32_16x16x32_bf16 a[136:139], v[84:87], v[32:35], a[136:139]
    v_lshl_add_u32 v252, v254, 4, v252
    s_waitcnt lgkmcnt(4)
    v_mfma_f32_16x16x32_bf16 a[144:147], v[88:91], v[32:35], a[144:147]
    v_and_b32 v254, 1, v250
    v_lshl_add_u32 v252, v254, 4, v252
    v_add_f32 v106, v106, v110
    v_mfma_f32_16x16x32_bf16 a[148:151], v[88:91], v[40:43], a[148:151]
    ds_read_b64_tr_b16 v[84:85], v240 offset:33952
    ds_read_b64_tr_b16 v[86:87], v240 offset:34464
    v_mfma_f32_16x16x32_bf16 v[128:131], v[88:91], v[48:51], v[128:131]
    s_lshl_b32 s51, s45, 4
    s_add_u32 s51, s51, s44
    s_mul_i32 s51, s51, 28672
    s_lshl_b32 s84, s44, 12
    v_mfma_f32_16x16x32_bf16 v[132:135], v[88:91], v[56:59], v[132:135]
    v_add_u32 v252, s51, v252
    v_add_f32 v107, v107, v111
    s_waitcnt lgkmcnt(4)
    v_mfma_f32_16x16x32_bf16 v[140:143], v[92:95], v[56:59], v[140:143]
    v_add_u32 v253, 6144, v252
    v_add_u32 v254, 12288, v252
    v_mfma_f32_16x16x32_bf16 v[136:139], v[92:95], v[48:51], v[136:139]
    ds_read_b64_tr_b16 v[88:89], v240 offset:33984
    ds_read_b64_tr_b16 v[90:91], v240 offset:34496
    v_mfma_f32_16x16x32_bf16 a[156:159], v[92:95], v[40:43], a[156:159]
    v_add_u32 v255, 18432, v252
    v_exp_f32 v0, v0
    v_mfma_f32_16x16x32_bf16 a[152:155], v[92:95], v[32:35], a[152:155]
    s_waitcnt lgkmcnt(4)
    v_mfma_f32_16x16x32_bf16 a[160:163], v[80:83], v[32:35], a[160:163]
    v_exp_f32 v1, v1
    v_mfma_f32_16x16x32_bf16 a[164:167], v[80:83], v[40:43], a[164:167]
    ds_read_b64_tr_b16 v[92:93], v240 offset:34016
    ds_read_b64_tr_b16 v[94:95], v240 offset:34528
    v_mfma_f32_16x16x32_bf16 v[144:147], v[80:83], v[48:51], v[144:147]
    v_exp_f32 v2, v2
    v_mfma_f32_16x16x32_bf16 v[148:151], v[80:83], v[56:59], v[148:151]
    v_exp_f32 v3, v3
    s_waitcnt lgkmcnt(4)
    v_mfma_f32_16x16x32_bf16 v[156:159], v[84:87], v[56:59], v[156:159]
    v_exp_f32 v4, v4
    v_mfma_f32_16x16x32_bf16 v[152:155], v[84:87], v[48:51], v[152:155]
    ds_read_b64_tr_b16 v[80:81], v240 offset:34048
    ds_read_b64_tr_b16 v[82:83], v240 offset:34560
    v_mfma_f32_16x16x32_bf16 a[172:175], v[84:87], v[40:43], a[172:175]
    v_exp_f32 v5, v5
    v_add_f32 v108, v0, v1
    v_mfma_f32_16x16x32_bf16 a[168:171], v[84:87], v[32:35], a[168:171]
    s_waitcnt lgkmcnt(4)
    s_add_u32 m0, s84, 135168
    s_mov_b32 s62, 0x00000000
    v_mfma_f32_16x16x32_bf16 a[176:179], v[88:91], v[32:35], a[176:179]
    buffer_load_dwordx4 v252, s[24:27], s62 offen lds
    v_mfma_f32_16x16x32_bf16 a[180:183], v[88:91], v[40:43], a[180:183]
    ds_read_b64_tr_b16 v[84:85], v240 offset:34080
    ds_read_b64_tr_b16 v[86:87], v240 offset:34592
    v_cvt_pk_bf16_f32 v0, v0, v1
    v_mfma_f32_16x16x32_bf16 v[160:163], v[88:91], v[48:51], v[160:163]
    v_exp_f32 v6, v6
    v_mfma_f32_16x16x32_bf16 v[164:167], v[88:91], v[56:59], v[164:167]
    v_add_f32 v108, v108, v2
    s_waitcnt lgkmcnt(4)
    v_mfma_f32_16x16x32_bf16 v[172:175], v[92:95], v[56:59], v[172:175]
    buffer_load_dwordx4 v253, s[24:27], s62 offen offset:1024 lds
    v_add_f32 v108, v108, v3
    v_mfma_f32_16x16x32_bf16 v[168:171], v[92:95], v[48:51], v[168:171]
    ds_read_b64_tr_b16 v[88:89], v240 offset:34112
    ds_read_b64_tr_b16 v[90:91], v240 offset:34624
    v_mfma_f32_16x16x32_bf16 a[188:191], v[92:95], v[40:43], a[188:191]
    buffer_load_dwordx4 v254, s[24:27], s62 offen offset:2048 lds
    v_mfma_f32_16x16x32_bf16 a[184:187], v[92:95], v[32:35], a[184:187]
    v_lshrrev_b32 v96, 2, v250
    v_cvt_pk_bf16_f32 v1, v2, v3
    s_waitcnt lgkmcnt(4)
    v_mfma_f32_16x16x32_bf16 a[192:195], v[80:83], v[32:35], a[192:195]
    v_lshlrev_b32 v96, 7, v96
    v_bfe_u32 v100, v250, 3, 2
    v_mfma_f32_16x16x32_bf16 a[196:199], v[80:83], v[40:43], a[196:199]
    ds_read_b64_tr_b16 v[92:93], v240 offset:34144
    ds_read_b64_tr_b16 v[94:95], v240 offset:34656
    v_mfma_f32_16x16x32_bf16 v[176:179], v[80:83], v[48:51], v[176:179]
    buffer_load_dwordx4 v255, s[24:27], s62 offen offset:3072 lds
    v_add_f32 v108, v108, v4
    v_mfma_f32_16x16x32_bf16 v[180:183], v[80:83], v[56:59], v[180:183]
    v_xor_b32 v100, s44, v100
    s_waitcnt lgkmcnt(4)
    v_mfma_f32_16x16x32_bf16 v[188:191], v[84:87], v[56:59], v[188:191]
    v_lshl_add_u32 v96, v100, 5, v96
    v_and_b32 v100, 3, v250
    v_mfma_f32_16x16x32_bf16 v[184:187], v[84:87], v[48:51], v[184:187]
    ds_read_b64_tr_b16 v[80:81], v240 offset:34176
    ds_read_b64_tr_b16 v[82:83], v240 offset:34688
    s_add_u32 m0, s84, 0
    s_mov_b32 s63, 0x0001c000
    v_mfma_f32_16x16x32_bf16 a[204:207], v[84:87], v[40:43], a[204:207]
    buffer_load_dwordx4 v252, s[24:27], s63 offen lds
    v_mfma_f32_16x16x32_bf16 a[200:203], v[84:87], v[32:35], a[200:203]
    v_lshl_add_u32 v96, v100, 3, v96
    v_add_f32 v108, v108, v5
    s_waitcnt lgkmcnt(4)
    v_mfma_f32_16x16x32_bf16 a[208:211], v[88:91], v[32:35], a[208:211]
    buffer_load_dwordx4 v253, s[24:27], s63 offen offset:1024 lds
    v_mfma_f32_16x16x32_bf16 a[212:215], v[88:91], v[40:43], a[212:215]
    ds_read_b64_tr_b16 v[84:85], v240 offset:34208
    ds_read_b64_tr_b16 v[86:87], v240 offset:34720
    v_mfma_f32_16x16x32_bf16 v[192:195], v[88:91], v[48:51], v[192:195]
    v_and_b32 v98, 1, v250
    v_lshlrev_b32 v98, 4, v98
    v_cvt_pk_bf16_f32 v2, v4, v5
    v_mfma_f32_16x16x32_bf16 v[196:199], v[88:91], v[56:59], v[196:199]
    v_mov_b32 v99, 0x3f80
    s_waitcnt lgkmcnt(4)
    v_mfma_f32_16x16x32_bf16 v[204:207], v[92:95], v[56:59], v[204:207]
    buffer_load_dwordx4 v254, s[24:27], s63 offen offset:2048 lds
    v_mfma_f32_16x16x32_bf16 v[200:203], v[92:95], v[48:51], v[200:203]
    ds_read_b64_tr_b16 v[88:89], v240 offset:34240
    ds_read_b64_tr_b16 v[90:91], v240 offset:34752
    v_add_f32 v108, v108, v6
    v_mfma_f32_16x16x32_bf16 a[220:223], v[92:95], v[40:43], a[220:223]
    v_lshlrev_b32 v99, v98, v99
    v_lshrrev_b32 v102, 4, v250
    v_mfma_f32_16x16x32_bf16 a[216:219], v[92:95], v[32:35], a[216:219]
    v_bfe_u32 v103, v250, 1, 3
    s_waitcnt lgkmcnt(4)
    v_mfma_f32_16x16x32_bf16 a[224:227], v[80:83], v[32:35], a[224:227]
    buffer_load_dwordx4 v255, s[24:27], s63 offen offset:3072 lds
    v_mfma_f32_16x16x32_bf16 a[228:231], v[80:83], v[40:43], a[228:231]
    ds_read_b64_tr_b16 v[92:93], v240 offset:34272
    ds_read_b64_tr_b16 v[94:95], v240 offset:34784
    v_mfma_f32_16x16x32_bf16 v[208:211], v[80:83], v[48:51], v[208:211]
    v_lshlrev_b32 v102, 1, v102
    v_cmp_eq_u32 s[50:51], v102, v103
    v_mfma_f32_16x16x32_bf16 v[212:215], v[80:83], v[56:59], v[212:215]
    s_waitcnt lgkmcnt(4)
    s_add_u32 m0, s84, 16384
    s_mov_b32 s62, 0x00038000
    v_mfma_f32_16x16x32_bf16 v[220:223], v[84:87], v[56:59], v[220:223]
    buffer_load_dwordx4 v252, s[24:27], s62 offen lds
    v_mfma_f32_16x16x32_bf16 v[216:219], v[84:87], v[48:51], v[216:219]
    v_or_b32 v102, 1, v102
    v_cndmask_b32 v100, 0, v99, s[50:51]
    v_mfma_f32_16x16x32_bf16 a[236:239], v[84:87], v[40:43], a[236:239]
    buffer_load_dwordx4 v253, s[24:27], s62 offen offset:1024 lds
    v_mfma_f32_16x16x32_bf16 a[232:235], v[84:87], v[32:35], a[232:235]
    v_cmp_eq_u32 s[50:51], v102, v103
    s_waitcnt lgkmcnt(2)
    v_mfma_f32_16x16x32_bf16 a[240:243], v[88:91], v[32:35], a[240:243]
    s_waitcnt vmcnt(20) lgkmcnt(0)
    s_barrier
    v_mfma_f32_16x16x32_bf16 a[244:247], v[88:91], v[40:43], a[244:247]
    ds_read_b128 v[80:83], v243
    v_mov_b32 v98, 0
    v_mfma_f32_16x16x32_bf16 v[224:227], v[88:91], v[48:51], v[224:227]
    ds_read_b128 v[84:87], v243 offset:512
    v_cndmask_b32 v101, 0, v99, s[50:51]
    v_mfma_f32_16x16x32_bf16 v[228:231], v[88:91], v[56:59], v[228:231]
    v_mov_b32 v99, 0
    v_mfma_f32_16x16x32_bf16 v[236:239], v[92:95], v[56:59], v[236:239]
    buffer_load_dwordx4 v254, s[24:27], s62 offen offset:2048 lds
    v_mfma_f32_16x16x32_bf16 v[232:235], v[92:95], v[48:51], v[232:235]
    ds_read_b128 v[88:91], v243 offset:64
    v_mov_b32 v102, 0
    v_mfma_f32_16x16x32_bf16 a[252:255], v[92:95], v[40:43], a[252:255]
    buffer_load_dwordx4 v255, s[24:27], s62 offen offset:3072 lds
    v_mfma_f32_16x16x32_bf16 a[248:251], v[92:95], v[32:35], a[248:251]
    v_mov_b32 v103, 0
    s_waitcnt lgkmcnt(2)
    v_mfma_f32_16x16x32_bf16 v[32:35], v[80:83], a[0:3], v[64:67]
    v_exp_f32 v7, v7
    v_mfma_f32_16x16x32_bf16 v[40:43], v[80:83], a[4:7], v[68:71]
    ds_read_b128 v[92:95], v243 offset:576
    v_exp_f32 v8, v8
    v_mfma_f32_16x16x32_bf16 v[48:51], v[80:83], a[8:11], v[72:75]
    v_exp_f32 v9, v9
    v_mfma_f32_16x16x32_bf16 v[56:59], v[80:83], a[12:15], v[76:79]
    s_waitcnt lgkmcnt(2)
    s_add_u32 m0, s47, 33792
    s_add_u32 s54, s54, 28672
    v_mfma_f32_16x16x32_bf16 v[60:63], v[84:87], a[12:15], v[76:79]
    buffer_load_dwordx4 v244, s[16:19], s54 offen lds
    v_add_f32 v108, v108, v7
    v_mfma_f32_16x16x32_bf16 v[52:55], v[84:87], a[8:11], v[72:75]
    ds_read_b128 v[80:83], v243 offset:128
    v_cvt_pk_bf16_f32 v3, v6, v7
    v_mfma_f32_16x16x32_bf16 v[44:47], v[84:87], a[4:7], v[68:71]
    v_exp_f32 v10, v10
    v_mfma_f32_16x16x32_bf16 v[36:39], v[84:87], a[0:3], v[64:67]
    v_exp_f32 v11, v11
    s_waitcnt lgkmcnt(2)
    v_mfma_f32_16x16x32_bf16 v[32:35], v[88:91], a[16:19], v[32:35]
    v_exp_f32 v12, v12
    v_mfma_f32_16x16x32_bf16 v[40:43], v[88:91], a[20:23], v[40:43]
    ds_read_b128 v[84:87], v243 offset:640
    v_add_f32 v109, v8, v9
    v_mfma_f32_16x16x32_bf16 v[48:51], v[88:91], a[24:27], v[48:51]
    v_exp_f32 v13, v13
    v_cvt_pk_bf16_f32 v8, v8, v9
    v_mfma_f32_16x16x32_bf16 v[56:59], v[88:91], a[28:31], v[56:59]
    v_add_f32 v109, v109, v10
    s_waitcnt lgkmcnt(2)
    v_mfma_f32_16x16x32_bf16 v[60:63], v[92:95], a[28:31], v[60:63]
    buffer_load_dwordx4 v245, s[16:19], s54 offen offset:1056 lds
    v_mfma_f32_16x16x32_bf16 v[52:55], v[92:95], a[24:27], v[52:55]
    ds_read_b128 v[88:91], v243 offset:192
    v_exp_f32 v14, v14
    v_mfma_f32_16x16x32_bf16 v[44:47], v[92:95], a[20:23], v[44:47]
    v_exp_f32 v15, v15
    v_mfma_f32_16x16x32_bf16 v[36:39], v[92:95], a[16:19], v[36:39]
    v_exp_f32 v16, v16
    s_waitcnt lgkmcnt(2)
    v_mfma_f32_16x16x32_bf16 v[32:35], v[80:83], a[32:35], v[32:35]
    v_exp_f32 v17, v17
    v_mfma_f32_16x16x32_bf16 v[40:43], v[80:83], a[36:39], v[40:43]
    ds_read_b128 v[92:95], v243 offset:704
    v_add_f32 v109, v109, v11
    v_mfma_f32_16x16x32_bf16 v[48:51], v[80:83], a[40:43], v[48:51]
    v_exp_f32 v18, v18
    v_cvt_pk_bf16_f32 v9, v10, v11
    v_mfma_f32_16x16x32_bf16 v[56:59], v[80:83], a[44:47], v[56:59]
    v_add_f32 v109, v109, v12
    s_waitcnt lgkmcnt(2)
    v_mfma_f32_16x16x32_bf16 v[60:63], v[84:87], a[44:47], v[60:63]
    buffer_load_dwordx4 v246, s[16:19], s54 offen offset:2112 lds
    v_mfma_f32_16x16x32_bf16 v[52:55], v[84:87], a[40:43], v[52:55]
    ds_read_b128 v[80:83], v243 offset:256
    v_exp_f32 v19, v19
    v_mfma_f32_16x16x32_bf16 v[44:47], v[84:87], a[36:39], v[44:47]
    v_exp_f32 v20, v20
    v_mfma_f32_16x16x32_bf16 v[36:39], v[84:87], a[32:35], v[36:39]
    v_add_f32 v109, v109, v13
    s_waitcnt lgkmcnt(2)
    v_mfma_f32_16x16x32_bf16 v[32:35], v[88:91], a[48:51], v[32:35]
    v_exp_f32 v21, v21
    v_cvt_pk_bf16_f32 v10, v12, v13
    v_mfma_f32_16x16x32_bf16 v[40:43], v[88:91], a[52:55], v[40:43]
    ds_read_b128 v[84:87], v243 offset:768
    v_add_f32 v109, v109, v14
    v_mfma_f32_16x16x32_bf16 v[48:51], v[88:91], a[56:59], v[48:51]
    v_exp_f32 v22, v22
    v_mfma_f32_16x16x32_bf16 v[56:59], v[88:91], a[60:63], v[56:59]
    v_exp_f32 v23, v23
    s_waitcnt lgkmcnt(2)
    v_mfma_f32_16x16x32_bf16 v[60:63], v[92:95], a[60:63], v[60:63]
    buffer_load_dwordx4 v247, s[16:19], s54 offen offset:3168 lds
    v_mfma_f32_16x16x32_bf16 v[52:55], v[92:95], a[56:59], v[52:55]
    ds_read_b128 v[88:91], v243 offset:320
    v_add_f32 v109, v109, v15
    v_mfma_f32_16x16x32_bf16 v[44:47], v[92:95], a[52:55], v[44:47]
    v_exp_f32 v24, v24
    v_cvt_pk_bf16_f32 v11, v14, v15
    v_mfma_f32_16x16x32_bf16 v[36:39], v[92:95], a[48:51], v[36:39]
    v_add_f32 v110, v16, v17
    s_waitcnt lgkmcnt(2)
    v_mfma_f32_16x16x32_bf16 v[32:35], v[80:83], a[64:67], v[32:35]
    v_exp_f32 v25, v25
    v_mfma_f32_16x16x32_bf16 v[40:43], v[80:83], a[68:71], v[40:43]
    ds_read_b128 v[92:95], v243 offset:832
    v_exp_f32 v26, v26
    v_mfma_f32_16x16x32_bf16 v[48:51], v[80:83], a[72:75], v[48:51]
    v_exp_f32 v27, v27
    v_mfma_f32_16x16x32_bf16 v[56:59], v[80:83], a[76:79], v[56:59]
    s_waitcnt lgkmcnt(2)
    s_add_u32 m0, s47, 38016
    s_add_u32 s54, s54, 4096
    v_mfma_f32_16x16x32_bf16 v[60:63], v[84:87], a[76:79], v[60:63]
    buffer_load_dwordx4 v244, s[16:19], s54 offen lds
    v_mfma_f32_16x16x32_bf16 v[52:55], v[84:87], a[72:75], v[52:55]
    ds_read_b128 v[80:83], v243 offset:384
    v_cvt_pk_bf16_f32 v16, v16, v17
    v_mfma_f32_16x16x32_bf16 v[44:47], v[84:87], a[68:71], v[44:47]
    v_exp_f32 v28, v28
    v_add_f32 v110, v110, v18
    v_mfma_f32_16x16x32_bf16 v[36:39], v[84:87], a[64:67], v[36:39]
    v_add_f32 v110, v110, v19
    s_waitcnt lgkmcnt(2)
    v_mfma_f32_16x16x32_bf16 v[32:35], v[88:91], a[80:83], v[32:35]
    v_exp_f32 v29, v29
    v_mfma_f32_16x16x32_bf16 v[40:43], v[88:91], a[84:87], v[40:43]
    ds_read_b128 v[84:87], v243 offset:896
    v_exp_f32 v30, v30
    v_mfma_f32_16x16x32_bf16 v[48:51], v[88:91], a[88:91], v[48:51]
    v_exp_f32 v31, v31
    v_mfma_f32_16x16x32_bf16 v[56:59], v[88:91], a[92:95], v[56:59]
    v_cvt_pk_bf16_f32 v17, v18, v19
    s_waitcnt lgkmcnt(2)
    v_mfma_f32_16x16x32_bf16 v[60:63], v[92:95], a[92:95], v[60:63]
    buffer_load_dwordx4 v245, s[16:19], s54 offen offset:1056 lds
    v_add_f32 v110, v110, v20
    v_mfma_f32_16x16x32_bf16 v[52:55], v[92:95], a[88:91], v[52:55]
    ds_read_b128 v[88:91], v243 offset:448
    v_add_f32 v110, v110, v21
    v_mfma_f32_16x16x32_bf16 v[44:47], v[92:95], a[84:87], v[44:47]
    v_cvt_pk_bf16_f32 v18, v20, v21
    v_add_f32 v110, v110, v22
    v_mfma_f32_16x16x32_bf16 v[36:39], v[92:95], a[80:83], v[36:39]
    v_add_f32 v110, v110, v23
    v_cvt_pk_bf16_f32 v19, v22, v23
    s_waitcnt lgkmcnt(2)
    v_mfma_f32_16x16x32_bf16 v[32:35], v[80:83], a[96:99], v[32:35]
    v_add_f32 v111, v24, v25
    v_cvt_pk_bf16_f32 v24, v24, v25
    v_mfma_f32_16x16x32_bf16 v[40:43], v[80:83], a[100:103], v[40:43]
    ds_read_b128 v[92:95], v243 offset:960
    v_add_f32 v111, v111, v26
    v_mfma_f32_16x16x32_bf16 v[48:51], v[80:83], a[104:107], v[48:51]
    v_add_f32 v111, v111, v27
    v_cvt_pk_bf16_f32 v25, v26, v27
    v_cvt_pk_bf16_f32 v26, v28, v29
    v_mfma_f32_16x16x32_bf16 v[56:59], v[80:83], a[108:111], v[56:59]
    v_add_f32 v111, v111, v28
    s_waitcnt lgkmcnt(2)
    v_mfma_f32_16x16x32_bf16 v[60:63], v[84:87], a[108:111], v[60:63]
    buffer_load_dwordx4 v246, s[16:19], s54 offen offset:2112 lds
    v_mfma_f32_16x16x32_bf16 v[52:55], v[84:87], a[104:107], v[52:55]
    v_add_f32 v111, v111, v29
    v_cvt_pk_bf16_f32 v27, v30, v31
    v_max3_f32 v251, v108, v109, v110
    v_mfma_f32_16x16x32_bf16 v[44:47], v[84:87], a[100:103], v[44:47]
    v_add_f32 v111, v111, v30
    v_mfma_f32_16x16x32_bf16 v[36:39], v[84:87], a[96:99], v[36:39]
    v_add_f32 v111, v111, v31
    s_waitcnt lgkmcnt(1)
    v_mfma_f32_16x16x32_bf16 v[32:35], v[88:91], a[112:115], v[32:35]
    s_waitcnt vmcnt(7) lgkmcnt(0)
    s_barrier
    v_mfma_f32_16x16x32_bf16 v[40:43], v[88:91], a[116:119], v[40:43]
    ds_read_b64_tr_b16 v[80:81], v241 offset:33792
    ds_read_b64_tr_b16 v[82:83], v241 offset:34304
    v_mfma_f32_16x16x32_bf16 v[48:51], v[88:91], a[120:123], v[48:51]
    ds_read_b64_tr_b16 v[84:85], v241 offset:33824
    ds_read_b64_tr_b16 v[86:87], v241 offset:34336
    v_max_f32 v251, v251, v111
    v_mfma_f32_16x16x32_bf16 v[56:59], v[88:91], a[124:127], v[56:59]
    v_cmp_nge_f32 vcc, s55, v251
    v_mfma_f32_16x16x32_bf16 v[60:63], v[92:95], a[124:127], v[60:63]
    buffer_load_dwordx4 v247, s[16:19], s54 offen offset:3168 lds
    v_mfma_f32_16x16x32_bf16 v[52:55], v[92:95], a[120:123], v[52:55]
    ds_read_b64_tr_b16 v[88:89], v241 offset:33856
    ds_read_b64_tr_b16 v[90:91], v241 offset:34368
    v_mfma_f32_16x16x32_bf16 v[44:47], v[92:95], a[116:119], v[44:47]
    v_mfma_f32_16x16x32_bf16 v[36:39], v[92:95], a[112:115], v[36:39]
    s_waitcnt lgkmcnt(4)
    s_cbranch_vccnz L_slow_u30
L_ret_u30:
    v_mfma_f32_16x16x32_bf16 a[128:131], v[80:83], v[0:3], a[128:131]
    v_exp_f32 v65, v48
    v_add_f32 v104, v104, v108
    v_mfma_f32_16x16x32_bf16 a[132:135], v[80:83], v[8:11], a[132:135]
    ds_read_b64_tr_b16 v[92:93], v241 offset:33888
    ds_read_b64_tr_b16 v[94:95], v241 offset:34400
    s_add_u32 m0, s84, 67584
    s_mov_b32 s63, 0x00054000
    v_mfma_f32_16x16x32_bf16 v[112:115], v[80:83], v[16:19], v[112:115]
    buffer_load_dwordx4 v252, s[24:27], s63 offen lds
    v_lshrrev_b32 v251, 5, v250
    v_mfma_f32_16x16x32_bf16 v[116:119], v[80:83], v[24:27], v[116:119]
    v_add_u32 v243, 131072, v96
    v_mul_u32_u24 v251, 10240, v251
    s_waitcnt lgkmcnt(4)
    v_mfma_f32_16x16x32_bf16 v[124:127], v[84:87], v[24:27], v[124:127]
    v_cmp_ne_u32 vcc, -1, v97
    s_nop 0
    s_cbranch_vccnz L_bwait
L_bret:
    v_lshl_add_u32 v251, v250, 7, v251
    v_mfma_f32_16x16x32_bf16 v[120:123], v[84:87], v[16:19], v[120:123]
    ds_read_b64_tr_b16 v[80:81], v241 offset:33920
    ds_read_b64_tr_b16 v[82:83], v241 offset:34432
    v_add_f32 v105, v105, v109
    v_mfma_f32_16x16x32_bf16 a[140:143], v[84:87], v[8:11], a[140:143]
    buffer_load_dwordx4 v253, s[24:27], s63 offen offset:1024 lds
    v_add_f32 v106, v106, v110
    v_mfma_f32_16x16x32_bf16 a[136:139], v[84:87], v[0:3], a[136:139]
    ds_read_b64_tr_b16 a[80:81], v96
    v_add_f32 v107, v107, v111
    s_waitcnt lgkmcnt(5)
    v_mfma_f32_16x16x32_bf16 a[144:147], v[88:91], v[0:3], a[144:147]
    buffer_load_dwordx4 v254, s[24:27], s63 offen offset:2048 lds
    v_mfma_f32_16x16x32_bf16 a[148:151], v[88:91], v[8:11], a[148:151]
    ds_read_b64_tr_b16 v[84:85], v241 offset:33952
    ds_read_b64_tr_b16 v[86:87], v241 offset:34464
    v_mfma_f32_16x16x32_bf16 v[128:131], v[88:91], v[16:19], v[128:131]
    ds_read_b64_tr_b16 a[82:83], v96 offset:2048
    ds_read_b64_tr_b16 a[84:85], v96 offset:4096
    v_mfma_f32_16x16x32_bf16 v[132:135], v[88:91], v[24:27], v[132:135]
    ds_read_b64_tr_b16 a[86:87], v96 offset:6144
    s_waitcnt lgkmcnt(8)
    v_mfma_f32_16x16x32_bf16 v[140:143], v[92:95], v[24:27], v[140:143]
    buffer_load_dwordx4 v255, s[24:27], s63 offen offset:3072 lds
    v_mfma_f32_16x16x32_bf16 v[136:139], v[92:95], v[16:19], v[136:139]
    ds_read_b64_tr_b16 v[88:89], v241 offset:33984
    ds_read_b64_tr_b16 v[90:91], v241 offset:34496
    v_mfma_f32_16x16x32_bf16 a[156:159], v[92:95], v[8:11], a[156:159]
    ds_read_b64_tr_b16 a[88:89], v96 offset:8192
    ds_read_b64_tr_b16 a[90:91], v96 offset:10240
    v_mfma_f32_16x16x32_bf16 a[152:155], v[92:95], v[0:3], a[152:155]
    ds_read_b64_tr_b16 a[92:93], v96 offset:12288
    s_waitcnt lgkmcnt(11)
    v_mfma_f32_16x16x32_bf16 a[160:163], v[80:83], v[0:3], a[160:163]
    ds_read_b64_tr_b16 a[94:95], v96 offset:14336
    ds_read_b64_tr_b16 a[96:97], v96 offset:16384
    v_mfma_f32_16x16x32_bf16 a[164:167], v[80:83], v[8:11], a[164:167]
    ds_read_b64_tr_b16 v[92:93], v241 offset:34016
    ds_read_b64_tr_b16 v[94:95], v241 offset:34528
    v_mfma_f32_16x16x32_bf16 v[144:147], v[80:83], v[16:19], v[144:147]
    ds_read_b64_tr_b16 a[98:99], v96 offset:18432
    ds_read_b64_tr_b16 a[100:101], v96 offset:20480
    v_mfma_f32_16x16x32_bf16 v[148:151], v[80:83], v[24:27], v[148:151]
    ds_read_b64_tr_b16 a[102:103], v96 offset:22528
    s_waitcnt lgkmcnt(15)
    v_mfma_f32_16x16x32_bf16 v[156:159], v[84:87], v[24:27], v[156:159]
    ds_read_b64_tr_b16 a[104:105], v96 offset:24576
    ds_read_b64_tr_b16 a[106:107], v96 offset:26624
    buffer_load_dword v79, v251, s[8:11], s83 offen
    v_mfma_f32_16x16x32_bf16 v[152:155], v[84:87], v[16:19], v[152:155]
    ds_read_b64_tr_b16 v[80:81], v241 offset:34048
    ds_read_b64_tr_b16 v[82:83], v241 offset:34560
    v_mfma_f32_16x16x32_bf16 a[172:175], v[84:87], v[8:11], a[172:175]
    ds_read_b64_tr_b16 a[108:109], v96 offset:28672
    ds_read_b64_tr_b16 a[110:111], v96 offset:30720
    v_mfma_f32_16x16x32_bf16 a[168:171], v[84:87], v[0:3], a[168:171]
    ds_read_b64_tr_b16 a[64:65], v243 offset:4096
    s_waitcnt lgkmcnt(15)
    v_mfma_f32_16x16x32_bf16 a[176:179], v[88:91], v[0:3], a[176:179]
    ds_read_b64_tr_b16 a[66:67], v243 offset:6144
    ds_read_b64_tr_b16 a[68:69], v243 offset:8192
    v_mfma_f32_16x16x32_bf16 a[180:183], v[88:91], v[8:11], a[180:183]
    ds_read_b64_tr_b16 v[84:85], v241 offset:34080
    ds_read_b64_tr_b16 v[86:87], v241 offset:34592
    v_mfma_f32_16x16x32_bf16 v[160:163], v[88:91], v[16:19], v[160:163]
    ds_read_b64_tr_b16 a[70:71], v243 offset:10240
    ds_read_b64_tr_b16 a[72:73], v243 offset:12288
    v_mfma_f32_16x16x32_bf16 v[164:167], v[88:91], v[24:27], v[164:167]
    ds_read_b64_tr_b16 a[74:75], v243 offset:14336
    s_waitcnt lgkmcnt(15)
    v_mfma_f32_16x16x32_bf16 v[172:175], v[92:95], v[24:27], v[172:175]
    ds_read_b64_tr_b16 a[76:77], v243 offset:16384
    ds_read_b64_tr_b16 a[78:79], v243 offset:18432
    v_mfma_f32_16x16x32_bf16 v[168:171], v[92:95], v[16:19], v[168:171]
    ds_read_b64_tr_b16 v[88:89], v241 offset:34112
    ds_read_b64_tr_b16 v[90:91], v241 offset:34624
    v_mfma_f32_16x16x32_bf16 a[188:191], v[92:95], v[8:11], a[188:191]
    v_add_u32 v96, 65536, v96
    v_and_b32 v246, 19, v250
    s_lshl_b32 s49, s61, 15
    s_add_u32 s49, s49, 98304
    v_add_u32 v244, s49, v248
    v_mfma_f32_16x16x32_bf16 a[184:187], v[92:95], v[0:3], a[184:187]
    v_mul_u32_u24 v246, 896, v246
    v_add_u32 v245, s49, v249
    v_and_b32 v97, 15, v250
    s_waitcnt lgkmcnt(14)
    v_mfma_f32_16x16x32_bf16 a[192:195], v[80:83], v[0:3], a[192:195]
    v_lshrrev_b32 v247, 5, v250
    v_lshl_add_u32 v246, v247, 7, v246
    s_lshl_b32 s49, s44, 8
    s_add_u32 s49, s49, 96256
    v_lshl_add_u32 v97, v97, 4, s49
    v_mfma_f32_16x16x32_bf16 a[196:199], v[80:83], v[8:11], a[196:199]
    ds_read_b64_tr_b16 v[92:93], v241 offset:34144
    ds_read_b64_tr_b16 v[94:95], v241 offset:34656
    v_xor_b32 v242, 256, v97
    v_mfma_f32_16x16x32_bf16 v[176:179], v[80:83], v[16:19], v[176:179]
    v_bfe_u32 v247, v250, 2, 2
    v_lshl_add_u32 v246, v247, 3, v246
    v_mfma_f32_16x16x32_bf16 v[180:183], v[80:83], v[24:27], v[180:183]
    v_exp_f32 v66, v49
    s_waitcnt lgkmcnt(9)
    v_mfma_f32_16x16x32_bf16 v[188:191], v[84:87], v[24:27], v[188:191]
    v_exp_f32 v67, v50
    v_mfma_f32_16x16x32_bf16 v[184:187], v[84:87], v[16:19], v[184:187]
    ds_read_b64_tr_b16 v[80:81], v241 offset:34176
    ds_read_b64_tr_b16 v[82:83], v241 offset:34688
    v_add_f32 v110, v65, v66
    v_mfma_f32_16x16x32_bf16 a[204:207], v[84:87], v[8:11], a[204:207]
    v_exp_f32 v69, v51
    v_cvt_pk_bf16_f32 v20, v65, v66
    v_mfma_f32_16x16x32_bf16 a[200:203], v[84:87], v[0:3], a[200:203]
    v_exp_f32 v70, v52
    s_waitcnt lgkmcnt(4)
    v_mfma_f32_16x16x32_bf16 a[208:211], v[88:91], v[0:3], a[208:211]
    v_exp_f32 v71, v53
    v_add_f32 v110, v110, v67
    v_mfma_f32_16x16x32_bf16 a[212:215], v[88:91], v[8:11], a[212:215]
    ds_read_b64_tr_b16 v[84:85], v241 offset:34208
    ds_read_b64_tr_b16 v[86:87], v241 offset:34720
    v_add_f32 v110, v110, v69
    v_mfma_f32_16x16x32_bf16 v[192:195], v[88:91], v[16:19], v[192:195]
    v_exp_f32 v77, v54
    v_cvt_pk_bf16_f32 v21, v67, v69
    v_mfma_f32_16x16x32_bf16 v[196:199], v[88:91], v[24:27], v[196:199]
    v_exp_f32 v78, v55
    s_waitcnt lgkmcnt(4)
    v_mfma_f32_16x16x32_bf16 v[204:207], v[92:95], v[24:27], v[204:207]
    v_exp_f32 v65, v56
    v_add_f32 v110, v110, v70
    v_mfma_f32_16x16x32_bf16 v[200:203], v[92:95], v[16:19], v[200:203]
    ds_read_b64_tr_b16 v[88:89], v241 offset:34240
    ds_read_b64_tr_b16 v[90:91], v241 offset:34752
    v_add_f32 v110, v110, v71
    v_mfma_f32_16x16x32_bf16 a[220:223], v[92:95], v[8:11], a[220:223]
    v_exp_f32 v66, v57
    v_cvt_pk_bf16_f32 v22, v70, v71
    v_mfma_f32_16x16x32_bf16 a[216:219], v[92:95], v[0:3], a[216:219]
    v_exp_f32 v67, v58
    s_waitcnt lgkmcnt(4)
    v_mfma_f32_16x16x32_bf16 a[224:227], v[80:83], v[0:3], a[224:227]
    v_exp_f32 v69, v59
    v_add_f32 v110, v110, v77
    v_mfma_f32_16x16x32_bf16 a[228:231], v[80:83], v[8:11], a[228:231]
    ds_read_b64_tr_b16 v[92:93], v241 offset:34272
    ds_read_b64_tr_b16 v[94:95], v241 offset:34784
    v_add_f32 v110, v110, v78
    v_mfma_f32_16x16x32_bf16 v[208:211], v[80:83], v[16:19], v[208:211]
    v_exp_f32 v70, v60
    v_cvt_pk_bf16_f32 v23, v77, v78
    v_mfma_f32_16x16x32_bf16 v[212:215], v[80:83], v[24:27], v[212:215]
    v_exp_f32 v71, v61
    s_waitcnt lgkmcnt(4)
    v_mfma_f32_16x16x32_bf16 v[220:223], v[84:87], v[24:27], v[220:223]
    v_exp_f32 v77, v62
    v_add_f32 v111, v65, v66
    v_mfma_f32_16x16x32_bf16 v[216:219], v[84:87], v[16:19], v[216:219]
    v_exp_f32 v78, v63
    v_cvt_pk_bf16_f32 v28, v65, v66
    v_mfma_f32_16x16x32_bf16 a[236:239], v[84:87], v[8:11], a[236:239]
    v_add_f32 v111, v111, v67
    v_cvt_pk_bf16_f32 v29, v67, v69
    v_cvt_pk_bf16_f32 v30, v70, v71
    v_mfma_f32_16x16x32_bf16 a[232:235], v[84:87], v[0:3], a[232:235]
    v_add_f32 v111, v111, v69
    v_cvt_pk_bf16_f32 v31, v77, v78
    s_waitcnt lgkmcnt(2)
    v_mfma_f32_16x16x32_bf16 a[240:243], v[88:91], v[0:3], a[240:243]
    s_waitcnt vmcnt(1) lgkmcnt(0)
    s_barrier
    v_add_f32 v111, v111, v70
    v_mfma_f32_16x16x32_bf16 a[244:247], v[88:91], v[8:11], a[244:247]
    ds_read_b64_tr_b16 a[0:1], v240 offset:33792
    ds_read_b64_tr_b16 a[2:3], v240 offset:34304
    v_add_f32 v111, v111, v71
    v_mfma_f32_16x16x32_bf16 v[224:227], v[88:91], v[16:19], v[224:227]
    ds_read_b64_tr_b16 a[4:5], v240 offset:33824
    ds_read_b64_tr_b16 a[6:7], v240 offset:34336
    v_add_f32 v111, v111, v77
    v_mfma_f32_16x16x32_bf16 v[228:231], v[88:91], v[24:27], v[228:231]
    ds_read_b64_tr_b16 a[8:9], v240 offset:33856
    ds_read_b64_tr_b16 a[10:11], v240 offset:34368
    ds_read_b64_tr_b16 a[12:13], v240 offset:33888
    ds_read_b64_tr_b16 a[14:15], v240 offset:34400
    s_add_u32 m0, s84, 0
    s_mov_b32 s62, 0x00000080
    v_mfma_f32_16x16x32_bf16 v[236:239], v[92:95], v[24:27], v[236:239]
    buffer_load_dwordx4 v252, s[24:27], s62 offen lds
    v_add_f32 v111, v111, v78
    v_mfma_f32_16x16x32_bf16 v[232:235], v[92:95], v[16:19], v[232:235]
    ds_read_b64_tr_b16 a[16:17], v240 offset:33920
    ds_read_b64_tr_b16 a[18:19], v240 offset:34432
    v_max_f32 v251, v110, v111
    v_mfma_f32_16x16x32_bf16 a[252:255], v[92:95], v[8:11], a[252:255]
    ds_read_b64_tr_b16 a[20:21], v240 offset:33952
    ds_read_b64_tr_b16 a[22:23], v240 offset:34464
    v_cmp_nge_f32 vcc, s55, v251
    v_mfma_f32_16x16x32_bf16 a[248:251], v[92:95], v[0:3], a[248:251]
    v_exp_f32 v65, v32
    s_waitcnt lgkmcnt(8)
    s_cbranch_vccnz L_slow_u31a
L_ret_u31a:
    v_mfma_f32_16x16x32_bf16 v[112:115], a[0:3], v[20:23], v[112:115]
    buffer_load_dwordx4 v253, s[24:27], s62 offen offset:1024 lds
    v_add_f32 v106, v106, v110
    v_add_f32 v107, v107, v111
    v_mfma_f32_16x16x32_bf16 v[116:119], a[0:3], v[28:31], v[116:119]
    ds_read_b64_tr_b16 a[24:25], v240 offset:33984
    ds_read_b64_tr_b16 a[26:27], v240 offset:34496
    v_exp_f32 v66, v33
    v_mov_b32 v110, v106
    v_mfma_f32_16x16x32_bf16 v[120:123], a[4:7], v[20:23], v[120:123]
    ds_read_b64_tr_b16 a[28:29], v240 offset:34016
    ds_read_b64_tr_b16 a[30:31], v240 offset:34528
    v_mov_b32 v111, v107
    v_permlane32_swap_b32 v106, v110
    v_mfma_f32_16x16x32_bf16 v[124:127], a[4:7], v[28:31], v[124:127]
    v_exp_f32 v67, v34
    v_add_f32 v108, v65, v66
    s_waitcnt lgkmcnt(8)
    v_mfma_f32_16x16x32_bf16 v[128:131], a[8:11], v[20:23], v[128:131]
    v_exp_f32 v69, v35
    v_cvt_pk_bf16_f32 v4, v65, v66
    v_permlane32_swap_b32 v107, v111
    v_mfma_f32_16x16x32_bf16 v[132:135], a[8:11], v[28:31], v[132:135]
    ds_read_b64_tr_b16 a[32:33], v240 offset:34048
    ds_read_b64_tr_b16 a[34:35], v240 offset:34560
    v_exp_f32 v70, v36
    v_add_f32 v106, v106, v110
    v_mfma_f32_16x16x32_bf16 v[136:139], a[12:15], v[20:23], v[136:139]
    ds_read_b64_tr_b16 a[36:37], v240 offset:34080
    ds_read_b64_tr_b16 a[38:39], v240 offset:34592
    v_add_f32 v108, v108, v67
    v_add_f32 v107, v107, v111
    v_mfma_f32_16x16x32_bf16 v[140:143], a[12:15], v[28:31], v[140:143]
    v_exp_f32 v71, v37
    v_add_f32 v108, v108, v69
    s_waitcnt lgkmcnt(8)
    v_mfma_f32_16x16x32_bf16 v[144:147], a[16:19], v[20:23], v[144:147]
    buffer_load_dwordx4 v254, s[24:27], s62 offen offset:2048 lds
    v_cvt_pk_bf16_f32 v5, v67, v69
    v_mov_b32 v110, v106
    v_mfma_f32_16x16x32_bf16 v[148:151], a[16:19], v[28:31], v[148:151]
    ds_read_b64_tr_b16 a[40:41], v240 offset:34112
    ds_read_b64_tr_b16 a[42:43], v240 offset:34624
    v_exp_f32 v77, v38
    v_mov_b32 v111, v107
    v_mfma_f32_16x16x32_bf16 v[152:155], a[20:23], v[20:23], v[152:155]
    ds_read_b64_tr_b16 a[44:45], v240 offset:34144
    ds_read_b64_tr_b16 a[46:47], v240 offset:34656
    v_add_f32 v108, v108, v70
    v_permlane16_swap_b32 v106, v110
    v_mfma_f32_16x16x32_bf16 v[156:159], a[20:23], v[28:31], v[156:159]
    v_exp_f32 v78, v39
    v_add_f32 v108, v108, v71
    s_waitcnt lgkmcnt(8)
    v_mfma_f32_16x16x32_bf16 v[160:163], a[24:27], v[20:23], v[160:163]
    buffer_load_dwordx4 v255, s[24:27], s62 offen offset:3072 lds
    v_cvt_pk_bf16_f32 v6, v70, v71
    v_permlane16_swap_b32 v107, v111
    v_mfma_f32_16x16x32_bf16 v[164:167], a[24:27], v[28:31], v[164:167]
    ds_read_b64_tr_b16 a[48:49], v240 offset:34176
    ds_read_b64_tr_b16 a[50:51], v240 offset:34688
    v_exp_f32 v65, v40
    v_add_f32 v106, v106, v110
    v_mfma_f32_16x16x32_bf16 v[168:171], a[28:31], v[20:23], v[168:171]
    ds_read_b64_tr_b16 a[52:53], v240 offset:34208
    ds_read_b64_tr_b16 a[54:55], v240 offset:34720
    v_add_f32 v108, v108, v77
    v_add_f32 v107, v107, v111
    v_mfma_f32_16x16x32_bf16 v[172:175], a[28:31], v[28:31], v[172:175]
    v_add_f32 v108, v108, v78
    s_waitcnt lgkmcnt(8)
    s_add_u32 m0, s84, 16384
    s_mov_b32 s63, 0x0001c080
    v_mfma_f32_16x16x32_bf16 v[176:179], a[32:35], v[20:23], v[176:179]
    buffer_load_dwordx4 v252, s[24:27], s63 offen lds
    v_cvt_pk_bf16_f32 v7, v77, v78
    v_cvt_pk_bf16_f32 v112, v112, v113
    v_mfma_f32_16x16x32_bf16 v[180:183], a[32:35], v[28:31], v[180:183]
    ds_read_b64_tr_b16 a[56:57], v240 offset:34240
    ds_read_b64_tr_b16 a[58:59], v240 offset:34752
    v_exp_f32 v66, v41
    v_cvt_pk_bf16_f32 v113, v114, v115
    v_mfma_f32_16x16x32_bf16 v[184:187], a[36:39], v[20:23], v[184:187]
    ds_read_b64_tr_b16 a[60:61], v240 offset:34272
    ds_read_b64_tr_b16 a[62:63], v240 offset:34784
    v_cvt_pk_bf16_f32 v114, v120, v121
    v_cvt_pk_bf16_f32 v115, v122, v123
    v_mfma_f32_16x16x32_bf16 v[188:191], a[36:39], v[28:31], v[188:191]
    v_exp_f32 v67, v42
    v_add_f32 v109, v65, v66
    s_waitcnt lgkmcnt(8)
    v_mfma_f32_16x16x32_bf16 v[192:195], a[40:43], v[20:23], v[192:195]
    v_exp_f32 v69, v43
    v_cvt_pk_bf16_f32 v12, v65, v66
    v_cvt_pk_bf16_f32 v116, v116, v117
    v_mfma_f32_16x16x32_bf16 v[196:199], a[40:43], v[28:31], v[196:199]
    v_exp_f32 v70, v44
    v_exp_f32 v71, v45
    v_cvt_pk_bf16_f32 v117, v118, v119
    v_mfma_f32_16x16x32_bf16 v[200:203], a[44:47], v[20:23], v[200:203]
    buffer_load_dwordx4 v253, s[24:27], s63 offen offset:1024 lds
    v_add_f32 v109, v109, v67
    v_cvt_pk_bf16_f32 v118, v124, v125
    v_mfma_f32_16x16x32_bf16 v[204:207], a[44:47], v[28:31], v[204:207]
    v_exp_f32 v77, v46
    v_add_f32 v109, v109, v69
    s_waitcnt lgkmcnt(4)
    v_mfma_f32_16x16x32_bf16 v[208:211], a[48:51], v[20:23], v[208:211]
    v_exp_f32 v78, v47
    v_cvt_pk_bf16_f32 v13, v67, v69
    v_cvt_pk_bf16_f32 v119, v126, v127
    v_mfma_f32_16x16x32_bf16 v[212:215], a[48:51], v[28:31], v[212:215]
    v_add_f32 v109, v109, v70
    v_cvt_pk_bf16_f32 v14, v70, v71
    ds_write_b128 v245, v[112:115]
    v_mfma_f32_16x16x32_bf16 v[216:219], a[52:55], v[20:23], v[216:219]
    v_add_f32 v109, v109, v71
    v_cvt_pk_bf16_f32 v15, v77, v78
    v_cvt_pk_bf16_f32 v128, v128, v129
    v_cvt_pk_bf16_f32 v129, v130, v131
    v_mfma_f32_16x16x32_bf16 v[220:223], a[52:55], v[28:31], v[220:223]
    v_add_f32 v109, v109, v77
    v_cvt_pk_bf16_f32 v130, v136, v137
    v_cvt_pk_bf16_f32 v131, v138, v139
    s_waitcnt lgkmcnt(1)
    v_mfma_f32_16x16x32_bf16 v[224:227], a[56:59], v[20:23], v[224:227]
    buffer_load_dwordx4 v254, s[24:27], s63 offen offset:2048 lds
    v_add_f32 v109, v109, v78
    v_cvt_pk_bf16_f32 v132, v132, v133
    v_mfma_f32_16x16x32_bf16 v[228:231], a[56:59], v[28:31], v[228:231]
    v_max_f32 v251, v108, v109
    ds_write_b128 v245, v[116:119] offset:1024
    v_cvt_pk_bf16_f32 v133, v134, v135
    v_mfma_f32_16x16x32_bf16 v[232:235], a[60:63], v[20:23], v[232:235]
    v_cmp_nge_f32 vcc, s55, v251
    ds_write_b128 v245, v[128:131] offset:4096
    v_mfma_f32_16x16x32_bf16 v[236:239], a[60:63], v[28:31], v[236:239]
    v_cvt_pk_bf16_f32 v134, v140, v141
    v_cvt_pk_bf16_f32 v135, v142, v143
    v_mov_b32 v73, v106
    s_cbranch_vccnz L_slow_u31b
L_ret_u31b:
    v_mfma_f32_16x16x32_bf16 a[128:131], a[0:3], v[4:7], a[128:131]
    ds_read_b64_tr_b16 a[112:113], v96 offset:2048
    ds_read_b64_tr_b16 a[114:115], v96 offset:4096
    v_mov_b32 v74, v76
    v_mov_b32 v75, v107
    v_mfma_f32_16x16x32_bf16 a[132:135], a[0:3], v[12:15], a[132:135]
    buffer_load_dwordx4 v255, s[24:27], s63 offen offset:3072 lds
    ds_write_b128 v245, v[132:135] offset:5120
    v_mfma_f32_16x16x32_bf16 a[136:139], a[4:7], v[4:7], a[136:139]
    ds_read_b64_tr_b16 a[116:117], v96 offset:6144
    ds_read_b64_tr_b16 a[118:119], v96 offset:8192
    ds_write_b128 v97, v[72:75]
    v_mfma_f32_16x16x32_bf16 a[140:143], a[4:7], v[12:15], a[140:143]
    ds_read_b64_tr_b16 a[120:121], v96 offset:10240
    ds_read_b64_tr_b16 a[122:123], v96 offset:12288
    v_cvt_pk_bf16_f32 v144, v144, v145
    v_cvt_pk_bf16_f32 v145, v146, v147
    v_mfma_f32_16x16x32_bf16 a[144:147], a[8:11], v[4:7], a[144:147]
    ds_read_b64_tr_b16 a[124:125], v96 offset:14336
    ds_read_b64_tr_b16 a[126:127], v96 offset:16384
    v_cvt_pk_bf16_f32 v146, v152, v153
    v_cvt_pk_bf16_f32 v147, v154, v155
    v_mfma_f32_16x16x32_bf16 a[148:151], a[8:11], v[12:15], a[148:151]
    ds_write_b128 v245, v[144:147] offset:8192
    v_cvt_pk_bf16_f32 v148, v148, v149
    v_cvt_pk_bf16_f32 v149, v150, v151
    v_mfma_f32_16x16x32_bf16 a[152:155], a[12:15], v[4:7], a[152:155]
    v_cvt_pk_bf16_f32 v150, v156, v157
    v_cvt_pk_bf16_f32 v151, v158, v159
    v_cvt_pk_bf16_f32 v160, v160, v161
    v_cvt_pk_bf16_f32 v161, v162, v163
    v_mfma_f32_16x16x32_bf16 a[156:159], a[12:15], v[12:15], a[156:159]
    ds_write_b128 v245, v[148:151] offset:9216
    v_cvt_pk_bf16_f32 v162, v168, v169
    v_mfma_f32_16x16x32_bf16 a[160:163], a[16:19], v[4:7], a[160:163]
    v_cvt_pk_bf16_f32 v163, v170, v171
    v_cvt_pk_bf16_f32 v164, v164, v165
    v_cvt_pk_bf16_f32 v165, v166, v167
    v_cvt_pk_bf16_f32 v166, v172, v173
    v_mfma_f32_16x16x32_bf16 a[164:167], a[16:19], v[12:15], a[164:167]
    ds_write_b128 v245, v[160:163] offset:12288
    v_cvt_pk_bf16_f32 v167, v174, v175
    v_cvt_pk_bf16_f32 v176, v176, v177
    v_mfma_f32_16x16x32_bf16 a[168:171], a[20:23], v[4:7], a[168:171]
    ds_write_b128 v245, v[164:167] offset:13312
    v_cvt_pk_bf16_f32 v177, v178, v179
    v_mfma_f32_16x16x32_bf16 a[172:175], a[20:23], v[12:15], a[172:175]
    v_cvt_pk_bf16_f32 v178, v184, v185
    v_cvt_pk_bf16_f32 v179, v186, v187
    v_cvt_pk_bf16_f32 v180, v180, v181
    v_cvt_pk_bf16_f32 v181, v182, v183
    v_mfma_f32_16x16x32_bf16 a[176:179], a[24:27], v[4:7], a[176:179]
    ds_write_b128 v245, v[176:179] offset:16384
    v_cvt_pk_bf16_f32 v182, v188, v189
    v_mfma_f32_16x16x32_bf16 a[180:183], a[24:27], v[12:15], a[180:183]
    v_cvt_pk_bf16_f32 v183, v190, v191
    v_cvt_pk_bf16_f32 v192, v192, v193
    v_cvt_pk_bf16_f32 v193, v194, v195
    v_cvt_pk_bf16_f32 v194, v200, v201
    v_cvt_pk_bf16_f32 v195, v202, v203
    v_mfma_f32_16x16x32_bf16 a[184:187], a[28:31], v[4:7], a[184:187]
    ds_write_b128 v245, v[180:183] offset:17408
    v_cvt_pk_bf16_f32 v196, v196, v197
    v_mfma_f32_16x16x32_bf16 a[188:191], a[28:31], v[12:15], a[188:191]
    ds_write_b128 v245, v[192:195] offset:20480
    v_cvt_pk_bf16_f32 v197, v198, v199
    v_mfma_f32_16x16x32_bf16 a[192:195], a[32:35], v[4:7], a[192:195]
    v_cvt_pk_bf16_f32 v198, v204, v205
    v_cvt_pk_bf16_f32 v199, v206, v207
    v_cvt_pk_bf16_f32 v208, v208, v209
    v_cvt_pk_bf16_f32 v209, v210, v211
    v_mfma_f32_16x16x32_bf16 a[196:199], a[32:35], v[12:15], a[196:199]
    ds_write_b128 v245, v[196:199] offset:21504
    v_cvt_pk_bf16_f32 v210, v216, v217
    v_cvt_pk_bf16_f32 v211, v218, v219
    v_mfma_f32_16x16x32_bf16 a[200:203], a[36:39], v[4:7], a[200:203]
    ds_write_b128 v245, v[208:211] offset:24576
    v_cvt_pk_bf16_f32 v212, v212, v213
    v_mfma_f32_16x16x32_bf16 a[204:207], a[36:39], v[12:15], a[204:207]
    v_cvt_pk_bf16_f32 v213, v214, v215
    v_cvt_pk_bf16_f32 v214, v220, v221
    v_cvt_pk_bf16_f32 v215, v222, v223
    v_cvt_pk_bf16_f32 v224, v224, v225
    v_mfma_f32_16x16x32_bf16 a[208:211], a[40:43], v[4:7], a[208:211]
    ds_write_b128 v245, v[212:215] offset:25600
    v_cvt_pk_bf16_f32 v225, v226, v227
    v_mfma_f32_16x16x32_bf16 a[212:215], a[40:43], v[12:15], a[212:215]
    v_cvt_pk_bf16_f32 v226, v232, v233
    v_cvt_pk_bf16_f32 v227, v234, v235
    v_cvt_pk_bf16_f32 v228, v228, v229
    v_cvt_pk_bf16_f32 v229, v230, v231
    v_cvt_pk_bf16_f32 v230, v236, v237
    v_mfma_f32_16x16x32_bf16 a[216:219], a[44:47], v[4:7], a[216:219]
    ds_write_b128 v245, v[224:227] offset:28672
    v_cvt_pk_bf16_f32 v231, v238, v239
    v_mfma_f32_16x16x32_bf16 a[220:223], a[44:47], v[12:15], a[220:223]
    ds_write_b128 v245, v[228:231] offset:29696
    v_add_f32 v104, v104, v108
    v_mfma_f32_16x16x32_bf16 a[224:227], a[48:51], v[4:7], a[224:227]
    s_waitcnt lgkmcnt(0)
    s_barrier
    v_add_f32 v105, v105, v109
    v_mov_b32 v108, v104
    v_mfma_f32_16x16x32_bf16 a[228:231], a[48:51], v[12:15], a[228:231]
    ds_read_b128 v[72:75], v242
    ds_read_b128 v[120:123], v244
    v_mov_b32 v109, v105
    s_add_u32 m0, s84, 67584
    s_mov_b32 s62, 0x00038080
    v_mfma_f32_16x16x32_bf16 a[232:235], a[52:55], v[4:7], a[232:235]
    ds_read_b128 v[124:127], v244 offset:1024
    ds_read_b128 v[136:139], v244 offset:4096
    buffer_load_dwordx4 v252, s[24:27], s62 offen lds
    v_permlane32_swap_b32 v104, v108
    v_permlane32_swap_b32 v105, v109
    v_mfma_f32_16x16x32_bf16 a[236:239], a[52:55], v[12:15], a[236:239]
    ds_read_b128 v[140:143], v244 offset:5120
    v_add_f32 v104, v104, v108
    v_add_f32 v105, v105, v109
    v_mfma_f32_16x16x32_bf16 a[240:243], a[56:59], v[4:7], a[240:243]
    buffer_load_dwordx4 v253, s[24:27], s62 offen offset:1024 lds
    v_mov_b32 v108, v104
    v_mov_b32 v109, v105
    v_mfma_f32_16x16x32_bf16 a[244:247], a[56:59], v[12:15], a[244:247]
    ds_read_b128 v[152:155], v244 offset:8192
    ds_read_b128 v[156:159], v244 offset:9216
    v_permlane16_swap_b32 v104, v108
    v_permlane16_swap_b32 v105, v109
    v_mfma_f32_16x16x32_bf16 a[248:251], a[60:63], v[4:7], a[248:251]
    v_add_f32 v104, v104, v108
    v_add_f32 v105, v105, v109
    v_add_u32 v248, 98304, v248
    v_mfma_f32_16x16x32_bf16 a[252:255], a[60:63], v[12:15], a[252:255]
    s_waitcnt lgkmcnt(4)
    v_cmp_neq_f32 vcc, v64, v72
    v_cmp_neq_f32 s[50:51], v68, v74
    s_nop 0
    s_or_b64 vcc, vcc, s[50:51]
    s_cbranch_vccnz L_rare
L_rret:
    v_mfma_f32_16x16x32_bf16 a[128:131], v[100:103], v[120:123], a[128:131]
    buffer_load_dwordx4 v254, s[24:27], s62 offen offset:2048 lds
    v_add_u32 v249, 98304, v249
    v_add_f32 v104, v104, v73
    v_add_f32 v105, v105, v75
    v_rcp_f32 v104, v104
    v_lshrrev_b32 v70, 4, v250
    v_mfma_f32_16x16x32_bf16 a[136:139], v[98:101], v[120:123], a[136:139]
    ds_read_b128 v[168:171], v244 offset:12288
    ds_read_b128 v[172:175], v244 offset:13312
    v_subrev_u32 v240, 131072, v243
    v_rcp_f32 v106, v105
    v_mov_b32 v105, v104
    v_mov_b32 v107, v106
    v_mul_u32_u24 v66, 7168, v70
    v_mfma_f32_16x16x32_bf16 a[132:135], v[100:103], v[124:127], a[132:135]
    buffer_load_dwordx4 v255, s[24:27], s62 offen offset:3072 lds
    v_subrev_u32 v241, 65536, v243
    v_and_b32 v71, 15, v250
    v_lshl_add_u32 v66, v71, 4, v66
    v_add_u32 v67, 16777216, v66
    s_mul_i32 s82, s2, 57344
    s_lshl_b32 s48, s44, 8
    v_mfma_f32_16x16x32_bf16 a[140:143], v[98:101], v[124:127], a[140:143]
    v_accvgpr_read_b32 v0, a128
    v_accvgpr_read_b32 v1, a129
    v_accvgpr_read_b32 v2, a130
    v_accvgpr_read_b32 v3, a131
    v_pk_mul_f32 v[0:1], v[0:1], v[104:105]
    s_waitcnt lgkmcnt(4)
    s_add_u32 m0, s84, 32768
    s_mov_b32 s63, 0x00054080
    v_mfma_f32_16x16x32_bf16 a[144:147], v[100:103], v[136:139], a[144:147]
    buffer_load_dwordx4 v252, s[24:27], s63 offen lds
    v_accvgpr_read_b32 v4, a136
    v_accvgpr_read_b32 v5, a137
    v_accvgpr_read_b32 v6, a138
    v_accvgpr_read_b32 v7, a139
    v_pk_mul_f32 v[2:3], v[2:3], v[104:105]
    s_add_u32 s82, s82, s48
    s_add_u32 s80, s82, 4096
    v_mfma_f32_16x16x32_bf16 a[152:155], v[98:101], v[136:139], a[152:155]
    ds_read_b128 v[184:187], v244 offset:16384
    ds_read_b128 v[188:191], v244 offset:17408
    v_pk_mul_f32 v[4:5], v[4:5], v[104:105]
    v_pk_mul_f32 v[6:7], v[6:7], v[104:105]
    v_cvt_pk_bf16_f32 v0, v0, v1
    v_cvt_pk_bf16_f32 v1, v2, v3
    v_cvt_pk_bf16_f32 v2, v4, v5
    v_cvt_pk_bf16_f32 v3, v6, v7
    v_mfma_f32_16x16x32_bf16 a[148:151], v[100:103], v[140:143], a[148:151]
    buffer_load_dwordx4 v253, s[24:27], s63 offen offset:1024 lds
    ds_write_b128 v244, v[0:3]
    v_accvgpr_read_b32 v8, a132
    v_accvgpr_read_b32 v9, a133
    v_mfma_f32_16x16x32_bf16 a[156:159], v[98:101], v[140:143], a[156:159]
    v_accvgpr_read_b32 v10, a134
    v_accvgpr_read_b32 v11, a135
    v_accvgpr_read_b32 v12, a140
    v_accvgpr_read_b32 v13, a141
    v_accvgpr_read_b32 v14, a142
    v_accvgpr_read_b32 v15, a143
    v_pk_mul_f32 v[8:9], v[8:9], v[106:107]
    s_waitcnt lgkmcnt(5)
    v_mfma_f32_16x16x32_bf16 a[160:163], v[100:103], v[152:155], a[160:163]
    buffer_load_dwordx4 v254, s[24:27], s63 offen offset:2048 lds
    v_pk_mul_f32 v[10:11], v[10:11], v[106:107]
    v_pk_mul_f32 v[12:13], v[12:13], v[106:107]
    v_pk_mul_f32 v[14:15], v[14:15], v[106:107]
    v_cvt_pk_bf16_f32 v8, v8, v9
    v_cvt_pk_bf16_f32 v9, v10, v11
    v_mfma_f32_16x16x32_bf16 a[168:171], v[98:101], v[152:155], a[168:171]
    ds_read_b128 v[200:203], v244 offset:20480
    ds_read_b128 v[204:207], v244 offset:21504
    v_cvt_pk_bf16_f32 v10, v12, v13
    v_cvt_pk_bf16_f32 v11, v14, v15
    ds_write_b128 v244, v[8:11] offset:1024
    v_accvgpr_read_b32 v16, a144
    v_mfma_f32_16x16x32_bf16 a[164:167], v[100:103], v[156:159], a[164:167]
    buffer_load_dwordx4 v255, s[24:27], s63 offen offset:3072 lds
    v_accvgpr_read_b32 v17, a145
    v_accvgpr_read_b32 v18, a146
    v_accvgpr_read_b32 v19, a147
    v_accvgpr_read_b32 v20, a152
    v_accvgpr_read_b32 v21, a153
    v_mfma_f32_16x16x32_bf16 a[172:175], v[98:101], v[156:159], a[172:175]
    v_accvgpr_read_b32 v22, a154
    v_accvgpr_read_b32 v23, a155
    v_pk_mul_f32 v[16:17], v[16:17], v[104:105]
    v_pk_mul_f32 v[18:19], v[18:19], v[104:105]
    v_pk_mul_f32 v[20:21], v[20:21], v[104:105]
    s_waitcnt lgkmcnt(6)
    s_add_u32 m0, s84, 49152
    s_mov_b32 s62, 0x00000100
    v_mfma_f32_16x16x32_bf16 a[176:179], v[100:103], v[168:171], a[176:179]
    buffer_load_dwordx4 v252, s[24:27], s62 offen lds
    v_pk_mul_f32 v[22:23], v[22:23], v[104:105]
    v_cvt_pk_bf16_f32 v16, v16, v17
    v_cvt_pk_bf16_f32 v17, v18, v19
    v_cvt_pk_bf16_f32 v18, v20, v21
    v_cvt_pk_bf16_f32 v19, v22, v23
    v_mfma_f32_16x16x32_bf16 a[184:187], v[98:101], v[168:171], a[184:187]
    ds_read_b128 v[216:219], v244 offset:24576
    ds_read_b128 v[220:223], v244 offset:25600
    ds_write_b128 v244, v[16:19] offset:4096
    v_accvgpr_read_b32 v24, a148
    v_accvgpr_read_b32 v25, a149
    v_accvgpr_read_b32 v26, a150
    v_mfma_f32_16x16x32_bf16 a[180:183], v[100:103], v[172:175], a[180:183]
    buffer_load_dwordx4 v253, s[24:27], s62 offen offset:1024 lds
    v_accvgpr_read_b32 v27, a151
    v_accvgpr_read_b32 v28, a156
    v_accvgpr_read_b32 v29, a157
    v_accvgpr_read_b32 v30, a158
    v_accvgpr_read_b32 v31, a159
    s_add_u32 s81, s82, 28672
    s_add_u32 s85, s82, 32768
    v_mfma_f32_16x16x32_bf16 a[188:191], v[98:101], v[172:175], a[188:191]
    v_pk_mul_f32 v[24:25], v[24:25], v[106:107]
    v_pk_mul_f32 v[26:27], v[26:27], v[106:107]
    v_pk_mul_f32 v[28:29], v[28:29], v[106:107]
    v_pk_mul_f32 v[30:31], v[30:31], v[106:107]
    v_cvt_pk_bf16_f32 v24, v24, v25
    v_cvt_pk_bf16_f32 v25, v26, v27
    v_cvt_pk_bf16_f32 v26, v28, v29
    s_waitcnt lgkmcnt(7)
    v_mfma_f32_16x16x32_bf16 a[192:195], v[100:103], v[184:187], a[192:195]
    buffer_load_dwordx4 v254, s[24:27], s62 offen offset:2048 lds
    v_cvt_pk_bf16_f32 v27, v30, v31
    ds_write_b128 v244, v[24:27] offset:5120
    v_accvgpr_read_b32 v32, a160
    s_mov_b32 s87, 0
    v_mfma_f32_16x16x32_bf16 a[200:203], v[98:101], v[184:187], a[200:203]
    ds_read_b128 v[232:235], v244 offset:28672
    ds_read_b128 v[236:239], v244 offset:29696
    v_accvgpr_read_b32 v33, a161
    v_accvgpr_read_b32 v34, a162
    v_accvgpr_read_b32 v35, a163
    v_accvgpr_read_b32 v36, a168
    v_accvgpr_read_b32 v37, a169
    v_accvgpr_read_b32 v38, a170
    v_mfma_f32_16x16x32_bf16 a[196:199], v[100:103], v[188:191], a[196:199]
    buffer_load_dwordx4 v255, s[24:27], s62 offen offset:3072 lds
    v_accvgpr_read_b32 v39, a171
    v_pk_mul_f32 v[32:33], v[32:33], v[104:105]
    v_pk_mul_f32 v[34:35], v[34:35], v[104:105]
    v_pk_mul_f32 v[36:37], v[36:37], v[104:105]
    v_pk_mul_f32 v[38:39], v[38:39], v[104:105]
    v_mfma_f32_16x16x32_bf16 a[204:207], v[98:101], v[188:191], a[204:207]
    v_cvt_pk_bf16_f32 v32, v32, v33
    v_cvt_pk_bf16_f32 v33, v34, v35
    v_cvt_pk_bf16_f32 v34, v36, v37
    v_cvt_pk_bf16_f32 v35, v38, v39
    ds_write_b128 v244, v[32:35] offset:8192
    s_waitcnt lgkmcnt(8)
    v_mfma_f32_16x16x32_bf16 a[208:211], v[100:103], v[200:203], a[208:211]
    v_accvgpr_read_b32 v40, a164
    v_accvgpr_read_b32 v41, a165
    v_accvgpr_read_b32 v42, a166
    v_accvgpr_read_b32 v43, a167
    v_accvgpr_read_b32 v44, a172
    v_accvgpr_read_b32 v45, a173
    v_accvgpr_read_b32 v46, a174
    v_mfma_f32_16x16x32_bf16 a[216:219], v[98:101], v[200:203], a[216:219]
    buffer_load_dwordx4 v[176:179], v67, s[36:39], s82 offen sc1
    v_accvgpr_read_b32 v47, a175
    v_pk_mul_f32 v[40:41], v[40:41], v[106:107]
    v_pk_mul_f32 v[42:43], v[42:43], v[106:107]
    v_pk_mul_f32 v[44:45], v[44:45], v[106:107]
    v_pk_mul_f32 v[46:47], v[46:47], v[106:107]
    v_cvt_pk_bf16_f32 v40, v40, v41
    v_cvt_pk_bf16_f32 v41, v42, v43
    v_cvt_pk_bf16_f32 v42, v44, v45
    v_mfma_f32_16x16x32_bf16 a[212:215], v[100:103], v[204:207], a[212:215]
    buffer_load_dwordx4 v[180:183], v67, s[36:39], s81 offen sc1
    v_cvt_pk_bf16_f32 v43, v46, v47
    ds_write_b128 v244, v[40:43] offset:9216
    v_accvgpr_read_b32 v48, a176
    v_accvgpr_read_b32 v49, a177
    v_accvgpr_read_b32 v50, a178
    v_mfma_f32_16x16x32_bf16 a[220:223], v[98:101], v[204:207], a[220:223]
    v_accvgpr_read_b32 v51, a179
    v_accvgpr_read_b32 v52, a184
    v_accvgpr_read_b32 v53, a185
    v_accvgpr_read_b32 v54, a186
    v_accvgpr_read_b32 v55, a187
    v_pk_mul_f32 v[48:49], v[48:49], v[104:105]
    v_pk_mul_f32 v[50:51], v[50:51], v[104:105]
    s_waitcnt lgkmcnt(6)
    v_mfma_f32_16x16x32_bf16 a[224:227], v[100:103], v[216:219], a[224:227]
    buffer_load_dwordx4 v[192:195], v67, s[36:39], s82 offen offset:1024 sc1
    v_pk_mul_f32 v[52:53], v[52:53], v[104:105]
    v_pk_mul_f32 v[54:55], v[54:55], v[104:105]
    v_cvt_pk_bf16_f32 v48, v48, v49
    v_cvt_pk_bf16_f32 v49, v50, v51
    v_cvt_pk_bf16_f32 v50, v52, v53
    v_cvt_pk_bf16_f32 v51, v54, v55
    v_accvgpr_read_b32 v56, a180
    v_mfma_f32_16x16x32_bf16 a[232:235], v[98:101], v[216:219], a[232:235]
    buffer_load_dwordx4 v[196:199], v67, s[36:39], s81 offen offset:1024 sc1
    ds_write_b128 v244, v[48:51] offset:12288
    v_accvgpr_read_b32 v57, a181
    v_accvgpr_read_b32 v58, a182
    v_accvgpr_read_b32 v59, a183
    v_accvgpr_read_b32 v60, a188
    v_accvgpr_read_b32 v61, a189
    v_mfma_f32_16x16x32_bf16 a[228:231], v[100:103], v[220:223], a[228:231]
    buffer_load_dwordx4 v[208:211], v67, s[36:39], s82 offen offset:2048 sc1
    v_accvgpr_read_b32 v62, a190
    v_accvgpr_read_b32 v63, a191
    v_pk_mul_f32 v[56:57], v[56:57], v[106:107]
    v_pk_mul_f32 v[58:59], v[58:59], v[106:107]
    v_pk_mul_f32 v[60:61], v[60:61], v[106:107]
    v_pk_mul_f32 v[62:63], v[62:63], v[106:107]
    v_cvt_pk_bf16_f32 v56, v56, v57
    v_mfma_f32_16x16x32_bf16 a[236:239], v[98:101], v[220:223], a[236:239]
    buffer_load_dwordx4 v[212:215], v67, s[36:39], s81 offen offset:2048 sc1
    v_cvt_pk_bf16_f32 v57, v58, v59
    v_cvt_pk_bf16_f32 v58, v60, v61
    v_cvt_pk_bf16_f32 v59, v62, v63
    ds_write_b128 v244, v[56:59] offset:13312
    s_waitcnt lgkmcnt(4)
    v_mfma_f32_16x16x32_bf16 a[240:243], v[100:103], v[232:235], a[240:243]
    s_waitcnt lgkmcnt(0)
    s_barrier
    v_accvgpr_read_b32 v0, a192
    v_accvgpr_read_b32 v1, a193
    v_accvgpr_read_b32 v2, a194
    v_accvgpr_read_b32 v3, a195
    v_mfma_f32_16x16x32_bf16 a[248:251], v[98:101], v[232:235], a[248:251]
    ds_read_b128 a[0:3], v248
    ds_read_b128 a[4:7], v248 offset:1024
    buffer_load_dwordx4 v[224:227], v67, s[36:39], s82 offen offset:3072 sc1
    v_accvgpr_read_b32 v4, a200
    v_accvgpr_read_b32 v5, a201
    v_accvgpr_read_b32 v6, a202
    v_accvgpr_read_b32 v7, a203
    v_pk_mul_f32 v[0:1], v[0:1], v[104:105]
    v_mfma_f32_16x16x32_bf16 a[244:247], v[100:103], v[236:239], a[244:247]
    ds_read_b128 a[8:11], v249
    ds_read_b128 a[12:15], v249 offset:1024
    buffer_load_dwordx4 v[228:231], v67, s[36:39], s81 offen offset:3072 sc1
    v_pk_mul_f32 v[2:3], v[2:3], v[104:105]
    v_pk_mul_f32 v[4:5], v[4:5], v[104:105]
    v_pk_mul_f32 v[6:7], v[6:7], v[104:105]
    v_cvt_pk_bf16_f32 v0, v0, v1
    v_mfma_f32_16x16x32_bf16 a[252:255], v[98:101], v[236:239], a[252:255]
    v_cvt_pk_bf16_f32 v1, v2, v3
    v_cvt_pk_bf16_f32 v2, v4, v5
    v_cvt_pk_bf16_f32 v3, v6, v7
    ds_write_b128 v244, v[0:3] offset:16384
    ds_read_b128 a[16:19], v248 offset:4096
    ds_read_b128 a[20:23], v248 offset:5120
    buffer_load_dwordx4 v[184:187], v67, s[36:39], s80 offen sc1
    v_accvgpr_read_b32 v8, a196
    v_accvgpr_read_b32 v9, a197
    v_accvgpr_read_b32 v10, a198
    v_accvgpr_read_b32 v11, a199
    v_accvgpr_read_b32 v12, a204
    ds_read_b128 a[24:27], v249 offset:4096
    ds_read_b128 a[28:31], v249 offset:5120
    v_accvgpr_read_b32 v13, a205
    v_accvgpr_read_b32 v14, a206
    v_accvgpr_read_b32 v15, a207
    v_pk_mul_f32 v[8:9], v[8:9], v[106:107]
    v_pk_mul_f32 v[10:11], v[10:11], v[106:107]
    v_pk_mul_f32 v[12:13], v[12:13], v[106:107]
    v_pk_mul_f32 v[14:15], v[14:15], v[106:107]
    v_cvt_pk_bf16_f32 v8, v8, v9
    v_cvt_pk_bf16_f32 v9, v10, v11
    v_cvt_pk_bf16_f32 v10, v12, v13
    v_cvt_pk_bf16_f32 v11, v14, v15
    ds_write_b128 v244, v[8:11] offset:17408
    v_accvgpr_read_b32 v16, a208
    v_accvgpr_read_b32 v17, a209
    s_waitcnt lgkmcnt(6)
    v_mfma_f32_16x16x32_bf16 v[144:147], a[64:67], a[0:3], 0
    ds_read_b128 a[32:35], v248 offset:8192
    ds_read_b128 a[36:39], v248 offset:9216
    buffer_load_dwordx4 v[188:191], v67, s[36:39], s85 offen sc1
    v_accvgpr_read_b32 v18, a210
    v_accvgpr_read_b32 v19, a211
    v_accvgpr_read_b32 v20, a216
    v_accvgpr_read_b32 v21, a217
    v_mfma_f32_16x16x32_bf16 v[148:151], a[64:67], a[4:7], 0
    ds_read_b128 a[40:43], v249 offset:8192
    ds_read_b128 a[44:47], v249 offset:9216
    v_accvgpr_read_b32 v22, a218
    v_accvgpr_read_b32 v23, a219
    v_pk_mul_f32 v[16:17], v[16:17], v[104:105]
    v_pk_mul_f32 v[18:19], v[18:19], v[104:105]
    v_mfma_f32_16x16x32_bf16 v[152:155], a[64:67], a[8:11], 0
    v_pk_mul_f32 v[20:21], v[20:21], v[104:105]
    v_pk_mul_f32 v[22:23], v[22:23], v[104:105]
    v_cvt_pk_bf16_f32 v16, v16, v17
    v_cvt_pk_bf16_f32 v17, v18, v19
    v_cvt_pk_bf16_f32 v18, v20, v21
    v_cvt_pk_bf16_f32 v19, v22, v23
    v_mfma_f32_16x16x32_bf16 v[156:159], a[64:67], a[12:15], 0
    buffer_load_dwordx4 v[200:203], v67, s[36:39], s80 offen offset:1024 sc1
    ds_write_b128 v244, v[16:19] offset:20480
    v_accvgpr_read_b32 v24, a212
    v_accvgpr_read_b32 v25, a213
    v_accvgpr_read_b32 v26, a214
    s_waitcnt lgkmcnt(6)
    v_mfma_f32_16x16x32_bf16 v[144:147], a[68:71], a[16:19], v[144:147]
    ds_read_b128 a[48:51], v248 offset:12288
    ds_read_b128 a[52:55], v248 offset:13312
    v_accvgpr_read_b32 v27, a215
    v_accvgpr_read_b32 v28, a220
    v_accvgpr_read_b32 v29, a221
    v_accvgpr_read_b32 v30, a222
    v_mfma_f32_16x16x32_bf16 v[148:151], a[68:71], a[20:23], v[148:151]
    ds_read_b128 a[56:59], v249 offset:12288
    ds_read_b128 a[60:63], v249 offset:13312
    v_accvgpr_read_b32 v31, a223
    v_pk_mul_f32 v[24:25], v[24:25], v[106:107]
    v_pk_mul_f32 v[26:27], v[26:27], v[106:107]
    v_pk_mul_f32 v[28:29], v[28:29], v[106:107]
    v_mfma_f32_16x16x32_bf16 v[152:155], a[68:71], a[24:27], v[152:155]
    v_pk_mul_f32 v[30:31], v[30:31], v[106:107]
    v_cvt_pk_bf16_f32 v24, v24, v25
    v_cvt_pk_bf16_f32 v25, v26, v27
    v_cvt_pk_bf16_f32 v26, v28, v29
    v_cvt_pk_bf16_f32 v27, v30, v31
    v_accvgpr_read_b32 v32, a224
    v_accvgpr_read_b32 v33, a225
    v_mfma_f32_16x16x32_bf16 v[156:159], a[68:71], a[28:31], v[156:159]
    buffer_load_dwordx4 v[204:207], v67, s[36:39], s85 offen offset:1024 sc1
    ds_write_b128 v244, v[24:27] offset:21504
    v_accvgpr_read_b32 v34, a226
    v_accvgpr_read_b32 v35, a227
    s_waitcnt lgkmcnt(6)
    v_mfma_f32_16x16x32_bf16 v[144:147], a[72:75], a[32:35], v[144:147]
    ds_read_b128 a[128:131], v248 offset:32768
    ds_read_b128 a[132:135], v248 offset:33792
    v_accvgpr_read_b32 v36, a232
    v_accvgpr_read_b32 v37, a233
    v_accvgpr_read_b32 v38, a234
    v_accvgpr_read_b32 v39, a235
    v_mfma_f32_16x16x32_bf16 v[148:151], a[72:75], a[36:39], v[148:151]
    ds_read_b128 a[136:139], v249 offset:32768
    ds_read_b128 a[140:143], v249 offset:33792
    v_pk_mul_f32 v[32:33], v[32:33], v[104:105]
    v_pk_mul_f32 v[34:35], v[34:35], v[104:105]
    v_pk_mul_f32 v[36:37], v[36:37], v[104:105]
    v_pk_mul_f32 v[38:39], v[38:39], v[104:105]
    v_cvt_pk_bf16_f32 v32, v32, v33
    v_mfma_f32_16x16x32_bf16 v[152:155], a[72:75], a[40:43], v[152:155]
    buffer_load_dwordx4 v[216:219], v67, s[36:39], s80 offen offset:2048 sc1
    v_cvt_pk_bf16_f32 v33, v34, v35
    v_cvt_pk_bf16_f32 v34, v36, v37
    v_cvt_pk_bf16_f32 v35, v38, v39
    ds_write_b128 v244, v[32:35] offset:24576
    v_mfma_f32_16x16x32_bf16 v[156:159], a[72:75], a[44:47], v[156:159]
    v_accvgpr_read_b32 v40, a228
    v_accvgpr_read_b32 v41, a229
    v_accvgpr_read_b32 v42, a230
    v_accvgpr_read_b32 v43, a231
    v_accvgpr_read_b32 v44, a236
    s_waitcnt lgkmcnt(6)
    v_mfma_f32_16x16x32_bf16 v[144:147], a[76:79], a[48:51], v[144:147]
    ds_read_b128 a[144:147], v248 offset:36864
    ds_read_b128 a[148:151], v248 offset:37888
    v_accvgpr_read_b32 v45, a237
    v_accvgpr_read_b32 v46, a238
    v_accvgpr_read_b32 v47, a239
    v_pk_mul_f32 v[40:41], v[40:41], v[106:107]
    v_mfma_f32_16x16x32_bf16 v[148:151], a[76:79], a[52:55], v[148:151]
    ds_read_b128 a[152:155], v249 offset:36864
    ds_read_b128 a[156:159], v249 offset:37888
    v_pk_mul_f32 v[42:43], v[42:43], v[106:107]
    v_pk_mul_f32 v[44:45], v[44:45], v[106:107]
    v_pk_mul_f32 v[46:47], v[46:47], v[106:107]
    v_cvt_pk_bf16_f32 v40, v40, v41
    v_cvt_pk_bf16_f32 v41, v42, v43
    v_mfma_f32_16x16x32_bf16 v[152:155], a[76:79], a[56:59], v[152:155]
    buffer_load_dwordx4 v[220:223], v67, s[36:39], s85 offen offset:2048 sc1
    v_cvt_pk_bf16_f32 v42, v44, v45
    v_cvt_pk_bf16_f32 v43, v46, v47
    ds_write_b128 v244, v[40:43] offset:25600
    v_accvgpr_read_b32 v48, a240
    v_mfma_f32_16x16x32_bf16 v[156:159], a[76:79], a[60:63], v[156:159]
    v_accvgpr_read_b32 v49, a241
    v_accvgpr_read_b32 v50, a242
    v_accvgpr_read_b32 v51, a243
    v_accvgpr_read_b32 v52, a248
    v_accvgpr_read_b32 v53, a249
    s_waitcnt lgkmcnt(6)
    v_mfma_f32_16x16x32_bf16 v[144:147], a[96:99], a[128:131], v[144:147]
    ds_read_b128 a[160:163], v248 offset:40960
    ds_read_b128 a[164:167], v248 offset:41984
    buffer_load_dwordx2 v[72:73], v246, s[8:11], s83 offen
    buffer_load_dwordx2 v[74:75], v246, s[8:11], s83 offen offset:256
    v_accvgpr_read_b32 v54, a250
    v_mfma_f32_16x16x32_bf16 v[148:151], a[96:99], a[132:135], v[148:151]
    ds_read_b128 a[168:171], v249 offset:40960
    ds_read_b128 a[172:175], v249 offset:41984
    buffer_load_dwordx2 v[76:77], v246, s[8:11], s83 offen offset:512
    s_mov_b32 exec_hi, 0
    buffer_load_dwordx2 v[78:79], v246, s[8:11], s83 offen offset:768
    s_mov_b32 exec_hi, -1
    v_mfma_f32_16x16x32_bf16 v[152:155], a[96:99], a[136:139], v[152:155]
    v_accvgpr_read_b32 v55, a251
    v_pk_mul_f32 v[48:49], v[48:49], v[104:105]
    v_pk_mul_f32 v[50:51], v[50:51], v[104:105]
    v_pk_mul_f32 v[52:53], v[52:53], v[104:105]
    v_pk_mul_f32 v[54:55], v[54:55], v[104:105]
    v_cvt_pk_bf16_f32 v48, v48, v49
    v_mfma_f32_16x16x32_bf16 v[156:159], a[96:99], a[140:143], v[156:159]
    v_cvt_pk_bf16_f32 v49, v50, v51
    v_cvt_pk_bf16_f32 v50, v52, v53
    v_cvt_pk_bf16_f32 v51, v54, v55
    ds_write_b128 v244, v[48:51] offset:28672
    s_waitcnt lgkmcnt(6)
    v_mfma_f32_16x16x32_bf16 v[144:147], a[100:103], a[144:147], v[144:147]
    ds_read_b128 a[176:179], v248 offset:45056
    ds_read_b128 a[180:183], v248 offset:46080
    v_accvgpr_read_b32 v56, a244
    v_accvgpr_read_b32 v57, a245
    v_accvgpr_read_b32 v58, a246
    v_accvgpr_read_b32 v59, a247
    v_mfma_f32_16x16x32_bf16 v[148:151], a[100:103], a[148:151], v[148:151]
    ds_read_b128 a[184:187], v249 offset:45056
    ds_read_b128 a[188:191], v249 offset:46080
    v_accvgpr_read_b32 v60, a252
    v_accvgpr_read_b32 v61, a253
    v_accvgpr_read_b32 v62, a254
    v_accvgpr_read_b32 v63, a255
    v_mfma_f32_16x16x32_bf16 v[152:155], a[100:103], a[152:155], v[152:155]
    v_pk_mul_f32 v[56:57], v[56:57], v[106:107]
    v_pk_mul_f32 v[58:59], v[58:59], v[106:107]
    v_pk_mul_f32 v[60:61], v[60:61], v[106:107]
    v_pk_mul_f32 v[62:63], v[62:63], v[106:107]
    v_cvt_pk_bf16_f32 v56, v56, v57
    v_cvt_pk_bf16_f32 v57, v58, v59
    v_mfma_f32_16x16x32_bf16 v[156:159], a[100:103], a[156:159], v[156:159]
    v_cvt_pk_bf16_f32 v58, v60, v61
    v_cvt_pk_bf16_f32 v59, v62, v63
    ds_write_b128 v244, v[56:59] offset:29696
    s_waitcnt lgkmcnt(6)
    v_mfma_f32_16x16x32_bf16 v[144:147], a[104:107], a[160:163], v[144:147]
    s_waitcnt lgkmcnt(0)
    s_barrier
    v_mfma_f32_16x16x32_bf16 v[148:151], a[104:107], a[164:167], v[148:151]
    ds_read_b128 v[0:3], v248 offset:16384
    ds_read_b128 v[4:7], v248 offset:17408
    v_mfma_f32_16x16x32_bf16 v[152:155], a[104:107], a[168:171], v[152:155]
    ds_read_b128 v[8:11], v249 offset:16384
    ds_read_b128 v[12:15], v249 offset:17408
    v_mfma_f32_16x16x32_bf16 v[156:159], a[104:107], a[172:175], v[156:159]
    v_bfe_u32 v64, v250, 2, 2
    v_mfma_f32_16x16x32_bf16 v[144:147], a[108:111], a[176:179], v[144:147]
    ds_read_b128 v[16:19], v248 offset:20480
    ds_read_b128 v[20:23], v248 offset:21504
    v_mfma_f32_16x16x32_bf16 v[148:151], a[108:111], a[180:183], v[148:151]
    ds_read_b128 v[24:27], v249 offset:20480
    ds_read_b128 v[28:31], v249 offset:21504
    s_add_u32 m0, s84, 98304
    s_mov_b32 s63, 0x0001c100
    v_mfma_f32_16x16x32_bf16 v[152:155], a[108:111], a[184:187], v[152:155]
    buffer_load_dwordx4 v252, s[24:27], s63 offen lds
    v_mfma_f32_16x16x32_bf16 v[156:159], a[108:111], a[188:191], v[156:159]
    v_mul_u32_u24 v64, 57344, v64
    s_waitcnt lgkmcnt(4)
    v_mfma_f32_16x16x32_bf16 v[144:147], a[80:83], v[0:3], v[144:147]
    ds_read_b128 v[32:35], v248 offset:24576
    ds_read_b128 v[36:39], v248 offset:25600
    v_mfma_f32_16x16x32_bf16 v[148:151], a[80:83], v[4:7], v[148:151]
    ds_read_b128 v[40:43], v249 offset:24576
    ds_read_b128 v[44:47], v249 offset:25600
    v_mfma_f32_16x16x32_bf16 v[152:155], a[80:83], v[8:11], v[152:155]
    buffer_load_dwordx4 v253, s[24:27], s63 offen offset:1024 lds
    v_mfma_f32_16x16x32_bf16 v[156:159], a[80:83], v[12:15], v[156:159]
    v_lshrrev_b32 v70, 4, v250
    s_waitcnt lgkmcnt(4)
    v_mfma_f32_16x16x32_bf16 v[144:147], a[84:87], v[16:19], v[144:147]
    ds_read_b128 v[48:51], v248 offset:28672
    ds_read_b128 v[52:55], v248 offset:29696
    v_mfma_f32_16x16x32_bf16 v[148:151], a[84:87], v[20:23], v[148:151]
    ds_read_b128 v[56:59], v249 offset:28672
    ds_read_b128 v[60:63], v249 offset:29696
    v_mfma_f32_16x16x32_bf16 v[152:155], a[84:87], v[24:27], v[152:155]
    buffer_load_dwordx4 v254, s[24:27], s63 offen offset:2048 lds
    v_mfma_f32_16x16x32_bf16 v[156:159], a[84:87], v[28:31], v[156:159]
    buffer_load_dwordx4 v255, s[24:27], s63 offen offset:3072 lds
    s_waitcnt lgkmcnt(4)
    v_mfma_f32_16x16x32_bf16 v[144:147], a[88:91], v[32:35], v[144:147]
    ds_read_b128 a[192:195], v248 offset:49152
    ds_read_b128 a[196:199], v248 offset:50176
    v_mfma_f32_16x16x32_bf16 v[148:151], a[88:91], v[36:39], v[148:151]
    ds_read_b128 a[200:203], v249 offset:49152
    ds_read_b128 a[204:207], v249 offset:50176
    v_mfma_f32_16x16x32_bf16 v[152:155], a[88:91], v[40:43], v[152:155]
    v_lshl_add_u32 v64, v70, 6, v64
    v_and_b32 v70, 3, v250
    v_mfma_f32_16x16x32_bf16 v[156:159], a[88:91], v[44:47], v[156:159]
    v_lshl_add_u32 v64, v70, 4, v64
    s_waitcnt lgkmcnt(4)
    v_mfma_f32_16x16x32_bf16 v[144:147], a[92:95], v[48:51], v[144:147]
    ds_read_b128 a[208:211], v248 offset:53248
    ds_read_b128 a[212:215], v248 offset:54272
    v_mfma_f32_16x16x32_bf16 v[148:151], a[92:95], v[52:55], v[148:151]
    ds_read_b128 a[216:219], v249 offset:53248
    ds_read_b128 a[220:223], v249 offset:54272
    s_add_u32 m0, s84, 131072
    s_mov_b32 s62, 0x00038100
    v_mfma_f32_16x16x32_bf16 v[152:155], a[92:95], v[56:59], v[152:155]
    buffer_load_dwordx4 v252, s[24:27], s62 offen lds
    v_mfma_f32_16x16x32_bf16 v[156:159], a[92:95], v[60:63], v[156:159]
    s_lshl_b32 s48, s44, 8
    s_add_u32 s58, s58, s48
    s_add_u32 s57, s57, s48
    s_waitcnt lgkmcnt(4)
    v_mfma_f32_16x16x32_bf16 v[144:147], a[112:115], a[192:195], v[144:147]
    ds_read_b128 a[224:227], v248 offset:57344
    ds_read_b128 a[228:231], v248 offset:58368
    v_mfma_f32_16x16x32_bf16 v[148:151], a[112:115], a[196:199], v[148:151]
    ds_read_b128 a[232:235], v249 offset:57344
    ds_read_b128 a[236:239], v249 offset:58368
    v_mfma_f32_16x16x32_bf16 v[152:155], a[112:115], a[200:203], v[152:155]
    buffer_load_dwordx4 v253, s[24:27], s62 offen offset:1024 lds
    v_mfma_f32_16x16x32_bf16 v[156:159], a[112:115], a[204:207], v[156:159]
    v_and_b32 v70, 1, v250
    s_waitcnt lgkmcnt(4)
    v_mfma_f32_16x16x32_bf16 v[144:147], a[116:119], a[208:211], v[144:147]
    ds_read_b128 a[240:243], v248 offset:61440
    ds_read_b128 a[244:247], v248 offset:62464
    v_mfma_f32_16x16x32_bf16 v[148:151], a[116:119], a[212:215], v[148:151]
    ds_read_b128 a[248:251], v249 offset:61440
    ds_read_b128 a[252:255], v249 offset:62464
    v_mfma_f32_16x16x32_bf16 v[152:155], a[116:119], a[216:219], v[152:155]
    buffer_load_dwordx4 v254, s[24:27], s62 offen offset:2048 lds
    v_mfma_f32_16x16x32_bf16 v[156:159], a[116:119], a[220:223], v[156:159]
    v_lshlrev_b32 v70, 4, v70
    s_waitcnt lgkmcnt(4)
    v_mfma_f32_16x16x32_bf16 v[144:147], a[120:123], a[224:227], v[144:147]
    s_waitcnt vmcnt(37) lgkmcnt(0)
    s_barrier
    v_mfma_f32_16x16x32_bf16 v[148:151], a[120:123], a[228:231], v[148:151]
    ds_read_b64_tr_b16 v[112:113], v240
    ds_read_b64_tr_b16 v[114:115], v240 offset:2048
    buffer_load_dwordx4 v255, s[24:27], s62 offen offset:3072 lds
    v_mfma_f32_16x16x32_bf16 v[152:155], a[120:123], a[232:235], v[152:155]
    ds_read_b64_tr_b16 v[116:117], v240 offset:4096
    ds_read_b64_tr_b16 v[118:119], v240 offset:6144
    v_mfma_f32_16x16x32_bf16 v[156:159], a[120:123], a[236:239], v[156:159]
    v_mov_b32 v71, 0x3f80
    v_mfma_f32_16x16x32_bf16 v[144:147], a[124:127], a[240:243], v[144:147]
    v_lshlrev_b32 v70, v70, v71
    v_bfe_u32 v71, v250, 1, 3
    v_mfma_f32_16x16x32_bf16 v[148:151], a[124:127], a[244:247], v[148:151]
    ds_read_b64_tr_b16 v[120:121], v240 offset:8192
    ds_read_b64_tr_b16 v[122:123], v240 offset:10240
    s_add_u32 m0, s84, 114688
    s_mov_b32 s63, 0x00054100
    v_mfma_f32_16x16x32_bf16 v[152:155], a[124:127], a[248:251], v[152:155]
    buffer_load_dwordx4 v252, s[24:27], s63 offen lds
    v_mfma_f32_16x16x32_bf16 v[156:159], a[124:127], a[252:255], v[156:159]
    v_cvt_pk_bf16_f32 v144, v144, v145
    s_waitcnt lgkmcnt(4)
    v_mfma_f32_16x16x32_bf16 v[160:163], v[112:115], a[0:3], 0
    v_cvt_pk_bf16_f32 v145, v146, v147
    v_cvt_pk_bf16_f32 v146, v148, v149
    v_mfma_f32_16x16x32_bf16 v[164:167], v[112:115], a[4:7], 0
    ds_read_b64_tr_b16 v[124:125], v240 offset:12288
    ds_read_b64_tr_b16 v[126:127], v240 offset:14336
    v_mfma_f32_16x16x32_bf16 v[168:171], v[112:115], a[8:11], 0
    buffer_load_dwordx4 v253, s[24:27], s63 offen offset:1024 lds
    v_mfma_f32_16x16x32_bf16 v[172:175], v[112:115], a[12:15], 0
    v_cvt_pk_bf16_f32 v147, v150, v151
    s_waitcnt lgkmcnt(4)
    v_mfma_f32_16x16x32_bf16 v[160:163], v[116:119], a[16:19], v[160:163]
    v_cvt_pk_bf16_f32 v152, v152, v153
    v_cvt_pk_bf16_f32 v153, v154, v155
    v_mfma_f32_16x16x32_bf16 v[164:167], v[116:119], a[20:23], v[164:167]
    ds_read_b64_tr_b16 v[128:129], v240 offset:16384
    ds_read_b64_tr_b16 v[130:131], v240 offset:18432
    v_mfma_f32_16x16x32_bf16 v[168:171], v[116:119], a[24:27], v[168:171]
    v_cvt_pk_bf16_f32 v154, v156, v157
    v_cvt_pk_bf16_f32 v155, v158, v159
    v_mfma_f32_16x16x32_bf16 v[172:175], v[116:119], a[28:31], v[172:175]
    v_cmp_eq_u32 s[50:51], 0, v71
    s_waitcnt lgkmcnt(4)
    v_mfma_f32_16x16x32_bf16 v[160:163], v[120:123], a[32:35], v[160:163]
    buffer_load_dwordx4 v254, s[24:27], s63 offen offset:2048 lds
    v_mfma_f32_16x16x32_bf16 v[164:167], v[120:123], a[36:39], v[164:167]
    ds_read_b64_tr_b16 v[132:133], v240 offset:20480
    ds_read_b64_tr_b16 v[134:135], v240 offset:22528
    v_mfma_f32_16x16x32_bf16 v[168:171], v[120:123], a[40:43], v[168:171]
    v_cndmask_b32 v96, 0, v70, s[50:51]
    v_mfma_f32_16x16x32_bf16 v[172:175], v[120:123], a[44:47], v[172:175]
    v_cmp_eq_u32 s[50:51], 1, v71
    s_waitcnt lgkmcnt(4)
    v_mfma_f32_16x16x32_bf16 v[160:163], v[124:127], a[48:51], v[160:163]
    buffer_load_dwordx4 v255, s[24:27], s63 offen offset:3072 lds
    v_mfma_f32_16x16x32_bf16 v[164:167], v[124:127], a[52:55], v[164:167]
    ds_read_b64_tr_b16 v[136:137], v240 offset:24576
    ds_read_b64_tr_b16 v[138:139], v240 offset:26624
    v_mfma_f32_16x16x32_bf16 v[168:171], v[124:127], a[56:59], v[168:171]
    buffer_store_dwordx4 v[144:147], v64, s[36:39], s58 offen sc1
    v_mfma_f32_16x16x32_bf16 v[172:175], v[124:127], a[60:63], v[172:175]
    s_waitcnt lgkmcnt(4)
    s_add_u32 m0, s84, 147456
    s_mov_b32 s62, 0x00000180
    v_mfma_f32_16x16x32_bf16 v[160:163], v[128:131], v[0:3], v[160:163]
    buffer_load_dwordx4 v252, s[24:27], s62 offen lds
    v_mfma_f32_16x16x32_bf16 v[164:167], v[128:131], v[4:7], v[164:167]
    ds_read_b64_tr_b16 v[140:141], v240 offset:28672
    ds_read_b64_tr_b16 v[142:143], v240 offset:30720
    v_mfma_f32_16x16x32_bf16 v[168:171], v[128:131], v[8:11], v[168:171]
    v_cndmask_b32 v97, 0, v70, s[50:51]
    v_mfma_f32_16x16x32_bf16 v[172:175], v[128:131], v[12:15], v[172:175]
    v_cmp_eq_u32 s[50:51], 2, v71
    s_waitcnt lgkmcnt(4)
    v_mfma_f32_16x16x32_bf16 v[160:163], v[132:135], v[16:19], v[160:163]
    buffer_load_dwordx4 v253, s[24:27], s62 offen offset:1024 lds
    v_mfma_f32_16x16x32_bf16 v[164:167], v[132:135], v[20:23], v[164:167]
    v_cndmask_b32 v98, 0, v70, s[50:51]
    v_mfma_f32_16x16x32_bf16 v[168:171], v[132:135], v[24:27], v[168:171]
    v_cmp_eq_u32 s[50:51], 3, v71
    v_mfma_f32_16x16x32_bf16 v[172:175], v[132:135], v[28:31], v[172:175]
    s_nop 0
    v_cndmask_b32 v99, 0, v70, s[50:51]
    s_waitcnt lgkmcnt(2)
    v_mfma_f32_16x16x32_bf16 v[160:163], v[136:139], v[32:35], v[160:163]
    s_waitcnt vmcnt(37) lgkmcnt(0)
    s_barrier
    v_mfma_f32_16x16x32_bf16 v[164:167], v[136:139], v[36:39], v[164:167]
    ds_read_b64_tr_b16 v[112:113], v241 offset:2048
    ds_read_b64_tr_b16 v[114:115], v241 offset:4096
    v_mfma_f32_16x16x32_bf16 v[168:171], v[136:139], v[40:43], v[168:171]
    ds_read_b64_tr_b16 v[116:117], v241 offset:6144
    ds_read_b64_tr_b16 v[118:119], v241 offset:8192
    v_mfma_f32_16x16x32_bf16 v[172:175], v[136:139], v[44:47], v[172:175]
    v_cmp_eq_u32 s[50:51], 4, v71
    v_mfma_f32_16x16x32_bf16 v[160:163], v[140:143], v[48:51], v[160:163]
    buffer_load_dwordx4 v254, s[24:27], s62 offen offset:2048 lds
    v_mfma_f32_16x16x32_bf16 v[164:167], v[140:143], v[52:55], v[164:167]
    ds_read_b64_tr_b16 v[120:121], v241 offset:10240
    ds_read_b64_tr_b16 v[122:123], v241 offset:12288
    v_mfma_f32_16x16x32_bf16 v[168:171], v[140:143], v[56:59], v[168:171]
    buffer_load_dwordx4 v255, s[24:27], s62 offen offset:3072 lds
    v_mfma_f32_16x16x32_bf16 v[172:175], v[140:143], v[60:63], v[172:175]
    v_cndmask_b32 v100, 0, v70, s[50:51]
    s_waitcnt lgkmcnt(4)
    v_mfma_f32_16x16x32_bf16 v[160:163], v[112:115], a[128:131], v[160:163]
    v_cmp_eq_u32 s[50:51], 5, v71
    v_mfma_f32_16x16x32_bf16 v[164:167], v[112:115], a[132:135], v[164:167]
    ds_read_b64_tr_b16 v[124:125], v241 offset:14336
    ds_read_b64_tr_b16 v[126:127], v241 offset:16384
    s_add_u32 m0, s84, 0
    s_mov_b32 s63, 0x0001c180
    v_mfma_f32_16x16x32_bf16 v[168:171], v[112:115], a[136:139], v[168:171]
    buffer_load_dwordx4 v252, s[24:27], s63 offen lds
    v_mfma_f32_16x16x32_bf16 v[172:175], v[112:115], a[140:143], v[172:175]
    v_cndmask_b32 v101, 0, v70, s[50:51]
    s_waitcnt lgkmcnt(4)
    v_mfma_f32_16x16x32_bf16 v[160:163], v[116:119], a[144:147], v[160:163]
    v_cmp_eq_u32 s[50:51], 6, v71
    v_mfma_f32_16x16x32_bf16 v[164:167], v[116:119], a[148:151], v[164:167]
    ds_read_b64_tr_b16 v[128:129], v240 offset:32768
    ds_read_b64_tr_b16 v[130:131], v240 offset:34816
    v_mfma_f32_16x16x32_bf16 v[168:171], v[116:119], a[152:155], v[168:171]
    buffer_load_dwordx4 v253, s[24:27], s63 offen offset:1024 lds
    v_mfma_f32_16x16x32_bf16 v[172:175], v[116:119], a[156:159], v[172:175]
    v_cndmask_b32 v102, 0, v70, s[50:51]
    s_waitcnt lgkmcnt(4)
    v_mfma_f32_16x16x32_bf16 v[160:163], v[120:123], a[160:163], v[160:163]
    v_cmp_eq_u32 s[50:51], 7, v71
    v_mfma_f32_16x16x32_bf16 v[164:167], v[120:123], a[164:167], v[164:167]
    ds_read_b64_tr_b16 v[132:133], v240 offset:36864
    ds_read_b64_tr_b16 v[134:135], v240 offset:38912
    v_mfma_f32_16x16x32_bf16 v[168:171], v[120:123], a[168:171], v[168:171]
    v_cndmask_b32 v103, 0, v70, s[50:51]
    v_mfma_f32_16x16x32_bf16 v[172:175], v[120:123], a[172:175], v[172:175]
    s_waitcnt lgkmcnt(4)
    v_mfma_f32_16x16x32_bf16 v[160:163], v[124:127], a[176:179], v[160:163]
    buffer_load_dwordx4 v254, s[24:27], s63 offen offset:2048 lds
    v_mfma_f32_16x16x32_bf16 v[164:167], v[124:127], a[180:183], v[164:167]
    ds_read_b64_tr_b16 v[136:137], v240 offset:40960
    ds_read_b64_tr_b16 v[138:139], v240 offset:43008
    v_mfma_f32_16x16x32_bf16 v[168:171], v[124:127], a[184:187], v[168:171]
    v_mfma_f32_16x16x32_bf16 v[172:175], v[124:127], a[188:191], v[172:175]
    s_waitcnt lgkmcnt(4)
    v_mfma_f32_16x16x32_bf16 v[160:163], v[128:131], a[192:195], v[160:163]
    buffer_load_dwordx4 v255, s[24:27], s63 offen offset:3072 lds
    v_mfma_f32_16x16x32_bf16 v[164:167], v[128:131], a[196:199], v[164:167]
    ds_read_b64_tr_b16 v[140:141], v240 offset:45056
    ds_read_b64_tr_b16 v[142:143], v240 offset:47104
    v_mfma_f32_16x16x32_bf16 v[168:171], v[128:131], a[200:203], v[168:171]
    buffer_store_dwordx4 v[152:155], v64, s[36:39], s57 offen sc1
    v_mfma_f32_16x16x32_bf16 v[172:175], v[128:131], a[204:207], v[172:175]
    s_waitcnt lgkmcnt(4)
    s_add_u32 m0, s84, 16384
    s_mov_b32 s62, 0x00038180
    v_mfma_f32_16x16x32_bf16 v[160:163], v[132:135], a[208:211], v[160:163]
    buffer_load_dwordx4 v252, s[24:27], s62 offen lds
    v_mfma_f32_16x16x32_bf16 v[164:167], v[132:135], a[212:215], v[164:167]
    v_mfma_f32_16x16x32_bf16 v[168:171], v[132:135], a[216:219], v[168:171]
    buffer_load_dwordx4 v253, s[24:27], s62 offen offset:1024 lds
    v_mfma_f32_16x16x32_bf16 v[172:175], v[132:135], a[220:223], v[172:175]
    s_waitcnt lgkmcnt(2)
    v_mfma_f32_16x16x32_bf16 v[160:163], v[136:139], a[224:227], v[160:163]
    s_waitcnt vmcnt(20) lgkmcnt(0)
    s_barrier
    v_mfma_f32_16x16x32_bf16 v[164:167], v[136:139], a[228:231], v[164:167]
    ds_read_b64_tr_b16 v[112:113], v240 offset:49152
    ds_read_b64_tr_b16 v[114:115], v240 offset:51200
    v_mfma_f32_16x16x32_bf16 v[168:171], v[136:139], a[232:235], v[168:171]
    ds_read_b64_tr_b16 v[116:117], v240 offset:53248
    ds_read_b64_tr_b16 v[118:119], v240 offset:55296
    v_mfma_f32_16x16x32_bf16 v[172:175], v[136:139], a[236:239], v[172:175]
    v_mfma_f32_16x16x32_bf16 v[160:163], v[140:143], a[240:243], v[160:163]
    v_mfma_f32_16x16x32_bf16 v[164:167], v[140:143], a[244:247], v[164:167]
    ds_read_b64_tr_b16 v[120:121], v240 offset:57344
    ds_read_b64_tr_b16 v[122:123], v240 offset:59392
    v_mfma_f32_16x16x32_bf16 v[168:171], v[140:143], a[248:251], v[168:171]
    buffer_load_dwordx4 v254, s[24:27], s62 offen offset:2048 lds
    v_mfma_f32_16x16x32_bf16 v[172:175], v[140:143], a[252:255], v[172:175]
    s_nop 1
    v_cvt_pk_bf16_f32 v160, v160, v161
    s_waitcnt lgkmcnt(4)
    v_mfma_f32_16x16x32_bf16 v[144:147], v[112:115], a[0:3], 0
    v_cvt_pk_bf16_f32 v161, v162, v163
    v_cvt_pk_bf16_f32 v162, v164, v165
    v_mfma_f32_16x16x32_bf16 v[148:151], v[112:115], a[4:7], 0
    ds_read_b64_tr_b16 v[124:125], v240 offset:61440
    ds_read_b64_tr_b16 v[126:127], v240 offset:63488
    v_mfma_f32_16x16x32_bf16 v[152:155], v[112:115], a[8:11], 0
    buffer_load_dwordx4 v255, s[24:27], s62 offen offset:3072 lds
    v_mfma_f32_16x16x32_bf16 v[156:159], v[112:115], a[12:15], 0
    v_cvt_pk_bf16_f32 v163, v166, v167
    s_waitcnt lgkmcnt(4)
    v_mfma_f32_16x16x32_bf16 v[144:147], v[116:119], a[16:19], v[144:147]
    v_cvt_pk_bf16_f32 v168, v168, v169
    v_cvt_pk_bf16_f32 v169, v170, v171
    v_mfma_f32_16x16x32_bf16 v[148:151], v[116:119], a[20:23], v[148:151]
    ds_read_b64_tr_b16 v[128:129], v241 offset:32768
    ds_read_b64_tr_b16 v[130:131], v241 offset:34816
    s_add_u32 m0, s84, 67584
    s_mov_b32 s63, 0x00054180
    v_mfma_f32_16x16x32_bf16 v[152:155], v[116:119], a[24:27], v[152:155]
    buffer_load_dwordx4 v252, s[24:27], s63 offen lds
    v_mfma_f32_16x16x32_bf16 v[156:159], v[116:119], a[28:31], v[156:159]
    v_cvt_pk_bf16_f32 v170, v172, v173
    s_waitcnt lgkmcnt(4)
    v_mfma_f32_16x16x32_bf16 v[144:147], v[120:123], a[32:35], v[144:147]
    v_cvt_pk_bf16_f32 v171, v174, v175
    v_mfma_f32_16x16x32_bf16 v[148:151], v[120:123], a[36:39], v[148:151]
    ds_read_b64_tr_b16 v[132:133], v241 offset:36864
    ds_read_b64_tr_b16 v[134:135], v241 offset:38912
    v_mfma_f32_16x16x32_bf16 v[152:155], v[120:123], a[40:43], v[152:155]
    buffer_load_dwordx4 v253, s[24:27], s63 offen offset:1024 lds
    v_mfma_f32_16x16x32_bf16 v[156:159], v[120:123], a[44:47], v[156:159]
    s_waitcnt lgkmcnt(4)
    v_mfma_f32_16x16x32_bf16 v[144:147], v[124:127], a[48:51], v[144:147]
    v_mfma_f32_16x16x32_bf16 v[148:151], v[124:127], a[52:55], v[148:151]
    ds_read_b64_tr_b16 v[136:137], v241 offset:40960
    ds_read_b64_tr_b16 v[138:139], v241 offset:43008
    v_mfma_f32_16x16x32_bf16 v[152:155], v[124:127], a[56:59], v[152:155]
    buffer_load_dwordx4 v254, s[24:27], s63 offen offset:2048 lds
    v_mfma_f32_16x16x32_bf16 v[156:159], v[124:127], a[60:63], v[156:159]
    s_waitcnt lgkmcnt(4)
    v_mfma_f32_16x16x32_bf16 v[144:147], v[128:131], v[0:3], v[144:147]
    v_mfma_f32_16x16x32_bf16 v[148:151], v[128:131], v[4:7], v[148:151]
    ds_read_b64_tr_b16 v[140:141], v241 offset:45056
    ds_read_b64_tr_b16 v[142:143], v241 offset:47104
    v_mfma_f32_16x16x32_bf16 v[152:155], v[128:131], v[8:11], v[152:155]
    buffer_load_dwordx4 v255, s[24:27], s63 offen offset:3072 lds
    v_mfma_f32_16x16x32_bf16 v[156:159], v[128:131], v[12:15], v[156:159]
    s_waitcnt lgkmcnt(4)
    v_mfma_f32_16x16x32_bf16 v[144:147], v[132:135], v[16:19], v[144:147]
    buffer_store_dwordx4 v[160:163], v64, s[36:39], s58 offen offset:1024 sc1
    v_mfma_f32_16x16x32_bf16 v[148:151], v[132:135], v[20:23], v[148:151]
    s_add_u32 m0, s84, 32768
    s_mov_b32 s62, 0x00000200
    v_mfma_f32_16x16x32_bf16 v[152:155], v[132:135], v[24:27], v[152:155]
    buffer_load_dwordx4 v252, s[24:27], s62 offen lds
    v_mfma_f32_16x16x32_bf16 v[156:159], v[132:135], v[28:31], v[156:159]
    s_waitcnt lgkmcnt(2)
    v_mfma_f32_16x16x32_bf16 v[144:147], v[136:139], v[32:35], v[144:147]
    s_waitcnt vmcnt(20) lgkmcnt(0)
    s_barrier
    v_mfma_f32_16x16x32_bf16 v[148:151], v[136:139], v[36:39], v[148:151]
    ds_read_b64_tr_b16 v[112:113], v243
    ds_read_b64_tr_b16 v[114:115], v243 offset:2048
    v_mfma_f32_16x16x32_bf16 v[152:155], v[136:139], v[40:43], v[152:155]
    ds_read_b64_tr_b16 v[116:117], v243 offset:4096
    ds_read_b64_tr_b16 v[118:119], v243 offset:6144
    v_mfma_f32_16x16x32_bf16 v[156:159], v[136:139], v[44:47], v[156:159]
    v_mfma_f32_16x16x32_bf16 v[144:147], v[140:143], v[48:51], v[144:147]
    buffer_load_dwordx4 v253, s[24:27], s62 offen offset:1024 lds
    v_mfma_f32_16x16x32_bf16 v[148:151], v[140:143], v[52:55], v[148:151]
    ds_read_b64_tr_b16 v[120:121], v243 offset:8192
    ds_read_b64_tr_b16 v[122:123], v243 offset:10240
    v_mfma_f32_16x16x32_bf16 v[152:155], v[140:143], v[56:59], v[152:155]
    buffer_store_dwordx4 v[168:171], v64, s[36:39], s57 offen offset:1024 sc1
    v_mfma_f32_16x16x32_bf16 v[156:159], v[140:143], v[60:63], v[156:159]
    s_waitcnt lgkmcnt(4)
    v_mfma_f32_16x16x32_bf16 v[144:147], v[112:115], a[128:131], v[144:147]
    buffer_load_dwordx4 v254, s[24:27], s62 offen offset:2048 lds
    v_mfma_f32_16x16x32_bf16 v[148:151], v[112:115], a[132:135], v[148:151]
    ds_read_b64_tr_b16 v[124:125], v243 offset:12288
    ds_read_b64_tr_b16 v[126:127], v243 offset:14336
    v_mfma_f32_16x16x32_bf16 v[152:155], v[112:115], a[136:139], v[152:155]
    v_mfma_f32_16x16x32_bf16 v[80:83], v[96:99], v[176:179], 0
    v_mfma_f32_16x16x32_bf16 v[156:159], v[112:115], a[140:143], v[156:159]
    s_waitcnt lgkmcnt(4)
    v_mfma_f32_16x16x32_bf16 v[144:147], v[116:119], a[144:147], v[144:147]
    buffer_load_dwordx4 v255, s[24:27], s62 offen offset:3072 lds
    v_mfma_f32_16x16x32_bf16 v[148:151], v[116:119], a[148:151], v[148:151]
    ds_read_b64_tr_b16 v[128:129], v241 offset:49152
    ds_read_b64_tr_b16 v[130:131], v241 offset:51200
    v_mfma_f32_16x16x32_bf16 v[152:155], v[116:119], a[152:155], v[152:155]
    v_mfma_f32_16x16x32_bf16 v[156:159], v[116:119], a[156:159], v[156:159]
    s_waitcnt lgkmcnt(4)
    v_mfma_f32_16x16x32_bf16 v[144:147], v[120:123], a[160:163], v[144:147]
    v_mfma_f32_16x16x32_bf16 v[80:83], v[96:99], v[180:183], v[80:83]
    v_mfma_f32_16x16x32_bf16 v[148:151], v[120:123], a[164:167], v[148:151]
    ds_read_b64_tr_b16 v[132:133], v241 offset:53248
    ds_read_b64_tr_b16 v[134:135], v241 offset:55296
    s_add_u32 m0, s84, 49152
    s_mov_b32 s63, 0x0001c200
    v_mfma_f32_16x16x32_bf16 v[152:155], v[120:123], a[168:171], v[152:155]
    buffer_load_dwordx4 v252, s[24:27], s63 offen lds
    v_mfma_f32_16x16x32_bf16 v[156:159], v[120:123], a[172:175], v[156:159]
    s_waitcnt lgkmcnt(4)
    v_mfma_f32_16x16x32_bf16 v[144:147], v[124:127], a[176:179], v[144:147]
    v_mfma_f32_16x16x32_bf16 v[148:151], v[124:127], a[180:183], v[148:151]
    ds_read_b64_tr_b16 v[136:137], v241 offset:57344
    ds_read_b64_tr_b16 v[138:139], v241 offset:59392
    v_mfma_f32_16x16x32_bf16 v[152:155], v[124:127], a[184:187], v[152:155]
    buffer_load_dwordx4 v253, s[24:27], s63 offen offset:1024 lds
    v_mfma_f32_16x16x32_bf16 v[156:159], v[124:127], a[188:191], v[156:159]
    s_waitcnt lgkmcnt(4)
    v_mfma_f32_16x16x32_bf16 v[144:147], v[128:131], a[192:195], v[144:147]
    v_mfma_f32_16x16x32_bf16 v[80:83], v[100:103], v[192:195], v[80:83]
    v_mfma_f32_16x16x32_bf16 v[148:151], v[128:131], a[196:199], v[148:151]
    ds_read_b64_tr_b16 v[140:141], v241 offset:61440
    ds_read_b64_tr_b16 v[142:143], v241 offset:63488
    v_mfma_f32_16x16x32_bf16 v[152:155], v[128:131], a[200:203], v[152:155]
    buffer_load_dwordx4 v254, s[24:27], s63 offen offset:2048 lds
    v_mfma_f32_16x16x32_bf16 v[156:159], v[128:131], a[204:207], v[156:159]
    s_waitcnt lgkmcnt(4)
    v_mfma_f32_16x16x32_bf16 v[144:147], v[132:135], a[208:211], v[144:147]
    v_mfma_f32_16x16x32_bf16 v[148:151], v[132:135], a[212:215], v[148:151]
    v_mfma_f32_16x16x32_bf16 v[152:155], v[132:135], a[216:219], v[152:155]
    buffer_load_dwordx4 v255, s[24:27], s63 offen offset:3072 lds
    v_mfma_f32_16x16x32_bf16 v[156:159], v[132:135], a[220:223], v[156:159]
    s_waitcnt lgkmcnt(2)
    v_mfma_f32_16x16x32_bf16 v[144:147], v[136:139], a[224:227], v[144:147]
    s_waitcnt vmcnt(19) lgkmcnt(0)
    s_barrier
    v_mfma_f32_16x16x32_bf16 v[148:151], v[136:139], a[228:231], v[148:151]
    ds_read_b64_tr_b16 v[112:113], v243 offset:16384
    ds_read_b64_tr_b16 v[114:115], v243 offset:18432
    v_mfma_f32_16x16x32_bf16 v[152:155], v[136:139], a[232:235], v[152:155]
    ds_read_b64_tr_b16 v[116:117], v243 offset:20480
    ds_read_b64_tr_b16 v[118:119], v243 offset:22528
    v_mfma_f32_16x16x32_bf16 v[156:159], v[136:139], a[236:239], v[156:159]
    s_add_u32 m0, s84, 98304
    s_mov_b32 s62, 0x00038200
    v_mfma_f32_16x16x32_bf16 v[144:147], v[140:143], a[240:243], v[144:147]
    buffer_load_dwordx4 v252, s[24:27], s62 offen lds
    v_mfma_f32_16x16x32_bf16 v[148:151], v[140:143], a[244:247], v[148:151]
    ds_read_b64_tr_b16 v[120:121], v243 offset:24576
    ds_read_b64_tr_b16 v[122:123], v243 offset:26624
    v_mfma_f32_16x16x32_bf16 v[152:155], v[140:143], a[248:251], v[152:155]
    v_mfma_f32_16x16x32_bf16 v[80:83], v[100:103], v[196:199], v[80:83]
    v_mfma_f32_16x16x32_bf16 v[156:159], v[140:143], a[252:255], v[156:159]
    s_nop 0
    v_cvt_pk_bf16_f32 v144, v144, v145
    s_waitcnt lgkmcnt(4)
    v_mfma_f32_16x16x32_bf16 v[160:163], v[112:115], a[0:3], 0
    buffer_load_dwordx4 v253, s[24:27], s62 offen offset:1024 lds
    v_mfma_f32_16x16x32_bf16 v[164:167], v[112:115], a[4:7], 0
    ds_read_b64_tr_b16 v[124:125], v243 offset:28672
    ds_read_b64_tr_b16 v[126:127], v243 offset:30720
    v_mfma_f32_16x16x32_bf16 v[168:171], v[112:115], a[8:11], 0
    v_cvt_pk_bf16_f32 v145, v146, v147
    v_cvt_pk_bf16_f32 v146, v148, v149
    v_mfma_f32_16x16x32_bf16 v[172:175], v[112:115], a[12:15], 0
    v_cvt_pk_bf16_f32 v147, v150, v151
    s_waitcnt lgkmcnt(4)
    v_mfma_f32_16x16x32_bf16 v[160:163], v[116:119], a[16:19], v[160:163]
    buffer_load_dwordx4 v254, s[24:27], s62 offen offset:2048 lds
    v_mfma_f32_16x16x32_bf16 v[164:167], v[116:119], a[20:23], v[164:167]
    ds_read_b64_tr_b16 v[128:129], v240
    ds_read_b64_tr_b16 v[130:131], v240 offset:2048
    v_mfma_f32_16x16x32_bf16 v[168:171], v[116:119], a[24:27], v[168:171]
    v_cvt_pk_bf16_f32 v152, v152, v153
    v_cvt_pk_bf16_f32 v153, v154, v155
    v_mfma_f32_16x16x32_bf16 v[172:175], v[116:119], a[28:31], v[172:175]
    v_cvt_pk_bf16_f32 v154, v156, v157
    s_waitcnt lgkmcnt(4)
    v_mfma_f32_16x16x32_bf16 v[160:163], v[120:123], a[32:35], v[160:163]
    buffer_load_dwordx4 v255, s[24:27], s62 offen offset:3072 lds
    v_mfma_f32_16x16x32_bf16 v[164:167], v[120:123], a[36:39], v[164:167]
    ds_read_b64_tr_b16 v[132:133], v240 offset:4096
    ds_read_b64_tr_b16 v[134:135], v240 offset:6144
    v_mfma_f32_16x16x32_bf16 v[168:171], v[120:123], a[40:43], v[168:171]
    v_cvt_pk_bf16_f32 v155, v158, v159
    v_mfma_f32_16x16x32_bf16 v[172:175], v[120:123], a[44:47], v[172:175]
    s_waitcnt lgkmcnt(4)
    v_mfma_f32_16x16x32_bf16 v[160:163], v[124:127], a[48:51], v[160:163]
    v_mfma_f32_16x16x32_bf16 v[84:87], v[96:99], v[208:211], 0
    v_mfma_f32_16x16x32_bf16 v[164:167], v[124:127], a[52:55], v[164:167]
    ds_read_b64_tr_b16 v[136:137], v240 offset:8192
    ds_read_b64_tr_b16 v[138:139], v240 offset:10240
    s_add_u32 m0, s84, 131072
    s_mov_b32 s63, 0x00054200
    v_mfma_f32_16x16x32_bf16 v[168:171], v[124:127], a[56:59], v[168:171]
    buffer_load_dwordx4 v252, s[24:27], s63 offen lds
    v_mfma_f32_16x16x32_bf16 v[172:175], v[124:127], a[60:63], v[172:175]
    s_waitcnt lgkmcnt(4)
    v_mfma_f32_16x16x32_bf16 v[160:163], v[128:131], v[0:3], v[160:163]
    v_mfma_f32_16x16x32_bf16 v[164:167], v[128:131], v[4:7], v[164:167]
    ds_read_b64_tr_b16 v[140:141], v240 offset:12288
    ds_read_b64_tr_b16 v[142:143], v240 offset:14336
    v_mfma_f32_16x16x32_bf16 v[168:171], v[128:131], v[8:11], v[168:171]
    buffer_load_dwordx4 v253, s[24:27], s63 offen offset:1024 lds
    v_mfma_f32_16x16x32_bf16 v[172:175], v[128:131], v[12:15], v[172:175]
    s_waitcnt lgkmcnt(4)
    v_mfma_f32_16x16x32_bf16 v[160:163], v[132:135], v[16:19], v[160:163]
    v_mfma_f32_16x16x32_bf16 v[84:87], v[96:99], v[212:215], v[84:87]
    v_mfma_f32_16x16x32_bf16 v[164:167], v[132:135], v[20:23], v[164:167]
    v_mfma_f32_16x16x32_bf16 v[168:171], v[132:135], v[24:27], v[168:171]
    buffer_load_dwordx4 v254, s[24:27], s63 offen offset:2048 lds
    v_mfma_f32_16x16x32_bf16 v[172:175], v[132:135], v[28:31], v[172:175]
    s_waitcnt lgkmcnt(2)
    v_mfma_f32_16x16x32_bf16 v[160:163], v[136:139], v[32:35], v[160:163]
    s_waitcnt vmcnt(17) lgkmcnt(0)
    s_barrier
    v_mfma_f32_16x16x32_bf16 v[164:167], v[136:139], v[36:39], v[164:167]
    ds_read_b64_tr_b16 v[112:113], v240 offset:16384
    ds_read_b64_tr_b16 v[114:115], v240 offset:18432
    v_mfma_f32_16x16x32_bf16 v[168:171], v[136:139], v[40:43], v[168:171]
    ds_read_b64_tr_b16 v[116:117], v240 offset:20480
    ds_read_b64_tr_b16 v[118:119], v240 offset:22528
    v_mfma_f32_16x16x32_bf16 v[172:175], v[136:139], v[44:47], v[172:175]
    v_mfma_f32_16x16x32_bf16 v[160:163], v[140:143], v[48:51], v[160:163]
    buffer_load_dwordx4 v255, s[24:27], s63 offen offset:3072 lds
    v_mfma_f32_16x16x32_bf16 v[164:167], v[140:143], v[52:55], v[164:167]
    ds_read_b64_tr_b16 v[120:121], v240 offset:24576
    ds_read_b64_tr_b16 v[122:123], v240 offset:26624
    v_mfma_f32_16x16x32_bf16 v[168:171], v[140:143], v[56:59], v[168:171]
    buffer_store_dwordx4 v[144:147], v64, s[36:39], s58 offen offset:2048 sc1
    v_mfma_f32_16x16x32_bf16 v[172:175], v[140:143], v[60:63], v[172:175]
    s_waitcnt lgkmcnt(4)
    s_add_u32 m0, s84, 114688
    s_mov_b32 s62, 0x00000280
    v_mfma_f32_16x16x32_bf16 v[160:163], v[112:115], a[128:131], v[160:163]
    buffer_load_dwordx4 v252, s[24:27], s62 offen lds
    v_mfma_f32_16x16x32_bf16 v[164:167], v[112:115], a[132:135], v[164:167]
    ds_read_b64_tr_b16 v[124:125], v240 offset:28672
    ds_read_b64_tr_b16 v[126:127], v240 offset:30720
    v_mfma_f32_16x16x32_bf16 v[168:171], v[112:115], a[136:139], v[168:171]
    buffer_store_dwordx4 v[152:155], v64, s[36:39], s57 offen offset:2048 sc1
    v_mfma_f32_16x16x32_bf16 v[172:175], v[112:115], a[140:143], v[172:175]
    s_waitcnt lgkmcnt(4)
    v_mfma_f32_16x16x32_bf16 v[160:163], v[116:119], a[144:147], v[160:163]
    buffer_load_dwordx4 v253, s[24:27], s62 offen offset:1024 lds
    v_mfma_f32_16x16x32_bf16 v[164:167], v[116:119], a[148:151], v[164:167]
    ds_read_b64_tr_b16 v[128:129], v241 offset:2048
    ds_read_b64_tr_b16 v[130:131], v241 offset:4096
    v_mfma_f32_16x16x32_bf16 v[168:171], v[116:119], a[152:155], v[168:171]
    v_mfma_f32_16x16x32_bf16 v[84:87], v[100:103], v[224:227], v[84:87]
    v_mfma_f32_16x16x32_bf16 v[172:175], v[116:119], a[156:159], v[172:175]
    s_waitcnt lgkmcnt(4)
    v_mfma_f32_16x16x32_bf16 v[160:163], v[120:123], a[160:163], v[160:163]
    buffer_load_dwordx4 v254, s[24:27], s62 offen offset:2048 lds
    v_mfma_f32_16x16x32_bf16 v[164:167], v[120:123], a[164:167], v[164:167]
    ds_read_b64_tr_b16 v[132:133], v241 offset:6144
    ds_read_b64_tr_b16 v[134:135], v241 offset:8192
    v_mfma_f32_16x16x32_bf16 v[168:171], v[120:123], a[168:171], v[168:171]
    v_mfma_f32_16x16x32_bf16 v[172:175], v[120:123], a[172:175], v[172:175]
    s_waitcnt lgkmcnt(4)
    v_mfma_f32_16x16x32_bf16 v[160:163], v[124:127], a[176:179], v[160:163]
    buffer_load_dwordx4 v255, s[24:27], s62 offen offset:3072 lds
    v_mfma_f32_16x16x32_bf16 v[164:167], v[124:127], a[180:183], v[164:167]
    ds_read_b64_tr_b16 v[136:137], v241 offset:10240
    ds_read_b64_tr_b16 v[138:139], v241 offset:12288
    v_mfma_f32_16x16x32_bf16 v[168:171], v[124:127], a[184:187], v[168:171]
    v_mfma_f32_16x16x32_bf16 v[84:87], v[100:103], v[228:231], v[84:87]
    v_mfma_f32_16x16x32_bf16 v[172:175], v[124:127], a[188:191], v[172:175]
    s_waitcnt lgkmcnt(4)
    v_mfma_f32_16x16x32_bf16 v[160:163], v[128:131], a[192:195], v[160:163]
    v_mfma_f32_16x16x32_bf16 v[164:167], v[128:131], a[196:199], v[164:167]
    ds_read_b64_tr_b16 v[140:141], v241 offset:14336
    ds_read_b64_tr_b16 v[142:143], v241 offset:16384
    s_add_u32 m0, s84, 147456
    s_mov_b32 s63, 0x0001c280
    v_mfma_f32_16x16x32_bf16 v[168:171], v[128:131], a[200:203], v[168:171]
    buffer_load_dwordx4 v252, s[24:27], s63 offen lds
    v_mfma_f32_16x16x32_bf16 v[172:175], v[128:131], a[204:207], v[172:175]
    s_waitcnt lgkmcnt(4)
    v_mfma_f32_16x16x32_bf16 v[160:163], v[132:135], a[208:211], v[160:163]
    v_mfma_f32_16x16x32_bf16 v[88:91], v[96:99], v[184:187], 0
    v_mfma_f32_16x16x32_bf16 v[164:167], v[132:135], a[212:215], v[164:167]
    buffer_load_dwordx4 v253, s[24:27], s63 offen offset:1024 lds
    v_mfma_f32_16x16x32_bf16 v[168:171], v[132:135], a[216:219], v[168:171]
    v_mfma_f32_16x16x32_bf16 v[172:175], v[132:135], a[220:223], v[172:175]
    s_waitcnt lgkmcnt(2)
    v_mfma_f32_16x16x32_bf16 v[160:163], v[136:139], a[224:227], v[160:163]
    s_waitcnt vmcnt(16) lgkmcnt(0)
    s_barrier
    v_mfma_f32_16x16x32_bf16 v[164:167], v[136:139], a[228:231], v[164:167]
    ds_read_b64_tr_b16 v[112:113], v240 offset:32768
    ds_read_b64_tr_b16 v[114:115], v240 offset:34816
    v_mfma_f32_16x16x32_bf16 v[168:171], v[136:139], a[232:235], v[168:171]
    ds_read_b64_tr_b16 v[116:117], v240 offset:36864
    ds_read_b64_tr_b16 v[118:119], v240 offset:38912
    v_mfma_f32_16x16x32_bf16 v[172:175], v[136:139], a[236:239], v[172:175]
    v_mfma_f32_16x16x32_bf16 v[160:163], v[140:143], a[240:243], v[160:163]
    buffer_load_dwordx4 v254, s[24:27], s63 offen offset:2048 lds
    v_mfma_f32_16x16x32_bf16 v[164:167], v[140:143], a[244:247], v[164:167]
    ds_read_b64_tr_b16 v[120:121], v240 offset:40960
    ds_read_b64_tr_b16 v[122:123], v240 offset:43008
    v_mfma_f32_16x16x32_bf16 v[168:171], v[140:143], a[248:251], v[168:171]
    buffer_load_dwordx4 v255, s[24:27], s63 offen offset:3072 lds
    v_mfma_f32_16x16x32_bf16 v[172:175], v[140:143], a[252:255], v[172:175]
    s_nop 0
    v_cvt_pk_bf16_f32 v160, v160, v161
    s_waitcnt lgkmcnt(4)
    v_mfma_f32_16x16x32_bf16 v[144:147], v[112:115], a[0:3], 0
    v_cvt_pk_bf16_f32 v161, v162, v163
    v_cvt_pk_bf16_f32 v162, v164, v165
    v_mfma_f32_16x16x32_bf16 v[148:151], v[112:115], a[4:7], 0
    ds_read_b64_tr_b16 v[124:125], v240 offset:45056
    ds_read_b64_tr_b16 v[126:127], v240 offset:47104
    s_add_u32 m0, s84, 0
    s_mov_b32 s62, 0x00038280
    v_mfma_f32_16x16x32_bf16 v[152:155], v[112:115], a[8:11], 0
    buffer_load_dwordx4 v252, s[24:27], s62 offen lds
    v_mfma_f32_16x16x32_bf16 v[156:159], v[112:115], a[12:15], 0
    v_cvt_pk_bf16_f32 v163, v166, v167
    s_waitcnt lgkmcnt(4)
    v_mfma_f32_16x16x32_bf16 v[144:147], v[116:119], a[16:19], v[144:147]
    v_cvt_pk_bf16_f32 v168, v168, v169
    v_cvt_pk_bf16_f32 v169, v170, v171
    v_mfma_f32_16x16x32_bf16 v[148:151], v[116:119], a[20:23], v[148:151]
    ds_read_b64_tr_b16 v[128:129], v240 offset:49152
    ds_read_b64_tr_b16 v[130:131], v240 offset:51200
    v_mfma_f32_16x16x32_bf16 v[152:155], v[116:119], a[24:27], v[152:155]
    buffer_load_dwordx4 v253, s[24:27], s62 offen offset:1024 lds
    v_mfma_f32_16x16x32_bf16 v[156:159], v[116:119], a[28:31], v[156:159]
    v_cvt_pk_bf16_f32 v170, v172, v173
    s_waitcnt lgkmcnt(4)
    v_mfma_f32_16x16x32_bf16 v[144:147], v[120:123], a[32:35], v[144:147]
    v_cvt_pk_bf16_f32 v171, v174, v175
    v_mfma_f32_16x16x32_bf16 v[148:151], v[120:123], a[36:39], v[148:151]
    ds_read_b64_tr_b16 v[132:133], v240 offset:53248
    ds_read_b64_tr_b16 v[134:135], v240 offset:55296
    v_mfma_f32_16x16x32_bf16 v[152:155], v[120:123], a[40:43], v[152:155]
    v_mfma_f32_16x16x32_bf16 v[88:91], v[96:99], v[188:191], v[88:91]
    v_mfma_f32_16x16x32_bf16 v[156:159], v[120:123], a[44:47], v[156:159]
    s_waitcnt lgkmcnt(4)
    v_mfma_f32_16x16x32_bf16 v[144:147], v[124:127], a[48:51], v[144:147]
    buffer_load_dwordx4 v254, s[24:27], s62 offen offset:2048 lds
    v_mfma_f32_16x16x32_bf16 v[148:151], v[124:127], a[52:55], v[148:151]
    ds_read_b64_tr_b16 v[136:137], v240 offset:57344
    ds_read_b64_tr_b16 v[138:139], v240 offset:59392
    v_mfma_f32_16x16x32_bf16 v[152:155], v[124:127], a[56:59], v[152:155]
    v_mfma_f32_16x16x32_bf16 v[156:159], v[124:127], a[60:63], v[156:159]
    s_waitcnt lgkmcnt(4)
    v_mfma_f32_16x16x32_bf16 v[144:147], v[128:131], v[0:3], v[144:147]
    buffer_load_dwordx4 v255, s[24:27], s62 offen offset:3072 lds
    v_mfma_f32_16x16x32_bf16 v[148:151], v[128:131], v[4:7], v[148:151]
    ds_read_b64_tr_b16 v[140:141], v240 offset:61440
    ds_read_b64_tr_b16 v[142:143], v240 offset:63488
    v_mfma_f32_16x16x32_bf16 v[152:155], v[128:131], v[8:11], v[152:155]
    v_mfma_f32_16x16x32_bf16 v[88:91], v[100:103], v[200:203], v[88:91]
    v_mfma_f32_16x16x32_bf16 v[156:159], v[128:131], v[12:15], v[156:159]
    s_waitcnt lgkmcnt(4)
    s_add_u32 m0, s84, 16384
    s_mov_b32 s63, 0x00054280
    v_mfma_f32_16x16x32_bf16 v[144:147], v[132:135], v[16:19], v[144:147]
    buffer_load_dwordx4 v252, s[24:27], s63 offen lds
    v_mfma_f32_16x16x32_bf16 v[148:151], v[132:135], v[20:23], v[148:151]
    v_mfma_f32_16x16x32_bf16 v[152:155], v[132:135], v[24:27], v[152:155]
    buffer_load_dwordx4 v253, s[24:27], s63 offen offset:1024 lds
    v_mfma_f32_16x16x32_bf16 v[156:159], v[132:135], v[28:31], v[156:159]
    s_waitcnt lgkmcnt(2)
    v_mfma_f32_16x16x32_bf16 v[144:147], v[136:139], v[32:35], v[144:147]
    s_waitcnt vmcnt(16) lgkmcnt(0)
    s_barrier
    v_mfma_f32_16x16x32_bf16 v[148:151], v[136:139], v[36:39], v[148:151]
    ds_read_b64_tr_b16 v[112:113], v241 offset:32768
    ds_read_b64_tr_b16 v[114:115], v241 offset:34816
    v_mfma_f32_16x16x32_bf16 v[152:155], v[136:139], v[40:43], v[152:155]
    ds_read_b64_tr_b16 v[116:117], v241 offset:36864
    ds_read_b64_tr_b16 v[118:119], v241 offset:38912
    v_mfma_f32_16x16x32_bf16 v[156:159], v[136:139], v[44:47], v[156:159]
    v_mfma_f32_16x16x32_bf16 v[144:147], v[140:143], v[48:51], v[144:147]
    v_mfma_f32_16x16x32_bf16 v[88:91], v[100:103], v[204:207], v[88:91]
    v_mfma_f32_16x16x32_bf16 v[148:151], v[140:143], v[52:55], v[148:151]
    ds_read_b64_tr_b16 v[120:121], v241 offset:40960
    ds_read_b64_tr_b16 v[122:123], v241 offset:43008
    v_mfma_f32_16x16x32_bf16 v[152:155], v[140:143], v[56:59], v[152:155]
    buffer_load_dwordx4 v254, s[24:27], s63 offen offset:2048 lds
    v_mfma_f32_16x16x32_bf16 v[156:159], v[140:143], v[60:63], v[156:159]
    s_waitcnt lgkmcnt(4)
    v_mfma_f32_16x16x32_bf16 v[144:147], v[112:115], a[128:131], v[144:147]
    v_mfma_f32_16x16x32_bf16 v[148:151], v[112:115], a[132:135], v[148:151]
    ds_read_b64_tr_b16 v[124:125], v241 offset:45056
    ds_read_b64_tr_b16 v[126:127], v241 offset:47104
    v_mfma_f32_16x16x32_bf16 v[152:155], v[112:115], a[136:139], v[152:155]
    buffer_load_dwordx4 v255, s[24:27], s63 offen offset:3072 lds
    v_mfma_f32_16x16x32_bf16 v[156:159], v[112:115], a[140:143], v[156:159]
    s_waitcnt lgkmcnt(4)
    v_mfma_f32_16x16x32_bf16 v[144:147], v[116:119], a[144:147], v[144:147]
    buffer_store_dwordx4 v[160:163], v64, s[36:39], s58 offen offset:3072 sc1
    v_mfma_f32_16x16x32_bf16 v[148:151], v[116:119], a[148:151], v[148:151]
    ds_read_b64_tr_b16 v[128:129], v243
    ds_read_b64_tr_b16 v[130:131], v243 offset:2048
    s_add_u32 m0, s84, 67584
    s_mov_b32 s62, 0x00000300
    v_mfma_f32_16x16x32_bf16 v[152:155], v[116:119], a[152:155], v[152:155]
    buffer_load_dwordx4 v252, s[24:27], s62 offen lds
    v_mfma_f32_16x16x32_bf16 v[156:159], v[116:119], a[156:159], v[156:159]
    s_waitcnt lgkmcnt(4)
    v_mfma_f32_16x16x32_bf16 v[144:147], v[120:123], a[160:163], v[144:147]
    buffer_store_dwordx4 v[168:171], v64, s[36:39], s57 offen offset:3072 sc1
    v_mfma_f32_16x16x32_bf16 v[148:151], v[120:123], a[164:167], v[148:151]
    ds_read_b64_tr_b16 v[132:133], v243 offset:4096
    ds_read_b64_tr_b16 v[134:135], v243 offset:6144
    v_mfma_f32_16x16x32_bf16 v[152:155], v[120:123], a[168:171], v[152:155]
    buffer_load_dwordx4 v253, s[24:27], s62 offen offset:1024 lds
    v_mfma_f32_16x16x32_bf16 v[156:159], v[120:123], a[172:175], v[156:159]
    s_waitcnt lgkmcnt(4)
    v_mfma_f32_16x16x32_bf16 v[144:147], v[124:127], a[176:179], v[144:147]
    v_mfma_f32_16x16x32_bf16 v[92:95], v[96:99], v[216:219], 0
    v_mfma_f32_16x16x32_bf16 v[148:151], v[124:127], a[180:183], v[148:151]
    ds_read_b64_tr_b16 v[136:137], v243 offset:8192
    ds_read_b64_tr_b16 v[138:139], v243 offset:10240
    v_mfma_f32_16x16x32_bf16 v[152:155], v[124:127], a[184:187], v[152:155]
    v_mfma_f32_16x16x32_bf16 v[156:159], v[124:127], a[188:191], v[156:159]
    s_waitcnt lgkmcnt(4)
    v_mfma_f32_16x16x32_bf16 v[144:147], v[128:131], a[192:195], v[144:147]
    buffer_load_dwordx4 v254, s[24:27], s62 offen offset:2048 lds
    v_mfma_f32_16x16x32_bf16 v[148:151], v[128:131], a[196:199], v[148:151]
    ds_read_b64_tr_b16 v[140:141], v243 offset:12288
    ds_read_b64_tr_b16 v[142:143], v243 offset:14336
    v_mfma_f32_16x16x32_bf16 v[152:155], v[128:131], a[200:203], v[152:155]
    v_mfma_f32_16x16x32_bf16 v[92:95], v[96:99], v[220:223], v[92:95]
    v_mfma_f32_16x16x32_bf16 v[156:159], v[128:131], a[204:207], v[156:159]
    s_waitcnt lgkmcnt(4)
    v_mfma_f32_16x16x32_bf16 v[144:147], v[132:135], a[208:211], v[144:147]
    buffer_load_dwordx4 v255, s[24:27], s62 offen offset:3072 lds
    v_mfma_f32_16x16x32_bf16 v[148:151], v[132:135], a[212:215], v[148:151]
    v_mfma_f32_16x16x32_bf16 v[152:155], v[132:135], a[216:219], v[152:155]
    s_add_u32 m0, s84, 32768
    s_mov_b32 s63, 0x0001c300
    buffer_load_dwordx4 v252, s[24:27], s63 offen lds
    v_mfma_f32_16x16x32_bf16 v[156:159], v[132:135], a[220:223], v[156:159]
    s_waitcnt lgkmcnt(2)
    v_mfma_f32_16x16x32_bf16 v[144:147], v[136:139], a[224:227], v[144:147]
    s_waitcnt vmcnt(15) lgkmcnt(0)
    s_barrier
    v_mfma_f32_16x16x32_bf16 v[148:151], v[136:139], a[228:231], v[148:151]
    ds_read_b64_tr_b16 v[112:113], v241 offset:49152
    ds_read_b64_tr_b16 v[114:115], v241 offset:51200
    v_mfma_f32_16x16x32_bf16 v[152:155], v[136:139], a[232:235], v[152:155]
    ds_read_b64_tr_b16 v[116:117], v241 offset:53248
    ds_read_b64_tr_b16 v[118:119], v241 offset:55296
    v_mfma_f32_16x16x32_bf16 v[156:159], v[136:139], a[236:239], v[156:159]
    v_mfma_f32_16x16x32_bf16 v[144:147], v[140:143], a[240:243], v[144:147]
    buffer_load_dwordx4 v253, s[24:27], s63 offen offset:1024 lds
    v_mfma_f32_16x16x32_bf16 v[148:151], v[140:143], a[244:247], v[148:151]
    ds_read_b64_tr_b16 v[120:121], v241 offset:57344
    ds_read_b64_tr_b16 v[122:123], v241 offset:59392
    v_mfma_f32_16x16x32_bf16 v[152:155], v[140:143], a[248:251], v[152:155]
    s_add_u32 s58, s58, 4096
    s_add_u32 s57, s57, 4096
    v_mfma_f32_16x16x32_bf16 v[156:159], v[140:143], a[252:255], v[156:159]
    v_cvt_pk_bf16_f32 v144, v144, v145
    s_waitcnt lgkmcnt(4)
    v_mfma_f32_16x16x32_bf16 v[160:163], v[112:115], a[0:3], 0
    v_cvt_pk_bf16_f32 v145, v146, v147
    v_cvt_pk_bf16_f32 v146, v148, v149
    v_mfma_f32_16x16x32_bf16 v[164:167], v[112:115], a[4:7], 0
    ds_read_b64_tr_b16 v[124:125], v241 offset:61440
    ds_read_b64_tr_b16 v[126:127], v241 offset:63488
    v_mfma_f32_16x16x32_bf16 v[168:171], v[112:115], a[8:11], 0
    buffer_load_dwordx4 v254, s[24:27], s63 offen offset:2048 lds
    v_mfma_f32_16x16x32_bf16 v[172:175], v[112:115], a[12:15], 0
    v_cvt_pk_bf16_f32 v147, v150, v151
    s_waitcnt lgkmcnt(4)
    v_mfma_f32_16x16x32_bf16 v[160:163], v[116:119], a[16:19], v[160:163]
    v_cvt_pk_bf16_f32 v152, v152, v153
    v_cvt_pk_bf16_f32 v153, v154, v155
    v_mfma_f32_16x16x32_bf16 v[164:167], v[116:119], a[20:23], v[164:167]
    ds_read_b64_tr_b16 v[128:129], v243 offset:16384
    ds_read_b64_tr_b16 v[130:131], v243 offset:18432
    v_mfma_f32_16x16x32_bf16 v[168:171], v[116:119], a[24:27], v[168:171]
    buffer_load_dwordx4 v255, s[24:27], s63 offen offset:3072 lds
    v_mfma_f32_16x16x32_bf16 v[172:175], v[116:119], a[28:31], v[172:175]
    v_cvt_pk_bf16_f32 v154, v156, v157
    s_waitcnt lgkmcnt(4)
    v_mfma_f32_16x16x32_bf16 v[160:163], v[120:123], a[32:35], v[160:163]
    buffer_store_dwordx4 v[144:147], v64, s[36:39], s58 offen sc1
    v_mfma_f32_16x16x32_bf16 v[164:167], v[120:123], a[36:39], v[164:167]
    ds_read_b64_tr_b16 v[132:133], v243 offset:20480
    ds_read_b64_tr_b16 v[134:135], v243 offset:22528
    s_add_u32 m0, s84, 49152
    s_mov_b32 s62, 0x00038300
    v_mfma_f32_16x16x32_bf16 v[168:171], v[120:123], a[40:43], v[168:171]
    buffer_load_dwordx4 v252, s[24:27], s62 offen lds
    v_mfma_f32_16x16x32_bf16 v[172:175], v[120:123], a[44:47], v[172:175]
    v_cvt_pk_bf16_f32 v155, v158, v159
    s_waitcnt lgkmcnt(4)
    v_mfma_f32_16x16x32_bf16 v[160:163], v[124:127], a[48:51], v[160:163]
    v_mfma_f32_16x16x32_bf16 v[164:167], v[124:127], a[52:55], v[164:167]
    ds_read_b64_tr_b16 v[136:137], v243 offset:24576
    ds_read_b64_tr_b16 v[138:139], v243 offset:26624
    v_mfma_f32_16x16x32_bf16 v[168:171], v[124:127], a[56:59], v[168:171]
    buffer_load_dwordx4 v253, s[24:27], s62 offen offset:1024 lds
    v_mfma_f32_16x16x32_bf16 v[172:175], v[124:127], a[60:63], v[172:175]
    s_waitcnt lgkmcnt(4)
    v_mfma_f32_16x16x32_bf16 v[160:163], v[128:131], v[0:3], v[160:163]
    v_mfma_f32_16x16x32_bf16 v[164:167], v[128:131], v[4:7], v[164:167]
    ds_read_b64_tr_b16 v[140:141], v243 offset:28672
    ds_read_b64_tr_b16 v[142:143], v243 offset:30720
    v_mfma_f32_16x16x32_bf16 v[168:171], v[128:131], v[8:11], v[168:171]
    v_mfma_f32_16x16x32_bf16 v[172:175], v[128:131], v[12:15], v[172:175]
    s_waitcnt lgkmcnt(4)
    v_mfma_f32_16x16x32_bf16 v[160:163], v[132:135], v[16:19], v[160:163]
    buffer_load_dwordx4 v254, s[24:27], s62 offen offset:2048 lds
    v_mfma_f32_16x16x32_bf16 v[164:167], v[132:135], v[20:23], v[164:167]
    v_mfma_f32_16x16x32_bf16 v[168:171], v[132:135], v[24:27], v[168:171]
    buffer_load_dwordx4 v255, s[24:27], s62 offen offset:3072 lds
    v_mfma_f32_16x16x32_bf16 v[172:175], v[132:135], v[28:31], v[172:175]
    s_waitcnt lgkmcnt(2)
    v_mfma_f32_16x16x32_bf16 v[160:163], v[136:139], v[32:35], v[160:163]
    s_waitcnt vmcnt(15) lgkmcnt(0)
    s_barrier
    v_mfma_f32_16x16x32_bf16 v[164:167], v[136:139], v[36:39], v[164:167]
    ds_read_b64_tr_b16 v[112:113], v240
    ds_read_b64_tr_b16 v[114:115], v240 offset:2048
    v_mfma_f32_16x16x32_bf16 v[168:171], v[136:139], v[40:43], v[168:171]
    ds_read_b64_tr_b16 v[116:117], v240 offset:4096
    ds_read_b64_tr_b16 v[118:119], v240 offset:6144
    v_mfma_f32_16x16x32_bf16 v[172:175], v[136:139], v[44:47], v[172:175]
    s_add_u32 m0, s84, 98304
    s_mov_b32 s63, 0x00054300
    v_mfma_f32_16x16x32_bf16 v[160:163], v[140:143], v[48:51], v[160:163]
    buffer_load_dwordx4 v252, s[24:27], s63 offen lds
    v_mfma_f32_16x16x32_bf16 v[164:167], v[140:143], v[52:55], v[164:167]
    ds_read_b64_tr_b16 v[120:121], v240 offset:8192
    ds_read_b64_tr_b16 v[122:123], v240 offset:10240
    v_mfma_f32_16x16x32_bf16 v[168:171], v[140:143], v[56:59], v[168:171]
    v_mfma_f32_16x16x32_bf16 v[172:175], v[140:143], v[60:63], v[172:175]
    s_waitcnt lgkmcnt(4)
    v_mfma_f32_16x16x32_bf16 v[160:163], v[112:115], a[128:131], v[160:163]
    buffer_load_dwordx4 v253, s[24:27], s63 offen offset:1024 lds
    v_mfma_f32_16x16x32_bf16 v[164:167], v[112:115], a[132:135], v[164:167]
    ds_read_b64_tr_b16 v[124:125], v240 offset:12288
    ds_read_b64_tr_b16 v[126:127], v240 offset:14336
    v_mfma_f32_16x16x32_bf16 v[168:171], v[112:115], a[136:139], v[168:171]
    v_mfma_f32_16x16x32_bf16 v[172:175], v[112:115], a[140:143], v[172:175]
    s_waitcnt lgkmcnt(4)
    v_mfma_f32_16x16x32_bf16 v[160:163], v[116:119], a[144:147], v[160:163]
    v_mfma_f32_16x16x32_bf16 v[164:167], v[116:119], a[148:151], v[164:167]
    ds_read_b64_tr_b16 v[128:129], v240 offset:16384
    ds_read_b64_tr_b16 v[130:131], v240 offset:18432
    v_mfma_f32_16x16x32_bf16 v[168:171], v[116:119], a[152:155], v[168:171]
    buffer_load_dwordx4 v254, s[24:27], s63 offen offset:2048 lds
    v_mfma_f32_16x16x32_bf16 v[172:175], v[116:119], a[156:159], v[172:175]
    s_waitcnt lgkmcnt(4)
    v_mfma_f32_16x16x32_bf16 v[160:163], v[120:123], a[160:163], v[160:163]
    v_mfma_f32_16x16x32_bf16 v[164:167], v[120:123], a[164:167], v[164:167]
    ds_read_b64_tr_b16 v[132:133], v240 offset:20480
    ds_read_b64_tr_b16 v[134:135], v240 offset:22528
    v_mfma_f32_16x16x32_bf16 v[168:171], v[120:123], a[168:171], v[168:171]
    buffer_load_dwordx4 v255, s[24:27], s63 offen offset:3072 lds
    v_mfma_f32_16x16x32_bf16 v[172:175], v[120:123], a[172:175], v[172:175]
    s_waitcnt lgkmcnt(4)
    v_mfma_f32_16x16x32_bf16 v[160:163], v[124:127], a[176:179], v[160:163]
    buffer_store_dwordx4 v[152:155], v64, s[36:39], s57 offen sc1
    v_mfma_f32_16x16x32_bf16 v[164:167], v[124:127], a[180:183], v[164:167]
    ds_read_b64_tr_b16 v[136:137], v240 offset:24576
    ds_read_b64_tr_b16 v[138:139], v240 offset:26624
    v_mfma_f32_16x16x32_bf16 v[168:171], v[124:127], a[184:187], v[168:171]
    v_mfma_f32_16x16x32_bf16 v[172:175], v[124:127], a[188:191], v[172:175]
    s_waitcnt lgkmcnt(4)
    v_mfma_f32_16x16x32_bf16 v[160:163], v[128:131], a[192:195], v[160:163]
    v_mfma_f32_16x16x32_bf16 v[164:167], v[128:131], a[196:199], v[164:167]
    ds_read_b64_tr_b16 v[140:141], v240 offset:28672
    ds_read_b64_tr_b16 v[142:143], v240 offset:30720
    v_mfma_f32_16x16x32_bf16 v[168:171], v[128:131], a[200:203], v[168:171]
    v_mfma_f32_16x16x32_bf16 v[172:175], v[128:131], a[204:207], v[172:175]
    s_waitcnt lgkmcnt(4)
    v_mfma_f32_16x16x32_bf16 v[160:163], v[132:135], a[208:211], v[160:163]
    v_mfma_f32_16x16x32_bf16 v[164:167], v[132:135], a[212:215], v[164:167]
    v_mfma_f32_16x16x32_bf16 v[168:171], v[132:135], a[216:219], v[168:171]
    v_mfma_f32_16x16x32_bf16 v[172:175], v[132:135], a[220:223], v[172:175]
    s_waitcnt lgkmcnt(2)
    v_mfma_f32_16x16x32_bf16 v[160:163], v[136:139], a[224:227], v[160:163]
    s_waitcnt vmcnt(10) lgkmcnt(0)
    s_barrier
    v_mfma_f32_16x16x32_bf16 v[164:167], v[136:139], a[228:231], v[164:167]
    ds_read_b64_tr_b16 v[112:113], v241 offset:2048
    ds_read_b64_tr_b16 v[114:115], v241 offset:4096
    v_mfma_f32_16x16x32_bf16 v[168:171], v[136:139], a[232:235], v[168:171]
    ds_read_b64_tr_b16 v[116:117], v241 offset:6144
    ds_read_b64_tr_b16 v[118:119], v241 offset:8192
    v_mfma_f32_16x16x32_bf16 v[172:175], v[136:139], a[236:239], v[172:175]
    v_mfma_f32_16x16x32_bf16 v[160:163], v[140:143], a[240:243], v[160:163]
    v_mfma_f32_16x16x32_bf16 v[164:167], v[140:143], a[244:247], v[164:167]
    ds_read_b64_tr_b16 v[120:121], v241 offset:10240
    ds_read_b64_tr_b16 v[122:123], v241 offset:12288
    v_mfma_f32_16x16x32_bf16 v[168:171], v[140:143], a[248:251], v[168:171]
    v_mfma_f32_16x16x32_bf16 v[172:175], v[140:143], a[252:255], v[172:175]
    s_nop 2
    v_cvt_pk_bf16_f32 v160, v160, v161
    s_waitcnt lgkmcnt(4)
    v_mfma_f32_16x16x32_bf16 v[144:147], v[112:115], a[0:3], 0
    v_cvt_pk_bf16_f32 v161, v162, v163
    v_cvt_pk_bf16_f32 v162, v164, v165
    v_mfma_f32_16x16x32_bf16 v[148:151], v[112:115], a[4:7], 0
    ds_read_b64_tr_b16 v[124:125], v241 offset:14336
    ds_read_b64_tr_b16 v[126:127], v241 offset:16384
    v_mfma_f32_16x16x32_bf16 v[152:155], v[112:115], a[8:11], 0
    v_cvt_pk_bf16_f32 v163, v166, v167
    v_cvt_pk_bf16_f32 v168, v168, v169
    v_mfma_f32_16x16x32_bf16 v[156:159], v[112:115], a[12:15], 0
    v_cvt_pk_bf16_f32 v169, v170, v171
    s_waitcnt lgkmcnt(4)
    v_mfma_f32_16x16x32_bf16 v[144:147], v[116:119], a[16:19], v[144:147]
    buffer_store_dwordx4 v[160:163], v64, s[36:39], s58 offen offset:1024 sc1
    v_mfma_f32_16x16x32_bf16 v[148:151], v[116:119], a[20:23], v[148:151]
    ds_read_b64_tr_b16 v[128:129], v240 offset:32768
    ds_read_b64_tr_b16 v[130:131], v240 offset:34816
    v_mfma_f32_16x16x32_bf16 v[152:155], v[116:119], a[24:27], v[152:155]
    v_cvt_pk_bf16_f32 v170, v172, v173
    v_cvt_pk_bf16_f32 v171, v174, v175
    v_mfma_f32_16x16x32_bf16 v[156:159], v[116:119], a[28:31], v[156:159]
    s_waitcnt lgkmcnt(4)
    v_mfma_f32_16x16x32_bf16 v[144:147], v[120:123], a[32:35], v[144:147]
    buffer_store_dwordx4 v[168:171], v64, s[36:39], s57 offen offset:1024 sc1
    v_mfma_f32_16x16x32_bf16 v[148:151], v[120:123], a[36:39], v[148:151]
    ds_read_b64_tr_b16 v[132:133], v240 offset:36864
    ds_read_b64_tr_b16 v[134:135], v240 offset:38912
    v_mfma_f32_16x16x32_bf16 v[152:155], v[120:123], a[40:43], v[152:155]
    v_mfma_f32_16x16x32_bf16 v[156:159], v[120:123], a[44:47], v[156:159]
    s_waitcnt lgkmcnt(4)
    v_mfma_f32_16x16x32_bf16 v[144:147], v[124:127], a[48:51], v[144:147]
    v_mfma_f32_16x16x32_bf16 v[148:151], v[124:127], a[52:55], v[148:151]
    ds_read_b64_tr_b16 v[136:137], v240 offset:40960
    ds_read_b64_tr_b16 v[138:139], v240 offset:43008
    v_mfma_f32_16x16x32_bf16 v[152:155], v[124:127], a[56:59], v[152:155]
    v_mfma_f32_16x16x32_bf16 v[156:159], v[124:127], a[60:63], v[156:159]
    s_waitcnt lgkmcnt(4)
    v_mfma_f32_16x16x32_bf16 v[144:147], v[128:131], v[0:3], v[144:147]
    v_mfma_f32_16x16x32_bf16 v[148:151], v[128:131], v[4:7], v[148:151]
    ds_read_b64_tr_b16 v[140:141], v240 offset:45056
    ds_read_b64_tr_b16 v[142:143], v240 offset:47104
    v_mfma_f32_16x16x32_bf16 v[152:155], v[128:131], v[8:11], v[152:155]
    v_mfma_f32_16x16x32_bf16 v[156:159], v[128:131], v[12:15], v[156:159]
    s_waitcnt lgkmcnt(4)
    v_mfma_f32_16x16x32_bf16 v[144:147], v[132:135], v[16:19], v[144:147]
    v_mfma_f32_16x16x32_bf16 v[148:151], v[132:135], v[20:23], v[148:151]
    v_mfma_f32_16x16x32_bf16 v[152:155], v[132:135], v[24:27], v[152:155]
    v_mfma_f32_16x16x32_bf16 v[156:159], v[132:135], v[28:31], v[156:159]
    s_waitcnt lgkmcnt(2)
    v_mfma_f32_16x16x32_bf16 v[144:147], v[136:139], v[32:35], v[144:147]
    s_waitcnt vmcnt(3) lgkmcnt(0)
    s_barrier
    v_mfma_f32_16x16x32_bf16 v[148:151], v[136:139], v[36:39], v[148:151]
    ds_read_b64_tr_b16 v[112:113], v240 offset:49152
    ds_read_b64_tr_b16 v[114:115], v240 offset:51200
    v_mfma_f32_16x16x32_bf16 v[152:155], v[136:139], v[40:43], v[152:155]
    ds_read_b64_tr_b16 v[116:117], v240 offset:53248
    ds_read_b64_tr_b16 v[118:119], v240 offset:55296
    v_mfma_f32_16x16x32_bf16 v[156:159], v[136:139], v[44:47], v[156:159]
    v_mfma_f32_16x16x32_bf16 v[144:147], v[140:143], v[48:51], v[144:147]
    buffer_load_dwordx4 v[216:219], v66, s[36:39], s80 offen offset:1024 sc1
    v_mfma_f32_16x16x32_bf16 v[148:151], v[140:143], v[52:55], v[148:151]
    ds_read_b64_tr_b16 v[120:121], v240 offset:57344
    ds_read_b64_tr_b16 v[122:123], v240 offset:59392
    buffer_load_dwordx4 v[220:223], v66, s[36:39], s85 offen offset:1024 sc1
    v_mfma_f32_16x16x32_bf16 v[152:155], v[140:143], v[56:59], v[152:155]
    v_mfma_f32_16x16x32_bf16 v[156:159], v[140:143], v[60:63], v[156:159]
    s_waitcnt lgkmcnt(4)
    v_mfma_f32_16x16x32_bf16 v[144:147], v[112:115], a[128:131], v[144:147]
    v_mfma_f32_16x16x32_bf16 v[148:151], v[112:115], a[132:135], v[148:151]
    ds_read_b64_tr_b16 v[124:125], v240 offset:61440
    ds_read_b64_tr_b16 v[126:127], v240 offset:63488
    v_mfma_f32_16x16x32_bf16 v[152:155], v[112:115], a[136:139], v[152:155]
    v_mfma_f32_16x16x32_bf16 v[156:159], v[112:115], a[140:143], v[156:159]
    s_waitcnt lgkmcnt(4)
    v_mfma_f32_16x16x32_bf16 v[144:147], v[116:119], a[144:147], v[144:147]
    v_mfma_f32_16x16x32_bf16 v[148:151], v[116:119], a[148:151], v[148:151]
    ds_read_b64_tr_b16 v[128:129], v241 offset:32768
    ds_read_b64_tr_b16 v[130:131], v241 offset:34816
    v_mfma_f32_16x16x32_bf16 v[152:155], v[116:119], a[152:155], v[152:155]
    v_mfma_f32_16x16x32_bf16 v[156:159], v[116:119], a[156:159], v[156:159]
    s_waitcnt lgkmcnt(4)
    v_mfma_f32_16x16x32_bf16 v[144:147], v[120:123], a[160:163], v[144:147]
    v_mfma_f32_16x16x32_bf16 v[148:151], v[120:123], a[164:167], v[148:151]
    ds_read_b64_tr_b16 v[132:133], v241 offset:36864
    ds_read_b64_tr_b16 v[134:135], v241 offset:38912
    v_mfma_f32_16x16x32_bf16 v[152:155], v[120:123], a[168:171], v[152:155]
    v_mfma_f32_16x16x32_bf16 v[156:159], v[120:123], a[172:175], v[156:159]
    s_waitcnt lgkmcnt(4)
    v_mfma_f32_16x16x32_bf16 v[144:147], v[124:127], a[176:179], v[144:147]
    v_mfma_f32_16x16x32_bf16 v[148:151], v[124:127], a[180:183], v[148:151]
    ds_read_b64_tr_b16 v[136:137], v241 offset:40960
    ds_read_b64_tr_b16 v[138:139], v241 offset:43008
    v_mfma_f32_16x16x32_bf16 v[152:155], v[124:127], a[184:187], v[152:155]
    v_mfma_f32_16x16x32_bf16 v[156:159], v[124:127], a[188:191], v[156:159]
    s_waitcnt lgkmcnt(4)
    v_mfma_f32_16x16x32_bf16 v[144:147], v[128:131], a[192:195], v[144:147]
    v_mfma_f32_16x16x32_bf16 v[148:151], v[128:131], a[196:199], v[148:151]
    ds_read_b64_tr_b16 v[140:141], v241 offset:45056
    ds_read_b64_tr_b16 v[142:143], v241 offset:47104
    v_mfma_f32_16x16x32_bf16 v[152:155], v[128:131], a[200:203], v[152:155]
    v_mfma_f32_16x16x32_bf16 v[156:159], v[128:131], a[204:207], v[156:159]
    s_waitcnt lgkmcnt(4)
    v_mfma_f32_16x16x32_bf16 v[144:147], v[132:135], a[208:211], v[144:147]
    v_mfma_f32_16x16x32_bf16 v[148:151], v[132:135], a[212:215], v[148:151]
    v_mfma_f32_16x16x32_bf16 v[152:155], v[132:135], a[216:219], v[152:155]
    v_mfma_f32_16x16x32_bf16 v[156:159], v[132:135], a[220:223], v[156:159]
    s_waitcnt lgkmcnt(2)
    v_mfma_f32_16x16x32_bf16 v[144:147], v[136:139], a[224:227], v[144:147]
    v_mfma_f32_16x16x32_bf16 v[148:151], v[136:139], a[228:231], v[148:151]
    v_mfma_f32_16x16x32_bf16 v[152:155], v[136:139], a[232:235], v[152:155]
    v_mfma_f32_16x16x32_bf16 v[156:159], v[136:139], a[236:239], v[156:159]
    s_waitcnt lgkmcnt(0)
    v_mfma_f32_16x16x32_bf16 v[144:147], v[140:143], a[240:243], v[144:147]
    v_mfma_f32_16x16x32_bf16 v[148:151], v[140:143], a[244:247], v[148:151]
    v_mfma_f32_16x16x32_bf16 v[152:155], v[140:143], a[248:251], v[152:155]
    v_mfma_f32_16x16x32_bf16 v[156:159], v[140:143], a[252:255], v[156:159]
    s_nop 4
    v_cvt_pk_bf16_f32 v144, v144, v145
    v_cvt_pk_bf16_f32 v145, v146, v147
    v_cvt_pk_bf16_f32 v146, v148, v149
    v_cvt_pk_bf16_f32 v147, v150, v151
    buffer_store_dwordx4 v[144:147], v64, s[36:39], s58 offen offset:2048 sc1
    v_cvt_pk_bf16_f32 v152, v152, v153
    v_cvt_pk_bf16_f32 v153, v154, v155
    v_cvt_pk_bf16_f32 v154, v156, v157
    v_cvt_pk_bf16_f32 v155, v158, v159
    buffer_store_dwordx4 v[152:155], v64, s[36:39], s57 offen offset:2048 sc1
    s_waitcnt vmcnt(2)
    v_max3_u32 v232, v216, v217, v218
    v_max3_u32 v233, v220, v221, v222
    v_max_u32 v232, v232, v219
    v_max_u32 v233, v233, v223
    v_cmp_eq_u32 s[20:21], -1, v232
    v_cmp_eq_u32 s[22:23], -1, v233
    s_nop 0
    s_or_b64 s[50:51], s[20:21], s[22:23]
    s_cselect_b32 s48, 0, 1
    s_cbranch_scc1 L_r0s
    buffer_load_dwordx4 v[176:179], v66, s[36:39], s82 offen sc1
    buffer_load_dwordx4 v[180:183], v66, s[36:39], s81 offen sc1
    buffer_load_dwordx4 v[184:187], v66, s[36:39], s82 offen offset:1024 sc1
    buffer_load_dwordx4 v[188:191], v66, s[36:39], s81 offen offset:1024 sc1
    buffer_load_dwordx4 v[192:195], v66, s[36:39], s82 offen offset:2048 sc1
    buffer_load_dwordx4 v[196:199], v66, s[36:39], s81 offen offset:2048 sc1
    buffer_load_dwordx4 v[200:203], v66, s[36:39], s82 offen offset:3072 sc1
    buffer_load_dwordx4 v[204:207], v66, s[36:39], s81 offen offset:3072 sc1
    buffer_load_dwordx4 v[208:211], v66, s[36:39], s80 offen sc1
    buffer_load_dwordx4 v[212:215], v66, s[36:39], s85 offen sc1
    buffer_load_dwordx4 v[224:227], v66, s[36:39], s80 offen offset:2048 sc1
    buffer_load_dwordx4 v[228:231], v66, s[36:39], s85 offen offset:2048 sc1
    s_branch L_r0b1
L_r0s:
    s_mov_b64 exec, s[20:21]
    s_cbranch_execz L_r0a0
    buffer_load_dwordx4 v[216:219], v66, s[36:39], s80 offen offset:1024 sc1
L_r0a0:
    s_mov_b64 exec, s[22:23]
    s_cbranch_execz L_r0a1
    buffer_load_dwordx4 v[220:223], v66, s[36:39], s85 offen offset:1024 sc1
L_r0a1:
    s_not_b64 exec, s[20:21]
    s_mov_b64 s[28:29], s[20:21]
    s_cbranch_execz L_r0b0
    buffer_load_dwordx4 v[176:179], v66, s[36:39], s82 offen sc1
    buffer_load_dwordx4 v[184:187], v66, s[36:39], s82 offen offset:1024 sc1
    buffer_load_dwordx4 v[192:195], v66, s[36:39], s82 offen offset:2048 sc1
    buffer_load_dwordx4 v[200:203], v66, s[36:39], s82 offen offset:3072 sc1
    buffer_load_dwordx4 v[208:211], v66, s[36:39], s80 offen sc1
    buffer_load_dwordx4 v[224:227], v66, s[36:39], s80 offen offset:2048 sc1
L_r0b0:
    s_not_b64 exec, s[22:23]
    s_mov_b64 s[30:31], s[22:23]
    s_cbranch_execz L_r0b1
    buffer_load_dwordx4 v[180:183], v66, s[36:39], s81 offen sc1
    buffer_load_dwordx4 v[188:191], v66, s[36:39], s81 offen offset:1024 sc1
    buffer_load_dwordx4 v[196:199], v66, s[36:39], s81 offen offset:2048 sc1
    buffer_load_dwordx4 v[204:207], v66, s[36:39], s81 offen offset:3072 sc1
    buffer_load_dwordx4 v[212:215], v66, s[36:39], s85 offen sc1
    buffer_load_dwordx4 v[228:231], v66, s[36:39], s85 offen offset:2048 sc1
L_r0b1:
    s_mov_b64 exec, -1
    v_cvt_pk_bf16_f32 v112, v80, v81
    v_cvt_pk_bf16_f32 v113, v82, v83
    v_cvt_pk_bf16_f32 v114, v84, v85
    v_cvt_pk_bf16_f32 v115, v86, v87
    v_cvt_pk_bf16_f32 v116, v88, v89
    v_cvt_pk_bf16_f32 v117, v90, v91
    v_cvt_pk_bf16_f32 v118, v92, v93
    v_cvt_pk_bf16_f32 v119, v94, v95
    v_lshlrev_b32 v80, 16, v112
    v_and_b32 v81, 0xffff0000, v112
    v_lshlrev_b32 v82, 16, v113
    v_and_b32 v83, 0xffff0000, v113
    v_lshlrev_b32 v84, 16, v114
    v_and_b32 v85, 0xffff0000, v114
    v_lshlrev_b32 v86, 16, v115
    v_and_b32 v87, 0xffff0000, v115
    v_lshlrev_b32 v88, 16, v116
    v_and_b32 v89, 0xffff0000, v116
    v_lshlrev_b32 v90, 16, v117
    v_and_b32 v91, 0xffff0000, v117
    v_lshlrev_b32 v92, 16, v118
    v_and_b32 v93, 0xffff0000, v118
    v_lshlrev_b32 v94, 16, v119
    v_and_b32 v95, 0xffff0000, v119
    v_mul_f32 v112, 0xbfb8aa3b, v80
    v_mul_f32 v113, 0xbfb8aa3b, v81
    v_mul_f32 v114, 0xbfb8aa3b, v82
    v_mul_f32 v115, 0xbfb8aa3b, v83
    v_mul_f32 v116, 0xbfb8aa3b, v84
    v_mul_f32 v117, 0xbfb8aa3b, v85
    v_mul_f32 v118, 0xbfb8aa3b, v86
    v_mul_f32 v119, 0xbfb8aa3b, v87
    v_mul_f32 v120, 0xbfb8aa3b, v88
    v_mul_f32 v121, 0xbfb8aa3b, v89
    v_mul_f32 v122, 0xbfb8aa3b, v90
    v_mul_f32 v123, 0xbfb8aa3b, v91
    v_mul_f32 v124, 0xbfb8aa3b, v92
    v_mul_f32 v125, 0xbfb8aa3b, v93
    v_mul_f32 v126, 0xbfb8aa3b, v94
    v_mul_f32 v127, 0xbfb8aa3b, v95
    v_exp_f32 v112, v112
    v_exp_f32 v113, v113
    v_exp_f32 v114, v114
    v_exp_f32 v115, v115
    v_exp_f32 v116, v116
    v_exp_f32 v117, v117
    v_exp_f32 v118, v118
    v_exp_f32 v119, v119
    v_exp_f32 v120, v120
    v_exp_f32 v121, v121
    v_exp_f32 v122, v122
    v_exp_f32 v123, v123
    v_exp_f32 v124, v124
    v_exp_f32 v125, v125
    v_exp_f32 v126, v126
    v_exp_f32 v127, v127
    v_add_f32 v112, 1.0, v112
    v_add_f32 v113, 1.0, v113
    v_add_f32 v114, 1.0, v114
    v_add_f32 v115, 1.0, v115
    v_add_f32 v116, 1.0, v116
    v_add_f32 v117, 1.0, v117
    v_add_f32 v118, 1.0, v118
    v_add_f32 v119, 1.0, v119
    v_add_f32 v120, 1.0, v120
    v_add_f32 v121, 1.0, v121
    v_add_f32 v122, 1.0, v122
    v_add_f32 v123, 1.0, v123
    v_add_f32 v124, 1.0, v124
    v_add_f32 v125, 1.0, v125
    v_add_f32 v126, 1.0, v126
    v_add_f32 v127, 1.0, v127
    v_rcp_f32 v112, v112
    v_rcp_f32 v113, v113
    v_rcp_f32 v114, v114
    v_rcp_f32 v115, v115
    v_rcp_f32 v116, v116
    v_rcp_f32 v117, v117
    v_rcp_f32 v118, v118
    v_rcp_f32 v119, v119
    v_rcp_f32 v120, v120
    v_rcp_f32 v121, v121
    v_rcp_f32 v122, v122
    v_rcp_f32 v123, v123
    v_rcp_f32 v124, v124
    v_rcp_f32 v125, v125
    v_rcp_f32 v126, v126
    v_rcp_f32 v127, v127
    v_pk_mul_f32 v[80:81], v[80:81], v[112:113]
    v_pk_mul_f32 v[82:83], v[82:83], v[114:115]
    v_pk_mul_f32 v[84:85], v[84:85], v[116:117]
    v_pk_mul_f32 v[86:87], v[86:87], v[118:119]
    v_pk_mul_f32 v[88:89], v[88:89], v[120:121]
    v_pk_mul_f32 v[90:91], v[90:91], v[122:123]
    v_pk_mul_f32 v[92:93], v[92:93], v[124:125]
    v_pk_mul_f32 v[94:95], v[94:95], v[126:127]
    v_cvt_pk_bf16_f32 v112, v80, v81
    v_cvt_pk_bf16_f32 v113, v82, v83
    v_cvt_pk_bf16_f32 v114, v84, v85
    v_cvt_pk_bf16_f32 v115, v86, v87
    v_cvt_pk_bf16_f32 v116, v88, v89
    v_cvt_pk_bf16_f32 v117, v90, v91
    v_cvt_pk_bf16_f32 v118, v92, v93
    v_cvt_pk_bf16_f32 v119, v94, v95
    v_lshlrev_b32 v80, 16, v112
    v_and_b32 v81, 0xffff0000, v112
    v_lshlrev_b32 v82, 16, v113
    v_and_b32 v83, 0xffff0000, v113
    v_lshlrev_b32 v84, 16, v114
    v_and_b32 v85, 0xffff0000, v114
    v_lshlrev_b32 v86, 16, v115
    v_and_b32 v87, 0xffff0000, v115
    v_lshlrev_b32 v88, 16, v116
    v_and_b32 v89, 0xffff0000, v116
    v_lshlrev_b32 v90, 16, v117
    v_and_b32 v91, 0xffff0000, v117
    v_lshlrev_b32 v92, 16, v118
    v_and_b32 v93, 0xffff0000, v118
    v_lshlrev_b32 v94, 16, v119
    v_and_b32 v95, 0xffff0000, v119
    v_lshlrev_b32 v128, 16, v72
    v_and_b32 v129, 0xffff0000, v72
    v_lshlrev_b32 v130, 16, v73
    v_and_b32 v131, 0xffff0000, v73
    v_lshlrev_b32 v132, 16, v74
    v_and_b32 v133, 0xffff0000, v74
    v_lshlrev_b32 v134, 16, v75
    v_and_b32 v135, 0xffff0000, v75
    v_lshlrev_b32 v136, 16, v76
    v_and_b32 v137, 0xffff0000, v76
    v_lshlrev_b32 v138, 16, v77
    v_and_b32 v139, 0xffff0000, v77
    v_lshlrev_b32 v140, 16, v78
    v_and_b32 v141, 0xffff0000, v78
    v_lshlrev_b32 v142, 16, v79
    v_and_b32 v143, 0xffff0000, v79
    s_cmp_eq_u32 s48, 1
    s_cbranch_scc1 L_tdone2
L_tw:
    s_or_b64 s[50:51], s[28:29], s[30:31]
    s_waitcnt vmcnt(0)
    s_cbranch_scc1 L_tr
L_tdone2:
L_chk0:
    s_waitcnt vmcnt(8)
    v_mfma_f32_16x16x32_bf16 v[160:163], v[96:99], v[176:179], 0
    v_mfma_f32_16x16x32_bf16 v[160:163], v[96:99], v[180:183], v[160:163]
    v_mfma_f32_16x16x32_bf16 v[160:163], v[100:103], v[184:187], v[160:163]
    v_mfma_f32_16x16x32_bf16 v[160:163], v[100:103], v[188:191], v[160:163]
    s_nop 7
    v_cvt_pk_bf16_f32 v232, v160, v161
    v_cvt_pk_bf16_f32 v233, v162, v163
    v_lshlrev_b32 v160, 16, v232
    v_and_b32 v161, 0xffff0000, v232
    v_lshlrev_b32 v162, 16, v233
    v_and_b32 v163, 0xffff0000, v233
    v_pk_mul_f32 v[160:161], v[160:161], v[80:81]
    v_pk_mul_f32 v[162:163], v[162:163], v[82:83]
    v_cvt_pk_bf16_f32 v232, v160, v161
    v_cvt_pk_bf16_f32 v233, v162, v163
    v_lshlrev_b32 v160, 16, v232
    v_and_b32 v161, 0xffff0000, v232
    v_lshlrev_b32 v162, 16, v233
    v_and_b32 v163, 0xffff0000, v233
    v_pk_add_f32 v[160:161], v[160:161], v[128:129]
    v_pk_add_f32 v[162:163], v[162:163], v[130:131]
    v_cvt_pk_bf16_f32 v160, v160, v161
    v_cvt_pk_bf16_f32 v161, v162, v163
    buffer_store_dwordx2 v[160:161], v246, s[40:43], s83 offen
L_chk1:
    s_waitcnt vmcnt(5)
    v_mfma_f32_16x16x32_bf16 v[164:167], v[96:99], v[192:195], 0
    v_mfma_f32_16x16x32_bf16 v[164:167], v[96:99], v[196:199], v[164:167]
    v_mfma_f32_16x16x32_bf16 v[164:167], v[100:103], v[200:203], v[164:167]
    v_mfma_f32_16x16x32_bf16 v[164:167], v[100:103], v[204:207], v[164:167]
    s_nop 7
    v_cvt_pk_bf16_f32 v232, v164, v165
    v_cvt_pk_bf16_f32 v233, v166, v167
    v_lshlrev_b32 v164, 16, v232
    v_and_b32 v165, 0xffff0000, v232
    v_lshlrev_b32 v166, 16, v233
    v_and_b32 v167, 0xffff0000, v233
    v_pk_mul_f32 v[164:165], v[164:165], v[84:85]
    v_pk_mul_f32 v[166:167], v[166:167], v[86:87]
    v_cvt_pk_bf16_f32 v232, v164, v165
    v_cvt_pk_bf16_f32 v233, v166, v167
    v_lshlrev_b32 v164, 16, v232
    v_and_b32 v165, 0xffff0000, v232
    v_lshlrev_b32 v166, 16, v233
    v_and_b32 v167, 0xffff0000, v233
    v_pk_add_f32 v[164:165], v[164:165], v[132:133]
    v_pk_add_f32 v[166:167], v[166:167], v[134:135]
    v_cvt_pk_bf16_f32 v164, v164, v165
    v_cvt_pk_bf16_f32 v165, v166, v167
    buffer_store_dwordx2 v[164:165], v246, s[40:43], s83 offen offset:256
L_chk2:
    s_waitcnt vmcnt(4)
    v_max3_u32 v232, v208, v209, v210
    v_max3_u32 v233, v212, v213, v214
    v_max_u32 v232, v232, v211
    v_max_u32 v233, v233, v215
    v_cmp_eq_u32 s[20:21], -1, v232
    v_cmp_eq_u32 s[22:23], -1, v233
    v_mfma_f32_16x16x32_bf16 v[168:171], v[96:99], v[208:211], 0
    v_mfma_f32_16x16x32_bf16 v[168:171], v[96:99], v[212:215], v[168:171]
    v_mfma_f32_16x16x32_bf16 v[168:171], v[100:103], v[216:219], v[168:171]
    v_mfma_f32_16x16x32_bf16 v[168:171], v[100:103], v[220:223], v[168:171]
    s_or_b64 s[50:51], s[20:21], s[22:23]
    s_cbranch_scc1 L_retry2
L_go2:
    s_nop 5
    v_cvt_pk_bf16_f32 v232, v168, v169
    v_cvt_pk_bf16_f32 v233, v170, v171
    v_lshlrev_b32 v168, 16, v232
    v_and_b32 v169, 0xffff0000, v232
    v_lshlrev_b32 v170, 16, v233
    v_and_b32 v171, 0xffff0000, v233
    v_pk_mul_f32 v[168:169], v[168:169], v[88:89]
    v_pk_mul_f32 v[170:171], v[170:171], v[90:91]
    v_cvt_pk_bf16_f32 v232, v168, v169
    v_cvt_pk_bf16_f32 v233, v170, v171
    v_lshlrev_b32 v168, 16, v232
    v_and_b32 v169, 0xffff0000, v232
    v_lshlrev_b32 v170, 16, v233
    v_and_b32 v171, 0xffff0000, v233
    v_pk_add_f32 v[168:169], v[168:169], v[136:137]
    v_pk_add_f32 v[170:171], v[170:171], v[138:139]
    v_cvt_pk_bf16_f32 v168, v168, v169
    v_cvt_pk_bf16_f32 v169, v170, v171
    buffer_store_dwordx2 v[168:169], v246, s[40:43], s83 offen offset:512
L_chk3:
    s_waitcnt vmcnt(3)
    v_max3_u32 v232, v224, v225, v226
    v_max3_u32 v233, v228, v229, v230
    v_max_u32 v232, v232, v227
    v_max_u32 v233, v233, v231
    v_cmp_eq_u32 s[20:21], -1, v232
    v_cmp_eq_u32 s[22:23], -1, v233
    v_mfma_f32_16x16x32_bf16 v[172:175], v[96:99], v[224:227], 0
    v_mfma_f32_16x16x32_bf16 v[172:175], v[96:99], v[228:231], v[172:175]
    s_or_b64 s[50:51], s[20:21], s[22:23]
    s_cbranch_scc1 L_retry3
L_go3:
    s_nop 5
    v_cvt_pk_bf16_f32 v232, v172, v173
    v_cvt_pk_bf16_f32 v233, v174, v175
    v_lshlrev_b32 v172, 16, v232
    v_and_b32 v173, 0xffff0000, v232
    v_lshlrev_b32 v174, 16, v233
    v_and_b32 v175, 0xffff0000, v233
    v_pk_mul_f32 v[172:173], v[172:173], v[92:93]
    v_pk_mul_f32 v[174:175], v[174:175], v[94:95]
    v_cvt_pk_bf16_f32 v232, v172, v173
    v_cvt_pk_bf16_f32 v233, v174, v175
    v_lshlrev_b32 v172, 16, v232
    v_and_b32 v173, 0xffff0000, v232
    v_lshlrev_b32 v174, 16, v233
    v_and_b32 v175, 0xffff0000, v233
    v_pk_add_f32 v[172:173], v[172:173], v[140:141]
    v_pk_add_f32 v[174:175], v[174:175], v[142:143]
    v_cvt_pk_bf16_f32 v172, v172, v173
    v_cvt_pk_bf16_f32 v173, v174, v175
    s_mov_b32 exec_hi, 0
    buffer_store_dwordx2 v[172:173], v246, s[40:43], s83 offen offset:768
    s_mov_b32 exec_hi, -1
    s_waitcnt vmcnt(0)
    s_endpgm
L_tr:
    v_max3_u32 v232, v216, v217, v218
    v_max3_u32 v233, v220, v221, v222
    v_max_u32 v232, v232, v219
    v_max_u32 v233, v233, v223
    v_cmp_eq_u32 s[20:21], -1, v232
    v_cmp_eq_u32 s[22:23], -1, v233
    s_mov_b64 exec, s[20:21]
    s_cbranch_execz L_r1a0
    buffer_load_dwordx4 v[216:219], v66, s[36:39], s80 offen offset:1024 sc1
L_r1a0:
    s_mov_b64 exec, s[22:23]
    s_cbranch_execz L_r1a1
    buffer_load_dwordx4 v[220:223], v66, s[36:39], s85 offen offset:1024 sc1
L_r1a1:
    s_andn2_b64 exec, s[28:29], s[20:21]
    s_mov_b64 s[28:29], s[20:21]
    s_cbranch_execz L_r1b0
    buffer_load_dwordx4 v[176:179], v66, s[36:39], s82 offen sc1
    buffer_load_dwordx4 v[184:187], v66, s[36:39], s82 offen offset:1024 sc1
    buffer_load_dwordx4 v[192:195], v66, s[36:39], s82 offen offset:2048 sc1
    buffer_load_dwordx4 v[200:203], v66, s[36:39], s82 offen offset:3072 sc1
    buffer_load_dwordx4 v[208:211], v66, s[36:39], s80 offen sc1
    buffer_load_dwordx4 v[224:227], v66, s[36:39], s80 offen offset:2048 sc1
L_r1b0:
    s_andn2_b64 exec, s[30:31], s[22:23]
    s_mov_b64 s[30:31], s[22:23]
    s_cbranch_execz L_r1b1
    buffer_load_dwordx4 v[180:183], v66, s[36:39], s81 offen sc1
    buffer_load_dwordx4 v[188:191], v66, s[36:39], s81 offen offset:1024 sc1
    buffer_load_dwordx4 v[196:199], v66, s[36:39], s81 offen offset:2048 sc1
    buffer_load_dwordx4 v[204:207], v66, s[36:39], s81 offen offset:3072 sc1
    buffer_load_dwordx4 v[212:215], v66, s[36:39], s85 offen sc1
    buffer_load_dwordx4 v[228:231], v66, s[36:39], s85 offen offset:2048 sc1
L_r1b1:
    s_mov_b64 exec, -1
    s_add_u32 s87, s87, 1
    s_cmp_lt_u32 s87, 262144
    s_cbranch_scc1 L_tw
    s_waitcnt vmcnt(0)
    s_branch L_tdone2
L_retry2:
    s_mov_b64 exec, s[20:21]
    s_cbranch_execz L_rs2_0
    buffer_load_dwordx4 v[208:211], v66, s[36:39], s80 offen sc1
L_rs2_0:
    s_mov_b64 exec, s[22:23]
    s_cbranch_execz L_rs2_1
    buffer_load_dwordx4 v[212:215], v66, s[36:39], s85 offen sc1
L_rs2_1:
    s_mov_b64 exec, -1
    s_add_u32 s87, s87, 1
    s_cmp_lt_u32 s87, 262144
    s_waitcnt vmcnt(0)
    s_cbranch_scc1 L_chk2
    s_nop 7
    s_branch L_go2
L_retry3:
    s_mov_b64 exec, s[20:21]
    s_cbranch_execz L_rs3_0
    buffer_load_dwordx4 v[224:227], v66, s[36:39], s80 offen offset:2048 sc1
L_rs3_0:
    s_mov_b64 exec, s[22:23]
    s_cbranch_execz L_rs3_1
    buffer_load_dwordx4 v[228:231], v66, s[36:39], s85 offen offset:2048 sc1
L_rs3_1:
    s_mov_b64 exec, -1
    s_add_u32 s87, s87, 1
    s_cmp_lt_u32 s87, 262144
    s_waitcnt vmcnt(0)
    s_cbranch_scc1 L_chk3
    s_nop 7
    s_branch L_go3
L_hot_end:
L_slow_u0:
    s_mov_b32 s80, 0
    s_mov_b32 s81, 0
    s_call_b64 s[78:79], L_sub_00
    s_call_b64 s[78:79], L_sub_01
    s_branch L_ret_u0
L_slow_u1:
    s_mov_b32 s80, 1
    s_mov_b32 s81, 1.0
    s_call_b64 s[78:79], L_sub_10
    s_call_b64 s[78:79], L_sub_11
    s_branch L_ret_u1
L_slow_l0:
    s_lshl_b32 s80, s52, 1
    s_add_u32 s80, s80, 2
    s_mov_b32 s81, 1.0
    s_call_b64 s[78:79], L_sub_00
    s_call_b64 s[78:79], L_sub_01
    s_branch L_ret_l0
L_slow_l1:
    s_lshl_b32 s80, s52, 1
    s_add_u32 s80, s80, 1
    s_mov_b32 s81, 1.0
    s_call_b64 s[78:79], L_sub_10
    s_call_b64 s[78:79], L_sub_11
    s_cmp_lt_u32 s52, 14
    s_branch L_ret_l1
L_slow_u30:
    s_mov_b32 s80, 30
    s_mov_b32 s81, 1.0
    s_call_b64 s[78:79], L_sub_00
    s_call_b64 s[78:79], L_sub_01
    s_branch L_ret_u30
L_slow_u31a:
    s_mov_b32 s80, 31
    s_mov_b32 s81, 0
    s_call_b64 s[78:79], L_sub_21
    s_branch L_ret_u31a
L_slow_u31b:
    s_mov_b32 s80, 31
    s_mov_b32 s81, 0
    s_call_b64 s[78:79], L_sub_20
    s_branch L_ret_u31b
L_sub_00:
    s_nop 15
    s_lshl_b32 s85, s80, 15
    s_lshl_b32 s86, s60, 14
    s_add_u32 s85, s85, s86
    s_add_u32 s85, s85, 128
    v_and_b32 v251, 15, v250
    v_lshlrev_b32 v251, 10, v251
    v_lshrrev_b32 v108, 4, v250
    v_lshl_add_u32 v251, v108, 4, v251
    v_mov_b32 v108, v72
    s_waitcnt vmcnt(0) lgkmcnt(0)
    buffer_load_dwordx4 v[72:75], v251, s[12:15], s85 offen offset:0
    s_waitcnt vmcnt(0)
    v_mfma_f32_16x16x32_bf16 v[0:3], v[72:75], a[0:3], v[64:67]
    v_mfma_f32_16x16x32_bf16 v[8:11], v[72:75], a[4:7], v[68:71]
    s_nop 7
    buffer_load_dwordx4 v[72:75], v251, s[12:15], s85 offen offset:512
    s_waitcnt vmcnt(0)
    v_mfma_f32_16x16x32_bf16 v[4:7], v[72:75], a[0:3], v[64:67]
    v_mfma_f32_16x16x32_bf16 v[12:15], v[72:75], a[4:7], v[68:71]
    s_nop 7
    buffer_load_dwordx4 v[72:75], v251, s[12:15], s85 offen offset:64
    s_waitcnt vmcnt(0)
    v_mfma_f32_16x16x32_bf16 v[0:3], v[72:75], a[16:19], v[0:3]
    v_mfma_f32_16x16x32_bf16 v[8:11], v[72:75], a[20:23], v[8:11]
    s_nop 7
    buffer_load_dwordx4 v[72:75], v251, s[12:15], s85 offen offset:576
    s_waitcnt vmcnt(0)
    v_mfma_f32_16x16x32_bf16 v[4:7], v[72:75], a[16:19], v[4:7]
    v_mfma_f32_16x16x32_bf16 v[12:15], v[72:75], a[20:23], v[12:15]
    s_nop 7
    buffer_load_dwordx4 v[72:75], v251, s[12:15], s85 offen offset:128
    s_waitcnt vmcnt(0)
    v_mfma_f32_16x16x32_bf16 v[0:3], v[72:75], a[32:35], v[0:3]
    v_mfma_f32_16x16x32_bf16 v[8:11], v[72:75], a[36:39], v[8:11]
    s_nop 7
    buffer_load_dwordx4 v[72:75], v251, s[12:15], s85 offen offset:640
    s_waitcnt vmcnt(0)
    v_mfma_f32_16x16x32_bf16 v[4:7], v[72:75], a[32:35], v[4:7]
    v_mfma_f32_16x16x32_bf16 v[12:15], v[72:75], a[36:39], v[12:15]
    s_nop 7
    buffer_load_dwordx4 v[72:75], v251, s[12:15], s85 offen offset:192
    s_waitcnt vmcnt(0)
    v_mfma_f32_16x16x32_bf16 v[0:3], v[72:75], a[48:51], v[0:3]
    v_mfma_f32_16x16x32_bf16 v[8:11], v[72:75], a[52:55], v[8:11]
    s_nop 7
    buffer_load_dwordx4 v[72:75], v251, s[12:15], s85 offen offset:704
    s_waitcnt vmcnt(0)
    v_mfma_f32_16x16x32_bf16 v[4:7], v[72:75], a[48:51], v[4:7]
    v_mfma_f32_16x16x32_bf16 v[12:15], v[72:75], a[52:55], v[12:15]
    s_nop 7
    buffer_load_dwordx4 v[72:75], v251, s[12:15], s85 offen offset:256
    s_waitcnt vmcnt(0)
    v_mfma_f32_16x16x32_bf16 v[0:3], v[72:75], a[64:67], v[0:3]
    v_mfma_f32_16x16x32_bf16 v[8:11], v[72:75], a[68:71], v[8:11]
    s_nop 7
    buffer_load_dwordx4 v[72:75], v251, s[12:15], s85 offen offset:768
    s_waitcnt vmcnt(0)
    v_mfma_f32_16x16x32_bf16 v[4:7], v[72:75], a[64:67], v[4:7]
    v_mfma_f32_16x16x32_bf16 v[12:15], v[72:75], a[68:71], v[12:15]
    s_nop 7
    buffer_load_dwordx4 v[72:75], v251, s[12:15], s85 offen offset:320
    s_waitcnt vmcnt(0)
    v_mfma_f32_16x16x32_bf16 v[0:3], v[72:75], a[80:83], v[0:3]
    v_mfma_f32_16x16x32_bf16 v[8:11], v[72:75], a[84:87], v[8:11]
    s_nop 7
    buffer_load_dwordx4 v[72:75], v251, s[12:15], s85 offen offset:832
    s_waitcnt vmcnt(0)
    v_mfma_f32_16x16x32_bf16 v[4:7], v[72:75], a[80:83], v[4:7]
    v_mfma_f32_16x16x32_bf16 v[12:15], v[72:75], a[84:87], v[12:15]
    s_nop 7
    buffer_load_dwordx4 v[72:75], v251, s[12:15], s85 offen offset:384
    s_waitcnt vmcnt(0)
    v_mfma_f32_16x16x32_bf16 v[0:3], v[72:75], a[96:99], v[0:3]
    v_mfma_f32_16x16x32_bf16 v[8:11], v[72:75], a[100:103], v[8:11]
    s_nop 7
    buffer_load_dwordx4 v[72:75], v251, s[12:15], s85 offen offset:896
    s_waitcnt vmcnt(0)
    v_mfma_f32_16x16x32_bf16 v[4:7], v[72:75], a[96:99], v[4:7]
    v_mfma_f32_16x16x32_bf16 v[12:15], v[72:75], a[100:103], v[12:15]
    s_nop 7
    buffer_load_dwordx4 v[72:75], v251, s[12:15], s85 offen offset:448
    s_waitcnt vmcnt(0)
    v_mfma_f32_16x16x32_bf16 v[0:3], v[72:75], a[112:115], v[0:3]
    v_mfma_f32_16x16x32_bf16 v[8:11], v[72:75], a[116:119], v[8:11]
    s_nop 7
    buffer_load_dwordx4 v[72:75], v251, s[12:15], s85 offen offset:960
    s_waitcnt vmcnt(0)
    v_mfma_f32_16x16x32_bf16 v[4:7], v[72:75], a[112:115], v[4:7]
    v_mfma_f32_16x16x32_bf16 v[12:15], v[72:75], a[116:119], v[12:15]
    s_nop 7
    s_nop 15
    v_mov_b32 v72, v108
    v_mov_b32 v73, v108
    v_mov_b32 v74, v108
    v_mov_b32 v75, v108
    v_max3_f32 v108, v0, v1, v2
    v_max3_f32 v108, v108, v3, v4
    v_max3_f32 v108, v108, v5, v6
    v_max_f32 v108, v108, v7
    v_mov_b32 v251, v108
    s_nop 1
    v_permlane32_swap_b32 v108, v251
    v_max_f32 v108, v108, v251
    v_mov_b32 v251, v108
    s_nop 1
    v_permlane16_swap_b32 v108, v251
    v_max_f32 v108, v108, v251
    v_add_f32 v108, 0x42200000, v108
    v_max_f32 v108, 0, v108
    v_ceil_f32 v108, v108
    v_max3_f32 v109, v8, v9, v10
    v_max3_f32 v109, v109, v11, v12
    v_max3_f32 v109, v109, v13, v14
    v_max_f32 v109, v109, v15
    v_mov_b32 v251, v109
    s_nop 1
    v_permlane32_swap_b32 v109, v251
    v_max_f32 v109, v109, v251
    v_mov_b32 v251, v109
    s_nop 1
    v_permlane16_swap_b32 v109, v251
    v_max_f32 v109, v109, v251
    v_add_f32 v109, 0x42200000, v109
    v_max_f32 v109, 0, v109
    v_ceil_f32 v109, v109
    v_sub_f32 v64, v64, v108
    v_sub_f32 v65, v65, v108
    v_sub_f32 v66, v66, v108
    v_sub_f32 v67, v67, v108
    v_mul_f32 v251, s81, v108
    v_sub_f32 v0, v0, v108
    v_sub_f32 v32, v32, v251
    v_sub_f32 v1, v1, v108
    v_sub_f32 v33, v33, v251
    v_sub_f32 v2, v2, v108
    v_sub_f32 v34, v34, v251
    v_sub_f32 v3, v3, v108
    v_sub_f32 v35, v35, v251
    v_sub_f32 v4, v4, v108
    v_sub_f32 v36, v36, v251
    v_sub_f32 v5, v5, v108
    v_sub_f32 v37, v37, v251
    v_sub_f32 v6, v6, v108
    v_sub_f32 v38, v38, v251
    v_sub_f32 v7, v7, v108
    v_sub_f32 v39, v39, v251
    v_sub_f32 v108, 0, v108
    v_cvt_i32_f32 v108, v108
    v_ldexp_f32 v104, v104, v108
    v_accvgpr_read_b32 v251, a128
    v_ldexp_f32 v251, v251, v108
    v_accvgpr_write_b32 a128, v251
    v_accvgpr_read_b32 v251, a129
    v_ldexp_f32 v251, v251, v108
    v_accvgpr_write_b32 a129, v251
    v_accvgpr_read_b32 v251, a130
    v_ldexp_f32 v251, v251, v108
    v_accvgpr_write_b32 a130, v251
    v_accvgpr_read_b32 v251, a131
    v_ldexp_f32 v251, v251, v108
    v_accvgpr_write_b32 a131, v251
    v_accvgpr_read_b32 v251, a136
    v_ldexp_f32 v251, v251, v108
    v_accvgpr_write_b32 a136, v251
    v_accvgpr_read_b32 v251, a137
    v_ldexp_f32 v251, v251, v108
    v_accvgpr_write_b32 a137, v251
    v_accvgpr_read_b32 v251, a138
    v_ldexp_f32 v251, v251, v108
    v_accvgpr_write_b32 a138, v251
    v_accvgpr_read_b32 v251, a139
    v_ldexp_f32 v251, v251, v108
    v_accvgpr_write_b32 a139, v251
    v_accvgpr_read_b32 v251, a144
    v_ldexp_f32 v251, v251, v108
    v_accvgpr_write_b32 a144, v251
    v_accvgpr_read_b32 v251, a145
    v_ldexp_f32 v251, v251, v108
    v_accvgpr_write_b32 a145, v251
    v_accvgpr_read_b32 v251, a146
    v_ldexp_f32 v251, v251, v108
    v_accvgpr_write_b32 a146, v251
    v_accvgpr_read_b32 v251, a147
    v_ldexp_f32 v251, v251, v108
    v_accvgpr_write_b32 a147, v251
    v_accvgpr_read_b32 v251, a152
    v_ldexp_f32 v251, v251, v108
    v_accvgpr_write_b32 a152, v251
    v_accvgpr_read_b32 v251, a153
    v_ldexp_f32 v251, v251, v108
    v_accvgpr_write_b32 a153, v251
    v_accvgpr_read_b32 v251, a154
    v_ldexp_f32 v251, v251, v108
    v_accvgpr_write_b32 a154, v251
    v_accvgpr_read_b32 v251, a155
    v_ldexp_f32 v251, v251, v108
    v_accvgpr_write_b32 a155, v251
    v_accvgpr_read_b32 v251, a160
    v_ldexp_f32 v251, v251, v108
    v_accvgpr_write_b32 a160, v251
    v_accvgpr_read_b32 v251, a161
    v_ldexp_f32 v251, v251, v108
    v_accvgpr_write_b32 a161, v251
    v_accvgpr_read_b32 v251, a162
    v_ldexp_f32 v251, v251, v108
    v_accvgpr_write_b32 a162, v251
    v_accvgpr_read_b32 v251, a163
    v_ldexp_f32 v251, v251, v108
    v_accvgpr_write_b32 a163, v251
    v_accvgpr_read_b32 v251, a168
    v_ldexp_f32 v251, v251, v108
    v_accvgpr_write_b32 a168, v251
    v_accvgpr_read_b32 v251, a169
    v_ldexp_f32 v251, v251, v108
    v_accvgpr_write_b32 a169, v251
    v_accvgpr_read_b32 v251, a170
    v_ldexp_f32 v251, v251, v108
    v_accvgpr_write_b32 a170, v251
    v_accvgpr_read_b32 v251, a171
    v_ldexp_f32 v251, v251, v108
    v_accvgpr_write_b32 a171, v251
    v_accvgpr_read_b32 v251, a176
    v_ldexp_f32 v251, v251, v108
    v_accvgpr_write_b32 a176, v251
    v_accvgpr_read_b32 v251, a177
    v_ldexp_f32 v251, v251, v108
    v_accvgpr_write_b32 a177, v251
    v_accvgpr_read_b32 v251, a178
    v_ldexp_f32 v251, v251, v108
    v_accvgpr_write_b32 a178, v251
    v_accvgpr_read_b32 v251, a179
    v_ldexp_f32 v251, v251, v108
    v_accvgpr_write_b32 a179, v251
    v_accvgpr_read_b32 v251, a184
    v_ldexp_f32 v251, v251, v108
    v_accvgpr_write_b32 a184, v251
    v_accvgpr_read_b32 v251, a185
    v_ldexp_f32 v251, v251, v108
    v_accvgpr_write_b32 a185, v251
    v_accvgpr_read_b32 v251, a186
    v_ldexp_f32 v251, v251, v108
    v_accvgpr_write_b32 a186, v251
    v_accvgpr_read_b32 v251, a187
    v_ldexp_f32 v251, v251, v108
    v_accvgpr_write_b32 a187, v251
    v_accvgpr_read_b32 v251, a192
    v_ldexp_f32 v251, v251, v108
    v_accvgpr_write_b32 a192, v251
    v_accvgpr_read_b32 v251, a193
    v_ldexp_f32 v251, v251, v108
    v_accvgpr_write_b32 a193, v251
    v_accvgpr_read_b32 v251, a194
    v_ldexp_f32 v251, v251, v108
    v_accvgpr_write_b32 a194, v251
    v_accvgpr_read_b32 v251, a195
    v_ldexp_f32 v251, v251, v108
    v_accvgpr_write_b32 a195, v251
    v_accvgpr_read_b32 v251, a200
    v_ldexp_f32 v251, v251, v108
    v_accvgpr_write_b32 a200, v251
    v_accvgpr_read_b32 v251, a201
    v_ldexp_f32 v251, v251, v108
    v_accvgpr_write_b32 a201, v251
    v_accvgpr_read_b32 v251, a202
    v_ldexp_f32 v251, v251, v108
    v_accvgpr_write_b32 a202, v251
    v_accvgpr_read_b32 v251, a203
    v_ldexp_f32 v251, v251, v108
    v_accvgpr_write_b32 a203, v251
    v_accvgpr_read_b32 v251, a208
    v_ldexp_f32 v251, v251, v108
    v_accvgpr_write_b32 a208, v251
    v_accvgpr_read_b32 v251, a209
    v_ldexp_f32 v251, v251, v108
    v_accvgpr_write_b32 a209, v251
    v_accvgpr_read_b32 v251, a210
    v_ldexp_f32 v251, v251, v108
    v_accvgpr_write_b32 a210, v251
    v_accvgpr_read_b32 v251, a211
    v_ldexp_f32 v251, v251, v108
    v_accvgpr_write_b32 a211, v251
    v_accvgpr_read_b32 v251, a216
    v_ldexp_f32 v251, v251, v108
    v_accvgpr_write_b32 a216, v251
    v_accvgpr_read_b32 v251, a217
    v_ldexp_f32 v251, v251, v108
    v_accvgpr_write_b32 a217, v251
    v_accvgpr_read_b32 v251, a218
    v_ldexp_f32 v251, v251, v108
    v_accvgpr_write_b32 a218, v251
    v_accvgpr_read_b32 v251, a219
    v_ldexp_f32 v251, v251, v108
    v_accvgpr_write_b32 a219, v251
    v_accvgpr_read_b32 v251, a224
    v_ldexp_f32 v251, v251, v108
    v_accvgpr_write_b32 a224, v251
    v_accvgpr_read_b32 v251, a225
    v_ldexp_f32 v251, v251, v108
    v_accvgpr_write_b32 a225, v251
    v_accvgpr_read_b32 v251, a226
    v_ldexp_f32 v251, v251, v108
    v_accvgpr_write_b32 a226, v251
    v_accvgpr_read_b32 v251, a227
    v_ldexp_f32 v251, v251, v108
    v_accvgpr_write_b32 a227, v251
    v_accvgpr_read_b32 v251, a232
    v_ldexp_f32 v251, v251, v108
    v_accvgpr_write_b32 a232, v251
    v_accvgpr_read_b32 v251, a233
    v_ldexp_f32 v251, v251, v108
    v_accvgpr_write_b32 a233, v251
    v_accvgpr_read_b32 v251, a234
    v_ldexp_f32 v251, v251, v108
    v_accvgpr_write_b32 a234, v251
    v_accvgpr_read_b32 v251, a235
    v_ldexp_f32 v251, v251, v108
    v_accvgpr_write_b32 a235, v251
    v_accvgpr_read_b32 v251, a240
    v_ldexp_f32 v251, v251, v108
    v_accvgpr_write_b32 a240, v251
    v_accvgpr_read_b32 v251, a241
    v_ldexp_f32 v251, v251, v108
    v_accvgpr_write_b32 a241, v251
    v_accvgpr_read_b32 v251, a242
    v_ldexp_f32 v251, v251, v108
    v_accvgpr_write_b32 a242, v251
    v_accvgpr_read_b32 v251, a243
    v_ldexp_f32 v251, v251, v108
    v_accvgpr_write_b32 a243, v251
    v_accvgpr_read_b32 v251, a248
    v_ldexp_f32 v251, v251, v108
    v_accvgpr_write_b32 a248, v251
    v_accvgpr_read_b32 v251, a249
    v_ldexp_f32 v251, v251, v108
    v_accvgpr_write_b32 a249, v251
    v_accvgpr_read_b32 v251, a250
    v_ldexp_f32 v251, v251, v108
    v_accvgpr_write_b32 a250, v251
    v_accvgpr_read_b32 v251, a251
    v_ldexp_f32 v251, v251, v108
    v_accvgpr_write_b32 a251, v251
    v_sub_f32 v68, v68, v109
    v_sub_f32 v69, v69, v109
    v_sub_f32 v70, v70, v109
    v_sub_f32 v71, v71, v109
    v_mul_f32 v251, s81, v109
    v_sub_f32 v8, v8, v109
    v_sub_f32 v40, v40, v251
    v_sub_f32 v9, v9, v109
    v_sub_f32 v41, v41, v251
    v_sub_f32 v10, v10, v109
    v_sub_f32 v42, v42, v251
    v_sub_f32 v11, v11, v109
    v_sub_f32 v43, v43, v251
    v_sub_f32 v12, v12, v109
    v_sub_f32 v44, v44, v251
    v_sub_f32 v13, v13, v109
    v_sub_f32 v45, v45, v251
    v_sub_f32 v14, v14, v109
    v_sub_f32 v46, v46, v251
    v_sub_f32 v15, v15, v109
    v_sub_f32 v47, v47, v251
    v_sub_f32 v109, 0, v109
    v_cvt_i32_f32 v109, v109
    v_ldexp_f32 v105, v105, v109
    v_accvgpr_read_b32 v251, a132
    v_ldexp_f32 v251, v251, v109
    v_accvgpr_write_b32 a132, v251
    v_accvgpr_read_b32 v251, a133
    v_ldexp_f32 v251, v251, v109
    v_accvgpr_write_b32 a133, v251
    v_accvgpr_read_b32 v251, a134
    v_ldexp_f32 v251, v251, v109
    v_accvgpr_write_b32 a134, v251
    v_accvgpr_read_b32 v251, a135
    v_ldexp_f32 v251, v251, v109
    v_accvgpr_write_b32 a135, v251
    v_accvgpr_read_b32 v251, a140
    v_ldexp_f32 v251, v251, v109
    v_accvgpr_write_b32 a140, v251
    v_accvgpr_read_b32 v251, a141
    v_ldexp_f32 v251, v251, v109
    v_accvgpr_write_b32 a141, v251
    v_accvgpr_read_b32 v251, a142
    v_ldexp_f32 v251, v251, v109
    v_accvgpr_write_b32 a142, v251
    v_accvgpr_read_b32 v251, a143
    v_ldexp_f32 v251, v251, v109
    v_accvgpr_write_b32 a143, v251
    v_accvgpr_read_b32 v251, a148
    v_ldexp_f32 v251, v251, v109
    v_accvgpr_write_b32 a148, v251
    v_accvgpr_read_b32 v251, a149
    v_ldexp_f32 v251, v251, v109
    v_accvgpr_write_b32 a149, v251
    v_accvgpr_read_b32 v251, a150
    v_ldexp_f32 v251, v251, v109
    v_accvgpr_write_b32 a150, v251
    v_accvgpr_read_b32 v251, a151
    v_ldexp_f32 v251, v251, v109
    v_accvgpr_write_b32 a151, v251
    v_accvgpr_read_b32 v251, a156
    v_ldexp_f32 v251, v251, v109
    v_accvgpr_write_b32 a156, v251
    v_accvgpr_read_b32 v251, a157
    v_ldexp_f32 v251, v251, v109
    v_accvgpr_write_b32 a157, v251
    v_accvgpr_read_b32 v251, a158
    v_ldexp_f32 v251, v251, v109
    v_accvgpr_write_b32 a158, v251
    v_accvgpr_read_b32 v251, a159
    v_ldexp_f32 v251, v251, v109
    v_accvgpr_write_b32 a159, v251
    v_accvgpr_read_b32 v251, a164
    v_ldexp_f32 v251, v251, v109
    v_accvgpr_write_b32 a164, v251
    v_accvgpr_read_b32 v251, a165
    v_ldexp_f32 v251, v251, v109
    v_accvgpr_write_b32 a165, v251
    v_accvgpr_read_b32 v251, a166
    v_ldexp_f32 v251, v251, v109
    v_accvgpr_write_b32 a166, v251
    v_accvgpr_read_b32 v251, a167
    v_ldexp_f32 v251, v251, v109
    v_accvgpr_write_b32 a167, v251
    v_accvgpr_read_b32 v251, a172
    v_ldexp_f32 v251, v251, v109
    v_accvgpr_write_b32 a172, v251
    v_accvgpr_read_b32 v251, a173
    v_ldexp_f32 v251, v251, v109
    v_accvgpr_write_b32 a173, v251
    v_accvgpr_read_b32 v251, a174
    v_ldexp_f32 v251, v251, v109
    v_accvgpr_write_b32 a174, v251
    v_accvgpr_read_b32 v251, a175
    v_ldexp_f32 v251, v251, v109
    v_accvgpr_write_b32 a175, v251
    v_accvgpr_read_b32 v251, a180
    v_ldexp_f32 v251, v251, v109
    v_accvgpr_write_b32 a180, v251
    v_accvgpr_read_b32 v251, a181
    v_ldexp_f32 v251, v251, v109
    v_accvgpr_write_b32 a181, v251
    v_accvgpr_read_b32 v251, a182
    v_ldexp_f32 v251, v251, v109
    v_accvgpr_write_b32 a182, v251
    v_accvgpr_read_b32 v251, a183
    v_ldexp_f32 v251, v251, v109
    v_accvgpr_write_b32 a183, v251
    v_accvgpr_read_b32 v251, a188
    v_ldexp_f32 v251, v251, v109
    v_accvgpr_write_b32 a188, v251
    v_accvgpr_read_b32 v251, a189
    v_ldexp_f32 v251, v251, v109
    v_accvgpr_write_b32 a189, v251
    v_accvgpr_read_b32 v251, a190
    v_ldexp_f32 v251, v251, v109
    v_accvgpr_write_b32 a190, v251
    v_accvgpr_read_b32 v251, a191
    v_ldexp_f32 v251, v251, v109
    v_accvgpr_write_b32 a191, v251
    v_accvgpr_read_b32 v251, a196
    v_ldexp_f32 v251, v251, v109
    v_accvgpr_write_b32 a196, v251
    v_accvgpr_read_b32 v251, a197
    v_ldexp_f32 v251, v251, v109
    v_accvgpr_write_b32 a197, v251
    v_accvgpr_read_b32 v251, a198
    v_ldexp_f32 v251, v251, v109
    v_accvgpr_write_b32 a198, v251
    v_accvgpr_read_b32 v251, a199
    v_ldexp_f32 v251, v251, v109
    v_accvgpr_write_b32 a199, v251
    v_accvgpr_read_b32 v251, a204
    v_ldexp_f32 v251, v251, v109
    v_accvgpr_write_b32 a204, v251
    v_accvgpr_read_b32 v251, a205
    v_ldexp_f32 v251, v251, v109
    v_accvgpr_write_b32 a205, v251
    v_accvgpr_read_b32 v251, a206
    v_ldexp_f32 v251, v251, v109
    v_accvgpr_write_b32 a206, v251
    v_accvgpr_read_b32 v251, a207
    v_ldexp_f32 v251, v251, v109
    v_accvgpr_write_b32 a207, v251
    v_accvgpr_read_b32 v251, a212
    v_ldexp_f32 v251, v251, v109
    v_accvgpr_write_b32 a212, v251
    v_accvgpr_read_b32 v251, a213
    v_ldexp_f32 v251, v251, v109
    v_accvgpr_write_b32 a213, v251
    v_accvgpr_read_b32 v251, a214
    v_ldexp_f32 v251, v251, v109
    v_accvgpr_write_b32 a214, v251
    v_accvgpr_read_b32 v251, a215
    v_ldexp_f32 v251, v251, v109
    v_accvgpr_write_b32 a215, v251
    v_accvgpr_read_b32 v251, a220
    v_ldexp_f32 v251, v251, v109
    v_accvgpr_write_b32 a220, v251
    v_accvgpr_read_b32 v251, a221
    v_ldexp_f32 v251, v251, v109
    v_accvgpr_write_b32 a221, v251
    v_accvgpr_read_b32 v251, a222
    v_ldexp_f32 v251, v251, v109
    v_accvgpr_write_b32 a222, v251
    v_accvgpr_read_b32 v251, a223
    v_ldexp_f32 v251, v251, v109
    v_accvgpr_write_b32 a223, v251
    v_accvgpr_read_b32 v251, a228
    v_ldexp_f32 v251, v251, v109
    v_accvgpr_write_b32 a228, v251
    v_accvgpr_read_b32 v251, a229
    v_ldexp_f32 v251, v251, v109
    v_accvgpr_write_b32 a229, v251
    v_accvgpr_read_b32 v251, a230
    v_ldexp_f32 v251, v251, v109
    v_accvgpr_write_b32 a230, v251
    v_accvgpr_read_b32 v251, a231
    v_ldexp_f32 v251, v251, v109
    v_accvgpr_write_b32 a231, v251
    v_accvgpr_read_b32 v251, a236
    v_ldexp_f32 v251, v251, v109
    v_accvgpr_write_b32 a236, v251
    v_accvgpr_read_b32 v251, a237
    v_ldexp_f32 v251, v251, v109
    v_accvgpr_write_b32 a237, v251
    v_accvgpr_read_b32 v251, a238
    v_ldexp_f32 v251, v251, v109
    v_accvgpr_write_b32 a238, v251
    v_accvgpr_read_b32 v251, a239
    v_ldexp_f32 v251, v251, v109
    v_accvgpr_write_b32 a239, v251
    v_accvgpr_read_b32 v251, a244
    v_ldexp_f32 v251, v251, v109
    v_accvgpr_write_b32 a244, v251
    v_accvgpr_read_b32 v251, a245
    v_ldexp_f32 v251, v251, v109
    v_accvgpr_write_b32 a245, v251
    v_accvgpr_read_b32 v251, a246
    v_ldexp_f32 v251, v251, v109
    v_accvgpr_write_b32 a246, v251
    v_accvgpr_read_b32 v251, a247
    v_ldexp_f32 v251, v251, v109
    v_accvgpr_write_b32 a247, v251
    v_accvgpr_read_b32 v251, a252
    v_ldexp_f32 v251, v251, v109
    v_accvgpr_write_b32 a252, v251
    v_accvgpr_read_b32 v251, a253
    v_ldexp_f32 v251, v251, v109
    v_accvgpr_write_b32 a253, v251
    v_accvgpr_read_b32 v251, a254
    v_ldexp_f32 v251, v251, v109
    v_accvgpr_write_b32 a254, v251
    v_accvgpr_read_b32 v251, a255
    v_ldexp_f32 v251, v251, v109
    v_accvgpr_write_b32 a255, v251
    v_exp_f32 v0, v0
    v_exp_f32 v1, v1
    v_exp_f32 v2, v2
    v_exp_f32 v3, v3
    v_exp_f32 v4, v4
    v_exp_f32 v5, v5
    v_exp_f32 v6, v6
    v_exp_f32 v7, v7
    v_add_f32 v108, v0, v1
    v_add_f32 v108, v108, v2
    v_add_f32 v108, v108, v3
    v_add_f32 v108, v108, v4
    v_add_f32 v108, v108, v5
    v_add_f32 v108, v108, v6
    v_add_f32 v108, v108, v7
    v_cvt_pk_bf16_f32 v0, v0, v1
    v_cvt_pk_bf16_f32 v1, v2, v3
    v_cvt_pk_bf16_f32 v2, v4, v5
    v_cvt_pk_bf16_f32 v3, v6, v7
    v_exp_f32 v8, v8
    v_exp_f32 v9, v9
    v_exp_f32 v10, v10
    v_exp_f32 v11, v11
    v_exp_f32 v12, v12
    v_exp_f32 v13, v13
    v_exp_f32 v14, v14
    v_exp_f32 v15, v15
    v_add_f32 v109, v8, v9
    v_add_f32 v109, v109, v10
    v_add_f32 v109, v109, v11
    v_add_f32 v109, v109, v12
    v_add_f32 v109, v109, v13
    v_add_f32 v109, v109, v14
    v_add_f32 v109, v109, v15
    v_cvt_pk_bf16_f32 v8, v8, v9
    v_cvt_pk_bf16_f32 v9, v10, v11
    v_cvt_pk_bf16_f32 v10, v12, v13
    v_cvt_pk_bf16_f32 v11, v14, v15
    s_nop 7
    s_setpc_b64 s[78:79]
L_sub_01:
    s_nop 15
    s_lshl_b32 s85, s80, 15
    s_lshl_b32 s86, s60, 14
    s_add_u32 s85, s85, s86
    s_add_u32 s85, s85, 128
    v_and_b32 v251, 15, v250
    v_lshlrev_b32 v251, 10, v251
    v_lshrrev_b32 v110, 4, v250
    v_lshl_add_u32 v251, v110, 4, v251
    v_mov_b32 v110, v64
    s_waitcnt vmcnt(0) lgkmcnt(0)
    buffer_load_dwordx4 v[64:67], v251, s[12:15], s85 offen offset:0
    s_waitcnt vmcnt(0)
    v_mfma_f32_16x16x32_bf16 v[16:19], v[64:67], a[8:11], v[72:75]
    v_mfma_f32_16x16x32_bf16 v[24:27], v[64:67], a[12:15], v[76:79]
    s_nop 7
    buffer_load_dwordx4 v[64:67], v251, s[12:15], s85 offen offset:512
    s_waitcnt vmcnt(0)
    v_mfma_f32_16x16x32_bf16 v[20:23], v[64:67], a[8:11], v[72:75]
    v_mfma_f32_16x16x32_bf16 v[28:31], v[64:67], a[12:15], v[76:79]
    s_nop 7
    buffer_load_dwordx4 v[64:67], v251, s[12:15], s85 offen offset:64
    s_waitcnt vmcnt(0)
    v_mfma_f32_16x16x32_bf16 v[16:19], v[64:67], a[24:27], v[16:19]
    v_mfma_f32_16x16x32_bf16 v[24:27], v[64:67], a[28:31], v[24:27]
    s_nop 7
    buffer_load_dwordx4 v[64:67], v251, s[12:15], s85 offen offset:576
    s_waitcnt vmcnt(0)
    v_mfma_f32_16x16x32_bf16 v[20:23], v[64:67], a[24:27], v[20:23]
    v_mfma_f32_16x16x32_bf16 v[28:31], v[64:67], a[28:31], v[28:31]
    s_nop 7
    buffer_load_dwordx4 v[64:67], v251, s[12:15], s85 offen offset:128
    s_waitcnt vmcnt(0)
    v_mfma_f32_16x16x32_bf16 v[16:19], v[64:67], a[40:43], v[16:19]
    v_mfma_f32_16x16x32_bf16 v[24:27], v[64:67], a[44:47], v[24:27]
    s_nop 7
    buffer_load_dwordx4 v[64:67], v251, s[12:15], s85 offen offset:640
    s_waitcnt vmcnt(0)
    v_mfma_f32_16x16x32_bf16 v[20:23], v[64:67], a[40:43], v[20:23]
    v_mfma_f32_16x16x32_bf16 v[28:31], v[64:67], a[44:47], v[28:31]
    s_nop 7
    buffer_load_dwordx4 v[64:67], v251, s[12:15], s85 offen offset:192
    s_waitcnt vmcnt(0)
    v_mfma_f32_16x16x32_bf16 v[16:19], v[64:67], a[56:59], v[16:19]
    v_mfma_f32_16x16x32_bf16 v[24:27], v[64:67], a[60:63], v[24:27]
    s_nop 7
    buffer_load_dwordx4 v[64:67], v251, s[12:15], s85 offen offset:704
    s_waitcnt vmcnt(0)
    v_mfma_f32_16x16x32_bf16 v[20:23], v[64:67], a[56:59], v[20:23]
    v_mfma_f32_16x16x32_bf16 v[28:31], v[64:67], a[60:63], v[28:31]
    s_nop 7
    buffer_load_dwordx4 v[64:67], v251, s[12:15], s85 offen offset:256
    s_waitcnt vmcnt(0)
    v_mfma_f32_16x16x32_bf16 v[16:19], v[64:67], a[72:75], v[16:19]
    v_mfma_f32_16x16x32_bf16 v[24:27], v[64:67], a[76:79], v[24:27]
    s_nop 7
    buffer_load_dwordx4 v[64:67], v251, s[12:15], s85 offen offset:768
    s_waitcnt vmcnt(0)
    v_mfma_f32_16x16x32_bf16 v[20:23], v[64:67], a[72:75], v[20:23]
    v_mfma_f32_16x16x32_bf16 v[28:31], v[64:67], a[76:79], v[28:31]
    s_nop 7
    buffer_load_dwordx4 v[64:67], v251, s[12:15], s85 offen offset:320
    s_waitcnt vmcnt(0)
    v_mfma_f32_16x16x32_bf16 v[16:19], v[64:67], a[88:91], v[16:19]
    v_mfma_f32_16x16x32_bf16 v[24:27], v[64:67], a[92:95], v[24:27]
    s_nop 7
    buffer_load_dwordx4 v[64:67], v251, s[12:15], s85 offen offset:832
    s_waitcnt vmcnt(0)
    v_mfma_f32_16x16x32_bf16 v[20:23], v[64:67], a[88:91], v[20:23]
    v_mfma_f32_16x16x32_bf16 v[28:31], v[64:67], a[92:95], v[28:31]
    s_nop 7
    buffer_load_dwordx4 v[64:67], v251, s[12:15], s85 offen offset:384
    s_waitcnt vmcnt(0)
    v_mfma_f32_16x16x32_bf16 v[16:19], v[64:67], a[104:107], v[16:19]
    v_mfma_f32_16x16x32_bf16 v[24:27], v[64:67], a[108:111], v[24:27]
    s_nop 7
    buffer_load_dwordx4 v[64:67], v251, s[12:15], s85 offen offset:896
    s_waitcnt vmcnt(0)
    v_mfma_f32_16x16x32_bf16 v[20:23], v[64:67], a[104:107], v[20:23]
    v_mfma_f32_16x16x32_bf16 v[28:31], v[64:67], a[108:111], v[28:31]
    s_nop 7
    buffer_load_dwordx4 v[64:67], v251, s[12:15], s85 offen offset:448
    s_waitcnt vmcnt(0)
    v_mfma_f32_16x16x32_bf16 v[16:19], v[64:67], a[120:123], v[16:19]
    v_mfma_f32_16x16x32_bf16 v[24:27], v[64:67], a[124:127], v[24:27]
    s_nop 7
    buffer_load_dwordx4 v[64:67], v251, s[12:15], s85 offen offset:960
    s_waitcnt vmcnt(0)
    v_mfma_f32_16x16x32_bf16 v[20:23], v[64:67], a[120:123], v[20:23]
    v_mfma_f32_16x16x32_bf16 v[28:31], v[64:67], a[124:127], v[28:31]
    s_nop 7
    s_nop 15
    v_mov_b32 v64, v110
    v_mov_b32 v65, v110
    v_mov_b32 v66, v110
    v_mov_b32 v67, v110
    v_max3_f32 v110, v16, v17, v18
    v_max3_f32 v110, v110, v19, v20
    v_max3_f32 v110, v110, v21, v22
    v_max_f32 v110, v110, v23
    v_mov_b32 v251, v110
    s_nop 1
    v_permlane32_swap_b32 v110, v251
    v_max_f32 v110, v110, v251
    v_mov_b32 v251, v110
    s_nop 1
    v_permlane16_swap_b32 v110, v251
    v_max_f32 v110, v110, v251
    v_add_f32 v110, 0x42200000, v110
    v_max_f32 v110, 0, v110
    v_ceil_f32 v110, v110
    v_max3_f32 v111, v24, v25, v26
    v_max3_f32 v111, v111, v27, v28
    v_max3_f32 v111, v111, v29, v30
    v_max_f32 v111, v111, v31
    v_mov_b32 v251, v111
    s_nop 1
    v_permlane32_swap_b32 v111, v251
    v_max_f32 v111, v111, v251
    v_mov_b32 v251, v111
    s_nop 1
    v_permlane16_swap_b32 v111, v251
    v_max_f32 v111, v111, v251
    v_add_f32 v111, 0x42200000, v111
    v_max_f32 v111, 0, v111
    v_ceil_f32 v111, v111
    v_sub_f32 v72, v72, v110
    v_sub_f32 v73, v73, v110
    v_sub_f32 v74, v74, v110
    v_sub_f32 v75, v75, v110
    v_mul_f32 v251, s81, v110
    v_sub_f32 v16, v16, v110
    v_sub_f32 v48, v48, v251
    v_sub_f32 v17, v17, v110
    v_sub_f32 v49, v49, v251
    v_sub_f32 v18, v18, v110
    v_sub_f32 v50, v50, v251
    v_sub_f32 v19, v19, v110
    v_sub_f32 v51, v51, v251
    v_sub_f32 v20, v20, v110
    v_sub_f32 v52, v52, v251
    v_sub_f32 v21, v21, v110
    v_sub_f32 v53, v53, v251
    v_sub_f32 v22, v22, v110
    v_sub_f32 v54, v54, v251
    v_sub_f32 v23, v23, v110
    v_sub_f32 v55, v55, v251
    v_sub_f32 v110, 0, v110
    v_cvt_i32_f32 v110, v110
    v_ldexp_f32 v106, v106, v110
    v_ldexp_f32 v112, v112, v110
    v_ldexp_f32 v113, v113, v110
    v_ldexp_f32 v114, v114, v110
    v_ldexp_f32 v115, v115, v110
    v_ldexp_f32 v120, v120, v110
    v_ldexp_f32 v121, v121, v110
    v_ldexp_f32 v122, v122, v110
    v_ldexp_f32 v123, v123, v110
    v_ldexp_f32 v128, v128, v110
    v_ldexp_f32 v129, v129, v110
    v_ldexp_f32 v130, v130, v110
    v_ldexp_f32 v131, v131, v110
    v_ldexp_f32 v136, v136, v110
    v_ldexp_f32 v137, v137, v110
    v_ldexp_f32 v138, v138, v110
    v_ldexp_f32 v139, v139, v110
    v_ldexp_f32 v144, v144, v110
    v_ldexp_f32 v145, v145, v110
    v_ldexp_f32 v146, v146, v110
    v_ldexp_f32 v147, v147, v110
    v_ldexp_f32 v152, v152, v110
    v_ldexp_f32 v153, v153, v110
    v_ldexp_f32 v154, v154, v110
    v_ldexp_f32 v155, v155, v110
    v_ldexp_f32 v160, v160, v110
    v_ldexp_f32 v161, v161, v110
    v_ldexp_f32 v162, v162, v110
    v_ldexp_f32 v163, v163, v110
    v_ldexp_f32 v168, v168, v110
    v_ldexp_f32 v169, v169, v110
    v_ldexp_f32 v170, v170, v110
    v_ldexp_f32 v171, v171, v110
    v_ldexp_f32 v176, v176, v110
    v_ldexp_f32 v177, v177, v110
    v_ldexp_f32 v178, v178, v110
    v_ldexp_f32 v179, v179, v110
    v_ldexp_f32 v184, v184, v110
    v_ldexp_f32 v185, v185, v110
    v_ldexp_f32 v186, v186, v110
    v_ldexp_f32 v187, v187, v110
    v_ldexp_f32 v192, v192, v110
    v_ldexp_f32 v193, v193, v110
    v_ldexp_f32 v194, v194, v110
    v_ldexp_f32 v195, v195, v110
    v_ldexp_f32 v200, v200, v110
    v_ldexp_f32 v201, v201, v110
    v_ldexp_f32 v202, v202, v110
    v_ldexp_f32 v203, v203, v110
    v_ldexp_f32 v208, v208, v110
    v_ldexp_f32 v209, v209, v110
    v_ldexp_f32 v210, v210, v110
    v_ldexp_f32 v211, v211, v110
    v_ldexp_f32 v216, v216, v110
    v_ldexp_f32 v217, v217, v110
    v_ldexp_f32 v218, v218, v110
    v_ldexp_f32 v219, v219, v110
    v_ldexp_f32 v224, v224, v110
    v_ldexp_f32 v225, v225, v110
    v_ldexp_f32 v226, v226, v110
    v_ldexp_f32 v227, v227, v110
    v_ldexp_f32 v232, v232, v110
    v_ldexp_f32 v233, v233, v110
    v_ldexp_f32 v234, v234, v110
    v_ldexp_f32 v235, v235, v110
    v_sub_f32 v76, v76, v111
    v_sub_f32 v77, v77, v111
    v_sub_f32 v78, v78, v111
    v_sub_f32 v79, v79, v111
    v_mul_f32 v251, s81, v111
    v_sub_f32 v24, v24, v111
    v_sub_f32 v56, v56, v251
    v_sub_f32 v25, v25, v111
    v_sub_f32 v57, v57, v251
    v_sub_f32 v26, v26, v111
    v_sub_f32 v58, v58, v251
    v_sub_f32 v27, v27, v111
    v_sub_f32 v59, v59, v251
    v_sub_f32 v28, v28, v111
    v_sub_f32 v60, v60, v251
    v_sub_f32 v29, v29, v111
    v_sub_f32 v61, v61, v251
    v_sub_f32 v30, v30, v111
    v_sub_f32 v62, v62, v251
    v_sub_f32 v31, v31, v111
    v_sub_f32 v63, v63, v251
    v_sub_f32 v111, 0, v111
    v_cvt_i32_f32 v111, v111
    v_ldexp_f32 v107, v107, v111
    v_ldexp_f32 v116, v116, v111
    v_ldexp_f32 v117, v117, v111
    v_ldexp_f32 v118, v118, v111
    v_ldexp_f32 v119, v119, v111
    v_ldexp_f32 v124, v124, v111
    v_ldexp_f32 v125, v125, v111
    v_ldexp_f32 v126, v126, v111
    v_ldexp_f32 v127, v127, v111
    v_ldexp_f32 v132, v132, v111
    v_ldexp_f32 v133, v133, v111
    v_ldexp_f32 v134, v134, v111
    v_ldexp_f32 v135, v135, v111
    v_ldexp_f32 v140, v140, v111
    v_ldexp_f32 v141, v141, v111
    v_ldexp_f32 v142, v142, v111
    v_ldexp_f32 v143, v143, v111
    v_ldexp_f32 v148, v148, v111
    v_ldexp_f32 v149, v149, v111
    v_ldexp_f32 v150, v150, v111
    v_ldexp_f32 v151, v151, v111
    v_ldexp_f32 v156, v156, v111
    v_ldexp_f32 v157, v157, v111
    v_ldexp_f32 v158, v158, v111
    v_ldexp_f32 v159, v159, v111
    v_ldexp_f32 v164, v164, v111
    v_ldexp_f32 v165, v165, v111
    v_ldexp_f32 v166, v166, v111
    v_ldexp_f32 v167, v167, v111
    v_ldexp_f32 v172, v172, v111
    v_ldexp_f32 v173, v173, v111
    v_ldexp_f32 v174, v174, v111
    v_ldexp_f32 v175, v175, v111
    v_ldexp_f32 v180, v180, v111
    v_ldexp_f32 v181, v181, v111
    v_ldexp_f32 v182, v182, v111
    v_ldexp_f32 v183, v183, v111
    v_ldexp_f32 v188, v188, v111
    v_ldexp_f32 v189, v189, v111
    v_ldexp_f32 v190, v190, v111
    v_ldexp_f32 v191, v191, v111
    v_ldexp_f32 v196, v196, v111
    v_ldexp_f32 v197, v197, v111
    v_ldexp_f32 v198, v198, v111
    v_ldexp_f32 v199, v199, v111
    v_ldexp_f32 v204, v204, v111
    v_ldexp_f32 v205, v205, v111
    v_ldexp_f32 v206, v206, v111
    v_ldexp_f32 v207, v207, v111
    v_ldexp_f32 v212, v212, v111
    v_ldexp_f32 v213, v213, v111
    v_ldexp_f32 v214, v214, v111
    v_ldexp_f32 v215, v215, v111
    v_ldexp_f32 v220, v220, v111
    v_ldexp_f32 v221, v221, v111
    v_ldexp_f32 v222, v222, v111
    v_ldexp_f32 v223, v223, v111
    v_ldexp_f32 v228, v228, v111
    v_ldexp_f32 v229, v229, v111
    v_ldexp_f32 v230, v230, v111
    v_ldexp_f32 v231, v231, v111
    v_ldexp_f32 v236, v236, v111
    v_ldexp_f32 v237, v237, v111
    v_ldexp_f32 v238, v238, v111
    v_ldexp_f32 v239, v239, v111
    v_exp_f32 v16, v16
    v_exp_f32 v17, v17
    v_exp_f32 v18, v18
    v_exp_f32 v19, v19
    v_exp_f32 v20, v20
    v_exp_f32 v21, v21
    v_exp_f32 v22, v22
    v_exp_f32 v23, v23
    v_add_f32 v110, v16, v17
    v_add_f32 v110, v110, v18
    v_add_f32 v110, v110, v19
    v_add_f32 v110, v110, v20
    v_add_f32 v110, v110, v21
    v_add_f32 v110, v110, v22
    v_add_f32 v110, v110, v23
    v_cvt_pk_bf16_f32 v16, v16, v17
    v_cvt_pk_bf16_f32 v17, v18, v19
    v_cvt_pk_bf16_f32 v18, v20, v21
    v_cvt_pk_bf16_f32 v19, v22, v23
    v_exp_f32 v24, v24
    v_exp_f32 v25, v25
    v_exp_f32 v26, v26
    v_exp_f32 v27, v27
    v_exp_f32 v28, v28
    v_exp_f32 v29, v29
    v_exp_f32 v30, v30
    v_exp_f32 v31, v31
    v_add_f32 v111, v24, v25
    v_add_f32 v111, v111, v26
    v_add_f32 v111, v111, v27
    v_add_f32 v111, v111, v28
    v_add_f32 v111, v111, v29
    v_add_f32 v111, v111, v30
    v_add_f32 v111, v111, v31
    v_cvt_pk_bf16_f32 v24, v24, v25
    v_cvt_pk_bf16_f32 v25, v26, v27
    v_cvt_pk_bf16_f32 v26, v28, v29
    v_cvt_pk_bf16_f32 v27, v30, v31
    s_nop 7
    s_setpc_b64 s[78:79]
L_sub_10:
    s_nop 15
    s_lshl_b32 s85, s80, 15
    s_lshl_b32 s86, s60, 14
    s_add_u32 s85, s85, s86
    s_add_u32 s85, s85, 128
    v_and_b32 v251, 15, v250
    v_lshlrev_b32 v251, 10, v251
    v_lshrrev_b32 v108, 4, v250
    v_lshl_add_u32 v251, v108, 4, v251
    v_mov_b32 v108, v72
    s_waitcnt vmcnt(0) lgkmcnt(0)
    buffer_load_dwordx4 v[72:75], v251, s[12:15], s85 offen offset:0
    s_waitcnt vmcnt(0)
    v_mfma_f32_16x16x32_bf16 v[32:35], v[72:75], a[0:3], v[64:67]
    v_mfma_f32_16x16x32_bf16 v[40:43], v[72:75], a[4:7], v[68:71]
    s_nop 7
    buffer_load_dwordx4 v[72:75], v251, s[12:15], s85 offen offset:512
    s_waitcnt vmcnt(0)
    v_mfma_f32_16x16x32_bf16 v[36:39], v[72:75], a[0:3], v[64:67]
    v_mfma_f32_16x16x32_bf16 v[44:47], v[72:75], a[4:7], v[68:71]
    s_nop 7
    buffer_load_dwordx4 v[72:75], v251, s[12:15], s85 offen offset:64
    s_waitcnt vmcnt(0)
    v_mfma_f32_16x16x32_bf16 v[32:35], v[72:75], a[16:19], v[32:35]
    v_mfma_f32_16x16x32_bf16 v[40:43], v[72:75], a[20:23], v[40:43]
    s_nop 7
    buffer_load_dwordx4 v[72:75], v251, s[12:15], s85 offen offset:576
    s_waitcnt vmcnt(0)
    v_mfma_f32_16x16x32_bf16 v[36:39], v[72:75], a[16:19], v[36:39]
    v_mfma_f32_16x16x32_bf16 v[44:47], v[72:75], a[20:23], v[44:47]
    s_nop 7
    buffer_load_dwordx4 v[72:75], v251, s[12:15], s85 offen offset:128
    s_waitcnt vmcnt(0)
    v_mfma_f32_16x16x32_bf16 v[32:35], v[72:75], a[32:35], v[32:35]
    v_mfma_f32_16x16x32_bf16 v[40:43], v[72:75], a[36:39], v[40:43]
    s_nop 7
    buffer_load_dwordx4 v[72:75], v251, s[12:15], s85 offen offset:640
    s_waitcnt vmcnt(0)
    v_mfma_f32_16x16x32_bf16 v[36:39], v[72:75], a[32:35], v[36:39]
    v_mfma_f32_16x16x32_bf16 v[44:47], v[72:75], a[36:39], v[44:47]
    s_nop 7
    buffer_load_dwordx4 v[72:75], v251, s[12:15], s85 offen offset:192
    s_waitcnt vmcnt(0)
    v_mfma_f32_16x16x32_bf16 v[32:35], v[72:75], a[48:51], v[32:35]
    v_mfma_f32_16x16x32_bf16 v[40:43], v[72:75], a[52:55], v[40:43]
    s_nop 7
    buffer_load_dwordx4 v[72:75], v251, s[12:15], s85 offen offset:704
    s_waitcnt vmcnt(0)
    v_mfma_f32_16x16x32_bf16 v[36:39], v[72:75], a[48:51], v[36:39]
    v_mfma_f32_16x16x32_bf16 v[44:47], v[72:75], a[52:55], v[44:47]
    s_nop 7
    buffer_load_dwordx4 v[72:75], v251, s[12:15], s85 offen offset:256
    s_waitcnt vmcnt(0)
    v_mfma_f32_16x16x32_bf16 v[32:35], v[72:75], a[64:67], v[32:35]
    v_mfma_f32_16x16x32_bf16 v[40:43], v[72:75], a[68:71], v[40:43]
    s_nop 7
    buffer_load_dwordx4 v[72:75], v251, s[12:15], s85 offen offset:768
    s_waitcnt vmcnt(0)
    v_mfma_f32_16x16x32_bf16 v[36:39], v[72:75], a[64:67], v[36:39]
    v_mfma_f32_16x16x32_bf16 v[44:47], v[72:75], a[68:71], v[44:47]
    s_nop 7
    buffer_load_dwordx4 v[72:75], v251, s[12:15], s85 offen offset:320
    s_waitcnt vmcnt(0)
    v_mfma_f32_16x16x32_bf16 v[32:35], v[72:75], a[80:83], v[32:35]
    v_mfma_f32_16x16x32_bf16 v[40:43], v[72:75], a[84:87], v[40:43]
    s_nop 7
    buffer_load_dwordx4 v[72:75], v251, s[12:15], s85 offen offset:832
    s_waitcnt vmcnt(0)
    v_mfma_f32_16x16x32_bf16 v[36:39], v[72:75], a[80:83], v[36:39]
    v_mfma_f32_16x16x32_bf16 v[44:47], v[72:75], a[84:87], v[44:47]
    s_nop 7
    buffer_load_dwordx4 v[72:75], v251, s[12:15], s85 offen offset:384
    s_waitcnt vmcnt(0)
    v_mfma_f32_16x16x32_bf16 v[32:35], v[72:75], a[96:99], v[32:35]
    v_mfma_f32_16x16x32_bf16 v[40:43], v[72:75], a[100:103], v[40:43]
    s_nop 7
    buffer_load_dwordx4 v[72:75], v251, s[12:15], s85 offen offset:896
    s_waitcnt vmcnt(0)
    v_mfma_f32_16x16x32_bf16 v[36:39], v[72:75], a[96:99], v[36:39]
    v_mfma_f32_16x16x32_bf16 v[44:47], v[72:75], a[100:103], v[44:47]
    s_nop 7
    buffer_load_dwordx4 v[72:75], v251, s[12:15], s85 offen offset:448
    s_waitcnt vmcnt(0)
    v_mfma_f32_16x16x32_bf16 v[32:35], v[72:75], a[112:115], v[32:35]
    v_mfma_f32_16x16x32_bf16 v[40:43], v[72:75], a[116:119], v[40:43]
    s_nop 7
    buffer_load_dwordx4 v[72:75], v251, s[12:15], s85 offen offset:960
    s_waitcnt vmcnt(0)
    v_mfma_f32_16x16x32_bf16 v[36:39], v[72:75], a[112:115], v[36:39]
    v_mfma_f32_16x16x32_bf16 v[44:47], v[72:75], a[116:119], v[44:47]
    s_nop 7
    s_nop 15
    v_mov_b32 v72, v108
    v_mov_b32 v73, v108
    v_mov_b32 v74, v108
    v_mov_b32 v75, v108
    v_max3_f32 v108, v32, v33, v34
    v_max3_f32 v108, v108, v35, v36
    v_max3_f32 v108, v108, v37, v38
    v_max_f32 v108, v108, v39
    v_mov_b32 v251, v108
    s_nop 1
    v_permlane32_swap_b32 v108, v251
    v_max_f32 v108, v108, v251
    v_mov_b32 v251, v108
    s_nop 1
    v_permlane16_swap_b32 v108, v251
    v_max_f32 v108, v108, v251
    v_add_f32 v108, 0x42200000, v108
    v_max_f32 v108, 0, v108
    v_ceil_f32 v108, v108
    v_max3_f32 v109, v40, v41, v42
    v_max3_f32 v109, v109, v43, v44
    v_max3_f32 v109, v109, v45, v46
    v_max_f32 v109, v109, v47
    v_mov_b32 v251, v109
    s_nop 1
    v_permlane32_swap_b32 v109, v251
    v_max_f32 v109, v109, v251
    v_mov_b32 v251, v109
    s_nop 1
    v_permlane16_swap_b32 v109, v251
    v_max_f32 v109, v109, v251
    v_add_f32 v109, 0x42200000, v109
    v_max_f32 v109, 0, v109
    v_ceil_f32 v109, v109
    v_sub_f32 v64, v64, v108
    v_sub_f32 v65, v65, v108
    v_sub_f32 v66, v66, v108
    v_sub_f32 v67, v67, v108
    v_mul_f32 v251, s81, v108
    v_sub_f32 v32, v32, v108
    v_sub_f32 v0, v0, v251
    v_sub_f32 v33, v33, v108
    v_sub_f32 v1, v1, v251
    v_sub_f32 v34, v34, v108
    v_sub_f32 v2, v2, v251
    v_sub_f32 v35, v35, v108
    v_sub_f32 v3, v3, v251
    v_sub_f32 v36, v36, v108
    v_sub_f32 v4, v4, v251
    v_sub_f32 v37, v37, v108
    v_sub_f32 v5, v5, v251
    v_sub_f32 v38, v38, v108
    v_sub_f32 v6, v6, v251
    v_sub_f32 v39, v39, v108
    v_sub_f32 v7, v7, v251
    v_sub_f32 v108, 0, v108
    v_cvt_i32_f32 v108, v108
    v_ldexp_f32 v104, v104, v108
    v_accvgpr_read_b32 v251, a128
    v_ldexp_f32 v251, v251, v108
    v_accvgpr_write_b32 a128, v251
    v_accvgpr_read_b32 v251, a129
    v_ldexp_f32 v251, v251, v108
    v_accvgpr_write_b32 a129, v251
    v_accvgpr_read_b32 v251, a130
    v_ldexp_f32 v251, v251, v108
    v_accvgpr_write_b32 a130, v251
    v_accvgpr_read_b32 v251, a131
    v_ldexp_f32 v251, v251, v108
    v_accvgpr_write_b32 a131, v251
    v_accvgpr_read_b32 v251, a136
    v_ldexp_f32 v251, v251, v108
    v_accvgpr_write_b32 a136, v251
    v_accvgpr_read_b32 v251, a137
    v_ldexp_f32 v251, v251, v108
    v_accvgpr_write_b32 a137, v251
    v_accvgpr_read_b32 v251, a138
    v_ldexp_f32 v251, v251, v108
    v_accvgpr_write_b32 a138, v251
    v_accvgpr_read_b32 v251, a139
    v_ldexp_f32 v251, v251, v108
    v_accvgpr_write_b32 a139, v251
    v_accvgpr_read_b32 v251, a144
    v_ldexp_f32 v251, v251, v108
    v_accvgpr_write_b32 a144, v251
    v_accvgpr_read_b32 v251, a145
    v_ldexp_f32 v251, v251, v108
    v_accvgpr_write_b32 a145, v251
    v_accvgpr_read_b32 v251, a146
    v_ldexp_f32 v251, v251, v108
    v_accvgpr_write_b32 a146, v251
    v_accvgpr_read_b32 v251, a147
    v_ldexp_f32 v251, v251, v108
    v_accvgpr_write_b32 a147, v251
    v_accvgpr_read_b32 v251, a152
    v_ldexp_f32 v251, v251, v108
    v_accvgpr_write_b32 a152, v251
    v_accvgpr_read_b32 v251, a153
    v_ldexp_f32 v251, v251, v108
    v_accvgpr_write_b32 a153, v251
    v_accvgpr_read_b32 v251, a154
    v_ldexp_f32 v251, v251, v108
    v_accvgpr_write_b32 a154, v251
    v_accvgpr_read_b32 v251, a155
    v_ldexp_f32 v251, v251, v108
    v_accvgpr_write_b32 a155, v251
    v_accvgpr_read_b32 v251, a160
    v_ldexp_f32 v251, v251, v108
    v_accvgpr_write_b32 a160, v251
    v_accvgpr_read_b32 v251, a161
    v_ldexp_f32 v251, v251, v108
    v_accvgpr_write_b32 a161, v251
    v_accvgpr_read_b32 v251, a162
    v_ldexp_f32 v251, v251, v108
    v_accvgpr_write_b32 a162, v251
    v_accvgpr_read_b32 v251, a163
    v_ldexp_f32 v251, v251, v108
    v_accvgpr_write_b32 a163, v251
    v_accvgpr_read_b32 v251, a168
    v_ldexp_f32 v251, v251, v108
    v_accvgpr_write_b32 a168, v251
    v_accvgpr_read_b32 v251, a169
    v_ldexp_f32 v251, v251, v108
    v_accvgpr_write_b32 a169, v251
    v_accvgpr_read_b32 v251, a170
    v_ldexp_f32 v251, v251, v108
    v_accvgpr_write_b32 a170, v251
    v_accvgpr_read_b32 v251, a171
    v_ldexp_f32 v251, v251, v108
    v_accvgpr_write_b32 a171, v251
    v_accvgpr_read_b32 v251, a176
    v_ldexp_f32 v251, v251, v108
    v_accvgpr_write_b32 a176, v251
    v_accvgpr_read_b32 v251, a177
    v_ldexp_f32 v251, v251, v108
    v_accvgpr_write_b32 a177, v251
    v_accvgpr_read_b32 v251, a178
    v_ldexp_f32 v251, v251, v108
    v_accvgpr_write_b32 a178, v251
    v_accvgpr_read_b32 v251, a179
    v_ldexp_f32 v251, v251, v108
    v_accvgpr_write_b32 a179, v251
    v_accvgpr_read_b32 v251, a184
    v_ldexp_f32 v251, v251, v108
    v_accvgpr_write_b32 a184, v251
    v_accvgpr_read_b32 v251, a185
    v_ldexp_f32 v251, v251, v108
    v_accvgpr_write_b32 a185, v251
    v_accvgpr_read_b32 v251, a186
    v_ldexp_f32 v251, v251, v108
    v_accvgpr_write_b32 a186, v251
    v_accvgpr_read_b32 v251, a187
    v_ldexp_f32 v251, v251, v108
    v_accvgpr_write_b32 a187, v251
    v_accvgpr_read_b32 v251, a192
    v_ldexp_f32 v251, v251, v108
    v_accvgpr_write_b32 a192, v251
    v_accvgpr_read_b32 v251, a193
    v_ldexp_f32 v251, v251, v108
    v_accvgpr_write_b32 a193, v251
    v_accvgpr_read_b32 v251, a194
    v_ldexp_f32 v251, v251, v108
    v_accvgpr_write_b32 a194, v251
    v_accvgpr_read_b32 v251, a195
    v_ldexp_f32 v251, v251, v108
    v_accvgpr_write_b32 a195, v251
    v_accvgpr_read_b32 v251, a200
    v_ldexp_f32 v251, v251, v108
    v_accvgpr_write_b32 a200, v251
    v_accvgpr_read_b32 v251, a201
    v_ldexp_f32 v251, v251, v108
    v_accvgpr_write_b32 a201, v251
    v_accvgpr_read_b32 v251, a202
    v_ldexp_f32 v251, v251, v108
    v_accvgpr_write_b32 a202, v251
    v_accvgpr_read_b32 v251, a203
    v_ldexp_f32 v251, v251, v108
    v_accvgpr_write_b32 a203, v251
    v_accvgpr_read_b32 v251, a208
    v_ldexp_f32 v251, v251, v108
    v_accvgpr_write_b32 a208, v251
    v_accvgpr_read_b32 v251, a209
    v_ldexp_f32 v251, v251, v108
    v_accvgpr_write_b32 a209, v251
    v_accvgpr_read_b32 v251, a210
    v_ldexp_f32 v251, v251, v108
    v_accvgpr_write_b32 a210, v251
    v_accvgpr_read_b32 v251, a211
    v_ldexp_f32 v251, v251, v108
    v_accvgpr_write_b32 a211, v251
    v_accvgpr_read_b32 v251, a216
    v_ldexp_f32 v251, v251, v108
    v_accvgpr_write_b32 a216, v251
    v_accvgpr_read_b32 v251, a217
    v_ldexp_f32 v251, v251, v108
    v_accvgpr_write_b32 a217, v251
    v_accvgpr_read_b32 v251, a218
    v_ldexp_f32 v251, v251, v108
    v_accvgpr_write_b32 a218, v251
    v_accvgpr_read_b32 v251, a219
    v_ldexp_f32 v251, v251, v108
    v_accvgpr_write_b32 a219, v251
    v_accvgpr_read_b32 v251, a224
    v_ldexp_f32 v251, v251, v108
    v_accvgpr_write_b32 a224, v251
    v_accvgpr_read_b32 v251, a225
    v_ldexp_f32 v251, v251, v108
    v_accvgpr_write_b32 a225, v251
    v_accvgpr_read_b32 v251, a226
    v_ldexp_f32 v251, v251, v108
    v_accvgpr_write_b32 a226, v251
    v_accvgpr_read_b32 v251, a227
    v_ldexp_f32 v251, v251, v108
    v_accvgpr_write_b32 a227, v251
    v_accvgpr_read_b32 v251, a232
    v_ldexp_f32 v251, v251, v108
    v_accvgpr_write_b32 a232, v251
    v_accvgpr_read_b32 v251, a233
    v_ldexp_f32 v251, v251, v108
    v_accvgpr_write_b32 a233, v251
    v_accvgpr_read_b32 v251, a234
    v_ldexp_f32 v251, v251, v108
    v_accvgpr_write_b32 a234, v251
    v_accvgpr_read_b32 v251, a235
    v_ldexp_f32 v251, v251, v108
    v_accvgpr_write_b32 a235, v251
    v_accvgpr_read_b32 v251, a240
    v_ldexp_f32 v251, v251, v108
    v_accvgpr_write_b32 a240, v251
    v_accvgpr_read_b32 v251, a241
    v_ldexp_f32 v251, v251, v108
    v_accvgpr_write_b32 a241, v251
    v_accvgpr_read_b32 v251, a242
    v_ldexp_f32 v251, v251, v108
    v_accvgpr_write_b32 a242, v251
    v_accvgpr_read_b32 v251, a243
    v_ldexp_f32 v251, v251, v108
    v_accvgpr_write_b32 a243, v251
    v_accvgpr_read_b32 v251, a248
    v_ldexp_f32 v251, v251, v108
    v_accvgpr_write_b32 a248, v251
    v_accvgpr_read_b32 v251, a249
    v_ldexp_f32 v251, v251, v108
    v_accvgpr_write_b32 a249, v251
    v_accvgpr_read_b32 v251, a250
    v_ldexp_f32 v251, v251, v108
    v_accvgpr_write_b32 a250, v251
    v_accvgpr_read_b32 v251, a251
    v_ldexp_f32 v251, v251, v108
    v_accvgpr_write_b32 a251, v251
    v_sub_f32 v68, v68, v109
    v_sub_f32 v69, v69, v109
    v_sub_f32 v70, v70, v109
    v_sub_f32 v71, v71, v109
    v_mul_f32 v251, s81, v109
    v_sub_f32 v40, v40, v109
    v_sub_f32 v8, v8, v251
    v_sub_f32 v41, v41, v109
    v_sub_f32 v9, v9, v251
    v_sub_f32 v42, v42, v109
    v_sub_f32 v10, v10, v251
    v_sub_f32 v43, v43, v109
    v_sub_f32 v11, v11, v251
    v_sub_f32 v44, v44, v109
    v_sub_f32 v12, v12, v251
    v_sub_f32 v45, v45, v109
    v_sub_f32 v13, v13, v251
    v_sub_f32 v46, v46, v109
    v_sub_f32 v14, v14, v251
    v_sub_f32 v47, v47, v109
    v_sub_f32 v15, v15, v251
    v_sub_f32 v109, 0, v109
    v_cvt_i32_f32 v109, v109
    v_ldexp_f32 v105, v105, v109
    v_accvgpr_read_b32 v251, a132
    v_ldexp_f32 v251, v251, v109
    v_accvgpr_write_b32 a132, v251
    v_accvgpr_read_b32 v251, a133
    v_ldexp_f32 v251, v251, v109
    v_accvgpr_write_b32 a133, v251
    v_accvgpr_read_b32 v251, a134
    v_ldexp_f32 v251, v251, v109
    v_accvgpr_write_b32 a134, v251
    v_accvgpr_read_b32 v251, a135
    v_ldexp_f32 v251, v251, v109
    v_accvgpr_write_b32 a135, v251
    v_accvgpr_read_b32 v251, a140
    v_ldexp_f32 v251, v251, v109
    v_accvgpr_write_b32 a140, v251
    v_accvgpr_read_b32 v251, a141
    v_ldexp_f32 v251, v251, v109
    v_accvgpr_write_b32 a141, v251
    v_accvgpr_read_b32 v251, a142
    v_ldexp_f32 v251, v251, v109
    v_accvgpr_write_b32 a142, v251
    v_accvgpr_read_b32 v251, a143
    v_ldexp_f32 v251, v251, v109
    v_accvgpr_write_b32 a143, v251
    v_accvgpr_read_b32 v251, a148
    v_ldexp_f32 v251, v251, v109
    v_accvgpr_write_b32 a148, v251
    v_accvgpr_read_b32 v251, a149
    v_ldexp_f32 v251, v251, v109
    v_accvgpr_write_b32 a149, v251
    v_accvgpr_read_b32 v251, a150
    v_ldexp_f32 v251, v251, v109
    v_accvgpr_write_b32 a150, v251
    v_accvgpr_read_b32 v251, a151
    v_ldexp_f32 v251, v251, v109
    v_accvgpr_write_b32 a151, v251
    v_accvgpr_read_b32 v251, a156
    v_ldexp_f32 v251, v251, v109
    v_accvgpr_write_b32 a156, v251
    v_accvgpr_read_b32 v251, a157
    v_ldexp_f32 v251, v251, v109
    v_accvgpr_write_b32 a157, v251
    v_accvgpr_read_b32 v251, a158
    v_ldexp_f32 v251, v251, v109
    v_accvgpr_write_b32 a158, v251
    v_accvgpr_read_b32 v251, a159
    v_ldexp_f32 v251, v251, v109
    v_accvgpr_write_b32 a159, v251
    v_accvgpr_read_b32 v251, a164
    v_ldexp_f32 v251, v251, v109
    v_accvgpr_write_b32 a164, v251
    v_accvgpr_read_b32 v251, a165
    v_ldexp_f32 v251, v251, v109
    v_accvgpr_write_b32 a165, v251
    v_accvgpr_read_b32 v251, a166
    v_ldexp_f32 v251, v251, v109
    v_accvgpr_write_b32 a166, v251
    v_accvgpr_read_b32 v251, a167
    v_ldexp_f32 v251, v251, v109
    v_accvgpr_write_b32 a167, v251
    v_accvgpr_read_b32 v251, a172
    v_ldexp_f32 v251, v251, v109
    v_accvgpr_write_b32 a172, v251
    v_accvgpr_read_b32 v251, a173
    v_ldexp_f32 v251, v251, v109
    v_accvgpr_write_b32 a173, v251
    v_accvgpr_read_b32 v251, a174
    v_ldexp_f32 v251, v251, v109
    v_accvgpr_write_b32 a174, v251
    v_accvgpr_read_b32 v251, a175
    v_ldexp_f32 v251, v251, v109
    v_accvgpr_write_b32 a175, v251
    v_accvgpr_read_b32 v251, a180
    v_ldexp_f32 v251, v251, v109
    v_accvgpr_write_b32 a180, v251
    v_accvgpr_read_b32 v251, a181
    v_ldexp_f32 v251, v251, v109
    v_accvgpr_write_b32 a181, v251
    v_accvgpr_read_b32 v251, a182
    v_ldexp_f32 v251, v251, v109
    v_accvgpr_write_b32 a182, v251
    v_accvgpr_read_b32 v251, a183
    v_ldexp_f32 v251, v251, v109
    v_accvgpr_write_b32 a183, v251
    v_accvgpr_read_b32 v251, a188
    v_ldexp_f32 v251, v251, v109
    v_accvgpr_write_b32 a188, v251
    v_accvgpr_read_b32 v251, a189
    v_ldexp_f32 v251, v251, v109
    v_accvgpr_write_b32 a189, v251
    v_accvgpr_read_b32 v251, a190
    v_ldexp_f32 v251, v251, v109
    v_accvgpr_write_b32 a190, v251
    v_accvgpr_read_b32 v251, a191
    v_ldexp_f32 v251, v251, v109
    v_accvgpr_write_b32 a191, v251
    v_accvgpr_read_b32 v251, a196
    v_ldexp_f32 v251, v251, v109
    v_accvgpr_write_b32 a196, v251
    v_accvgpr_read_b32 v251, a197
    v_ldexp_f32 v251, v251, v109
    v_accvgpr_write_b32 a197, v251
    v_accvgpr_read_b32 v251, a198
    v_ldexp_f32 v251, v251, v109
    v_accvgpr_write_b32 a198, v251
    v_accvgpr_read_b32 v251, a199
    v_ldexp_f32 v251, v251, v109
    v_accvgpr_write_b32 a199, v251
    v_accvgpr_read_b32 v251, a204
    v_ldexp_f32 v251, v251, v109
    v_accvgpr_write_b32 a204, v251
    v_accvgpr_read_b32 v251, a205
    v_ldexp_f32 v251, v251, v109
    v_accvgpr_write_b32 a205, v251
    v_accvgpr_read_b32 v251, a206
    v_ldexp_f32 v251, v251, v109
    v_accvgpr_write_b32 a206, v251
    v_accvgpr_read_b32 v251, a207
    v_ldexp_f32 v251, v251, v109
    v_accvgpr_write_b32 a207, v251
    v_accvgpr_read_b32 v251, a212
    v_ldexp_f32 v251, v251, v109
    v_accvgpr_write_b32 a212, v251
    v_accvgpr_read_b32 v251, a213
    v_ldexp_f32 v251, v251, v109
    v_accvgpr_write_b32 a213, v251
    v_accvgpr_read_b32 v251, a214
    v_ldexp_f32 v251, v251, v109
    v_accvgpr_write_b32 a214, v251
    v_accvgpr_read_b32 v251, a215
    v_ldexp_f32 v251, v251, v109
    v_accvgpr_write_b32 a215, v251
    v_accvgpr_read_b32 v251, a220
    v_ldexp_f32 v251, v251, v109
    v_accvgpr_write_b32 a220, v251
    v_accvgpr_read_b32 v251, a221
    v_ldexp_f32 v251, v251, v109
    v_accvgpr_write_b32 a221, v251
    v_accvgpr_read_b32 v251, a222
    v_ldexp_f32 v251, v251, v109
    v_accvgpr_write_b32 a222, v251
    v_accvgpr_read_b32 v251, a223
    v_ldexp_f32 v251, v251, v109
    v_accvgpr_write_b32 a223, v251
    v_accvgpr_read_b32 v251, a228
    v_ldexp_f32 v251, v251, v109
    v_accvgpr_write_b32 a228, v251
    v_accvgpr_read_b32 v251, a229
    v_ldexp_f32 v251, v251, v109
    v_accvgpr_write_b32 a229, v251
    v_accvgpr_read_b32 v251, a230
    v_ldexp_f32 v251, v251, v109
    v_accvgpr_write_b32 a230, v251
    v_accvgpr_read_b32 v251, a231
    v_ldexp_f32 v251, v251, v109
    v_accvgpr_write_b32 a231, v251
    v_accvgpr_read_b32 v251, a236
    v_ldexp_f32 v251, v251, v109
    v_accvgpr_write_b32 a236, v251
    v_accvgpr_read_b32 v251, a237
    v_ldexp_f32 v251, v251, v109
    v_accvgpr_write_b32 a237, v251
    v_accvgpr_read_b32 v251, a238
    v_ldexp_f32 v251, v251, v109
    v_accvgpr_write_b32 a238, v251
    v_accvgpr_read_b32 v251, a239
    v_ldexp_f32 v251, v251, v109
    v_accvgpr_write_b32 a239, v251
    v_accvgpr_read_b32 v251, a244
    v_ldexp_f32 v251, v251, v109
    v_accvgpr_write_b32 a244, v251
    v_accvgpr_read_b32 v251, a245
    v_ldexp_f32 v251, v251, v109
    v_accvgpr_write_b32 a245, v251
    v_accvgpr_read_b32 v251, a246
    v_ldexp_f32 v251, v251, v109
    v_accvgpr_write_b32 a246, v251
    v_accvgpr_read_b32 v251, a247
    v_ldexp_f32 v251, v251, v109
    v_accvgpr_write_b32 a247, v251
    v_accvgpr_read_b32 v251, a252
    v_ldexp_f32 v251, v251, v109
    v_accvgpr_write_b32 a252, v251
    v_accvgpr_read_b32 v251, a253
    v_ldexp_f32 v251, v251, v109
    v_accvgpr_write_b32 a253, v251
    v_accvgpr_read_b32 v251, a254
    v_ldexp_f32 v251, v251, v109
    v_accvgpr_write_b32 a254, v251
    v_accvgpr_read_b32 v251, a255
    v_ldexp_f32 v251, v251, v109
    v_accvgpr_write_b32 a255, v251
    v_exp_f32 v32, v32
    v_exp_f32 v33, v33
    v_exp_f32 v34, v34
    v_exp_f32 v35, v35
    v_exp_f32 v36, v36
    v_exp_f32 v37, v37
    v_exp_f32 v38, v38
    v_exp_f32 v39, v39
    v_add_f32 v108, v32, v33
    v_add_f32 v108, v108, v34
    v_add_f32 v108, v108, v35
    v_add_f32 v108, v108, v36
    v_add_f32 v108, v108, v37
    v_add_f32 v108, v108, v38
    v_add_f32 v108, v108, v39
    v_cvt_pk_bf16_f32 v32, v32, v33
    v_cvt_pk_bf16_f32 v33, v34, v35
    v_cvt_pk_bf16_f32 v34, v36, v37
    v_cvt_pk_bf16_f32 v35, v38, v39
    v_exp_f32 v40, v40
    v_exp_f32 v41, v41
    v_exp_f32 v42, v42
    v_exp_f32 v43, v43
    v_exp_f32 v44, v44
    v_exp_f32 v45, v45
    v_exp_f32 v46, v46
    v_exp_f32 v47, v47
    v_add_f32 v109, v40, v41
    v_add_f32 v109, v109, v42
    v_add_f32 v109, v109, v43
    v_add_f32 v109, v109, v44
    v_add_f32 v109, v109, v45
    v_add_f32 v109, v109, v46
    v_add_f32 v109, v109, v47
    v_cvt_pk_bf16_f32 v40, v40, v41
    v_cvt_pk_bf16_f32 v41, v42, v43
    v_cvt_pk_bf16_f32 v42, v44, v45
    v_cvt_pk_bf16_f32 v43, v46, v47
    s_nop 7
    s_setpc_b64 s[78:79]
L_sub_11:
    s_nop 15
    s_lshl_b32 s85, s80, 15
    s_lshl_b32 s86, s60, 14
    s_add_u32 s85, s85, s86
    s_add_u32 s85, s85, 128
    v_and_b32 v251, 15, v250
    v_lshlrev_b32 v251, 10, v251
    v_lshrrev_b32 v110, 4, v250
    v_lshl_add_u32 v251, v110, 4, v251
    v_mov_b32 v110, v64
    s_waitcnt vmcnt(0) lgkmcnt(0)
    buffer_load_dwordx4 v[64:67], v251, s[12:15], s85 offen offset:0
    s_waitcnt vmcnt(0)
    v_mfma_f32_16x16x32_bf16 v[48:51], v[64:67], a[8:11], v[72:75]
    v_mfma_f32_16x16x32_bf16 v[56:59], v[64:67], a[12:15], v[76:79]
    s_nop 7
    buffer_load_dwordx4 v[64:67], v251, s[12:15], s85 offen offset:512
    s_waitcnt vmcnt(0)
    v_mfma_f32_16x16x32_bf16 v[52:55], v[64:67], a[8:11], v[72:75]
    v_mfma_f32_16x16x32_bf16 v[60:63], v[64:67], a[12:15], v[76:79]
    s_nop 7
    buffer_load_dwordx4 v[64:67], v251, s[12:15], s85 offen offset:64
    s_waitcnt vmcnt(0)
    v_mfma_f32_16x16x32_bf16 v[48:51], v[64:67], a[24:27], v[48:51]
    v_mfma_f32_16x16x32_bf16 v[56:59], v[64:67], a[28:31], v[56:59]
    s_nop 7
    buffer_load_dwordx4 v[64:67], v251, s[12:15], s85 offen offset:576
    s_waitcnt vmcnt(0)
    v_mfma_f32_16x16x32_bf16 v[52:55], v[64:67], a[24:27], v[52:55]
    v_mfma_f32_16x16x32_bf16 v[60:63], v[64:67], a[28:31], v[60:63]
    s_nop 7
    buffer_load_dwordx4 v[64:67], v251, s[12:15], s85 offen offset:128
    s_waitcnt vmcnt(0)
    v_mfma_f32_16x16x32_bf16 v[48:51], v[64:67], a[40:43], v[48:51]
    v_mfma_f32_16x16x32_bf16 v[56:59], v[64:67], a[44:47], v[56:59]
    s_nop 7
    buffer_load_dwordx4 v[64:67], v251, s[12:15], s85 offen offset:640
    s_waitcnt vmcnt(0)
    v_mfma_f32_16x16x32_bf16 v[52:55], v[64:67], a[40:43], v[52:55]
    v_mfma_f32_16x16x32_bf16 v[60:63], v[64:67], a[44:47], v[60:63]
    s_nop 7
    buffer_load_dwordx4 v[64:67], v251, s[12:15], s85 offen offset:192
    s_waitcnt vmcnt(0)
    v_mfma_f32_16x16x32_bf16 v[48:51], v[64:67], a[56:59], v[48:51]
    v_mfma_f32_16x16x32_bf16 v[56:59], v[64:67], a[60:63], v[56:59]
    s_nop 7
    buffer_load_dwordx4 v[64:67], v251, s[12:15], s85 offen offset:704
    s_waitcnt vmcnt(0)
    v_mfma_f32_16x16x32_bf16 v[52:55], v[64:67], a[56:59], v[52:55]
    v_mfma_f32_16x16x32_bf16 v[60:63], v[64:67], a[60:63], v[60:63]
    s_nop 7
    buffer_load_dwordx4 v[64:67], v251, s[12:15], s85 offen offset:256
    s_waitcnt vmcnt(0)
    v_mfma_f32_16x16x32_bf16 v[48:51], v[64:67], a[72:75], v[48:51]
    v_mfma_f32_16x16x32_bf16 v[56:59], v[64:67], a[76:79], v[56:59]
    s_nop 7
    buffer_load_dwordx4 v[64:67], v251, s[12:15], s85 offen offset:768
    s_waitcnt vmcnt(0)
    v_mfma_f32_16x16x32_bf16 v[52:55], v[64:67], a[72:75], v[52:55]
    v_mfma_f32_16x16x32_bf16 v[60:63], v[64:67], a[76:79], v[60:63]
    s_nop 7
    buffer_load_dwordx4 v[64:67], v251, s[12:15], s85 offen offset:320
    s_waitcnt vmcnt(0)
    v_mfma_f32_16x16x32_bf16 v[48:51], v[64:67], a[88:91], v[48:51]
    v_mfma_f32_16x16x32_bf16 v[56:59], v[64:67], a[92:95], v[56:59]
    s_nop 7
    buffer_load_dwordx4 v[64:67], v251, s[12:15], s85 offen offset:832
    s_waitcnt vmcnt(0)
    v_mfma_f32_16x16x32_bf16 v[52:55], v[64:67], a[88:91], v[52:55]
    v_mfma_f32_16x16x32_bf16 v[60:63], v[64:67], a[92:95], v[60:63]
    s_nop 7
    buffer_load_dwordx4 v[64:67], v251, s[12:15], s85 offen offset:384
    s_waitcnt vmcnt(0)
    v_mfma_f32_16x16x32_bf16 v[48:51], v[64:67], a[104:107], v[48:51]
    v_mfma_f32_16x16x32_bf16 v[56:59], v[64:67], a[108:111], v[56:59]
    s_nop 7
    buffer_load_dwordx4 v[64:67], v251, s[12:15], s85 offen offset:896
    s_waitcnt vmcnt(0)
    v_mfma_f32_16x16x32_bf16 v[52:55], v[64:67], a[104:107], v[52:55]
    v_mfma_f32_16x16x32_bf16 v[60:63], v[64:67], a[108:111], v[60:63]
    s_nop 7
    buffer_load_dwordx4 v[64:67], v251, s[12:15], s85 offen offset:448
    s_waitcnt vmcnt(0)
    v_mfma_f32_16x16x32_bf16 v[48:51], v[64:67], a[120:123], v[48:51]
    v_mfma_f32_16x16x32_bf16 v[56:59], v[64:67], a[124:127], v[56:59]
    s_nop 7
    buffer_load_dwordx4 v[64:67], v251, s[12:15], s85 offen offset:960
    s_waitcnt vmcnt(0)
    v_mfma_f32_16x16x32_bf16 v[52:55], v[64:67], a[120:123], v[52:55]
    v_mfma_f32_16x16x32_bf16 v[60:63], v[64:67], a[124:127], v[60:63]
    s_nop 7
    s_nop 15
    v_mov_b32 v64, v110
    v_mov_b32 v65, v110
    v_mov_b32 v66, v110
    v_mov_b32 v67, v110
    v_max3_f32 v110, v48, v49, v50
    v_max3_f32 v110, v110, v51, v52
    v_max3_f32 v110, v110, v53, v54
    v_max_f32 v110, v110, v55
    v_mov_b32 v251, v110
    s_nop 1
    v_permlane32_swap_b32 v110, v251
    v_max_f32 v110, v110, v251
    v_mov_b32 v251, v110
    s_nop 1
    v_permlane16_swap_b32 v110, v251
    v_max_f32 v110, v110, v251
    v_add_f32 v110, 0x42200000, v110
    v_max_f32 v110, 0, v110
    v_ceil_f32 v110, v110
    v_max3_f32 v111, v56, v57, v58
    v_max3_f32 v111, v111, v59, v60
    v_max3_f32 v111, v111, v61, v62
    v_max_f32 v111, v111, v63
    v_mov_b32 v251, v111
    s_nop 1
    v_permlane32_swap_b32 v111, v251
    v_max_f32 v111, v111, v251
    v_mov_b32 v251, v111
    s_nop 1
    v_permlane16_swap_b32 v111, v251
    v_max_f32 v111, v111, v251
    v_add_f32 v111, 0x42200000, v111
    v_max_f32 v111, 0, v111
    v_ceil_f32 v111, v111
    v_sub_f32 v72, v72, v110
    v_sub_f32 v73, v73, v110
    v_sub_f32 v74, v74, v110
    v_sub_f32 v75, v75, v110
    v_mul_f32 v251, s81, v110
    v_sub_f32 v48, v48, v110
    v_sub_f32 v16, v16, v251
    v_sub_f32 v49, v49, v110
    v_sub_f32 v17, v17, v251
    v_sub_f32 v50, v50, v110
    v_sub_f32 v18, v18, v251
    v_sub_f32 v51, v51, v110
    v_sub_f32 v19, v19, v251
    v_sub_f32 v52, v52, v110
    v_sub_f32 v20, v20, v251
    v_sub_f32 v53, v53, v110
    v_sub_f32 v21, v21, v251
    v_sub_f32 v54, v54, v110
    v_sub_f32 v22, v22, v251
    v_sub_f32 v55, v55, v110
    v_sub_f32 v23, v23, v251
    v_sub_f32 v110, 0, v110
    v_cvt_i32_f32 v110, v110
    v_ldexp_f32 v106, v106, v110
    v_ldexp_f32 v112, v112, v110
    v_ldexp_f32 v113, v113, v110
    v_ldexp_f32 v114, v114, v110
    v_ldexp_f32 v115, v115, v110
    v_ldexp_f32 v120, v120, v110
    v_ldexp_f32 v121, v121, v110
    v_ldexp_f32 v122, v122, v110
    v_ldexp_f32 v123, v123, v110
    v_ldexp_f32 v128, v128, v110
    v_ldexp_f32 v129, v129, v110
    v_ldexp_f32 v130, v130, v110
    v_ldexp_f32 v131, v131, v110
    v_ldexp_f32 v136, v136, v110
    v_ldexp_f32 v137, v137, v110
    v_ldexp_f32 v138, v138, v110
    v_ldexp_f32 v139, v139, v110
    v_ldexp_f32 v144, v144, v110
    v_ldexp_f32 v145, v145, v110
    v_ldexp_f32 v146, v146, v110
    v_ldexp_f32 v147, v147, v110
    v_ldexp_f32 v152, v152, v110
    v_ldexp_f32 v153, v153, v110
    v_ldexp_f32 v154, v154, v110
    v_ldexp_f32 v155, v155, v110
    v_ldexp_f32 v160, v160, v110
    v_ldexp_f32 v161, v161, v110
    v_ldexp_f32 v162, v162, v110
    v_ldexp_f32 v163, v163, v110
    v_ldexp_f32 v168, v168, v110
    v_ldexp_f32 v169, v169, v110
    v_ldexp_f32 v170, v170, v110
    v_ldexp_f32 v171, v171, v110
    v_ldexp_f32 v176, v176, v110
    v_ldexp_f32 v177, v177, v110
    v_ldexp_f32 v178, v178, v110
    v_ldexp_f32 v179, v179, v110
    v_ldexp_f32 v184, v184, v110
    v_ldexp_f32 v185, v185, v110
    v_ldexp_f32 v186, v186, v110
    v_ldexp_f32 v187, v187, v110
    v_ldexp_f32 v192, v192, v110
    v_ldexp_f32 v193, v193, v110
    v_ldexp_f32 v194, v194, v110
    v_ldexp_f32 v195, v195, v110
    v_ldexp_f32 v200, v200, v110
    v_ldexp_f32 v201, v201, v110
    v_ldexp_f32 v202, v202, v110
    v_ldexp_f32 v203, v203, v110
    v_ldexp_f32 v208, v208, v110
    v_ldexp_f32 v209, v209, v110
    v_ldexp_f32 v210, v210, v110
    v_ldexp_f32 v211, v211, v110
    v_ldexp_f32 v216, v216, v110
    v_ldexp_f32 v217, v217, v110
    v_ldexp_f32 v218, v218, v110
    v_ldexp_f32 v219, v219, v110
    v_ldexp_f32 v224, v224, v110
    v_ldexp_f32 v225, v225, v110
    v_ldexp_f32 v226, v226, v110
    v_ldexp_f32 v227, v227, v110
    v_ldexp_f32 v232, v232, v110
    v_ldexp_f32 v233, v233, v110
    v_ldexp_f32 v234, v234, v110
    v_ldexp_f32 v235, v235, v110
    v_sub_f32 v76, v76, v111
    v_sub_f32 v77, v77, v111
    v_sub_f32 v78, v78, v111
    v_sub_f32 v79, v79, v111
    v_mul_f32 v251, s81, v111
    v_sub_f32 v56, v56, v111
    v_sub_f32 v24, v24, v251
    v_sub_f32 v57, v57, v111
    v_sub_f32 v25, v25, v251
    v_sub_f32 v58, v58, v111
    v_sub_f32 v26, v26, v251
    v_sub_f32 v59, v59, v111
    v_sub_f32 v27, v27, v251
    v_sub_f32 v60, v60, v111
    v_sub_f32 v28, v28, v251
    v_sub_f32 v61, v61, v111
    v_sub_f32 v29, v29, v251
    v_sub_f32 v62, v62, v111
    v_sub_f32 v30, v30, v251
    v_sub_f32 v63, v63, v111
    v_sub_f32 v31, v31, v251
    v_sub_f32 v111, 0, v111
    v_cvt_i32_f32 v111, v111
    v_ldexp_f32 v107, v107, v111
    v_ldexp_f32 v116, v116, v111
    v_ldexp_f32 v117, v117, v111
    v_ldexp_f32 v118, v118, v111
    v_ldexp_f32 v119, v119, v111
    v_ldexp_f32 v124, v124, v111
    v_ldexp_f32 v125, v125, v111
    v_ldexp_f32 v126, v126, v111
    v_ldexp_f32 v127, v127, v111
    v_ldexp_f32 v132, v132, v111
    v_ldexp_f32 v133, v133, v111
    v_ldexp_f32 v134, v134, v111
    v_ldexp_f32 v135, v135, v111
    v_ldexp_f32 v140, v140, v111
    v_ldexp_f32 v141, v141, v111
    v_ldexp_f32 v142, v142, v111
    v_ldexp_f32 v143, v143, v111
    v_ldexp_f32 v148, v148, v111
    v_ldexp_f32 v149, v149, v111
    v_ldexp_f32 v150, v150, v111
    v_ldexp_f32 v151, v151, v111
    v_ldexp_f32 v156, v156, v111
    v_ldexp_f32 v157, v157, v111
    v_ldexp_f32 v158, v158, v111
    v_ldexp_f32 v159, v159, v111
    v_ldexp_f32 v164, v164, v111
    v_ldexp_f32 v165, v165, v111
    v_ldexp_f32 v166, v166, v111
    v_ldexp_f32 v167, v167, v111
    v_ldexp_f32 v172, v172, v111
    v_ldexp_f32 v173, v173, v111
    v_ldexp_f32 v174, v174, v111
    v_ldexp_f32 v175, v175, v111
    v_ldexp_f32 v180, v180, v111
    v_ldexp_f32 v181, v181, v111
    v_ldexp_f32 v182, v182, v111
    v_ldexp_f32 v183, v183, v111
    v_ldexp_f32 v188, v188, v111
    v_ldexp_f32 v189, v189, v111
    v_ldexp_f32 v190, v190, v111
    v_ldexp_f32 v191, v191, v111
    v_ldexp_f32 v196, v196, v111
    v_ldexp_f32 v197, v197, v111
    v_ldexp_f32 v198, v198, v111
    v_ldexp_f32 v199, v199, v111
    v_ldexp_f32 v204, v204, v111
    v_ldexp_f32 v205, v205, v111
    v_ldexp_f32 v206, v206, v111
    v_ldexp_f32 v207, v207, v111
    v_ldexp_f32 v212, v212, v111
    v_ldexp_f32 v213, v213, v111
    v_ldexp_f32 v214, v214, v111
    v_ldexp_f32 v215, v215, v111
    v_ldexp_f32 v220, v220, v111
    v_ldexp_f32 v221, v221, v111
    v_ldexp_f32 v222, v222, v111
    v_ldexp_f32 v223, v223, v111
    v_ldexp_f32 v228, v228, v111
    v_ldexp_f32 v229, v229, v111
    v_ldexp_f32 v230, v230, v111
    v_ldexp_f32 v231, v231, v111
    v_ldexp_f32 v236, v236, v111
    v_ldexp_f32 v237, v237, v111
    v_ldexp_f32 v238, v238, v111
    v_ldexp_f32 v239, v239, v111
    v_exp_f32 v48, v48
    v_exp_f32 v49, v49
    v_exp_f32 v50, v50
    v_exp_f32 v51, v51
    v_exp_f32 v52, v52
    v_exp_f32 v53, v53
    v_exp_f32 v54, v54
    v_exp_f32 v55, v55
    v_add_f32 v110, v48, v49
    v_add_f32 v110, v110, v50
    v_add_f32 v110, v110, v51
    v_add_f32 v110, v110, v52
    v_add_f32 v110, v110, v53
    v_add_f32 v110, v110, v54
    v_add_f32 v110, v110, v55
    v_cvt_pk_bf16_f32 v48, v48, v49
    v_cvt_pk_bf16_f32 v49, v50, v51
    v_cvt_pk_bf16_f32 v50, v52, v53
    v_cvt_pk_bf16_f32 v51, v54, v55
    v_exp_f32 v56, v56
    v_exp_f32 v57, v57
    v_exp_f32 v58, v58
    v_exp_f32 v59, v59
    v_exp_f32 v60, v60
    v_exp_f32 v61, v61
    v_exp_f32 v62, v62
    v_exp_f32 v63, v63
    v_add_f32 v111, v56, v57
    v_add_f32 v111, v111, v58
    v_add_f32 v111, v111, v59
    v_add_f32 v111, v111, v60
    v_add_f32 v111, v111, v61
    v_add_f32 v111, v111, v62
    v_add_f32 v111, v111, v63
    v_cvt_pk_bf16_f32 v56, v56, v57
    v_cvt_pk_bf16_f32 v57, v58, v59
    v_cvt_pk_bf16_f32 v58, v60, v61
    v_cvt_pk_bf16_f32 v59, v62, v63
    s_nop 7
    s_setpc_b64 s[78:79]
L_sub_20:
    s_nop 15
    v_max3_f32 v108, v32, v33, v34
    v_max3_f32 v108, v108, v35, v36
    v_max3_f32 v108, v108, v37, v38
    v_max_f32 v108, v108, v39
    v_mov_b32 v251, v108
    s_nop 1
    v_permlane32_swap_b32 v108, v251
    v_max_f32 v108, v108, v251
    v_mov_b32 v251, v108
    s_nop 1
    v_permlane16_swap_b32 v108, v251
    v_max_f32 v108, v108, v251
    v_add_f32 v108, 0x42200000, v108
    v_max_f32 v108, 0, v108
    v_ceil_f32 v108, v108
    v_max3_f32 v109, v40, v41, v42
    v_max3_f32 v109, v109, v43, v44
    v_max3_f32 v109, v109, v45, v46
    v_max_f32 v109, v109, v47
    v_mov_b32 v251, v109
    s_nop 1
    v_permlane32_swap_b32 v109, v251
    v_max_f32 v109, v109, v251
    v_mov_b32 v251, v109
    s_nop 1
    v_permlane16_swap_b32 v109, v251
    v_max_f32 v109, v109, v251
    v_add_f32 v109, 0x42200000, v109
    v_max_f32 v109, 0, v109
    v_ceil_f32 v109, v109
    v_sub_f32 v64, v64, v108
    v_mul_f32 v251, s81, v108
    v_sub_f32 v32, v32, v108
    v_sub_f32 v33, v33, v108
    v_sub_f32 v34, v34, v108
    v_sub_f32 v35, v35, v108
    v_sub_f32 v36, v36, v108
    v_sub_f32 v37, v37, v108
    v_sub_f32 v38, v38, v108
    v_sub_f32 v39, v39, v108
    v_sub_f32 v108, 0, v108
    v_cvt_i32_f32 v108, v108
    v_ldexp_f32 v104, v104, v108
    v_accvgpr_read_b32 v251, a128
    v_ldexp_f32 v251, v251, v108
    v_accvgpr_write_b32 a128, v251
    v_accvgpr_read_b32 v251, a129
    v_ldexp_f32 v251, v251, v108
    v_accvgpr_write_b32 a129, v251
    v_accvgpr_read_b32 v251, a130
    v_ldexp_f32 v251, v251, v108
    v_accvgpr_write_b32 a130, v251
    v_accvgpr_read_b32 v251, a131
    v_ldexp_f32 v251, v251, v108
    v_accvgpr_write_b32 a131, v251
    v_accvgpr_read_b32 v251, a136
    v_ldexp_f32 v251, v251, v108
    v_accvgpr_write_b32 a136, v251
    v_accvgpr_read_b32 v251, a137
    v_ldexp_f32 v251, v251, v108
    v_accvgpr_write_b32 a137, v251
    v_accvgpr_read_b32 v251, a138
    v_ldexp_f32 v251, v251, v108
    v_accvgpr_write_b32 a138, v251
    v_accvgpr_read_b32 v251, a139
    v_ldexp_f32 v251, v251, v108
    v_accvgpr_write_b32 a139, v251
    v_accvgpr_read_b32 v251, a144
    v_ldexp_f32 v251, v251, v108
    v_accvgpr_write_b32 a144, v251
    v_accvgpr_read_b32 v251, a145
    v_ldexp_f32 v251, v251, v108
    v_accvgpr_write_b32 a145, v251
    v_accvgpr_read_b32 v251, a146
    v_ldexp_f32 v251, v251, v108
    v_accvgpr_write_b32 a146, v251
    v_accvgpr_read_b32 v251, a147
    v_ldexp_f32 v251, v251, v108
    v_accvgpr_write_b32 a147, v251
    v_accvgpr_read_b32 v251, a152
    v_ldexp_f32 v251, v251, v108
    v_accvgpr_write_b32 a152, v251
    v_accvgpr_read_b32 v251, a153
    v_ldexp_f32 v251, v251, v108
    v_accvgpr_write_b32 a153, v251
    v_accvgpr_read_b32 v251, a154
    v_ldexp_f32 v251, v251, v108
    v_accvgpr_write_b32 a154, v251
    v_accvgpr_read_b32 v251, a155
    v_ldexp_f32 v251, v251, v108
    v_accvgpr_write_b32 a155, v251
    v_accvgpr_read_b32 v251, a160
    v_ldexp_f32 v251, v251, v108
    v_accvgpr_write_b32 a160, v251
    v_accvgpr_read_b32 v251, a161
    v_ldexp_f32 v251, v251, v108
    v_accvgpr_write_b32 a161, v251
    v_accvgpr_read_b32 v251, a162
    v_ldexp_f32 v251, v251, v108
    v_accvgpr_write_b32 a162, v251
    v_accvgpr_read_b32 v251, a163
    v_ldexp_f32 v251, v251, v108
    v_accvgpr_write_b32 a163, v251
    v_accvgpr_read_b32 v251, a168
    v_ldexp_f32 v251, v251, v108
    v_accvgpr_write_b32 a168, v251
    v_accvgpr_read_b32 v251, a169
    v_ldexp_f32 v251, v251, v108
    v_accvgpr_write_b32 a169, v251
    v_accvgpr_read_b32 v251, a170
    v_ldexp_f32 v251, v251, v108
    v_accvgpr_write_b32 a170, v251
    v_accvgpr_read_b32 v251, a171
    v_ldexp_f32 v251, v251, v108
    v_accvgpr_write_b32 a171, v251
    v_accvgpr_read_b32 v251, a176
    v_ldexp_f32 v251, v251, v108
    v_accvgpr_write_b32 a176, v251
    v_accvgpr_read_b32 v251, a177
    v_ldexp_f32 v251, v251, v108
    v_accvgpr_write_b32 a177, v251
    v_accvgpr_read_b32 v251, a178
    v_ldexp_f32 v251, v251, v108
    v_accvgpr_write_b32 a178, v251
    v_accvgpr_read_b32 v251, a179
    v_ldexp_f32 v251, v251, v108
    v_accvgpr_write_b32 a179, v251
    v_accvgpr_read_b32 v251, a184
    v_ldexp_f32 v251, v251, v108
    v_accvgpr_write_b32 a184, v251
    v_accvgpr_read_b32 v251, a185
    v_ldexp_f32 v251, v251, v108
    v_accvgpr_write_b32 a185, v251
    v_accvgpr_read_b32 v251, a186
    v_ldexp_f32 v251, v251, v108
    v_accvgpr_write_b32 a186, v251
    v_accvgpr_read_b32 v251, a187
    v_ldexp_f32 v251, v251, v108
    v_accvgpr_write_b32 a187, v251
    v_accvgpr_read_b32 v251, a192
    v_ldexp_f32 v251, v251, v108
    v_accvgpr_write_b32 a192, v251
    v_accvgpr_read_b32 v251, a193
    v_ldexp_f32 v251, v251, v108
    v_accvgpr_write_b32 a193, v251
    v_accvgpr_read_b32 v251, a194
    v_ldexp_f32 v251, v251, v108
    v_accvgpr_write_b32 a194, v251
    v_accvgpr_read_b32 v251, a195
    v_ldexp_f32 v251, v251, v108
    v_accvgpr_write_b32 a195, v251
    v_accvgpr_read_b32 v251, a200
    v_ldexp_f32 v251, v251, v108
    v_accvgpr_write_b32 a200, v251
    v_accvgpr_read_b32 v251, a201
    v_ldexp_f32 v251, v251, v108
    v_accvgpr_write_b32 a201, v251
    v_accvgpr_read_b32 v251, a202
    v_ldexp_f32 v251, v251, v108
    v_accvgpr_write_b32 a202, v251
    v_accvgpr_read_b32 v251, a203
    v_ldexp_f32 v251, v251, v108
    v_accvgpr_write_b32 a203, v251
    v_accvgpr_read_b32 v251, a208
    v_ldexp_f32 v251, v251, v108
    v_accvgpr_write_b32 a208, v251
    v_accvgpr_read_b32 v251, a209
    v_ldexp_f32 v251, v251, v108
    v_accvgpr_write_b32 a209, v251
    v_accvgpr_read_b32 v251, a210
    v_ldexp_f32 v251, v251, v108
    v_accvgpr_write_b32 a210, v251
    v_accvgpr_read_b32 v251, a211
    v_ldexp_f32 v251, v251, v108
    v_accvgpr_write_b32 a211, v251
    v_accvgpr_read_b32 v251, a216
    v_ldexp_f32 v251, v251, v108
    v_accvgpr_write_b32 a216, v251
    v_accvgpr_read_b32 v251, a217
    v_ldexp_f32 v251, v251, v108
    v_accvgpr_write_b32 a217, v251
    v_accvgpr_read_b32 v251, a218
    v_ldexp_f32 v251, v251, v108
    v_accvgpr_write_b32 a218, v251
    v_accvgpr_read_b32 v251, a219
    v_ldexp_f32 v251, v251, v108
    v_accvgpr_write_b32 a219, v251
    v_accvgpr_read_b32 v251, a224
    v_ldexp_f32 v251, v251, v108
    v_accvgpr_write_b32 a224, v251
    v_accvgpr_read_b32 v251, a225
    v_ldexp_f32 v251, v251, v108
    v_accvgpr_write_b32 a225, v251
    v_accvgpr_read_b32 v251, a226
    v_ldexp_f32 v251, v251, v108
    v_accvgpr_write_b32 a226, v251
    v_accvgpr_read_b32 v251, a227
    v_ldexp_f32 v251, v251, v108
    v_accvgpr_write_b32 a227, v251
    v_accvgpr_read_b32 v251, a232
    v_ldexp_f32 v251, v251, v108
    v_accvgpr_write_b32 a232, v251
    v_accvgpr_read_b32 v251, a233
    v_ldexp_f32 v251, v251, v108
    v_accvgpr_write_b32 a233, v251
    v_accvgpr_read_b32 v251, a234
    v_ldexp_f32 v251, v251, v108
    v_accvgpr_write_b32 a234, v251
    v_accvgpr_read_b32 v251, a235
    v_ldexp_f32 v251, v251, v108
    v_accvgpr_write_b32 a235, v251
    v_accvgpr_read_b32 v251, a240
    v_ldexp_f32 v251, v251, v108
    v_accvgpr_write_b32 a240, v251
    v_accvgpr_read_b32 v251, a241
    v_ldexp_f32 v251, v251, v108
    v_accvgpr_write_b32 a241, v251
    v_accvgpr_read_b32 v251, a242
    v_ldexp_f32 v251, v251, v108
    v_accvgpr_write_b32 a242, v251
    v_accvgpr_read_b32 v251, a243
    v_ldexp_f32 v251, v251, v108
    v_accvgpr_write_b32 a243, v251
    v_accvgpr_read_b32 v251, a248
    v_ldexp_f32 v251, v251, v108
    v_accvgpr_write_b32 a248, v251
    v_accvgpr_read_b32 v251, a249
    v_ldexp_f32 v251, v251, v108
    v_accvgpr_write_b32 a249, v251
    v_accvgpr_read_b32 v251, a250
    v_ldexp_f32 v251, v251, v108
    v_accvgpr_write_b32 a250, v251
    v_accvgpr_read_b32 v251, a251
    v_ldexp_f32 v251, v251, v108
    v_accvgpr_write_b32 a251, v251
    v_sub_f32 v68, v68, v109
    v_mul_f32 v251, s81, v109
    v_sub_f32 v40, v40, v109
    v_sub_f32 v41, v41, v109
    v_sub_f32 v42, v42, v109
    v_sub_f32 v43, v43, v109
    v_sub_f32 v44, v44, v109
    v_sub_f32 v45, v45, v109
    v_sub_f32 v46, v46, v109
    v_sub_f32 v47, v47, v109
    v_sub_f32 v109, 0, v109
    v_cvt_i32_f32 v109, v109
    v_ldexp_f32 v105, v105, v109
    v_accvgpr_read_b32 v251, a132
    v_ldexp_f32 v251, v251, v109
    v_accvgpr_write_b32 a132, v251
    v_accvgpr_read_b32 v251, a133
    v_ldexp_f32 v251, v251, v109
    v_accvgpr_write_b32 a133, v251
    v_accvgpr_read_b32 v251, a134
    v_ldexp_f32 v251, v251, v109
    v_accvgpr_write_b32 a134, v251
    v_accvgpr_read_b32 v251, a135
    v_ldexp_f32 v251, v251, v109
    v_accvgpr_write_b32 a135, v251
    v_accvgpr_read_b32 v251, a140
    v_ldexp_f32 v251, v251, v109
    v_accvgpr_write_b32 a140, v251
    v_accvgpr_read_b32 v251, a141
    v_ldexp_f32 v251, v251, v109
    v_accvgpr_write_b32 a141, v251
    v_accvgpr_read_b32 v251, a142
    v_ldexp_f32 v251, v251, v109
    v_accvgpr_write_b32 a142, v251
    v_accvgpr_read_b32 v251, a143
    v_ldexp_f32 v251, v251, v109
    v_accvgpr_write_b32 a143, v251
    v_accvgpr_read_b32 v251, a148
    v_ldexp_f32 v251, v251, v109
    v_accvgpr_write_b32 a148, v251
    v_accvgpr_read_b32 v251, a149
    v_ldexp_f32 v251, v251, v109
    v_accvgpr_write_b32 a149, v251
    v_accvgpr_read_b32 v251, a150
    v_ldexp_f32 v251, v251, v109
    v_accvgpr_write_b32 a150, v251
    v_accvgpr_read_b32 v251, a151
    v_ldexp_f32 v251, v251, v109
    v_accvgpr_write_b32 a151, v251
    v_accvgpr_read_b32 v251, a156
    v_ldexp_f32 v251, v251, v109
    v_accvgpr_write_b32 a156, v251
    v_accvgpr_read_b32 v251, a157
    v_ldexp_f32 v251, v251, v109
    v_accvgpr_write_b32 a157, v251
    v_accvgpr_read_b32 v251, a158
    v_ldexp_f32 v251, v251, v109
    v_accvgpr_write_b32 a158, v251
    v_accvgpr_read_b32 v251, a159
    v_ldexp_f32 v251, v251, v109
    v_accvgpr_write_b32 a159, v251
    v_accvgpr_read_b32 v251, a164
    v_ldexp_f32 v251, v251, v109
    v_accvgpr_write_b32 a164, v251
    v_accvgpr_read_b32 v251, a165
    v_ldexp_f32 v251, v251, v109
    v_accvgpr_write_b32 a165, v251
    v_accvgpr_read_b32 v251, a166
    v_ldexp_f32 v251, v251, v109
    v_accvgpr_write_b32 a166, v251
    v_accvgpr_read_b32 v251, a167
    v_ldexp_f32 v251, v251, v109
    v_accvgpr_write_b32 a167, v251
    v_accvgpr_read_b32 v251, a172
    v_ldexp_f32 v251, v251, v109
    v_accvgpr_write_b32 a172, v251
    v_accvgpr_read_b32 v251, a173
    v_ldexp_f32 v251, v251, v109
    v_accvgpr_write_b32 a173, v251
    v_accvgpr_read_b32 v251, a174
    v_ldexp_f32 v251, v251, v109
    v_accvgpr_write_b32 a174, v251
    v_accvgpr_read_b32 v251, a175
    v_ldexp_f32 v251, v251, v109
    v_accvgpr_write_b32 a175, v251
    v_accvgpr_read_b32 v251, a180
    v_ldexp_f32 v251, v251, v109
    v_accvgpr_write_b32 a180, v251
    v_accvgpr_read_b32 v251, a181
    v_ldexp_f32 v251, v251, v109
    v_accvgpr_write_b32 a181, v251
    v_accvgpr_read_b32 v251, a182
    v_ldexp_f32 v251, v251, v109
    v_accvgpr_write_b32 a182, v251
    v_accvgpr_read_b32 v251, a183
    v_ldexp_f32 v251, v251, v109
    v_accvgpr_write_b32 a183, v251
    v_accvgpr_read_b32 v251, a188
    v_ldexp_f32 v251, v251, v109
    v_accvgpr_write_b32 a188, v251
    v_accvgpr_read_b32 v251, a189
    v_ldexp_f32 v251, v251, v109
    v_accvgpr_write_b32 a189, v251
    v_accvgpr_read_b32 v251, a190
    v_ldexp_f32 v251, v251, v109
    v_accvgpr_write_b32 a190, v251
    v_accvgpr_read_b32 v251, a191
    v_ldexp_f32 v251, v251, v109
    v_accvgpr_write_b32 a191, v251
    v_accvgpr_read_b32 v251, a196
    v_ldexp_f32 v251, v251, v109
    v_accvgpr_write_b32 a196, v251
    v_accvgpr_read_b32 v251, a197
    v_ldexp_f32 v251, v251, v109
    v_accvgpr_write_b32 a197, v251
    v_accvgpr_read_b32 v251, a198
    v_ldexp_f32 v251, v251, v109
    v_accvgpr_write_b32 a198, v251
    v_accvgpr_read_b32 v251, a199
    v_ldexp_f32 v251, v251, v109
    v_accvgpr_write_b32 a199, v251
    v_accvgpr_read_b32 v251, a204
    v_ldexp_f32 v251, v251, v109
    v_accvgpr_write_b32 a204, v251
    v_accvgpr_read_b32 v251, a205
    v_ldexp_f32 v251, v251, v109
    v_accvgpr_write_b32 a205, v251
    v_accvgpr_read_b32 v251, a206
    v_ldexp_f32 v251, v251, v109
    v_accvgpr_write_b32 a206, v251
    v_accvgpr_read_b32 v251, a207
    v_ldexp_f32 v251, v251, v109
    v_accvgpr_write_b32 a207, v251
    v_accvgpr_read_b32 v251, a212
    v_ldexp_f32 v251, v251, v109
    v_accvgpr_write_b32 a212, v251
    v_accvgpr_read_b32 v251, a213
    v_ldexp_f32 v251, v251, v109
    v_accvgpr_write_b32 a213, v251
    v_accvgpr_read_b32 v251, a214
    v_ldexp_f32 v251, v251, v109
    v_accvgpr_write_b32 a214, v251
    v_accvgpr_read_b32 v251, a215
    v_ldexp_f32 v251, v251, v109
    v_accvgpr_write_b32 a215, v251
    v_accvgpr_read_b32 v251, a220
    v_ldexp_f32 v251, v251, v109
    v_accvgpr_write_b32 a220, v251
    v_accvgpr_read_b32 v251, a221
    v_ldexp_f32 v251, v251, v109
    v_accvgpr_write_b32 a221, v251
    v_accvgpr_read_b32 v251, a222
    v_ldexp_f32 v251, v251, v109
    v_accvgpr_write_b32 a222, v251
    v_accvgpr_read_b32 v251, a223
    v_ldexp_f32 v251, v251, v109
    v_accvgpr_write_b32 a223, v251
    v_accvgpr_read_b32 v251, a228
    v_ldexp_f32 v251, v251, v109
    v_accvgpr_write_b32 a228, v251
    v_accvgpr_read_b32 v251, a229
    v_ldexp_f32 v251, v251, v109
    v_accvgpr_write_b32 a229, v251
    v_accvgpr_read_b32 v251, a230
    v_ldexp_f32 v251, v251, v109
    v_accvgpr_write_b32 a230, v251
    v_accvgpr_read_b32 v251, a231
    v_ldexp_f32 v251, v251, v109
    v_accvgpr_write_b32 a231, v251
    v_accvgpr_read_b32 v251, a236
    v_ldexp_f32 v251, v251, v109
    v_accvgpr_write_b32 a236, v251
    v_accvgpr_read_b32 v251, a237
    v_ldexp_f32 v251, v251, v109
    v_accvgpr_write_b32 a237, v251
    v_accvgpr_read_b32 v251, a238
    v_ldexp_f32 v251, v251, v109
    v_accvgpr_write_b32 a238, v251
    v_accvgpr_read_b32 v251, a239
    v_ldexp_f32 v251, v251, v109
    v_accvgpr_write_b32 a239, v251
    v_accvgpr_read_b32 v251, a244
    v_ldexp_f32 v251, v251, v109
    v_accvgpr_write_b32 a244, v251
    v_accvgpr_read_b32 v251, a245
    v_ldexp_f32 v251, v251, v109
    v_accvgpr_write_b32 a245, v251
    v_accvgpr_read_b32 v251, a246
    v_ldexp_f32 v251, v251, v109
    v_accvgpr_write_b32 a246, v251
    v_accvgpr_read_b32 v251, a247
    v_ldexp_f32 v251, v251, v109
    v_accvgpr_write_b32 a247, v251
    v_accvgpr_read_b32 v251, a252
    v_ldexp_f32 v251, v251, v109
    v_accvgpr_write_b32 a252, v251
    v_accvgpr_read_b32 v251, a253
    v_ldexp_f32 v251, v251, v109
    v_accvgpr_write_b32 a253, v251
    v_accvgpr_read_b32 v251, a254
    v_ldexp_f32 v251, v251, v109
    v_accvgpr_write_b32 a254, v251
    v_accvgpr_read_b32 v251, a255
    v_ldexp_f32 v251, v251, v109
    v_accvgpr_write_b32 a255, v251
    v_exp_f32 v32, v32
    v_exp_f32 v33, v33
    v_exp_f32 v34, v34
    v_exp_f32 v35, v35
    v_exp_f32 v36, v36
    v_exp_f32 v37, v37
    v_exp_f32 v38, v38
    v_exp_f32 v39, v39
    v_add_f32 v108, v32, v33
    v_add_f32 v108, v108, v34
    v_add_f32 v108, v108, v35
    v_add_f32 v108, v108, v36
    v_add_f32 v108, v108, v37
    v_add_f32 v108, v108, v38
    v_add_f32 v108, v108, v39
    v_cvt_pk_bf16_f32 v4, v32, v33
    v_cvt_pk_bf16_f32 v5, v34, v35
    v_cvt_pk_bf16_f32 v6, v36, v37
    v_cvt_pk_bf16_f32 v7, v38, v39
    v_exp_f32 v40, v40
    v_exp_f32 v41, v41
    v_exp_f32 v42, v42
    v_exp_f32 v43, v43
    v_exp_f32 v44, v44
    v_exp_f32 v45, v45
    v_exp_f32 v46, v46
    v_exp_f32 v47, v47
    v_add_f32 v109, v40, v41
    v_add_f32 v109, v109, v42
    v_add_f32 v109, v109, v43
    v_add_f32 v109, v109, v44
    v_add_f32 v109, v109, v45
    v_add_f32 v109, v109, v46
    v_add_f32 v109, v109, v47
    v_cvt_pk_bf16_f32 v12, v40, v41
    v_cvt_pk_bf16_f32 v13, v42, v43
    v_cvt_pk_bf16_f32 v14, v44, v45
    v_cvt_pk_bf16_f32 v15, v46, v47
    s_nop 7
    s_setpc_b64 s[78:79]
L_sub_21:
    s_nop 15
    v_max3_f32 v110, v48, v49, v50
    v_max3_f32 v110, v110, v51, v52
    v_max3_f32 v110, v110, v53, v54
    v_max_f32 v110, v110, v55
    v_mov_b32 v251, v110
    s_nop 1
    v_permlane32_swap_b32 v110, v251
    v_max_f32 v110, v110, v251
    v_mov_b32 v251, v110
    s_nop 1
    v_permlane16_swap_b32 v110, v251
    v_max_f32 v110, v110, v251
    v_add_f32 v110, 0x42200000, v110
    v_max_f32 v110, 0, v110
    v_ceil_f32 v110, v110
    v_max3_f32 v111, v56, v57, v58
    v_max3_f32 v111, v111, v59, v60
    v_max3_f32 v111, v111, v61, v62
    v_max_f32 v111, v111, v63
    v_mov_b32 v251, v111
    s_nop 1
    v_permlane32_swap_b32 v111, v251
    v_max_f32 v111, v111, v251
    v_mov_b32 v251, v111
    s_nop 1
    v_permlane16_swap_b32 v111, v251
    v_max_f32 v111, v111, v251
    v_add_f32 v111, 0x42200000, v111
    v_max_f32 v111, 0, v111
    v_ceil_f32 v111, v111
    v_sub_f32 v72, v72, v110
    v_mul_f32 v251, s81, v110
    v_sub_f32 v48, v48, v110
    v_sub_f32 v49, v49, v110
    v_sub_f32 v50, v50, v110
    v_sub_f32 v51, v51, v110
    v_sub_f32 v52, v52, v110
    v_sub_f32 v53, v53, v110
    v_sub_f32 v54, v54, v110
    v_sub_f32 v55, v55, v110
    v_sub_f32 v110, 0, v110
    v_cvt_i32_f32 v110, v110
    v_ldexp_f32 v106, v106, v110
    v_ldexp_f32 v112, v112, v110
    v_ldexp_f32 v113, v113, v110
    v_ldexp_f32 v114, v114, v110
    v_ldexp_f32 v115, v115, v110
    v_ldexp_f32 v120, v120, v110
    v_ldexp_f32 v121, v121, v110
    v_ldexp_f32 v122, v122, v110
    v_ldexp_f32 v123, v123, v110
    v_ldexp_f32 v128, v128, v110
    v_ldexp_f32 v129, v129, v110
    v_ldexp_f32 v130, v130, v110
    v_ldexp_f32 v131, v131, v110
    v_ldexp_f32 v136, v136, v110
    v_ldexp_f32 v137, v137, v110
    v_ldexp_f32 v138, v138, v110
    v_ldexp_f32 v139, v139, v110
    v_ldexp_f32 v144, v144, v110
    v_ldexp_f32 v145, v145, v110
    v_ldexp_f32 v146, v146, v110
    v_ldexp_f32 v147, v147, v110
    v_ldexp_f32 v152, v152, v110
    v_ldexp_f32 v153, v153, v110
    v_ldexp_f32 v154, v154, v110
    v_ldexp_f32 v155, v155, v110
    v_ldexp_f32 v160, v160, v110
    v_ldexp_f32 v161, v161, v110
    v_ldexp_f32 v162, v162, v110
    v_ldexp_f32 v163, v163, v110
    v_ldexp_f32 v168, v168, v110
    v_ldexp_f32 v169, v169, v110
    v_ldexp_f32 v170, v170, v110
    v_ldexp_f32 v171, v171, v110
    v_ldexp_f32 v176, v176, v110
    v_ldexp_f32 v177, v177, v110
    v_ldexp_f32 v178, v178, v110
    v_ldexp_f32 v179, v179, v110
    v_ldexp_f32 v184, v184, v110
    v_ldexp_f32 v185, v185, v110
    v_ldexp_f32 v186, v186, v110
    v_ldexp_f32 v187, v187, v110
    v_ldexp_f32 v192, v192, v110
    v_ldexp_f32 v193, v193, v110
    v_ldexp_f32 v194, v194, v110
    v_ldexp_f32 v195, v195, v110
    v_ldexp_f32 v200, v200, v110
    v_ldexp_f32 v201, v201, v110
    v_ldexp_f32 v202, v202, v110
    v_ldexp_f32 v203, v203, v110
    v_ldexp_f32 v208, v208, v110
    v_ldexp_f32 v209, v209, v110
    v_ldexp_f32 v210, v210, v110
    v_ldexp_f32 v211, v211, v110
    v_ldexp_f32 v216, v216, v110
    v_ldexp_f32 v217, v217, v110
    v_ldexp_f32 v218, v218, v110
    v_ldexp_f32 v219, v219, v110
    v_ldexp_f32 v224, v224, v110
    v_ldexp_f32 v225, v225, v110
    v_ldexp_f32 v226, v226, v110
    v_ldexp_f32 v227, v227, v110
    v_ldexp_f32 v232, v232, v110
    v_ldexp_f32 v233, v233, v110
    v_ldexp_f32 v234, v234, v110
    v_ldexp_f32 v235, v235, v110
    v_sub_f32 v76, v76, v111
    v_mul_f32 v251, s81, v111
    v_sub_f32 v56, v56, v111
    v_sub_f32 v57, v57, v111
    v_sub_f32 v58, v58, v111
    v_sub_f32 v59, v59, v111
    v_sub_f32 v60, v60, v111
    v_sub_f32 v61, v61, v111
    v_sub_f32 v62, v62, v111
    v_sub_f32 v63, v63, v111
    v_sub_f32 v111, 0, v111
    v_cvt_i32_f32 v111, v111
    v_ldexp_f32 v107, v107, v111
    v_ldexp_f32 v116, v116, v111
    v_ldexp_f32 v117, v117, v111
    v_ldexp_f32 v118, v118, v111
    v_ldexp_f32 v119, v119, v111
    v_ldexp_f32 v124, v124, v111
    v_ldexp_f32 v125, v125, v111
    v_ldexp_f32 v126, v126, v111
    v_ldexp_f32 v127, v127, v111
    v_ldexp_f32 v132, v132, v111
    v_ldexp_f32 v133, v133, v111
    v_ldexp_f32 v134, v134, v111
    v_ldexp_f32 v135, v135, v111
    v_ldexp_f32 v140, v140, v111
    v_ldexp_f32 v141, v141, v111
    v_ldexp_f32 v142, v142, v111
    v_ldexp_f32 v143, v143, v111
    v_ldexp_f32 v148, v148, v111
    v_ldexp_f32 v149, v149, v111
    v_ldexp_f32 v150, v150, v111
    v_ldexp_f32 v151, v151, v111
    v_ldexp_f32 v156, v156, v111
    v_ldexp_f32 v157, v157, v111
    v_ldexp_f32 v158, v158, v111
    v_ldexp_f32 v159, v159, v111
    v_ldexp_f32 v164, v164, v111
    v_ldexp_f32 v165, v165, v111
    v_ldexp_f32 v166, v166, v111
    v_ldexp_f32 v167, v167, v111
    v_ldexp_f32 v172, v172, v111
    v_ldexp_f32 v173, v173, v111
    v_ldexp_f32 v174, v174, v111
    v_ldexp_f32 v175, v175, v111
    v_ldexp_f32 v180, v180, v111
    v_ldexp_f32 v181, v181, v111
    v_ldexp_f32 v182, v182, v111
    v_ldexp_f32 v183, v183, v111
    v_ldexp_f32 v188, v188, v111
    v_ldexp_f32 v189, v189, v111
    v_ldexp_f32 v190, v190, v111
    v_ldexp_f32 v191, v191, v111
    v_ldexp_f32 v196, v196, v111
    v_ldexp_f32 v197, v197, v111
    v_ldexp_f32 v198, v198, v111
    v_ldexp_f32 v199, v199, v111
    v_ldexp_f32 v204, v204, v111
    v_ldexp_f32 v205, v205, v111
    v_ldexp_f32 v206, v206, v111
    v_ldexp_f32 v207, v207, v111
    v_ldexp_f32 v212, v212, v111
    v_ldexp_f32 v213, v213, v111
    v_ldexp_f32 v214, v214, v111
    v_ldexp_f32 v215, v215, v111
    v_ldexp_f32 v220, v220, v111
    v_ldexp_f32 v221, v221, v111
    v_ldexp_f32 v222, v222, v111
    v_ldexp_f32 v223, v223, v111
    v_ldexp_f32 v228, v228, v111
    v_ldexp_f32 v229, v229, v111
    v_ldexp_f32 v230, v230, v111
    v_ldexp_f32 v231, v231, v111
    v_ldexp_f32 v236, v236, v111
    v_ldexp_f32 v237, v237, v111
    v_ldexp_f32 v238, v238, v111
    v_ldexp_f32 v239, v239, v111
    v_exp_f32 v48, v48
    v_exp_f32 v49, v49
    v_exp_f32 v50, v50
    v_exp_f32 v51, v51
    v_exp_f32 v52, v52
    v_exp_f32 v53, v53
    v_exp_f32 v54, v54
    v_exp_f32 v55, v55
    v_add_f32 v110, v48, v49
    v_add_f32 v110, v110, v50
    v_add_f32 v110, v110, v51
    v_add_f32 v110, v110, v52
    v_add_f32 v110, v110, v53
    v_add_f32 v110, v110, v54
    v_add_f32 v110, v110, v55
    v_cvt_pk_bf16_f32 v20, v48, v49
    v_cvt_pk_bf16_f32 v21, v50, v51
    v_cvt_pk_bf16_f32 v22, v52, v53
    v_cvt_pk_bf16_f32 v23, v54, v55
    v_exp_f32 v56, v56
    v_exp_f32 v57, v57
    v_exp_f32 v58, v58
    v_exp_f32 v59, v59
    v_exp_f32 v60, v60
    v_exp_f32 v61, v61
    v_exp_f32 v62, v62
    v_exp_f32 v63, v63
    v_add_f32 v111, v56, v57
    v_add_f32 v111, v111, v58
    v_add_f32 v111, v111, v59
    v_add_f32 v111, v111, v60
    v_add_f32 v111, v111, v61
    v_add_f32 v111, v111, v62
    v_add_f32 v111, v111, v63
    v_cvt_pk_bf16_f32 v28, v56, v57
    v_cvt_pk_bf16_f32 v29, v58, v59
    v_cvt_pk_bf16_f32 v30, v60, v61
    v_cvt_pk_bf16_f32 v31, v62, v63
    s_nop 7
    s_setpc_b64 s[78:79]
L_rare:
    s_nop 15
    ds_read_b128 v[120:123], v244 offset:0
    s_waitcnt lgkmcnt(0)
    ds_read_b128 v[124:127], v244 offset:1024
    s_waitcnt lgkmcnt(0)
    ds_read_b128 v[136:139], v244 offset:4096
    s_waitcnt lgkmcnt(0)
    ds_read_b128 v[140:143], v244 offset:5120
    s_waitcnt lgkmcnt(0)
    ds_read_b128 v[152:155], v244 offset:8192
    s_waitcnt lgkmcnt(0)
    ds_read_b128 v[156:159], v244 offset:9216
    s_waitcnt lgkmcnt(0)
    ds_read_b128 v[168:171], v244 offset:12288
    s_waitcnt lgkmcnt(0)
    ds_read_b128 v[172:175], v244 offset:13312
    s_waitcnt lgkmcnt(0)
    ds_read_b128 v[184:187], v244 offset:16384
    s_waitcnt lgkmcnt(0)
    ds_read_b128 v[188:191], v244 offset:17408
    s_waitcnt lgkmcnt(0)
    ds_read_b128 v[200:203], v244 offset:20480
    s_waitcnt lgkmcnt(0)
    ds_read_b128 v[204:207], v244 offset:21504
    s_waitcnt lgkmcnt(0)
    ds_read_b128 v[216:219], v244 offset:24576
    s_waitcnt lgkmcnt(0)
    ds_read_b128 v[220:223], v244 offset:25600
    s_waitcnt lgkmcnt(0)
    ds_read_b128 v[232:235], v244 offset:28672
    s_waitcnt lgkmcnt(0)
    ds_read_b128 v[236:239], v244 offset:29696
    s_waitcnt lgkmcnt(0)
    v_min_f32 v0, v64, v72
    v_sub_f32 v2, v0, v64
    v_sub_f32 v3, v0, v72
    v_cvt_i32_f32 v2, v2
    v_cvt_i32_f32 v3, v3
    v_ldexp_f32 v104, v104, v2
    v_ldexp_f32 v73, v73, v3
    v_accvgpr_read_b32 v251, a128
    v_ldexp_f32 v251, v251, v2
    v_accvgpr_write_b32 a128, v251
    v_accvgpr_read_b32 v251, a129
    v_ldexp_f32 v251, v251, v2
    v_accvgpr_write_b32 a129, v251
    v_accvgpr_read_b32 v251, a130
    v_ldexp_f32 v251, v251, v2
    v_accvgpr_write_b32 a130, v251
    v_accvgpr_read_b32 v251, a131
    v_ldexp_f32 v251, v251, v2
    v_accvgpr_write_b32 a131, v251
    v_accvgpr_read_b32 v251, a136
    v_ldexp_f32 v251, v251, v2
    v_accvgpr_write_b32 a136, v251
    v_accvgpr_read_b32 v251, a137
    v_ldexp_f32 v251, v251, v2
    v_accvgpr_write_b32 a137, v251
    v_accvgpr_read_b32 v251, a138
    v_ldexp_f32 v251, v251, v2
    v_accvgpr_write_b32 a138, v251
    v_accvgpr_read_b32 v251, a139
    v_ldexp_f32 v251, v251, v2
    v_accvgpr_write_b32 a139, v251
    v_accvgpr_read_b32 v251, a144
    v_ldexp_f32 v251, v251, v2
    v_accvgpr_write_b32 a144, v251
    v_accvgpr_read_b32 v251, a145
    v_ldexp_f32 v251, v251, v2
    v_accvgpr_write_b32 a145, v251
    v_accvgpr_read_b32 v251, a146
    v_ldexp_f32 v251, v251, v2
    v_accvgpr_write_b32 a146, v251
    v_accvgpr_read_b32 v251, a147
    v_ldexp_f32 v251, v251, v2
    v_accvgpr_write_b32 a147, v251
    v_accvgpr_read_b32 v251, a152
    v_ldexp_f32 v251, v251, v2
    v_accvgpr_write_b32 a152, v251
    v_accvgpr_read_b32 v251, a153
    v_ldexp_f32 v251, v251, v2
    v_accvgpr_write_b32 a153, v251
    v_accvgpr_read_b32 v251, a154
    v_ldexp_f32 v251, v251, v2
    v_accvgpr_write_b32 a154, v251
    v_accvgpr_read_b32 v251, a155
    v_ldexp_f32 v251, v251, v2
    v_accvgpr_write_b32 a155, v251
    v_accvgpr_read_b32 v251, a160
    v_ldexp_f32 v251, v251, v2
    v_accvgpr_write_b32 a160, v251
    v_accvgpr_read_b32 v251, a161
    v_ldexp_f32 v251, v251, v2
    v_accvgpr_write_b32 a161, v251
    v_accvgpr_read_b32 v251, a162
    v_ldexp_f32 v251, v251, v2
    v_accvgpr_write_b32 a162, v251
    v_accvgpr_read_b32 v251, a163
    v_ldexp_f32 v251, v251, v2
    v_accvgpr_write_b32 a163, v251
    v_accvgpr_read_b32 v251, a168
    v_ldexp_f32 v251, v251, v2
    v_accvgpr_write_b32 a168, v251
    v_accvgpr_read_b32 v251, a169
    v_ldexp_f32 v251, v251, v2
    v_accvgpr_write_b32 a169, v251
    v_accvgpr_read_b32 v251, a170
    v_ldexp_f32 v251, v251, v2
    v_accvgpr_write_b32 a170, v251
    v_accvgpr_read_b32 v251, a171
    v_ldexp_f32 v251, v251, v2
    v_accvgpr_write_b32 a171, v251
    v_accvgpr_read_b32 v251, a176
    v_ldexp_f32 v251, v251, v2
    v_accvgpr_write_b32 a176, v251
    v_accvgpr_read_b32 v251, a177
    v_ldexp_f32 v251, v251, v2
    v_accvgpr_write_b32 a177, v251
    v_accvgpr_read_b32 v251, a178
    v_ldexp_f32 v251, v251, v2
    v_accvgpr_write_b32 a178, v251
    v_accvgpr_read_b32 v251, a179
    v_ldexp_f32 v251, v251, v2
    v_accvgpr_write_b32 a179, v251
    v_accvgpr_read_b32 v251, a184
    v_ldexp_f32 v251, v251, v2
    v_accvgpr_write_b32 a184, v251
    v_accvgpr_read_b32 v251, a185
    v_ldexp_f32 v251, v251, v2
    v_accvgpr_write_b32 a185, v251
    v_accvgpr_read_b32 v251, a186
    v_ldexp_f32 v251, v251, v2
    v_accvgpr_write_b32 a186, v251
    v_accvgpr_read_b32 v251, a187
    v_ldexp_f32 v251, v251, v2
    v_accvgpr_write_b32 a187, v251
    v_accvgpr_read_b32 v251, a192
    v_ldexp_f32 v251, v251, v2
    v_accvgpr_write_b32 a192, v251
    v_accvgpr_read_b32 v251, a193
    v_ldexp_f32 v251, v251, v2
    v_accvgpr_write_b32 a193, v251
    v_accvgpr_read_b32 v251, a194
    v_ldexp_f32 v251, v251, v2
    v_accvgpr_write_b32 a194, v251
    v_accvgpr_read_b32 v251, a195
    v_ldexp_f32 v251, v251, v2
    v_accvgpr_write_b32 a195, v251
    v_accvgpr_read_b32 v251, a200
    v_ldexp_f32 v251, v251, v2
    v_accvgpr_write_b32 a200, v251
    v_accvgpr_read_b32 v251, a201
    v_ldexp_f32 v251, v251, v2
    v_accvgpr_write_b32 a201, v251
    v_accvgpr_read_b32 v251, a202
    v_ldexp_f32 v251, v251, v2
    v_accvgpr_write_b32 a202, v251
    v_accvgpr_read_b32 v251, a203
    v_ldexp_f32 v251, v251, v2
    v_accvgpr_write_b32 a203, v251
    v_accvgpr_read_b32 v251, a208
    v_ldexp_f32 v251, v251, v2
    v_accvgpr_write_b32 a208, v251
    v_accvgpr_read_b32 v251, a209
    v_ldexp_f32 v251, v251, v2
    v_accvgpr_write_b32 a209, v251
    v_accvgpr_read_b32 v251, a210
    v_ldexp_f32 v251, v251, v2
    v_accvgpr_write_b32 a210, v251
    v_accvgpr_read_b32 v251, a211
    v_ldexp_f32 v251, v251, v2
    v_accvgpr_write_b32 a211, v251
    v_accvgpr_read_b32 v251, a216
    v_ldexp_f32 v251, v251, v2
    v_accvgpr_write_b32 a216, v251
    v_accvgpr_read_b32 v251, a217
    v_ldexp_f32 v251, v251, v2
    v_accvgpr_write_b32 a217, v251
    v_accvgpr_read_b32 v251, a218
    v_ldexp_f32 v251, v251, v2
    v_accvgpr_write_b32 a218, v251
    v_accvgpr_read_b32 v251, a219
    v_ldexp_f32 v251, v251, v2
    v_accvgpr_write_b32 a219, v251
    v_accvgpr_read_b32 v251, a224
    v_ldexp_f32 v251, v251, v2
    v_accvgpr_write_b32 a224, v251
    v_accvgpr_read_b32 v251, a225
    v_ldexp_f32 v251, v251, v2
    v_accvgpr_write_b32 a225, v251
    v_accvgpr_read_b32 v251, a226
    v_ldexp_f32 v251, v251, v2
    v_accvgpr_write_b32 a226, v251
    v_accvgpr_read_b32 v251, a227
    v_ldexp_f32 v251, v251, v2
    v_accvgpr_write_b32 a227, v251
    v_accvgpr_read_b32 v251, a232
    v_ldexp_f32 v251, v251, v2
    v_accvgpr_write_b32 a232, v251
    v_accvgpr_read_b32 v251, a233
    v_ldexp_f32 v251, v251, v2
    v_accvgpr_write_b32 a233, v251
    v_accvgpr_read_b32 v251, a234
    v_ldexp_f32 v251, v251, v2
    v_accvgpr_write_b32 a234, v251
    v_accvgpr_read_b32 v251, a235
    v_ldexp_f32 v251, v251, v2
    v_accvgpr_write_b32 a235, v251
    v_accvgpr_read_b32 v251, a240
    v_ldexp_f32 v251, v251, v2
    v_accvgpr_write_b32 a240, v251
    v_accvgpr_read_b32 v251, a241
    v_ldexp_f32 v251, v251, v2
    v_accvgpr_write_b32 a241, v251
    v_accvgpr_read_b32 v251, a242
    v_ldexp_f32 v251, v251, v2
    v_accvgpr_write_b32 a242, v251
    v_accvgpr_read_b32 v251, a243
    v_ldexp_f32 v251, v251, v2
    v_accvgpr_write_b32 a243, v251
    v_accvgpr_read_b32 v251, a248
    v_ldexp_f32 v251, v251, v2
    v_accvgpr_write_b32 a248, v251
    v_accvgpr_read_b32 v251, a249
    v_ldexp_f32 v251, v251, v2
    v_accvgpr_write_b32 a249, v251
    v_accvgpr_read_b32 v251, a250
    v_ldexp_f32 v251, v251, v2
    v_accvgpr_write_b32 a250, v251
    v_accvgpr_read_b32 v251, a251
    v_ldexp_f32 v251, v251, v2
    v_accvgpr_write_b32 a251, v251
    v_lshlrev_b32 v0, 16, v120
    v_and_b32 v1, 0xffff0000, v120
    v_ldexp_f32 v0, v0, v3
    v_ldexp_f32 v1, v1, v3
    v_cvt_pk_bf16_f32 v120, v0, v1
    v_lshlrev_b32 v0, 16, v121
    v_and_b32 v1, 0xffff0000, v121
    v_ldexp_f32 v0, v0, v3
    v_ldexp_f32 v1, v1, v3
    v_cvt_pk_bf16_f32 v121, v0, v1
    v_lshlrev_b32 v0, 16, v122
    v_and_b32 v1, 0xffff0000, v122
    v_ldexp_f32 v0, v0, v3
    v_ldexp_f32 v1, v1, v3
    v_cvt_pk_bf16_f32 v122, v0, v1
    v_lshlrev_b32 v0, 16, v123
    v_and_b32 v1, 0xffff0000, v123
    v_ldexp_f32 v0, v0, v3
    v_ldexp_f32 v1, v1, v3
    v_cvt_pk_bf16_f32 v123, v0, v1
    ds_write_b128 v244, v[120:123] offset:0
    v_lshlrev_b32 v0, 16, v136
    v_and_b32 v1, 0xffff0000, v136
    v_ldexp_f32 v0, v0, v3
    v_ldexp_f32 v1, v1, v3
    v_cvt_pk_bf16_f32 v136, v0, v1
    v_lshlrev_b32 v0, 16, v137
    v_and_b32 v1, 0xffff0000, v137
    v_ldexp_f32 v0, v0, v3
    v_ldexp_f32 v1, v1, v3
    v_cvt_pk_bf16_f32 v137, v0, v1
    v_lshlrev_b32 v0, 16, v138
    v_and_b32 v1, 0xffff0000, v138
    v_ldexp_f32 v0, v0, v3
    v_ldexp_f32 v1, v1, v3
    v_cvt_pk_bf16_f32 v138, v0, v1
    v_lshlrev_b32 v0, 16, v139
    v_and_b32 v1, 0xffff0000, v139
    v_ldexp_f32 v0, v0, v3
    v_ldexp_f32 v1, v1, v3
    v_cvt_pk_bf16_f32 v139, v0, v1
    ds_write_b128 v244, v[136:139] offset:4096
    v_lshlrev_b32 v0, 16, v152
    v_and_b32 v1, 0xffff0000, v152
    v_ldexp_f32 v0, v0, v3
    v_ldexp_f32 v1, v1, v3
    v_cvt_pk_bf16_f32 v152, v0, v1
    v_lshlrev_b32 v0, 16, v153
    v_and_b32 v1, 0xffff0000, v153
    v_ldexp_f32 v0, v0, v3
    v_ldexp_f32 v1, v1, v3
    v_cvt_pk_bf16_f32 v153, v0, v1
    v_lshlrev_b32 v0, 16, v154
    v_and_b32 v1, 0xffff0000, v154
    v_ldexp_f32 v0, v0, v3
    v_ldexp_f32 v1, v1, v3
    v_cvt_pk_bf16_f32 v154, v0, v1
    v_lshlrev_b32 v0, 16, v155
    v_and_b32 v1, 0xffff0000, v155
    v_ldexp_f32 v0, v0, v3
    v_ldexp_f32 v1, v1, v3
    v_cvt_pk_bf16_f32 v155, v0, v1
    ds_write_b128 v244, v[152:155] offset:8192
    v_lshlrev_b32 v0, 16, v168
    v_and_b32 v1, 0xffff0000, v168
    v_ldexp_f32 v0, v0, v3
    v_ldexp_f32 v1, v1, v3
    v_cvt_pk_bf16_f32 v168, v0, v1
    v_lshlrev_b32 v0, 16, v169
    v_and_b32 v1, 0xffff0000, v169
    v_ldexp_f32 v0, v0, v3
    v_ldexp_f32 v1, v1, v3
    v_cvt_pk_bf16_f32 v169, v0, v1
    v_lshlrev_b32 v0, 16, v170
    v_and_b32 v1, 0xffff0000, v170
    v_ldexp_f32 v0, v0, v3
    v_ldexp_f32 v1, v1, v3
    v_cvt_pk_bf16_f32 v170, v0, v1
    v_lshlrev_b32 v0, 16, v171
    v_and_b32 v1, 0xffff0000, v171
    v_ldexp_f32 v0, v0, v3
    v_ldexp_f32 v1, v1, v3
    v_cvt_pk_bf16_f32 v171, v0, v1
    ds_write_b128 v244, v[168:171] offset:12288
    v_lshlrev_b32 v0, 16, v184
    v_and_b32 v1, 0xffff0000, v184
    v_ldexp_f32 v0, v0, v3
    v_ldexp_f32 v1, v1, v3
    v_cvt_pk_bf16_f32 v184, v0, v1
    v_lshlrev_b32 v0, 16, v185
    v_and_b32 v1, 0xffff0000, v185
    v_ldexp_f32 v0, v0, v3
    v_ldexp_f32 v1, v1, v3
    v_cvt_pk_bf16_f32 v185, v0, v1
    v_lshlrev_b32 v0, 16, v186
    v_and_b32 v1, 0xffff0000, v186
    v_ldexp_f32 v0, v0, v3
    v_ldexp_f32 v1, v1, v3
    v_cvt_pk_bf16_f32 v186, v0, v1
    v_lshlrev_b32 v0, 16, v187
    v_and_b32 v1, 0xffff0000, v187
    v_ldexp_f32 v0, v0, v3
    v_ldexp_f32 v1, v1, v3
    v_cvt_pk_bf16_f32 v187, v0, v1
    ds_write_b128 v244, v[184:187] offset:16384
    v_lshlrev_b32 v0, 16, v200
    v_and_b32 v1, 0xffff0000, v200
    v_ldexp_f32 v0, v0, v3
    v_ldexp_f32 v1, v1, v3
    v_cvt_pk_bf16_f32 v200, v0, v1
    v_lshlrev_b32 v0, 16, v201
    v_and_b32 v1, 0xffff0000, v201
    v_ldexp_f32 v0, v0, v3
    v_ldexp_f32 v1, v1, v3
    v_cvt_pk_bf16_f32 v201, v0, v1
    v_lshlrev_b32 v0, 16, v202
    v_and_b32 v1, 0xffff0000, v202
    v_ldexp_f32 v0, v0, v3
    v_ldexp_f32 v1, v1, v3
    v_cvt_pk_bf16_f32 v202, v0, v1
    v_lshlrev_b32 v0, 16, v203
    v_and_b32 v1, 0xffff0000, v203
    v_ldexp_f32 v0, v0, v3
    v_ldexp_f32 v1, v1, v3
    v_cvt_pk_bf16_f32 v203, v0, v1
    ds_write_b128 v244, v[200:203] offset:20480
    v_lshlrev_b32 v0, 16, v216
    v_and_b32 v1, 0xffff0000, v216
    v_ldexp_f32 v0, v0, v3
    v_ldexp_f32 v1, v1, v3
    v_cvt_pk_bf16_f32 v216, v0, v1
    v_lshlrev_b32 v0, 16, v217
    v_and_b32 v1, 0xffff0000, v217
    v_ldexp_f32 v0, v0, v3
    v_ldexp_f32 v1, v1, v3
    v_cvt_pk_bf16_f32 v217, v0, v1
    v_lshlrev_b32 v0, 16, v218
    v_and_b32 v1, 0xffff0000, v218
    v_ldexp_f32 v0, v0, v3
    v_ldexp_f32 v1, v1, v3
    v_cvt_pk_bf16_f32 v218, v0, v1
    v_lshlrev_b32 v0, 16, v219
    v_and_b32 v1, 0xffff0000, v219
    v_ldexp_f32 v0, v0, v3
    v_ldexp_f32 v1, v1, v3
    v_cvt_pk_bf16_f32 v219, v0, v1
    ds_write_b128 v244, v[216:219] offset:24576
    v_lshlrev_b32 v0, 16, v232
    v_and_b32 v1, 0xffff0000, v232
    v_ldexp_f32 v0, v0, v3
    v_ldexp_f32 v1, v1, v3
    v_cvt_pk_bf16_f32 v232, v0, v1
    v_lshlrev_b32 v0, 16, v233
    v_and_b32 v1, 0xffff0000, v233
    v_ldexp_f32 v0, v0, v3
    v_ldexp_f32 v1, v1, v3
    v_cvt_pk_bf16_f32 v233, v0, v1
    v_lshlrev_b32 v0, 16, v234
    v_and_b32 v1, 0xffff0000, v234
    v_ldexp_f32 v0, v0, v3
    v_ldexp_f32 v1, v1, v3
    v_cvt_pk_bf16_f32 v234, v0, v1
    v_lshlrev_b32 v0, 16, v235
    v_and_b32 v1, 0xffff0000, v235
    v_ldexp_f32 v0, v0, v3
    v_ldexp_f32 v1, v1, v3
    v_cvt_pk_bf16_f32 v235, v0, v1
    ds_write_b128 v244, v[232:235] offset:28672
    v_min_f32 v0, v68, v74
    v_sub_f32 v2, v0, v68
    v_sub_f32 v3, v0, v74
    v_cvt_i32_f32 v2, v2
    v_cvt_i32_f32 v3, v3
    v_ldexp_f32 v105, v105, v2
    v_ldexp_f32 v75, v75, v3
    v_accvgpr_read_b32 v251, a132
    v_ldexp_f32 v251, v251, v2
    v_accvgpr_write_b32 a132, v251
    v_accvgpr_read_b32 v251, a133
    v_ldexp_f32 v251, v251, v2
    v_accvgpr_write_b32 a133, v251
    v_accvgpr_read_b32 v251, a134
    v_ldexp_f32 v251, v251, v2
    v_accvgpr_write_b32 a134, v251
    v_accvgpr_read_b32 v251, a135
    v_ldexp_f32 v251, v251, v2
    v_accvgpr_write_b32 a135, v251
    v_accvgpr_read_b32 v251, a140
    v_ldexp_f32 v251, v251, v2
    v_accvgpr_write_b32 a140, v251
    v_accvgpr_read_b32 v251, a141
    v_ldexp_f32 v251, v251, v2
    v_accvgpr_write_b32 a141, v251
    v_accvgpr_read_b32 v251, a142
    v_ldexp_f32 v251, v251, v2
    v_accvgpr_write_b32 a142, v251
    v_accvgpr_read_b32 v251, a143
    v_ldexp_f32 v251, v251, v2
    v_accvgpr_write_b32 a143, v251
    v_accvgpr_read_b32 v251, a148
    v_ldexp_f32 v251, v251, v2
    v_accvgpr_write_b32 a148, v251
    v_accvgpr_read_b32 v251, a149
    v_ldexp_f32 v251, v251, v2
    v_accvgpr_write_b32 a149, v251
    v_accvgpr_read_b32 v251, a150
    v_ldexp_f32 v251, v251, v2
    v_accvgpr_write_b32 a150, v251
    v_accvgpr_read_b32 v251, a151
    v_ldexp_f32 v251, v251, v2
    v_accvgpr_write_b32 a151, v251
    v_accvgpr_read_b32 v251, a156
    v_ldexp_f32 v251, v251, v2
    v_accvgpr_write_b32 a156, v251
    v_accvgpr_read_b32 v251, a157
    v_ldexp_f32 v251, v251, v2
    v_accvgpr_write_b32 a157, v251
    v_accvgpr_read_b32 v251, a158
    v_ldexp_f32 v251, v251, v2
    v_accvgpr_write_b32 a158, v251
    v_accvgpr_read_b32 v251, a159
    v_ldexp_f32 v251, v251, v2
    v_accvgpr_write_b32 a159, v251
    v_accvgpr_read_b32 v251, a164
    v_ldexp_f32 v251, v251, v2
    v_accvgpr_write_b32 a164, v251
    v_accvgpr_read_b32 v251, a165
    v_ldexp_f32 v251, v251, v2
    v_accvgpr_write_b32 a165, v251
    v_accvgpr_read_b32 v251, a166
    v_ldexp_f32 v251, v251, v2
    v_accvgpr_write_b32 a166, v251
    v_accvgpr_read_b32 v251, a167
    v_ldexp_f32 v251, v251, v2
    v_accvgpr_write_b32 a167, v251
    v_accvgpr_read_b32 v251, a172
    v_ldexp_f32 v251, v251, v2
    v_accvgpr_write_b32 a172, v251
    v_accvgpr_read_b32 v251, a173
    v_ldexp_f32 v251, v251, v2
    v_accvgpr_write_b32 a173, v251
    v_accvgpr_read_b32 v251, a174
    v_ldexp_f32 v251, v251, v2
    v_accvgpr_write_b32 a174, v251
    v_accvgpr_read_b32 v251, a175
    v_ldexp_f32 v251, v251, v2
    v_accvgpr_write_b32 a175, v251
    v_accvgpr_read_b32 v251, a180
    v_ldexp_f32 v251, v251, v2
    v_accvgpr_write_b32 a180, v251
    v_accvgpr_read_b32 v251, a181
    v_ldexp_f32 v251, v251, v2
    v_accvgpr_write_b32 a181, v251
    v_accvgpr_read_b32 v251, a182
    v_ldexp_f32 v251, v251, v2
    v_accvgpr_write_b32 a182, v251
    v_accvgpr_read_b32 v251, a183
    v_ldexp_f32 v251, v251, v2
    v_accvgpr_write_b32 a183, v251
    v_accvgpr_read_b32 v251, a188
    v_ldexp_f32 v251, v251, v2
    v_accvgpr_write_b32 a188, v251
    v_accvgpr_read_b32 v251, a189
    v_ldexp_f32 v251, v251, v2
    v_accvgpr_write_b32 a189, v251
    v_accvgpr_read_b32 v251, a190
    v_ldexp_f32 v251, v251, v2
    v_accvgpr_write_b32 a190, v251
    v_accvgpr_read_b32 v251, a191
    v_ldexp_f32 v251, v251, v2
    v_accvgpr_write_b32 a191, v251
    v_accvgpr_read_b32 v251, a196
    v_ldexp_f32 v251, v251, v2
    v_accvgpr_write_b32 a196, v251
    v_accvgpr_read_b32 v251, a197
    v_ldexp_f32 v251, v251, v2
    v_accvgpr_write_b32 a197, v251
    v_accvgpr_read_b32 v251, a198
    v_ldexp_f32 v251, v251, v2
    v_accvgpr_write_b32 a198, v251
    v_accvgpr_read_b32 v251, a199
    v_ldexp_f32 v251, v251, v2
    v_accvgpr_write_b32 a199, v251
    v_accvgpr_read_b32 v251, a204
    v_ldexp_f32 v251, v251, v2
    v_accvgpr_write_b32 a204, v251
    v_accvgpr_read_b32 v251, a205
    v_ldexp_f32 v251, v251, v2
    v_accvgpr_write_b32 a205, v251
    v_accvgpr_read_b32 v251, a206
    v_ldexp_f32 v251, v251, v2
    v_accvgpr_write_b32 a206, v251
    v_accvgpr_read_b32 v251, a207
    v_ldexp_f32 v251, v251, v2
    v_accvgpr_write_b32 a207, v251
    v_accvgpr_read_b32 v251, a212
    v_ldexp_f32 v251, v251, v2
    v_accvgpr_write_b32 a212, v251
    v_accvgpr_read_b32 v251, a213
    v_ldexp_f32 v251, v251, v2
    v_accvgpr_write_b32 a213, v251
    v_accvgpr_read_b32 v251, a214
    v_ldexp_f32 v251, v251, v2
    v_accvgpr_write_b32 a214, v251
    v_accvgpr_read_b32 v251, a215
    v_ldexp_f32 v251, v251, v2
    v_accvgpr_write_b32 a215, v251
    v_accvgpr_read_b32 v251, a220
    v_ldexp_f32 v251, v251, v2
    v_accvgpr_write_b32 a220, v251
    v_accvgpr_read_b32 v251, a221
    v_ldexp_f32 v251, v251, v2
    v_accvgpr_write_b32 a221, v251
    v_accvgpr_read_b32 v251, a222
    v_ldexp_f32 v251, v251, v2
    v_accvgpr_write_b32 a222, v251
    v_accvgpr_read_b32 v251, a223
    v_ldexp_f32 v251, v251, v2
    v_accvgpr_write_b32 a223, v251
    v_accvgpr_read_b32 v251, a228
    v_ldexp_f32 v251, v251, v2
    v_accvgpr_write_b32 a228, v251
    v_accvgpr_read_b32 v251, a229
    v_ldexp_f32 v251, v251, v2
    v_accvgpr_write_b32 a229, v251
    v_accvgpr_read_b32 v251, a230
    v_ldexp_f32 v251, v251, v2
    v_accvgpr_write_b32 a230, v251
    v_accvgpr_read_b32 v251, a231
    v_ldexp_f32 v251, v251, v2
    v_accvgpr_write_b32 a231, v251
    v_accvgpr_read_b32 v251, a236
    v_ldexp_f32 v251, v251, v2
    v_accvgpr_write_b32 a236, v251
    v_accvgpr_read_b32 v251, a237
    v_ldexp_f32 v251, v251, v2
    v_accvgpr_write_b32 a237, v251
    v_accvgpr_read_b32 v251, a238
    v_ldexp_f32 v251, v251, v2
    v_accvgpr_write_b32 a238, v251
    v_accvgpr_read_b32 v251, a239
    v_ldexp_f32 v251, v251, v2
    v_accvgpr_write_b32 a239, v251
    v_accvgpr_read_b32 v251, a244
    v_ldexp_f32 v251, v251, v2
    v_accvgpr_write_b32 a244, v251
    v_accvgpr_read_b32 v251, a245
    v_ldexp_f32 v251, v251, v2
    v_accvgpr_write_b32 a245, v251
    v_accvgpr_read_b32 v251, a246
    v_ldexp_f32 v251, v251, v2
    v_accvgpr_write_b32 a246, v251
    v_accvgpr_read_b32 v251, a247
    v_ldexp_f32 v251, v251, v2
    v_accvgpr_write_b32 a247, v251
    v_accvgpr_read_b32 v251, a252
    v_ldexp_f32 v251, v251, v2
    v_accvgpr_write_b32 a252, v251
    v_accvgpr_read_b32 v251, a253
    v_ldexp_f32 v251, v251, v2
    v_accvgpr_write_b32 a253, v251
    v_accvgpr_read_b32 v251, a254
    v_ldexp_f32 v251, v251, v2
    v_accvgpr_write_b32 a254, v251
    v_accvgpr_read_b32 v251, a255
    v_ldexp_f32 v251, v251, v2
    v_accvgpr_write_b32 a255, v251
    v_lshlrev_b32 v0, 16, v124
    v_and_b32 v1, 0xffff0000, v124
    v_ldexp_f32 v0, v0, v3
    v_ldexp_f32 v1, v1, v3
    v_cvt_pk_bf16_f32 v124, v0, v1
    v_lshlrev_b32 v0, 16, v125
    v_and_b32 v1, 0xffff0000, v125
    v_ldexp_f32 v0, v0, v3
    v_ldexp_f32 v1, v1, v3
    v_cvt_pk_bf16_f32 v125, v0, v1
    v_lshlrev_b32 v0, 16, v126
    v_and_b32 v1, 0xffff0000, v126
    v_ldexp_f32 v0, v0, v3
    v_ldexp_f32 v1, v1, v3
    v_cvt_pk_bf16_f32 v126, v0, v1
    v_lshlrev_b32 v0, 16, v127
    v_and_b32 v1, 0xffff0000, v127
    v_ldexp_f32 v0, v0, v3
    v_ldexp_f32 v1, v1, v3
    v_cvt_pk_bf16_f32 v127, v0, v1
    ds_write_b128 v244, v[124:127] offset:1024
    v_lshlrev_b32 v0, 16, v140
    v_and_b32 v1, 0xffff0000, v140
    v_ldexp_f32 v0, v0, v3
    v_ldexp_f32 v1, v1, v3
    v_cvt_pk_bf16_f32 v140, v0, v1
    v_lshlrev_b32 v0, 16, v141
    v_and_b32 v1, 0xffff0000, v141
    v_ldexp_f32 v0, v0, v3
    v_ldexp_f32 v1, v1, v3
    v_cvt_pk_bf16_f32 v141, v0, v1
    v_lshlrev_b32 v0, 16, v142
    v_and_b32 v1, 0xffff0000, v142
    v_ldexp_f32 v0, v0, v3
    v_ldexp_f32 v1, v1, v3
    v_cvt_pk_bf16_f32 v142, v0, v1
    v_lshlrev_b32 v0, 16, v143
    v_and_b32 v1, 0xffff0000, v143
    v_ldexp_f32 v0, v0, v3
    v_ldexp_f32 v1, v1, v3
    v_cvt_pk_bf16_f32 v143, v0, v1
    ds_write_b128 v244, v[140:143] offset:5120
    v_lshlrev_b32 v0, 16, v156
    v_and_b32 v1, 0xffff0000, v156
    v_ldexp_f32 v0, v0, v3
    v_ldexp_f32 v1, v1, v3
    v_cvt_pk_bf16_f32 v156, v0, v1
    v_lshlrev_b32 v0, 16, v157
    v_and_b32 v1, 0xffff0000, v157
    v_ldexp_f32 v0, v0, v3
    v_ldexp_f32 v1, v1, v3
    v_cvt_pk_bf16_f32 v157, v0, v1
    v_lshlrev_b32 v0, 16, v158
    v_and_b32 v1, 0xffff0000, v158
    v_ldexp_f32 v0, v0, v3
    v_ldexp_f32 v1, v1, v3
    v_cvt_pk_bf16_f32 v158, v0, v1
    v_lshlrev_b32 v0, 16, v159
    v_and_b32 v1, 0xffff0000, v159
    v_ldexp_f32 v0, v0, v3
    v_ldexp_f32 v1, v1, v3
    v_cvt_pk_bf16_f32 v159, v0, v1
    ds_write_b128 v244, v[156:159] offset:9216
    v_lshlrev_b32 v0, 16, v172
    v_and_b32 v1, 0xffff0000, v172
    v_ldexp_f32 v0, v0, v3
    v_ldexp_f32 v1, v1, v3
    v_cvt_pk_bf16_f32 v172, v0, v1
    v_lshlrev_b32 v0, 16, v173
    v_and_b32 v1, 0xffff0000, v173
    v_ldexp_f32 v0, v0, v3
    v_ldexp_f32 v1, v1, v3
    v_cvt_pk_bf16_f32 v173, v0, v1
    v_lshlrev_b32 v0, 16, v174
    v_and_b32 v1, 0xffff0000, v174
    v_ldexp_f32 v0, v0, v3
    v_ldexp_f32 v1, v1, v3
    v_cvt_pk_bf16_f32 v174, v0, v1
    v_lshlrev_b32 v0, 16, v175
    v_and_b32 v1, 0xffff0000, v175
    v_ldexp_f32 v0, v0, v3
    v_ldexp_f32 v1, v1, v3
    v_cvt_pk_bf16_f32 v175, v0, v1
    ds_write_b128 v244, v[172:175] offset:13312
    v_lshlrev_b32 v0, 16, v188
    v_and_b32 v1, 0xffff0000, v188
    v_ldexp_f32 v0, v0, v3
    v_ldexp_f32 v1, v1, v3
    v_cvt_pk_bf16_f32 v188, v0, v1
    v_lshlrev_b32 v0, 16, v189
    v_and_b32 v1, 0xffff0000, v189
    v_ldexp_f32 v0, v0, v3
    v_ldexp_f32 v1, v1, v3
    v_cvt_pk_bf16_f32 v189, v0, v1
    v_lshlrev_b32 v0, 16, v190
    v_and_b32 v1, 0xffff0000, v190
    v_ldexp_f32 v0, v0, v3
    v_ldexp_f32 v1, v1, v3
    v_cvt_pk_bf16_f32 v190, v0, v1
    v_lshlrev_b32 v0, 16, v191
    v_and_b32 v1, 0xffff0000, v191
    v_ldexp_f32 v0, v0, v3
    v_ldexp_f32 v1, v1, v3
    v_cvt_pk_bf16_f32 v191, v0, v1
    ds_write_b128 v244, v[188:191] offset:17408
    v_lshlrev_b32 v0, 16, v204
    v_and_b32 v1, 0xffff0000, v204
    v_ldexp_f32 v0, v0, v3
    v_ldexp_f32 v1, v1, v3
    v_cvt_pk_bf16_f32 v204, v0, v1
    v_lshlrev_b32 v0, 16, v205
    v_and_b32 v1, 0xffff0000, v205
    v_ldexp_f32 v0, v0, v3
    v_ldexp_f32 v1, v1, v3
    v_cvt_pk_bf16_f32 v205, v0, v1
    v_lshlrev_b32 v0, 16, v206
    v_and_b32 v1, 0xffff0000, v206
    v_ldexp_f32 v0, v0, v3
    v_ldexp_f32 v1, v1, v3
    v_cvt_pk_bf16_f32 v206, v0, v1
    v_lshlrev_b32 v0, 16, v207
    v_and_b32 v1, 0xffff0000, v207
    v_ldexp_f32 v0, v0, v3
    v_ldexp_f32 v1, v1, v3
    v_cvt_pk_bf16_f32 v207, v0, v1
    ds_write_b128 v244, v[204:207] offset:21504
    v_lshlrev_b32 v0, 16, v220
    v_and_b32 v1, 0xffff0000, v220
    v_ldexp_f32 v0, v0, v3
    v_ldexp_f32 v1, v1, v3
    v_cvt_pk_bf16_f32 v220, v0, v1
    v_lshlrev_b32 v0, 16, v221
    v_and_b32 v1, 0xffff0000, v221
    v_ldexp_f32 v0, v0, v3
    v_ldexp_f32 v1, v1, v3
    v_cvt_pk_bf16_f32 v221, v0, v1
    v_lshlrev_b32 v0, 16, v222
    v_and_b32 v1, 0xffff0000, v222
    v_ldexp_f32 v0, v0, v3
    v_ldexp_f32 v1, v1, v3
    v_cvt_pk_bf16_f32 v222, v0, v1
    v_lshlrev_b32 v0, 16, v223
    v_and_b32 v1, 0xffff0000, v223
    v_ldexp_f32 v0, v0, v3
    v_ldexp_f32 v1, v1, v3
    v_cvt_pk_bf16_f32 v223, v0, v1
    ds_write_b128 v244, v[220:223] offset:25600
    v_lshlrev_b32 v0, 16, v236
    v_and_b32 v1, 0xffff0000, v236
    v_ldexp_f32 v0, v0, v3
    v_ldexp_f32 v1, v1, v3
    v_cvt_pk_bf16_f32 v236, v0, v1
    v_lshlrev_b32 v0, 16, v237
    v_and_b32 v1, 0xffff0000, v237
    v_ldexp_f32 v0, v0, v3
    v_ldexp_f32 v1, v1, v3
    v_cvt_pk_bf16_f32 v237, v0, v1
    v_lshlrev_b32 v0, 16, v238
    v_and_b32 v1, 0xffff0000, v238
    v_ldexp_f32 v0, v0, v3
    v_ldexp_f32 v1, v1, v3
    v_cvt_pk_bf16_f32 v238, v0, v1
    v_lshlrev_b32 v0, 16, v239
    v_and_b32 v1, 0xffff0000, v239
    v_ldexp_f32 v0, v0, v3
    v_ldexp_f32 v1, v1, v3
    v_cvt_pk_bf16_f32 v239, v0, v1
    ds_write_b128 v244, v[236:239] offset:29696
    s_waitcnt lgkmcnt(0)
    s_nop 7
    s_branch L_rret
L_bwait:
    s_mov_b32 s87, 0
    s_lshl_b32 s86, s46, 3
L_bwait1:
    v_and_b32 v97, 4, v250
    buffer_load_dword v97, v97, s[4:7], s86 offen sc1
    s_add_u32 s87, s87, 1
    s_waitcnt vmcnt(0)
    v_cmp_ne_u32 vcc, -1, v97
    s_cmp_lt_u32 s87, 262144
    s_cbranch_scc0 L_bwait2
    s_cbranch_vccnz L_bwait1
L_bwait2:
    s_mov_b32 s87, 0
    s_branch L_bret
L_k1_exit:
    s_endpgm
.section .rodata,"a"
.p2align 6
.amdhsa_kernel recurrent_scan__gqa_block_cached__glu_gated_geglu__prompt_kernel
  .amdhsa_next_free_vgpr 512
  .amdhsa_next_free_sgpr 102
  .amdhsa_accum_offset 256
  .amdhsa_group_segment_fixed_size 0
  .amdhsa_kernarg_size 96
  .amdhsa_user_sgpr_count 2
  .amdhsa_user_sgpr_kernarg_segment_ptr 1
  .amdhsa_system_sgpr_workgroup_id_x 1
.end_amdhsa_kernel
```
